```python
import torch

def _softmax(x, axis=-1):
    return torch.softmax(x, dim=axis)

def _gelu(x):
    return torch.nn.functional.gelu(x, approximate='tanh')

def _silu(x):
    return torch.nn.functional.silu(x)

def _sigmoid(x):
    return torch.sigmoid(x)

def _layernorm(x, axis=-1, eps=1e-05):
    m = x.mean(dim=axis, keepdim=True)
    v = x.var(dim=axis, keepdim=True, unbiased=False)
    return (x - m) / torch.sqrt(v + eps)

def _scatter_add(tgt, idx, src, axis=0):
    return tgt.clone().index_add_(axis, idx, src)

def _segment_sum(src, seg, n):
    out = torch.zeros((n,) + src.shape[1:], dtype=src.dtype)
    return out.index_add_(0, seg, src)

def _pad(x, pw):
    flat = tuple((v for pair in reversed(pw) for v in pair))
    return torch.nn.functional.pad(x, flat)
kernel_name = 'parallel_sum__ssm_conv_h3__mixer_gmlp__prompt'

def setup_inputs():

    _w = lambda a: (lambda t: t.to(torch.bfloat16) if t.is_floating_point() else t)(torch.as_tensor(a))

    def _A_setup():
        B, S, D = (1, 2048, 576)
        ks = 4
        return {'q': _w((lambda *s: torch.randn(*s, dtype=torch.bfloat16) * 0.05)(B, S, D)), 'k': _w((lambda *s: torch.randn(*s, dtype=torch.bfloat16) * 1.6)(B, S, D)), 'v': _w((lambda *s: torch.randn(*s, dtype=torch.bfloat16) * 0.4)(B, S, D)), 'shift_k': _w((lambda *s: torch.randn(*s, dtype=torch.bfloat16) * 1.6)(D, ks) * 0.5), 'ssm_k': _w((lambda *s: torch.randn(*s, dtype=torch.bfloat16) * 3.2)(D, S) * (1.0 / S ** 0.5)), 'ssm_D': _w((lambda *s: torch.randn(*s, dtype=torch.bfloat16) * 0.8)(D))}
    _A_in = _A_setup()

    def _B_setup():
        B, S, D, F = (1, 2048, 576, 4608)
        Fh = F // 2
        return {'x': _w((lambda *s: torch.randn(*s, dtype=torch.bfloat16) * 0.05)(B, S, D)), 'w_in': _w((lambda *s: torch.randn(*s, dtype=torch.bfloat16) * 0.4)(D, 2 * Fh)), 'w_sp': _w(0.01 * (lambda *s: torch.randn(*s, dtype=torch.bfloat16) * 0.4)(S, S)), 'b_sp': _w(1.0 + 0.01 * (lambda *s: torch.randn(*s, dtype=torch.bfloat16) * 0.05)(S)), 'w_out': _w((lambda *s: torch.randn(*s, dtype=torch.bfloat16) * 0.05)(Fh, D))}
    _B_in = _B_setup()
    return {'A_q': _A_in['q'], 'A_k': _A_in['k'], 'A_v': _A_in['v'], 'A_shift_k': _A_in['shift_k'], 'A_ssm_k': _A_in['ssm_k'], 'A_ssm_D': _A_in['ssm_D'], 'B_x': _B_in['x'], 'B_w_in': _B_in['w_in'], 'B_w_sp': _B_in['w_sp'], 'B_b_sp': _B_in['b_sp'], 'B_w_out': _B_in['w_out']}

def reference(A_q, A_k, A_v, A_shift_k, A_ssm_k, A_ssm_D, B_x, B_w_in, B_w_sp, B_b_sp, B_w_out):

    def _A_ref(q, k, v, shift_k, ssm_k, ssm_D):
        B, S, D = q.shape
        ks = shift_k.shape[-1]
        k_pad = _pad(k, ((0, 0), (ks - 1, 0), (0, 0)))
        k_shift = torch.zeros_like(k)
        for t in range(ks):
            k_shift = k_shift + k_pad[:, t:t + S, :] * shift_k[:, ks - 1 - t][None, None, :]
        kv = k_shift * v
        L = 2 * S
        kv_pad = _pad(kv, ((0, 0), (0, S), (0, 0)))
        kf_pad = _pad(ssm_k, ((0, 0), (0, S)))
        kv_f = (lambda x, axes=(-2, -1): torch.fft.rfft2(x.float(), dim=axes))(kv_pad[:, None, :, :], axes=(1, 2))
        kf_f = (lambda x, axes=(-2, -1): torch.fft.rfft2(x.float(), dim=axes))(kf_pad[:, None, :], axes=(1, 2))
        kf_f = (lambda x, *d: x.permute(*d))(kf_f, 1, 2, 0)
        y_f = kv_f * kf_f[None, :, :, :]
        y = (lambda x, s, axes=(-2, -1): torch.fft.irfft2(x, s=s, dim=axes).to(torch.bfloat16))(y_f, (1, L), axes=(1, 2))[:, 0, :S, :]
        y = y + kv * ssm_D[None, None, :]
        return q * y

    def _B_ref(x, w_in, w_sp, b_sp, w_out):
        B, S, D = x.shape
        F = w_in.shape[-1]
        Fh = F // 2
        z = _gelu(torch.einsum('bsd,df->bsf', x, w_in))
        z1 = z[..., :Fh].clone()
        z2 = _layernorm(z[..., Fh:], axis=-1)
        g = torch.einsum('ts,bsf->btf', w_sp, z2) + b_sp[None, :, None]
        return torch.einsum('bsf,fd->bsd', z1 * g, w_out)
    x = A_q
    xn = _layernorm(x, axis=-1)
    return x + _A_ref(xn, A_k, A_v, A_shift_k, A_ssm_k, A_ssm_D) + _B_ref(xn, B_w_in, B_w_sp, B_b_sp, B_w_out)
```

```asm
; @launch grid=(256,1,1) block=(512,1,1) lds=163840
.amdgcn_target "amdgcn-amd-amdhsa--gfx950"
.text
.globl parallel_sum__ssm_conv_h3__mixer_gmlp__prompt_kernel
.p2align 8
.type parallel_sum__ssm_conv_h3__mixer_gmlp__prompt_kernel,@function
parallel_sum__ssm_conv_h3__mixer_gmlp__prompt_kernel:
s_load_dwordx8 s[52:59], s[0:1], 0
s_load_dwordx4 s[60:63], s[0:1], 56
s_load_dwordx4 s[64:67], s[0:1], 96
s_cmp_ge_u32 s2, 256
s_cbranch_scc1 L_end
v_lshrrev_b32 v1, 6, v0
v_and_b32 v255, 63, v0
v_readfirstlane_b32 s49, v1
s_and_b32 s16, s2, 7
s_lshr_b32 s17, s2, 3
s_cmp_lt_u32 s17, 8
s_cbranch_scc1 L_help
s_sub_u32 s17, s17, 8
s_lshr_b32 s18, s16, 1
s_lshl_b32 s18, s18, 2
s_and_b32 s98, s17, 3
s_add_u32 s18, s18, s98
s_and_b32 s19, s16, 1
s_mul_i32 s19, s19, 6
s_lshr_b32 s99, s17, 2
s_add_u32 s19, s19, s99
s_getpc_b64 s[4:5]
L_pc:
s_sub_u32 s4, s4, L_pc-parallel_sum__ssm_conv_h3__mixer_gmlp__prompt_kernel
s_subb_u32 s5, s5, 0
s_and_b32 s27, s49, 3
s_lshr_b32 s25, s27, 1
s_and_b32 s26, s27, 1
s_cmp_lt_u32 s49, 4
s_cbranch_scc1 L_A
s_lshl_b32 s24, s18, 7
s_lshl_b32 s30, s27, 5
s_add_u32 s24, s24, s30
v_lshrrev_b32 v210, 5, v255
v_lshlrev_b32 v210, 3, v210
v_bfe_u32 v211, v255, 3, 2
v_add3_u32 v208, v210, v211, s24
v_and_b32 v211, 7, v255
v_lshrrev_b32 v212, 4, v255
v_xor_b32 v211, v211, v212
v_lshlrev_b32 v209, 4, v211
v_mul_u32_u24 v210, 1152, v208
v_add_u32 v200, v210, v209
v_xor_b32 v201, 64, v200
v_add_u32 v201, 18432, v201
s_mul_i32 s30, s27, 147456
s_mul_i32 s31, s19, 384
s_add_u32 s30, s30, s31
v_add_u32 v210, 0, v255
v_mul_u32_u24 v211, 2731, v210
v_lshrrev_b32 v211, 16, v211
v_mul_u32_u24 v212, 24, v211
v_sub_u32 v210, v210, v212
v_and_b32 v212, 2, v211
v_xor_b32 v210, v210, v212
v_mul_u32_u24 v211, 9216, v211
v_lshl_add_u32 v211, v210, 4, v211
v_add_u32 v202, s30, v211
v_xor_b32 v205, 64, v202
v_add_u32 v205, 73728, v205
v_add_u32 v210, 64, v255
v_mul_u32_u24 v211, 2731, v210
v_lshrrev_b32 v211, 16, v211
v_mul_u32_u24 v212, 24, v211
v_sub_u32 v210, v210, v212
v_and_b32 v212, 2, v211
v_xor_b32 v210, v210, v212
v_mul_u32_u24 v211, 9216, v211
v_lshl_add_u32 v211, v210, 4, v211
v_add_u32 v203, s30, v211
v_xor_b32 v206, 64, v203
v_add_u32 v206, 73728, v206
v_add_u32 v210, 128, v255
v_mul_u32_u24 v211, 2731, v210
v_lshrrev_b32 v211, 16, v211
v_mul_u32_u24 v212, 24, v211
v_sub_u32 v210, v210, v212
v_and_b32 v212, 2, v211
v_xor_b32 v210, v210, v212
v_mul_u32_u24 v211, 9216, v211
v_lshl_add_u32 v211, v210, 4, v211
v_add_u32 v204, s30, v211
v_xor_b32 v207, 64, v204
v_add_u32 v207, 73728, v207
s_add_u32 s46, s98, s99
s_and_b32 s46, s46, 1
s_lshl_b32 s46, s46, 2
s_add_u32 s40, s46, 0
s_mul_i32 s31, s40, 57
s_lshr_b32 s31, s31, 9
s_mul_i32 s31, s31, 9
s_sub_u32 s40, s40, s31
s_add_u32 s41, s46, 0
s_mul_i32 s31, s41, 57
s_lshr_b32 s31, s31, 9
s_mul_i32 s31, s31, 9
s_sub_u32 s41, s41, s31
s_lshl_b32 s40, s40, 7
s_add_u32 s42, s40, 4608
s_mul_i32 s41, s41, 589824
s_add_u32 s43, s41, 4608
s_mul_i32 s47, s27, 6144
s_add_u32 s47, s47, 49152
s_lshl_b32 s48, s27, 12
s_mov_b32 s10, 2359296
s_mov_b32 s11, 0x20000
s_mov_b32 s14, 5308416
s_mov_b32 s15, 0x20000
s_waitcnt lgkmcnt(0)
s_mov_b32 s8, s52
s_and_b32 s9, s53, 0xffff
s_mov_b32 s12, s60
s_and_b32 s13, s61, 0xffff
s_setprio 1
s_add_u32 m0, s47, 0
s_nop 0
buffer_load_dwordx4 v202, s[12:15], s43 offen lds
s_add_u32 m0, s47, 1024
s_nop 0
buffer_load_dwordx4 v203, s[12:15], s43 offen lds
s_add_u32 m0, s47, 2048
s_nop 0
buffer_load_dwordx4 v204, s[12:15], s43 offen lds
s_add_u32 m0, s47, 3072
s_nop 0
buffer_load_dwordx4 v205, s[12:15], s43 offen lds
s_add_u32 m0, s47, 4096
s_nop 0
buffer_load_dwordx4 v206, s[12:15], s43 offen lds
s_add_u32 m0, s47, 5120
s_nop 0
buffer_load_dwordx4 v207, s[12:15], s43 offen lds
s_add_u32 s41, s41, 589824
s_cmp_eq_u32 s41, 5308416
s_cselect_b32 s41, 0, s41
s_add_u32 s43, s41, 4608
s_add_u32 m0, s48, 0
s_nop 0
buffer_load_dwordx4 v200, s[8:11], s40 offen lds
s_add_u32 m0, s48, 1024
s_nop 0
buffer_load_dwordx4 v201, s[8:11], s40 offen lds
s_add_u32 m0, s48, 2048
s_nop 0
buffer_load_dwordx4 v200, s[8:11], s42 offen lds
s_add_u32 m0, s48, 3072
s_nop 0
buffer_load_dwordx4 v201, s[8:11], s42 offen lds
s_add_u32 s40, s40, 128
s_cmp_eq_u32 s40, 1152
s_cselect_b32 s40, 0, s40
s_add_u32 s42, s40, 4608
s_add_u32 m0, s47, 24576
s_nop 0
buffer_load_dwordx4 v202, s[12:15], s43 offen lds
s_add_u32 m0, s47, 25600
s_nop 0
buffer_load_dwordx4 v203, s[12:15], s43 offen lds
s_add_u32 m0, s47, 26624
s_nop 0
buffer_load_dwordx4 v204, s[12:15], s43 offen lds
s_add_u32 m0, s47, 27648
s_nop 0
buffer_load_dwordx4 v205, s[12:15], s43 offen lds
s_add_u32 m0, s47, 28672
s_nop 0
buffer_load_dwordx4 v206, s[12:15], s43 offen lds
s_mov_b32 s6, s66
s_mov_b32 s7, s67
s_mov_b32 s68, s64
s_and_b32 s69, s65, 0xffff
s_mov_b32 s70, 256
s_mov_b32 s71, 0x20000
s_add_u32 s20, s6, 41943040
s_addc_u32 s21, s7, 0
s_and_b32 s21, s21, 0xffff
s_mov_b32 s22, 1409024
s_mov_b32 s23, 0x20000
v_lshlrev_b32 v176, 2, v255
v_lshlrev_b32 v177, 3, v255
v_lshlrev_b32 v238, 4, v255
s_mul_i32 s36, s19, 1536
s_mul_i32 s31, s27, 384
s_add_u32 s36, s36, s31
s_add_u32 s36, s36, 1081344
s_lshl_b32 s30, s27, 7
s_add_u32 s30, s30, 147456
v_add_u32 v188, s30, v176
s_mul_i32 s30, s27, 192
s_add_u32 s30, s30, 148480
v_add_u32 v189, s30, v176
v_min_u32 v181, 47, v255
v_lshlrev_b32 v181, 3, v181
s_lshl_b32 s37, s24, 4
s_add_u32 s37, s37, 1048576
s_add_u32 s38, s36, 18432
v_and_b32 v179, 31, v255
v_lshlrev_b32 v179, 4, v179
v_and_b32 v239, 15, v255
v_lshrrev_b32 v240, 1, v239
v_lshrrev_b32 v241, 4, v255
v_xor_b32 v240, v240, v241
v_lshlrev_b32 v240, 4, v240
s_lshl_b32 s31, s25, 13
v_lshl_add_u32 v224, v239, 7, v240
v_add_u32 v224, s31, v224
v_xor_b32 v225, 64, v224
v_bfe_u32 v239, v255, 2, 2
v_lshl_add_u32 v239, v241, 3, v239
v_mul_u32_u24 v239, 384, v239
v_and_b32 v240, 3, v255
v_lshl_add_u32 v239, v240, 3, v239
v_add_u32 v239, 49152, v239
v_bfe_u32 v240, v255, 3, 2
s_mul_i32 s30, s26, 6
s_add_u32 s31, s30, 0
v_xor_b32 v242, s31, v240
v_lshl_add_u32 v226, v242, 5, v239
v_add_u32 v232, 49152, v226
s_add_u32 s31, s30, 1
v_xor_b32 v242, s31, v240
v_lshl_add_u32 v227, v242, 5, v239
v_add_u32 v233, 49152, v227
s_add_u32 s31, s30, 2
v_xor_b32 v242, s31, v240
v_lshl_add_u32 v228, v242, 5, v239
v_add_u32 v234, 49152, v228
s_add_u32 s31, s30, 3
v_xor_b32 v242, s31, v240
v_lshl_add_u32 v229, v242, 5, v239
v_add_u32 v235, 49152, v229
s_add_u32 s31, s30, 4
v_xor_b32 v242, s31, v240
v_lshl_add_u32 v230, v242, 5, v239
v_add_u32 v236, 49152, v230
s_add_u32 s31, s30, 5
v_xor_b32 v242, s31, v240
v_lshl_add_u32 v231, v242, 5, v239
v_add_u32 v237, 49152, v231
v_mov_b32 v244, 0x409d30fc
v_mov_b32 v246, 1.0
v_lshrrev_b32 v240, 4, v255
s_mul_i32 s31, s26, 384
s_add_u32 s31, s31, 149248
v_lshl_add_u32 v240, v240, 4, s31
v_bfe_u32 v241, v255, 2, 2
v_and_b32 v242, 3, v255
v_lshl_add_u32 v241, v241, 3, v242
s_lshl_b32 s31, s25, 6
v_add_u32 v242, s31, v241
v_lshlrev_b32 v241, 2, v242
v_add_u32 v241, 147456, v241
v_lshlrev_b32 v242, 1, v242
v_mov_b32 v2, 0
s_lshl_b32 s30, s17, 2
s_add_u32 s30, s30, s27
s_lshl_b32 s30, s30, 7
v_mul_u32_u24 v245, 12288, v255
v_add_u32 v245, s30, v245
v_min_u32 v245, code_end-parallel_sum__ssm_conv_h3__mixer_gmlp__prompt_kernel-4, v245
s_waitcnt vmcnt(5)
s_barrier
s_add_u32 m0, s47, 29696
s_nop 0
buffer_load_dwordx4 v207, s[12:15], s43 offen lds
s_add_u32 s41, s41, 589824
s_cmp_eq_u32 s41, 5308416
s_cselect_b32 s41, 0, s41
s_add_u32 s43, s41, 4608
s_add_u32 m0, s48, 16384
s_nop 0
buffer_load_dwordx4 v200, s[8:11], s40 offen lds
s_add_u32 m0, s48, 17408
s_nop 0
buffer_load_dwordx4 v201, s[8:11], s40 offen lds
s_add_u32 m0, s48, 18432
s_nop 0
buffer_load_dwordx4 v200, s[8:11], s42 offen lds
s_add_u32 m0, s48, 19456
s_nop 0
buffer_load_dwordx4 v201, s[8:11], s42 offen lds
s_add_u32 s40, s40, 128
s_cmp_eq_u32 s40, 1152
s_cselect_b32 s40, 0, s40
s_add_u32 s42, s40, 4608
s_add_u32 m0, s47, 49152
s_nop 0
buffer_load_dwordx4 v202, s[12:15], s43 offen lds
s_add_u32 m0, s47, 50176
s_nop 0
buffer_load_dwordx4 v203, s[12:15], s43 offen lds
s_add_u32 m0, s47, 51200
s_nop 0
buffer_load_dwordx4 v204, s[12:15], s43 offen lds
s_add_u32 m0, s47, 52224
s_nop 0
buffer_load_dwordx4 v205, s[12:15], s43 offen lds
s_add_u32 m0, s47, 53248
s_nop 0
buffer_load_dwordx4 v206, s[12:15], s43 offen lds
s_add_u32 m0, s47, 54272
s_nop 0
buffer_load_dwordx4 v207, s[12:15], s43 offen lds
s_add_u32 s41, s41, 589824
s_cmp_eq_u32 s41, 5308416
s_cselect_b32 s41, 0, s41
s_add_u32 s43, s41, 4608
s_add_u32 m0, s48, 32768
s_nop 0
buffer_load_dwordx4 v200, s[8:11], s40 offen lds
s_add_u32 m0, s48, 33792
s_nop 0
buffer_load_dwordx4 v201, s[8:11], s40 offen lds
s_add_u32 m0, s48, 34816
s_nop 0
buffer_load_dwordx4 v200, s[8:11], s42 offen lds
s_add_u32 m0, s48, 35840
s_nop 0
buffer_load_dwordx4 v201, s[8:11], s42 offen lds
s_add_u32 s40, s40, 128
s_cmp_eq_u32 s40, 1152
s_cselect_b32 s40, 0, s40
s_add_u32 s42, s40, 4608
s_waitcnt vmcnt(10)
s_barrier
s_add_u32 m0, s47, 73728
s_nop 0
buffer_load_dwordx4 v202, s[12:15], s43 offen lds
s_add_u32 m0, s47, 74752
s_nop 0
buffer_load_dwordx4 v203, s[12:15], s43 offen lds
s_add_u32 m0, s47, 75776
s_nop 0
buffer_load_dwordx4 v204, s[12:15], s43 offen lds
s_add_u32 m0, s47, 76800
s_nop 0
buffer_load_dwordx4 v205, s[12:15], s43 offen lds
s_add_u32 m0, s47, 77824
s_nop 0
buffer_load_dwordx4 v206, s[12:15], s43 offen lds
s_add_u32 m0, s47, 78848
s_nop 0
buffer_load_dwordx4 v207, s[12:15], s43 offen lds
s_add_u32 s41, s41, 589824
s_cmp_eq_u32 s41, 5308416
s_cselect_b32 s41, 0, s41
s_add_u32 s43, s41, 4608
s_add_u32 m0, s48, 0
s_nop 0
buffer_load_dwordx4 v200, s[8:11], s40 offen lds
s_add_u32 m0, s48, 1024
s_nop 0
buffer_load_dwordx4 v201, s[8:11], s40 offen lds
s_add_u32 m0, s48, 2048
s_nop 0
buffer_load_dwordx4 v200, s[8:11], s42 offen lds
s_add_u32 m0, s48, 3072
s_nop 0
buffer_load_dwordx4 v201, s[8:11], s42 offen lds
s_add_u32 s40, s40, 128
s_cmp_eq_u32 s40, 1152
s_cselect_b32 s40, 0, s40
s_add_u32 s42, s40, 4608
s_waitcnt vmcnt(10)
s_barrier
s_add_u32 m0, s47, 0
s_nop 0
buffer_load_dwordx4 v202, s[12:15], s43 offen lds
s_add_u32 m0, s47, 1024
s_nop 0
buffer_load_dwordx4 v203, s[12:15], s43 offen lds
s_add_u32 m0, s47, 2048
s_nop 0
buffer_load_dwordx4 v204, s[12:15], s43 offen lds
s_add_u32 m0, s47, 3072
s_nop 0
buffer_load_dwordx4 v205, s[12:15], s43 offen lds
s_add_u32 m0, s47, 4096
s_nop 0
buffer_load_dwordx4 v206, s[12:15], s43 offen lds
s_add_u32 m0, s47, 5120
s_nop 0
buffer_load_dwordx4 v207, s[12:15], s43 offen lds
s_add_u32 s41, s41, 589824
s_cmp_eq_u32 s41, 5308416
s_cselect_b32 s41, 0, s41
s_add_u32 s43, s41, 4608
s_add_u32 m0, s48, 16384
s_nop 0
buffer_load_dwordx4 v200, s[8:11], s40 offen lds
s_add_u32 m0, s48, 17408
s_nop 0
buffer_load_dwordx4 v201, s[8:11], s40 offen lds
s_add_u32 m0, s48, 18432
s_nop 0
buffer_load_dwordx4 v200, s[8:11], s42 offen lds
s_add_u32 m0, s48, 19456
s_nop 0
buffer_load_dwordx4 v201, s[8:11], s42 offen lds
s_add_u32 s40, s40, 128
s_cmp_eq_u32 s40, 1152
s_cselect_b32 s40, 0, s40
s_add_u32 s42, s40, 4608
s_waitcnt vmcnt(10)
s_barrier
s_add_u32 m0, s47, 24576
s_nop 0
buffer_load_dwordx4 v202, s[12:15], s43 offen lds
s_add_u32 m0, s47, 25600
s_nop 0
buffer_load_dwordx4 v203, s[12:15], s43 offen lds
s_add_u32 m0, s47, 26624
s_nop 0
buffer_load_dwordx4 v204, s[12:15], s43 offen lds
s_add_u32 m0, s47, 27648
s_nop 0
buffer_load_dwordx4 v205, s[12:15], s43 offen lds
s_add_u32 m0, s47, 28672
s_nop 0
buffer_load_dwordx4 v206, s[12:15], s43 offen lds
s_add_u32 m0, s47, 29696
s_nop 0
buffer_load_dwordx4 v207, s[12:15], s43 offen lds
s_add_u32 s41, s41, 589824
s_cmp_eq_u32 s41, 5308416
s_cselect_b32 s41, 0, s41
s_add_u32 s43, s41, 4608
s_add_u32 m0, s48, 32768
s_nop 0
buffer_load_dwordx4 v200, s[8:11], s40 offen lds
s_add_u32 m0, s48, 33792
s_nop 0
buffer_load_dwordx4 v201, s[8:11], s40 offen lds
s_add_u32 m0, s48, 34816
s_nop 0
buffer_load_dwordx4 v200, s[8:11], s42 offen lds
s_add_u32 m0, s48, 35840
s_nop 0
buffer_load_dwordx4 v201, s[8:11], s42 offen lds
s_add_u32 s40, s40, 128
s_cmp_eq_u32 s40, 1152
s_cselect_b32 s40, 0, s40
s_add_u32 s42, s40, 4608
s_waitcnt vmcnt(10)
s_barrier
s_add_u32 m0, s47, 49152
s_nop 0
buffer_load_dwordx4 v202, s[12:15], s43 offen lds
s_add_u32 m0, s47, 50176
s_nop 0
buffer_load_dwordx4 v203, s[12:15], s43 offen lds
s_add_u32 m0, s47, 51200
s_nop 0
buffer_load_dwordx4 v204, s[12:15], s43 offen lds
s_add_u32 m0, s47, 52224
s_nop 0
buffer_load_dwordx4 v205, s[12:15], s43 offen lds
s_add_u32 m0, s47, 53248
s_nop 0
buffer_load_dwordx4 v206, s[12:15], s43 offen lds
s_add_u32 m0, s47, 54272
s_nop 0
buffer_load_dwordx4 v207, s[12:15], s43 offen lds
s_add_u32 s41, s41, 589824
s_cmp_eq_u32 s41, 5308416
s_cselect_b32 s41, 0, s41
s_add_u32 s43, s41, 4608
s_add_u32 m0, s48, 0
s_nop 0
buffer_load_dwordx4 v200, s[8:11], s40 offen lds
s_add_u32 m0, s48, 1024
s_nop 0
buffer_load_dwordx4 v201, s[8:11], s40 offen lds
s_add_u32 m0, s48, 2048
s_nop 0
buffer_load_dwordx4 v200, s[8:11], s42 offen lds
s_add_u32 m0, s48, 3072
s_nop 0
buffer_load_dwordx4 v201, s[8:11], s42 offen lds
s_add_u32 s40, s40, 128
s_cmp_eq_u32 s40, 1152
s_cselect_b32 s40, 0, s40
s_add_u32 s42, s40, 4608
buffer_load_dword v180, off, s[68:71], 0 sc1
s_waitcnt vmcnt(11)
s_barrier
s_add_u32 m0, s47, 73728
s_nop 0
buffer_load_dwordx4 v202, s[12:15], s43 offen lds
s_add_u32 m0, s47, 74752
s_nop 0
buffer_load_dwordx4 v203, s[12:15], s43 offen lds
s_add_u32 m0, s47, 75776
s_nop 0
buffer_load_dwordx4 v204, s[12:15], s43 offen lds
s_add_u32 m0, s47, 76800
s_nop 0
buffer_load_dwordx4 v205, s[12:15], s43 offen lds
s_add_u32 m0, s47, 77824
s_nop 0
buffer_load_dwordx4 v206, s[12:15], s43 offen lds
s_add_u32 m0, s47, 78848
s_nop 0
buffer_load_dwordx4 v207, s[12:15], s43 offen lds
s_add_u32 s41, s41, 589824
s_cmp_eq_u32 s41, 5308416
s_cselect_b32 s41, 0, s41
s_add_u32 s43, s41, 4608
s_add_u32 m0, s48, 16384
s_nop 0
buffer_load_dwordx4 v200, s[8:11], s40 offen lds
s_add_u32 m0, s48, 17408
s_nop 0
buffer_load_dwordx4 v201, s[8:11], s40 offen lds
s_add_u32 m0, s48, 18432
s_nop 0
buffer_load_dwordx4 v200, s[8:11], s42 offen lds
s_add_u32 m0, s48, 19456
s_nop 0
buffer_load_dwordx4 v201, s[8:11], s42 offen lds
s_add_u32 s40, s40, 128
s_cmp_eq_u32 s40, 1152
s_cselect_b32 s40, 0, s40
s_add_u32 s42, s40, 4608
s_mov_b64 exec, 0xff
global_load_dword v243, v245, s[4:5]
s_mov_b64 exec, -1
s_waitcnt vmcnt(12)
s_barrier
s_add_u32 m0, s47, 0
s_nop 0
buffer_load_dwordx4 v202, s[12:15], s43 offen lds
s_add_u32 m0, s47, 1024
s_nop 0
buffer_load_dwordx4 v203, s[12:15], s43 offen lds
s_add_u32 m0, s47, 2048
s_nop 0
buffer_load_dwordx4 v204, s[12:15], s43 offen lds
s_add_u32 m0, s47, 3072
s_nop 0
buffer_load_dwordx4 v205, s[12:15], s43 offen lds
s_add_u32 m0, s47, 4096
s_nop 0
buffer_load_dwordx4 v206, s[12:15], s43 offen lds
s_add_u32 m0, s47, 5120
s_nop 0
buffer_load_dwordx4 v207, s[12:15], s43 offen lds
s_add_u32 s41, s41, 589824
s_cmp_eq_u32 s41, 5308416
s_cselect_b32 s41, 0, s41
s_add_u32 s43, s41, 4608
s_add_u32 m0, s48, 32768
s_nop 0
buffer_load_dwordx4 v200, s[8:11], s40 offen lds
s_add_u32 m0, s48, 33792
s_nop 0
buffer_load_dwordx4 v201, s[8:11], s40 offen lds
s_add_u32 m0, s48, 34816
s_nop 0
buffer_load_dwordx4 v200, s[8:11], s42 offen lds
s_add_u32 m0, s48, 35840
s_nop 0
buffer_load_dwordx4 v201, s[8:11], s42 offen lds
s_add_u32 s40, s40, 128
s_cmp_eq_u32 s40, 1152
s_cselect_b32 s40, 0, s40
s_add_u32 s42, s40, 4608
s_waitcnt vmcnt(21)
s_mov_b32 s78, 0x20000
s_branch L_ln_c
L_ln_l:
buffer_load_dword v180, off, s[68:71], 0 sc1
s_waitcnt vmcnt(0)
L_ln_c:
v_readfirstlane_b32 s64, v180
s_sub_u32 s78, s78, 1
s_cbranch_scc1 L_ln_o
s_cmp_eq_u32 s64, 0
s_cbranch_scc1 L_ln_l
L_ln_o:
v_mov_b32 v193, s64
s_waitcnt vmcnt(11)
s_barrier
buffer_load_dwordx4 v[182:185], v179, s[20:23], s37 offen sc0 sc1
buffer_load_dwordx2 v[186:187], v181, s[20:23], s38 offen sc0 sc1
s_add_u32 m0, s47, 24576
s_nop 0
buffer_load_dwordx4 v202, s[12:15], s41 offen lds
s_add_u32 m0, s47, 25600
s_nop 0
buffer_load_dwordx4 v203, s[12:15], s41 offen lds
s_add_u32 m0, s47, 26624
s_nop 0
buffer_load_dwordx4 v204, s[12:15], s41 offen lds
s_add_u32 m0, s47, 27648
s_nop 0
buffer_load_dwordx4 v205, s[12:15], s41 offen lds
s_waitcnt vmcnt(6)
s_barrier
s_waitcnt vmcnt(4)
s_mov_b32 s78, 0x20000
L_cc:
v_xor_b32 v180, v183, v193
v_bitop3_b32 v180, v180, v185, v193 bitop3:0xf6
v_bitop3_b32 v180, v180, v187, v193 bitop3:0xf6
v_cmp_ne_u32 vcc, 0, v180
s_cbranch_vccnz L_cl
L_co:
v_mul_f32 v184, 0x3eeff558, v184
s_mov_b32 exec_hi, 0xffff
ds_write_b32 v189, v186
v_mul_f32_e64 v182, -v182, v184
s_mov_b32 exec_hi, 0
ds_write_b32 v188, v184
ds_write_b32 v188, v182 offset:512
v_mov_b32 v180, 153088
ds_write_b32 v180, v193 offset:4
s_mov_b64 exec, -1
s_waitcnt lgkmcnt(0)
s_barrier
s_setprio 0
s_mov_b64 exec, 0xff
global_load_dword v243, v245, s[4:5]
s_mov_b64 exec, -1
s_add_u32 m0, s47, 28672
s_nop 0
buffer_load_dwordx4 v206, s[12:15], s41 offen lds
s_add_u32 m0, s47, 29696
s_nop 0
buffer_load_dwordx4 v207, s[12:15], s41 offen lds
s_add_u32 s41, s41, 589824
s_cmp_eq_u32 s41, 5308416
s_cselect_b32 s41, 0, s41
s_add_u32 s43, s41, 4608
s_add_u32 m0, s48, 0
s_nop 0
buffer_load_dwordx4 v200, s[8:11], s40 offen lds
s_add_u32 m0, s48, 1024
s_nop 0
buffer_load_dwordx4 v201, s[8:11], s40 offen lds
s_add_u32 m0, s48, 2048
s_nop 0
buffer_load_dwordx4 v200, s[8:11], s42 offen lds
s_add_u32 m0, s48, 3072
s_nop 0
buffer_load_dwordx4 v201, s[8:11], s42 offen lds
s_add_u32 s40, s40, 128
s_cmp_eq_u32 s40, 1152
s_cselect_b32 s40, 0, s40
s_add_u32 s42, s40, 4608
s_add_u32 m0, s47, 49152
s_nop 0
buffer_load_dwordx4 v202, s[12:15], s41 offen lds
s_add_u32 m0, s47, 50176
s_nop 0
buffer_load_dwordx4 v203, s[12:15], s41 offen lds
s_add_u32 m0, s47, 51200
s_nop 0
buffer_load_dwordx4 v204, s[12:15], s41 offen lds
s_add_u32 m0, s47, 52224
s_nop 0
buffer_load_dwordx4 v205, s[12:15], s41 offen lds
s_add_u32 m0, s47, 53248
s_nop 0
buffer_load_dwordx4 v206, s[12:15], s41 offen lds
s_add_u32 m0, s47, 54272
s_nop 0
buffer_load_dwordx4 v207, s[12:15], s41 offen lds
s_add_u32 s41, s41, 589824
s_cmp_eq_u32 s41, 5308416
s_cselect_b32 s41, 0, s41
s_add_u32 s43, s41, 4608
s_add_u32 m0, s48, 16384
s_nop 0
buffer_load_dwordx4 v200, s[8:11], s40 offen lds
s_add_u32 m0, s48, 17408
s_nop 0
buffer_load_dwordx4 v201, s[8:11], s40 offen lds
s_add_u32 m0, s48, 18432
s_nop 0
buffer_load_dwordx4 v200, s[8:11], s42 offen lds
s_add_u32 m0, s48, 19456
s_nop 0
buffer_load_dwordx4 v201, s[8:11], s42 offen lds
s_add_u32 s40, s40, 128
s_cmp_eq_u32 s40, 1152
s_cselect_b32 s40, 0, s40
s_add_u32 s42, s40, 4608
s_load_dwordx2 s[68:69], s[0:1], 72
s_lshl_b32 s32, s18, 2
s_lshl_b32 s33, s25, 1
s_add_u32 s32, s32, s33
s_mul_i32 s60, s32, 144
s_mul_i32 s33, s19, 6
s_add_u32 s60, s60, s33
s_mul_i32 s33, s26, 3
s_add_u32 s60, s60, s33
s_lshl_b32 s60, s60, 10
s_add_u32 s61, s60, 73728
s_add_u32 s62, s60, 147456
s_add_u32 s63, s60, 221184
s_add_u32 s36, s6, 20971520
s_addc_u32 s37, s7, 0
s_and_b32 s37, s37, 0xffff
s_mov_b32 s38, 9437184
s_mov_b32 s39, 0x20000
s_waitcnt lgkmcnt(0)
s_mov_b32 s72, s68
s_and_b32 s73, s69, 0xffff
s_mov_b32 s74, 4096
s_mov_b32 s75, 0x20000
s_lshl_b32 s30, s18, 8
buffer_load_ushort v248, v242, s[72:75], s30 offen offset:0
buffer_load_ushort v249, v242, s[72:75], s30 offen offset:8
buffer_load_ushort v250, v242, s[72:75], s30 offen offset:64
buffer_load_ushort v251, v242, s[72:75], s30 offen offset:72
s_lshl_b32 s59, s18, 1
s_add_u32 s59, s59, s25
s_mul_i32 s59, s59, 12
s_add_u32 s59, s59, s19
s_lshl_b32 s59, s59, 1
s_add_u32 s59, s59, s26
s_lshl_b32 s59, s59, 7
s_add_u32 s59, s59, 1310720
s_mov_b32 exec_hi, 0
buffer_store_dword v2, v176, s[20:23], s59 offen sc0 sc1
s_mov_b32 exec_hi, -1
s_add_u32 m0, s47, 73728
s_nop 0
buffer_load_dwordx4 v202, s[12:15], s41 offen lds
s_add_u32 m0, s47, 74752
s_nop 0
buffer_load_dwordx4 v203, s[12:15], s41 offen lds
s_add_u32 m0, s47, 75776
s_nop 0
buffer_load_dwordx4 v204, s[12:15], s41 offen lds
s_add_u32 m0, s47, 76800
s_nop 0
buffer_load_dwordx4 v205, s[12:15], s41 offen lds
s_add_u32 m0, s47, 77824
s_nop 0
buffer_load_dwordx4 v206, s[12:15], s41 offen lds
s_add_u32 m0, s47, 78848
s_nop 0
buffer_load_dwordx4 v207, s[12:15], s41 offen lds
s_add_u32 s41, s41, 589824
s_cmp_eq_u32 s41, 5308416
s_cselect_b32 s41, 0, s41
s_add_u32 s43, s41, 4608
s_add_u32 m0, s48, 32768
s_nop 0
buffer_load_dwordx4 v200, s[8:11], s40 offen lds
s_add_u32 m0, s48, 33792
s_nop 0
buffer_load_dwordx4 v201, s[8:11], s40 offen lds
s_add_u32 m0, s48, 34816
s_nop 0
buffer_load_dwordx4 v200, s[8:11], s42 offen lds
s_add_u32 m0, s48, 35840
s_nop 0
buffer_load_dwordx4 v201, s[8:11], s42 offen lds
s_add_u32 s40, s40, 128
s_cmp_eq_u32 s40, 1152
s_cselect_b32 s40, 0, s40
s_add_u32 s42, s40, 4608
s_add_u32 m0, s47, 0
s_nop 0
buffer_load_dwordx4 v202, s[12:15], s41 offen lds
s_add_u32 m0, s47, 1024
s_nop 0
buffer_load_dwordx4 v203, s[12:15], s41 offen lds
s_add_u32 m0, s47, 2048
s_nop 0
buffer_load_dwordx4 v204, s[12:15], s41 offen lds
s_add_u32 m0, s47, 3072
s_nop 0
buffer_load_dwordx4 v205, s[12:15], s41 offen lds
s_add_u32 m0, s47, 4096
s_nop 0
buffer_load_dwordx4 v206, s[12:15], s41 offen lds
s_add_u32 m0, s47, 5120
s_nop 0
buffer_load_dwordx4 v207, s[12:15], s41 offen lds
s_add_u32 s41, s41, 589824
s_cmp_eq_u32 s41, 5308416
s_cselect_b32 s41, 0, s41
s_add_u32 s43, s41, 4608
s_waitcnt vmcnt(31)
s_barrier
ds_read_b128 v[96:99], v224 offset:0
ds_read_b128 v[100:103], v224 offset:2048
ds_read_b128 v[104:107], v224 offset:4096
ds_read_b128 v[108:111], v224 offset:6144
ds_read_b64_tr_b16 v[128:129], v226 offset:24576
ds_read_b64_tr_b16 v[130:131], v226 offset:26112
ds_read_b64_tr_b16 v[132:133], v227 offset:24576
ds_read_b64_tr_b16 v[134:135], v227 offset:26112
ds_read_b64_tr_b16 v[136:137], v228 offset:24576
ds_read_b64_tr_b16 v[138:139], v228 offset:26112
ds_read_b64_tr_b16 v[140:141], v229 offset:24576
ds_read_b64_tr_b16 v[142:143], v229 offset:26112
ds_read_b64_tr_b16 v[144:145], v230 offset:24576
ds_read_b64_tr_b16 v[146:147], v230 offset:26112
ds_read_b64_tr_b16 v[148:149], v231 offset:24576
ds_read_b64_tr_b16 v[150:151], v231 offset:26112
s_waitcnt lgkmcnt(0)
v_mfma_f32_16x16x32_bf16 v[0:3], v[128:131], v[96:99], 0
ds_read_b128 v[112:115], v225 offset:0
v_mfma_f32_16x16x32_bf16 v[24:27], v[128:131], v[100:103], 0
ds_read_b128 v[116:119], v225 offset:2048
v_mfma_f32_16x16x32_bf16 v[48:51], v[128:131], v[104:107], 0
ds_read_b128 v[120:123], v225 offset:4096
v_mfma_f32_16x16x32_bf16 v[72:75], v[128:131], v[108:111], 0
ds_read_b128 v[124:127], v225 offset:6144
v_mfma_f32_16x16x32_bf16 v[4:7], v[132:135], v[96:99], 0
v_mfma_f32_16x16x32_bf16 v[28:31], v[132:135], v[100:103], 0
ds_read_b64_tr_b16 v[152:153], v226 offset:36864
v_mfma_f32_16x16x32_bf16 v[52:55], v[132:135], v[104:107], 0
ds_read_b64_tr_b16 v[154:155], v226 offset:38400
v_mfma_f32_16x16x32_bf16 v[76:79], v[132:135], v[108:111], 0
ds_read_b64_tr_b16 v[156:157], v227 offset:36864
v_mfma_f32_16x16x32_bf16 v[8:11], v[136:139], v[96:99], 0
ds_read_b64_tr_b16 v[158:159], v227 offset:38400
v_mfma_f32_16x16x32_bf16 v[32:35], v[136:139], v[100:103], 0
v_mfma_f32_16x16x32_bf16 v[56:59], v[136:139], v[104:107], 0
ds_read_b64_tr_b16 v[160:161], v228 offset:36864
v_mfma_f32_16x16x32_bf16 v[80:83], v[136:139], v[108:111], 0
ds_read_b64_tr_b16 v[162:163], v228 offset:38400
v_mfma_f32_16x16x32_bf16 v[12:15], v[140:143], v[96:99], 0
ds_read_b64_tr_b16 v[164:165], v229 offset:36864
v_mfma_f32_16x16x32_bf16 v[36:39], v[140:143], v[100:103], 0
ds_read_b64_tr_b16 v[166:167], v229 offset:38400
v_mfma_f32_16x16x32_bf16 v[60:63], v[140:143], v[104:107], 0
v_mfma_f32_16x16x32_bf16 v[84:87], v[140:143], v[108:111], 0
ds_read_b64_tr_b16 v[168:169], v230 offset:36864
v_mfma_f32_16x16x32_bf16 v[16:19], v[144:147], v[96:99], 0
ds_read_b64_tr_b16 v[170:171], v230 offset:38400
v_mfma_f32_16x16x32_bf16 v[40:43], v[144:147], v[100:103], 0
ds_read_b64_tr_b16 v[172:173], v231 offset:36864
v_mfma_f32_16x16x32_bf16 v[64:67], v[144:147], v[104:107], 0
ds_read_b64_tr_b16 v[174:175], v231 offset:38400
v_mfma_f32_16x16x32_bf16 v[88:91], v[144:147], v[108:111], 0
v_mfma_f32_16x16x32_bf16 v[20:23], v[148:151], v[96:99], 0
v_mfma_f32_16x16x32_bf16 v[44:47], v[148:151], v[100:103], 0
v_mfma_f32_16x16x32_bf16 v[68:71], v[148:151], v[104:107], 0
v_mfma_f32_16x16x32_bf16 v[92:95], v[148:151], v[108:111], 0
s_waitcnt vmcnt(21) lgkmcnt(0)
s_barrier
v_mfma_f32_16x16x32_bf16 v[0:3], v[152:155], v[112:115], v[0:3]
ds_read_b128 v[96:99], v224 offset:16384
v_mfma_f32_16x16x32_bf16 v[24:27], v[152:155], v[116:119], v[24:27]
ds_read_b128 v[100:103], v224 offset:18432
v_mfma_f32_16x16x32_bf16 v[48:51], v[152:155], v[120:123], v[48:51]
ds_read_b128 v[104:107], v224 offset:20480
v_mfma_f32_16x16x32_bf16 v[72:75], v[152:155], v[124:127], v[72:75]
ds_read_b128 v[108:111], v224 offset:22528
v_mfma_f32_16x16x32_bf16 v[4:7], v[156:159], v[112:115], v[4:7]
v_mfma_f32_16x16x32_bf16 v[28:31], v[156:159], v[116:119], v[28:31]
ds_read_b64_tr_b16 v[128:129], v232 offset:0
v_mfma_f32_16x16x32_bf16 v[52:55], v[156:159], v[120:123], v[52:55]
ds_read_b64_tr_b16 v[130:131], v232 offset:1536
v_mfma_f32_16x16x32_bf16 v[76:79], v[156:159], v[124:127], v[76:79]
ds_read_b64_tr_b16 v[132:133], v233 offset:0
v_mfma_f32_16x16x32_bf16 v[8:11], v[160:163], v[112:115], v[8:11]
ds_read_b64_tr_b16 v[134:135], v233 offset:1536
v_mfma_f32_16x16x32_bf16 v[32:35], v[160:163], v[116:119], v[32:35]
v_mfma_f32_16x16x32_bf16 v[56:59], v[160:163], v[120:123], v[56:59]
ds_read_b64_tr_b16 v[136:137], v234 offset:0
v_mfma_f32_16x16x32_bf16 v[80:83], v[160:163], v[124:127], v[80:83]
ds_read_b64_tr_b16 v[138:139], v234 offset:1536
v_mfma_f32_16x16x32_bf16 v[12:15], v[164:167], v[112:115], v[12:15]
ds_read_b64_tr_b16 v[140:141], v235 offset:0
v_mfma_f32_16x16x32_bf16 v[36:39], v[164:167], v[116:119], v[36:39]
ds_read_b64_tr_b16 v[142:143], v235 offset:1536
v_mfma_f32_16x16x32_bf16 v[60:63], v[164:167], v[120:123], v[60:63]
v_mfma_f32_16x16x32_bf16 v[84:87], v[164:167], v[124:127], v[84:87]
ds_read_b64_tr_b16 v[144:145], v236 offset:0
v_mfma_f32_16x16x32_bf16 v[16:19], v[168:171], v[112:115], v[16:19]
ds_read_b64_tr_b16 v[146:147], v236 offset:1536
v_mfma_f32_16x16x32_bf16 v[40:43], v[168:171], v[116:119], v[40:43]
ds_read_b64_tr_b16 v[148:149], v237 offset:0
v_mfma_f32_16x16x32_bf16 v[64:67], v[168:171], v[120:123], v[64:67]
ds_read_b64_tr_b16 v[150:151], v237 offset:1536
v_mfma_f32_16x16x32_bf16 v[88:91], v[168:171], v[124:127], v[88:91]
v_mfma_f32_16x16x32_bf16 v[20:23], v[172:175], v[112:115], v[20:23]
v_mfma_f32_16x16x32_bf16 v[44:47], v[172:175], v[116:119], v[44:47]
v_mfma_f32_16x16x32_bf16 v[68:71], v[172:175], v[120:123], v[68:71]
v_mfma_f32_16x16x32_bf16 v[92:95], v[172:175], v[124:127], v[92:95]
s_waitcnt lgkmcnt(0)
v_mfma_f32_16x16x32_bf16 v[0:3], v[128:131], v[96:99], v[0:3]
ds_read_b128 v[112:115], v225 offset:16384
v_mfma_f32_16x16x32_bf16 v[24:27], v[128:131], v[100:103], v[24:27]
ds_read_b128 v[116:119], v225 offset:18432
v_mfma_f32_16x16x32_bf16 v[48:51], v[128:131], v[104:107], v[48:51]
ds_read_b128 v[120:123], v225 offset:20480
v_mfma_f32_16x16x32_bf16 v[72:75], v[128:131], v[108:111], v[72:75]
ds_read_b128 v[124:127], v225 offset:22528
v_mfma_f32_16x16x32_bf16 v[4:7], v[132:135], v[96:99], v[4:7]
v_mfma_f32_16x16x32_bf16 v[28:31], v[132:135], v[100:103], v[28:31]
ds_read_b64_tr_b16 v[152:153], v232 offset:12288
v_mfma_f32_16x16x32_bf16 v[52:55], v[132:135], v[104:107], v[52:55]
ds_read_b64_tr_b16 v[154:155], v232 offset:13824
v_mfma_f32_16x16x32_bf16 v[76:79], v[132:135], v[108:111], v[76:79]
ds_read_b64_tr_b16 v[156:157], v233 offset:12288
v_mfma_f32_16x16x32_bf16 v[8:11], v[136:139], v[96:99], v[8:11]
ds_read_b64_tr_b16 v[158:159], v233 offset:13824
v_mfma_f32_16x16x32_bf16 v[32:35], v[136:139], v[100:103], v[32:35]
v_mfma_f32_16x16x32_bf16 v[56:59], v[136:139], v[104:107], v[56:59]
ds_read_b64_tr_b16 v[160:161], v234 offset:12288
v_mfma_f32_16x16x32_bf16 v[80:83], v[136:139], v[108:111], v[80:83]
ds_read_b64_tr_b16 v[162:163], v234 offset:13824
v_mfma_f32_16x16x32_bf16 v[12:15], v[140:143], v[96:99], v[12:15]
ds_read_b64_tr_b16 v[164:165], v235 offset:12288
v_mfma_f32_16x16x32_bf16 v[36:39], v[140:143], v[100:103], v[36:39]
ds_read_b64_tr_b16 v[166:167], v235 offset:13824
v_mfma_f32_16x16x32_bf16 v[60:63], v[140:143], v[104:107], v[60:63]
v_mfma_f32_16x16x32_bf16 v[84:87], v[140:143], v[108:111], v[84:87]
ds_read_b64_tr_b16 v[168:169], v236 offset:12288
v_mfma_f32_16x16x32_bf16 v[16:19], v[144:147], v[96:99], v[16:19]
ds_read_b64_tr_b16 v[170:171], v236 offset:13824
v_mfma_f32_16x16x32_bf16 v[40:43], v[144:147], v[100:103], v[40:43]
ds_read_b64_tr_b16 v[172:173], v237 offset:12288
v_mfma_f32_16x16x32_bf16 v[64:67], v[144:147], v[104:107], v[64:67]
ds_read_b64_tr_b16 v[174:175], v237 offset:13824
v_mfma_f32_16x16x32_bf16 v[88:91], v[144:147], v[108:111], v[88:91]
v_mfma_f32_16x16x32_bf16 v[20:23], v[148:151], v[96:99], v[20:23]
v_mfma_f32_16x16x32_bf16 v[44:47], v[148:151], v[100:103], v[44:47]
v_mfma_f32_16x16x32_bf16 v[68:71], v[148:151], v[104:107], v[68:71]
v_mfma_f32_16x16x32_bf16 v[92:95], v[148:151], v[108:111], v[92:95]
s_waitcnt vmcnt(6) lgkmcnt(0)
s_barrier
v_mfma_f32_16x16x32_bf16 v[0:3], v[152:155], v[112:115], v[0:3]
ds_read_b128 v[96:99], v224 offset:32768
v_mfma_f32_16x16x32_bf16 v[24:27], v[152:155], v[116:119], v[24:27]
ds_read_b128 v[100:103], v224 offset:34816
v_mfma_f32_16x16x32_bf16 v[48:51], v[152:155], v[120:123], v[48:51]
ds_read_b128 v[104:107], v224 offset:36864
v_mfma_f32_16x16x32_bf16 v[72:75], v[152:155], v[124:127], v[72:75]
ds_read_b128 v[108:111], v224 offset:38912
v_mfma_f32_16x16x32_bf16 v[4:7], v[156:159], v[112:115], v[4:7]
v_mfma_f32_16x16x32_bf16 v[28:31], v[156:159], v[116:119], v[28:31]
ds_read_b64_tr_b16 v[128:129], v232 offset:24576
v_mfma_f32_16x16x32_bf16 v[52:55], v[156:159], v[120:123], v[52:55]
ds_read_b64_tr_b16 v[130:131], v232 offset:26112
v_mfma_f32_16x16x32_bf16 v[76:79], v[156:159], v[124:127], v[76:79]
ds_read_b64_tr_b16 v[132:133], v233 offset:24576
v_mfma_f32_16x16x32_bf16 v[8:11], v[160:163], v[112:115], v[8:11]
ds_read_b64_tr_b16 v[134:135], v233 offset:26112
v_mfma_f32_16x16x32_bf16 v[32:35], v[160:163], v[116:119], v[32:35]
v_mfma_f32_16x16x32_bf16 v[56:59], v[160:163], v[120:123], v[56:59]
ds_read_b64_tr_b16 v[136:137], v234 offset:24576
v_mfma_f32_16x16x32_bf16 v[80:83], v[160:163], v[124:127], v[80:83]
ds_read_b64_tr_b16 v[138:139], v234 offset:26112
v_mfma_f32_16x16x32_bf16 v[12:15], v[164:167], v[112:115], v[12:15]
ds_read_b64_tr_b16 v[140:141], v235 offset:24576
v_mfma_f32_16x16x32_bf16 v[36:39], v[164:167], v[116:119], v[36:39]
ds_read_b64_tr_b16 v[142:143], v235 offset:26112
v_mfma_f32_16x16x32_bf16 v[60:63], v[164:167], v[120:123], v[60:63]
v_mfma_f32_16x16x32_bf16 v[84:87], v[164:167], v[124:127], v[84:87]
ds_read_b64_tr_b16 v[144:145], v236 offset:24576
v_mfma_f32_16x16x32_bf16 v[16:19], v[168:171], v[112:115], v[16:19]
ds_read_b64_tr_b16 v[146:147], v236 offset:26112
v_mfma_f32_16x16x32_bf16 v[40:43], v[168:171], v[116:119], v[40:43]
ds_read_b64_tr_b16 v[148:149], v237 offset:24576
v_mfma_f32_16x16x32_bf16 v[64:67], v[168:171], v[120:123], v[64:67]
ds_read_b64_tr_b16 v[150:151], v237 offset:26112
v_mfma_f32_16x16x32_bf16 v[88:91], v[168:171], v[124:127], v[88:91]
v_mfma_f32_16x16x32_bf16 v[20:23], v[172:175], v[112:115], v[20:23]
v_mfma_f32_16x16x32_bf16 v[44:47], v[172:175], v[116:119], v[44:47]
v_mfma_f32_16x16x32_bf16 v[68:71], v[172:175], v[120:123], v[68:71]
v_mfma_f32_16x16x32_bf16 v[92:95], v[172:175], v[124:127], v[92:95]
s_waitcnt lgkmcnt(0)
v_mfma_f32_16x16x32_bf16 v[0:3], v[128:131], v[96:99], v[0:3]
ds_read_b128 v[112:115], v225 offset:32768
v_mfma_f32_16x16x32_bf16 v[24:27], v[128:131], v[100:103], v[24:27]
ds_read_b128 v[116:119], v225 offset:34816
v_mfma_f32_16x16x32_bf16 v[48:51], v[128:131], v[104:107], v[48:51]
ds_read_b128 v[120:123], v225 offset:36864
v_mfma_f32_16x16x32_bf16 v[72:75], v[128:131], v[108:111], v[72:75]
ds_read_b128 v[124:127], v225 offset:38912
v_mfma_f32_16x16x32_bf16 v[4:7], v[132:135], v[96:99], v[4:7]
v_mfma_f32_16x16x32_bf16 v[28:31], v[132:135], v[100:103], v[28:31]
ds_read_b64_tr_b16 v[152:153], v232 offset:36864
v_mfma_f32_16x16x32_bf16 v[52:55], v[132:135], v[104:107], v[52:55]
ds_read_b64_tr_b16 v[154:155], v232 offset:38400
v_mfma_f32_16x16x32_bf16 v[76:79], v[132:135], v[108:111], v[76:79]
ds_read_b64_tr_b16 v[156:157], v233 offset:36864
v_mfma_f32_16x16x32_bf16 v[8:11], v[136:139], v[96:99], v[8:11]
ds_read_b64_tr_b16 v[158:159], v233 offset:38400
v_mfma_f32_16x16x32_bf16 v[32:35], v[136:139], v[100:103], v[32:35]
v_mfma_f32_16x16x32_bf16 v[56:59], v[136:139], v[104:107], v[56:59]
ds_read_b64_tr_b16 v[160:161], v234 offset:36864
v_mfma_f32_16x16x32_bf16 v[80:83], v[136:139], v[108:111], v[80:83]
ds_read_b64_tr_b16 v[162:163], v234 offset:38400
v_mfma_f32_16x16x32_bf16 v[12:15], v[140:143], v[96:99], v[12:15]
ds_read_b64_tr_b16 v[164:165], v235 offset:36864
v_mfma_f32_16x16x32_bf16 v[36:39], v[140:143], v[100:103], v[36:39]
ds_read_b64_tr_b16 v[166:167], v235 offset:38400
v_mfma_f32_16x16x32_bf16 v[60:63], v[140:143], v[104:107], v[60:63]
v_mfma_f32_16x16x32_bf16 v[84:87], v[140:143], v[108:111], v[84:87]
ds_read_b64_tr_b16 v[168:169], v236 offset:36864
v_mfma_f32_16x16x32_bf16 v[16:19], v[144:147], v[96:99], v[16:19]
ds_read_b64_tr_b16 v[170:171], v236 offset:38400
v_mfma_f32_16x16x32_bf16 v[40:43], v[144:147], v[100:103], v[40:43]
ds_read_b64_tr_b16 v[172:173], v237 offset:36864
v_mfma_f32_16x16x32_bf16 v[64:67], v[144:147], v[104:107], v[64:67]
ds_read_b64_tr_b16 v[174:175], v237 offset:38400
v_mfma_f32_16x16x32_bf16 v[88:91], v[144:147], v[108:111], v[88:91]
v_mfma_f32_16x16x32_bf16 v[20:23], v[148:151], v[96:99], v[20:23]
v_mfma_f32_16x16x32_bf16 v[44:47], v[148:151], v[100:103], v[44:47]
v_mfma_f32_16x16x32_bf16 v[68:71], v[148:151], v[104:107], v[68:71]
v_mfma_f32_16x16x32_bf16 v[92:95], v[148:151], v[108:111], v[92:95]
s_waitcnt vmcnt(0) lgkmcnt(0)
s_barrier
v_mfma_f32_16x16x32_bf16 v[0:3], v[152:155], v[112:115], v[0:3]
ds_read_b128 v[96:99], v224 offset:0
v_mfma_f32_16x16x32_bf16 v[24:27], v[152:155], v[116:119], v[24:27]
ds_read_b128 v[100:103], v224 offset:2048
v_mfma_f32_16x16x32_bf16 v[48:51], v[152:155], v[120:123], v[48:51]
ds_read_b128 v[104:107], v224 offset:4096
v_mfma_f32_16x16x32_bf16 v[72:75], v[152:155], v[124:127], v[72:75]
ds_read_b128 v[108:111], v224 offset:6144
v_mfma_f32_16x16x32_bf16 v[4:7], v[156:159], v[112:115], v[4:7]
v_mfma_f32_16x16x32_bf16 v[28:31], v[156:159], v[116:119], v[28:31]
ds_read_b64_tr_b16 v[128:129], v226 offset:0
v_mfma_f32_16x16x32_bf16 v[52:55], v[156:159], v[120:123], v[52:55]
ds_read_b64_tr_b16 v[130:131], v226 offset:1536
v_mfma_f32_16x16x32_bf16 v[76:79], v[156:159], v[124:127], v[76:79]
ds_read_b64_tr_b16 v[132:133], v227 offset:0
v_mfma_f32_16x16x32_bf16 v[8:11], v[160:163], v[112:115], v[8:11]
ds_read_b64_tr_b16 v[134:135], v227 offset:1536
v_mfma_f32_16x16x32_bf16 v[32:35], v[160:163], v[116:119], v[32:35]
v_mfma_f32_16x16x32_bf16 v[56:59], v[160:163], v[120:123], v[56:59]
ds_read_b64_tr_b16 v[136:137], v228 offset:0
v_mfma_f32_16x16x32_bf16 v[80:83], v[160:163], v[124:127], v[80:83]
ds_read_b64_tr_b16 v[138:139], v228 offset:1536
v_mfma_f32_16x16x32_bf16 v[12:15], v[164:167], v[112:115], v[12:15]
ds_read_b64_tr_b16 v[140:141], v229 offset:0
v_mfma_f32_16x16x32_bf16 v[36:39], v[164:167], v[116:119], v[36:39]
ds_read_b64_tr_b16 v[142:143], v229 offset:1536
v_mfma_f32_16x16x32_bf16 v[60:63], v[164:167], v[120:123], v[60:63]
v_mfma_f32_16x16x32_bf16 v[84:87], v[164:167], v[124:127], v[84:87]
ds_read_b64_tr_b16 v[144:145], v230 offset:0
v_mfma_f32_16x16x32_bf16 v[16:19], v[168:171], v[112:115], v[16:19]
ds_read_b64_tr_b16 v[146:147], v230 offset:1536
v_mfma_f32_16x16x32_bf16 v[40:43], v[168:171], v[116:119], v[40:43]
ds_read_b64_tr_b16 v[148:149], v231 offset:0
v_mfma_f32_16x16x32_bf16 v[64:67], v[168:171], v[120:123], v[64:67]
ds_read_b64_tr_b16 v[150:151], v231 offset:1536
v_mfma_f32_16x16x32_bf16 v[88:91], v[168:171], v[124:127], v[88:91]
v_mfma_f32_16x16x32_bf16 v[20:23], v[172:175], v[112:115], v[20:23]
v_mfma_f32_16x16x32_bf16 v[44:47], v[172:175], v[116:119], v[44:47]
v_mfma_f32_16x16x32_bf16 v[68:71], v[172:175], v[120:123], v[68:71]
v_mfma_f32_16x16x32_bf16 v[92:95], v[172:175], v[124:127], v[92:95]
s_waitcnt lgkmcnt(0)
v_mfma_f32_16x16x32_bf16 v[0:3], v[128:131], v[96:99], v[0:3]
ds_read_b128 v[112:115], v225 offset:0
v_mfma_f32_16x16x32_bf16 v[24:27], v[128:131], v[100:103], v[24:27]
ds_read_b128 v[116:119], v225 offset:2048
v_mfma_f32_16x16x32_bf16 v[48:51], v[128:131], v[104:107], v[48:51]
ds_read_b128 v[120:123], v225 offset:4096
v_mfma_f32_16x16x32_bf16 v[72:75], v[128:131], v[108:111], v[72:75]
ds_read_b128 v[124:127], v225 offset:6144
v_mfma_f32_16x16x32_bf16 v[4:7], v[132:135], v[96:99], v[4:7]
v_mfma_f32_16x16x32_bf16 v[28:31], v[132:135], v[100:103], v[28:31]
ds_read_b64_tr_b16 v[152:153], v226 offset:12288
v_mfma_f32_16x16x32_bf16 v[52:55], v[132:135], v[104:107], v[52:55]
ds_read_b64_tr_b16 v[154:155], v226 offset:13824
v_mfma_f32_16x16x32_bf16 v[76:79], v[132:135], v[108:111], v[76:79]
ds_read_b64_tr_b16 v[156:157], v227 offset:12288
v_mfma_f32_16x16x32_bf16 v[8:11], v[136:139], v[96:99], v[8:11]
ds_read_b64_tr_b16 v[158:159], v227 offset:13824
v_mfma_f32_16x16x32_bf16 v[32:35], v[136:139], v[100:103], v[32:35]
v_mfma_f32_16x16x32_bf16 v[56:59], v[136:139], v[104:107], v[56:59]
ds_read_b64_tr_b16 v[160:161], v228 offset:12288
v_mfma_f32_16x16x32_bf16 v[80:83], v[136:139], v[108:111], v[80:83]
ds_read_b64_tr_b16 v[162:163], v228 offset:13824
v_mfma_f32_16x16x32_bf16 v[12:15], v[140:143], v[96:99], v[12:15]
ds_read_b64_tr_b16 v[164:165], v229 offset:12288
v_mfma_f32_16x16x32_bf16 v[36:39], v[140:143], v[100:103], v[36:39]
ds_read_b64_tr_b16 v[166:167], v229 offset:13824
v_mfma_f32_16x16x32_bf16 v[60:63], v[140:143], v[104:107], v[60:63]
v_mfma_f32_16x16x32_bf16 v[84:87], v[140:143], v[108:111], v[84:87]
ds_read_b64_tr_b16 v[168:169], v230 offset:12288
v_mfma_f32_16x16x32_bf16 v[16:19], v[144:147], v[96:99], v[16:19]
ds_read_b64_tr_b16 v[170:171], v230 offset:13824
v_mfma_f32_16x16x32_bf16 v[40:43], v[144:147], v[100:103], v[40:43]
ds_read_b64_tr_b16 v[172:173], v231 offset:12288
v_mfma_f32_16x16x32_bf16 v[64:67], v[144:147], v[104:107], v[64:67]
ds_read_b64_tr_b16 v[174:175], v231 offset:13824
v_mfma_f32_16x16x32_bf16 v[88:91], v[144:147], v[108:111], v[88:91]
v_mfma_f32_16x16x32_bf16 v[20:23], v[148:151], v[96:99], v[20:23]
v_mfma_f32_16x16x32_bf16 v[44:47], v[148:151], v[100:103], v[44:47]
v_mfma_f32_16x16x32_bf16 v[68:71], v[148:151], v[104:107], v[68:71]
v_mfma_f32_16x16x32_bf16 v[92:95], v[148:151], v[108:111], v[92:95]
s_waitcnt lgkmcnt(0)
s_barrier
v_mfma_f32_16x16x32_bf16 v[0:3], v[152:155], v[112:115], v[0:3]
ds_read_b128 v[96:99], v224 offset:16384
v_mfma_f32_16x16x32_bf16 v[24:27], v[152:155], v[116:119], v[24:27]
ds_read_b128 v[100:103], v224 offset:18432
v_mfma_f32_16x16x32_bf16 v[48:51], v[152:155], v[120:123], v[48:51]
ds_read_b128 v[104:107], v224 offset:20480
v_mfma_f32_16x16x32_bf16 v[72:75], v[152:155], v[124:127], v[72:75]
ds_read_b128 v[108:111], v224 offset:22528
v_mfma_f32_16x16x32_bf16 v[4:7], v[156:159], v[112:115], v[4:7]
v_mfma_f32_16x16x32_bf16 v[28:31], v[156:159], v[116:119], v[28:31]
ds_read_b64_tr_b16 v[128:129], v226 offset:24576
v_mfma_f32_16x16x32_bf16 v[52:55], v[156:159], v[120:123], v[52:55]
ds_read_b64_tr_b16 v[130:131], v226 offset:26112
v_mfma_f32_16x16x32_bf16 v[76:79], v[156:159], v[124:127], v[76:79]
ds_read_b64_tr_b16 v[132:133], v227 offset:24576
v_mfma_f32_16x16x32_bf16 v[8:11], v[160:163], v[112:115], v[8:11]
ds_read_b64_tr_b16 v[134:135], v227 offset:26112
v_mfma_f32_16x16x32_bf16 v[32:35], v[160:163], v[116:119], v[32:35]
v_mfma_f32_16x16x32_bf16 v[56:59], v[160:163], v[120:123], v[56:59]
ds_read_b64_tr_b16 v[136:137], v228 offset:24576
v_mfma_f32_16x16x32_bf16 v[80:83], v[160:163], v[124:127], v[80:83]
ds_read_b64_tr_b16 v[138:139], v228 offset:26112
v_mfma_f32_16x16x32_bf16 v[12:15], v[164:167], v[112:115], v[12:15]
ds_read_b64_tr_b16 v[140:141], v229 offset:24576
v_mfma_f32_16x16x32_bf16 v[36:39], v[164:167], v[116:119], v[36:39]
ds_read_b64_tr_b16 v[142:143], v229 offset:26112
v_mfma_f32_16x16x32_bf16 v[60:63], v[164:167], v[120:123], v[60:63]
v_mfma_f32_16x16x32_bf16 v[84:87], v[164:167], v[124:127], v[84:87]
ds_read_b64_tr_b16 v[144:145], v230 offset:24576
v_mfma_f32_16x16x32_bf16 v[16:19], v[168:171], v[112:115], v[16:19]
ds_read_b64_tr_b16 v[146:147], v230 offset:26112
v_mfma_f32_16x16x32_bf16 v[40:43], v[168:171], v[116:119], v[40:43]
ds_read_b64_tr_b16 v[148:149], v231 offset:24576
v_mfma_f32_16x16x32_bf16 v[64:67], v[168:171], v[120:123], v[64:67]
ds_read_b64_tr_b16 v[150:151], v231 offset:26112
v_mfma_f32_16x16x32_bf16 v[88:91], v[168:171], v[124:127], v[88:91]
v_mfma_f32_16x16x32_bf16 v[20:23], v[172:175], v[112:115], v[20:23]
v_mfma_f32_16x16x32_bf16 v[44:47], v[172:175], v[116:119], v[44:47]
v_mfma_f32_16x16x32_bf16 v[68:71], v[172:175], v[120:123], v[68:71]
v_mfma_f32_16x16x32_bf16 v[92:95], v[172:175], v[124:127], v[92:95]
s_waitcnt lgkmcnt(0)
v_mfma_f32_16x16x32_bf16 v[0:3], v[128:131], v[96:99], v[0:3]
ds_read_b128 v[112:115], v225 offset:16384
v_mfma_f32_16x16x32_bf16 v[24:27], v[128:131], v[100:103], v[24:27]
ds_read_b128 v[116:119], v225 offset:18432
v_mfma_f32_16x16x32_bf16 v[48:51], v[128:131], v[104:107], v[48:51]
ds_read_b128 v[120:123], v225 offset:20480
v_mfma_f32_16x16x32_bf16 v[72:75], v[128:131], v[108:111], v[72:75]
ds_read_b128 v[124:127], v225 offset:22528
v_mfma_f32_16x16x32_bf16 v[4:7], v[132:135], v[96:99], v[4:7]
v_mfma_f32_16x16x32_bf16 v[28:31], v[132:135], v[100:103], v[28:31]
ds_read_b64_tr_b16 v[152:153], v226 offset:36864
v_mfma_f32_16x16x32_bf16 v[52:55], v[132:135], v[104:107], v[52:55]
ds_read_b64_tr_b16 v[154:155], v226 offset:38400
v_mfma_f32_16x16x32_bf16 v[76:79], v[132:135], v[108:111], v[76:79]
ds_read_b64_tr_b16 v[156:157], v227 offset:36864
v_mfma_f32_16x16x32_bf16 v[8:11], v[136:139], v[96:99], v[8:11]
ds_read_b64_tr_b16 v[158:159], v227 offset:38400
v_mfma_f32_16x16x32_bf16 v[32:35], v[136:139], v[100:103], v[32:35]
v_mfma_f32_16x16x32_bf16 v[56:59], v[136:139], v[104:107], v[56:59]
ds_read_b64_tr_b16 v[160:161], v228 offset:36864
v_mfma_f32_16x16x32_bf16 v[80:83], v[136:139], v[108:111], v[80:83]
ds_read_b64_tr_b16 v[162:163], v228 offset:38400
v_mfma_f32_16x16x32_bf16 v[12:15], v[140:143], v[96:99], v[12:15]
ds_read_b64_tr_b16 v[164:165], v229 offset:36864
v_mfma_f32_16x16x32_bf16 v[36:39], v[140:143], v[100:103], v[36:39]
ds_read_b64_tr_b16 v[166:167], v229 offset:38400
v_mfma_f32_16x16x32_bf16 v[60:63], v[140:143], v[104:107], v[60:63]
v_mfma_f32_16x16x32_bf16 v[84:87], v[140:143], v[108:111], v[84:87]
ds_read_b64_tr_b16 v[168:169], v230 offset:36864
v_mfma_f32_16x16x32_bf16 v[16:19], v[144:147], v[96:99], v[16:19]
ds_read_b64_tr_b16 v[170:171], v230 offset:38400
v_mfma_f32_16x16x32_bf16 v[40:43], v[144:147], v[100:103], v[40:43]
ds_read_b64_tr_b16 v[172:173], v231 offset:36864
v_mfma_f32_16x16x32_bf16 v[64:67], v[144:147], v[104:107], v[64:67]
ds_read_b64_tr_b16 v[174:175], v231 offset:38400
v_mfma_f32_16x16x32_bf16 v[88:91], v[144:147], v[108:111], v[88:91]
v_mfma_f32_16x16x32_bf16 v[20:23], v[148:151], v[96:99], v[20:23]
v_mfma_f32_16x16x32_bf16 v[44:47], v[148:151], v[100:103], v[44:47]
v_mfma_f32_16x16x32_bf16 v[68:71], v[148:151], v[104:107], v[68:71]
v_mfma_f32_16x16x32_bf16 v[92:95], v[148:151], v[108:111], v[92:95]
s_waitcnt lgkmcnt(0)
s_barrier
v_mfma_f32_16x16x32_bf16 v[0:3], v[152:155], v[112:115], v[0:3]
ds_read_b128 v[96:99], v224 offset:32768
v_mfma_f32_16x16x32_bf16 v[24:27], v[152:155], v[116:119], v[24:27]
ds_read_b128 v[100:103], v224 offset:34816
v_mfma_f32_16x16x32_bf16 v[48:51], v[152:155], v[120:123], v[48:51]
ds_read_b128 v[104:107], v224 offset:36864
v_mfma_f32_16x16x32_bf16 v[72:75], v[152:155], v[124:127], v[72:75]
ds_read_b128 v[108:111], v224 offset:38912
v_mfma_f32_16x16x32_bf16 v[4:7], v[156:159], v[112:115], v[4:7]
v_mfma_f32_16x16x32_bf16 v[28:31], v[156:159], v[116:119], v[28:31]
ds_read_b64_tr_b16 v[128:129], v232 offset:0
v_mfma_f32_16x16x32_bf16 v[52:55], v[156:159], v[120:123], v[52:55]
ds_read_b64_tr_b16 v[130:131], v232 offset:1536
v_mfma_f32_16x16x32_bf16 v[76:79], v[156:159], v[124:127], v[76:79]
ds_read_b64_tr_b16 v[132:133], v233 offset:0
v_mfma_f32_16x16x32_bf16 v[8:11], v[160:163], v[112:115], v[8:11]
ds_read_b64_tr_b16 v[134:135], v233 offset:1536
v_mfma_f32_16x16x32_bf16 v[32:35], v[160:163], v[116:119], v[32:35]
v_mfma_f32_16x16x32_bf16 v[56:59], v[160:163], v[120:123], v[56:59]
ds_read_b64_tr_b16 v[136:137], v234 offset:0
v_mfma_f32_16x16x32_bf16 v[80:83], v[160:163], v[124:127], v[80:83]
ds_read_b64_tr_b16 v[138:139], v234 offset:1536
v_mfma_f32_16x16x32_bf16 v[12:15], v[164:167], v[112:115], v[12:15]
ds_read_b64_tr_b16 v[140:141], v235 offset:0
v_mfma_f32_16x16x32_bf16 v[36:39], v[164:167], v[116:119], v[36:39]
ds_read_b64_tr_b16 v[142:143], v235 offset:1536
v_mfma_f32_16x16x32_bf16 v[60:63], v[164:167], v[120:123], v[60:63]
v_mfma_f32_16x16x32_bf16 v[84:87], v[164:167], v[124:127], v[84:87]
ds_read_b64_tr_b16 v[144:145], v236 offset:0
v_mfma_f32_16x16x32_bf16 v[16:19], v[168:171], v[112:115], v[16:19]
ds_read_b64_tr_b16 v[146:147], v236 offset:1536
v_mfma_f32_16x16x32_bf16 v[40:43], v[168:171], v[116:119], v[40:43]
ds_read_b64_tr_b16 v[148:149], v237 offset:0
v_mfma_f32_16x16x32_bf16 v[64:67], v[168:171], v[120:123], v[64:67]
ds_read_b64_tr_b16 v[150:151], v237 offset:1536
v_mfma_f32_16x16x32_bf16 v[88:91], v[168:171], v[124:127], v[88:91]
v_mfma_f32_16x16x32_bf16 v[20:23], v[172:175], v[112:115], v[20:23]
v_mfma_f32_16x16x32_bf16 v[44:47], v[172:175], v[116:119], v[44:47]
v_mfma_f32_16x16x32_bf16 v[68:71], v[172:175], v[120:123], v[68:71]
v_mfma_f32_16x16x32_bf16 v[92:95], v[172:175], v[124:127], v[92:95]
s_waitcnt lgkmcnt(0)
v_mfma_f32_16x16x32_bf16 v[0:3], v[128:131], v[96:99], v[0:3]
ds_read_b128 v[112:115], v225 offset:32768
v_mfma_f32_16x16x32_bf16 v[24:27], v[128:131], v[100:103], v[24:27]
ds_read_b128 v[116:119], v225 offset:34816
v_mfma_f32_16x16x32_bf16 v[48:51], v[128:131], v[104:107], v[48:51]
ds_read_b128 v[120:123], v225 offset:36864
v_mfma_f32_16x16x32_bf16 v[72:75], v[128:131], v[108:111], v[72:75]
ds_read_b128 v[124:127], v225 offset:38912
v_mfma_f32_16x16x32_bf16 v[4:7], v[132:135], v[96:99], v[4:7]
v_mfma_f32_16x16x32_bf16 v[28:31], v[132:135], v[100:103], v[28:31]
ds_read_b64_tr_b16 v[152:153], v232 offset:12288
v_mfma_f32_16x16x32_bf16 v[52:55], v[132:135], v[104:107], v[52:55]
ds_read_b64_tr_b16 v[154:155], v232 offset:13824
v_mfma_f32_16x16x32_bf16 v[76:79], v[132:135], v[108:111], v[76:79]
ds_read_b64_tr_b16 v[156:157], v233 offset:12288
v_mfma_f32_16x16x32_bf16 v[8:11], v[136:139], v[96:99], v[8:11]
ds_read_b64_tr_b16 v[158:159], v233 offset:13824
v_mfma_f32_16x16x32_bf16 v[32:35], v[136:139], v[100:103], v[32:35]
v_mfma_f32_16x16x32_bf16 v[56:59], v[136:139], v[104:107], v[56:59]
ds_read_b64_tr_b16 v[160:161], v234 offset:12288
v_mfma_f32_16x16x32_bf16 v[80:83], v[136:139], v[108:111], v[80:83]
ds_read_b64_tr_b16 v[162:163], v234 offset:13824
v_mfma_f32_16x16x32_bf16 v[12:15], v[140:143], v[96:99], v[12:15]
ds_read_b64_tr_b16 v[164:165], v235 offset:12288
v_mfma_f32_16x16x32_bf16 v[36:39], v[140:143], v[100:103], v[36:39]
ds_read_b64_tr_b16 v[166:167], v235 offset:13824
v_mfma_f32_16x16x32_bf16 v[60:63], v[140:143], v[104:107], v[60:63]
v_mfma_f32_16x16x32_bf16 v[84:87], v[140:143], v[108:111], v[84:87]
ds_read_b64_tr_b16 v[168:169], v236 offset:12288
v_mfma_f32_16x16x32_bf16 v[16:19], v[144:147], v[96:99], v[16:19]
ds_read_b64_tr_b16 v[170:171], v236 offset:13824
v_mfma_f32_16x16x32_bf16 v[40:43], v[144:147], v[100:103], v[40:43]
ds_read_b64_tr_b16 v[172:173], v237 offset:12288
v_mfma_f32_16x16x32_bf16 v[64:67], v[144:147], v[104:107], v[64:67]
ds_read_b64_tr_b16 v[174:175], v237 offset:13824
v_mfma_f32_16x16x32_bf16 v[88:91], v[144:147], v[108:111], v[88:91]
v_mfma_f32_16x16x32_bf16 v[20:23], v[148:151], v[96:99], v[20:23]
v_mfma_f32_16x16x32_bf16 v[44:47], v[148:151], v[100:103], v[44:47]
v_mfma_f32_16x16x32_bf16 v[68:71], v[148:151], v[104:107], v[68:71]
v_mfma_f32_16x16x32_bf16 v[92:95], v[148:151], v[108:111], v[92:95]
s_waitcnt lgkmcnt(0)
s_barrier
v_mfma_f32_16x16x32_bf16 v[0:3], v[152:155], v[112:115], v[0:3]
ds_read_b128 v[96:99], v224 offset:0
v_mfma_f32_16x16x32_bf16 v[24:27], v[152:155], v[116:119], v[24:27]
ds_read_b128 v[100:103], v224 offset:2048
v_mfma_f32_16x16x32_bf16 v[48:51], v[152:155], v[120:123], v[48:51]
ds_read_b128 v[104:107], v224 offset:4096
v_mfma_f32_16x16x32_bf16 v[72:75], v[152:155], v[124:127], v[72:75]
ds_read_b128 v[108:111], v224 offset:6144
v_mfma_f32_16x16x32_bf16 v[4:7], v[156:159], v[112:115], v[4:7]
v_mfma_f32_16x16x32_bf16 v[28:31], v[156:159], v[116:119], v[28:31]
ds_read_b64_tr_b16 v[128:129], v232 offset:24576
v_mfma_f32_16x16x32_bf16 v[52:55], v[156:159], v[120:123], v[52:55]
ds_read_b64_tr_b16 v[130:131], v232 offset:26112
v_mfma_f32_16x16x32_bf16 v[76:79], v[156:159], v[124:127], v[76:79]
ds_read_b64_tr_b16 v[132:133], v233 offset:24576
v_mfma_f32_16x16x32_bf16 v[8:11], v[160:163], v[112:115], v[8:11]
ds_read_b64_tr_b16 v[134:135], v233 offset:26112
v_mfma_f32_16x16x32_bf16 v[32:35], v[160:163], v[116:119], v[32:35]
v_mfma_f32_16x16x32_bf16 v[56:59], v[160:163], v[120:123], v[56:59]
ds_read_b64_tr_b16 v[136:137], v234 offset:24576
v_mfma_f32_16x16x32_bf16 v[80:83], v[160:163], v[124:127], v[80:83]
ds_read_b64_tr_b16 v[138:139], v234 offset:26112
v_mfma_f32_16x16x32_bf16 v[12:15], v[164:167], v[112:115], v[12:15]
ds_read_b64_tr_b16 v[140:141], v235 offset:24576
v_mfma_f32_16x16x32_bf16 v[36:39], v[164:167], v[116:119], v[36:39]
ds_read_b64_tr_b16 v[142:143], v235 offset:26112
v_mfma_f32_16x16x32_bf16 v[60:63], v[164:167], v[120:123], v[60:63]
v_mfma_f32_16x16x32_bf16 v[84:87], v[164:167], v[124:127], v[84:87]
ds_read_b64_tr_b16 v[144:145], v236 offset:24576
v_mfma_f32_16x16x32_bf16 v[16:19], v[168:171], v[112:115], v[16:19]
ds_read_b64_tr_b16 v[146:147], v236 offset:26112
v_mfma_f32_16x16x32_bf16 v[40:43], v[168:171], v[116:119], v[40:43]
ds_read_b64_tr_b16 v[148:149], v237 offset:24576
v_mfma_f32_16x16x32_bf16 v[64:67], v[168:171], v[120:123], v[64:67]
ds_read_b64_tr_b16 v[150:151], v237 offset:26112
v_mfma_f32_16x16x32_bf16 v[88:91], v[168:171], v[124:127], v[88:91]
v_mfma_f32_16x16x32_bf16 v[20:23], v[172:175], v[112:115], v[20:23]
v_mfma_f32_16x16x32_bf16 v[44:47], v[172:175], v[116:119], v[44:47]
v_mfma_f32_16x16x32_bf16 v[68:71], v[172:175], v[120:123], v[68:71]
v_mfma_f32_16x16x32_bf16 v[92:95], v[172:175], v[124:127], v[92:95]
s_waitcnt lgkmcnt(0)
v_mfma_f32_16x16x32_bf16 v[0:3], v[128:131], v[96:99], v[0:3]
ds_read_b128 v[112:115], v225 offset:0
v_mfma_f32_16x16x32_bf16 v[24:27], v[128:131], v[100:103], v[24:27]
ds_read_b128 v[116:119], v225 offset:2048
v_mfma_f32_16x16x32_bf16 v[48:51], v[128:131], v[104:107], v[48:51]
ds_read_b128 v[120:123], v225 offset:4096
v_mfma_f32_16x16x32_bf16 v[72:75], v[128:131], v[108:111], v[72:75]
ds_read_b128 v[124:127], v225 offset:6144
v_mfma_f32_16x16x32_bf16 v[4:7], v[132:135], v[96:99], v[4:7]
v_mfma_f32_16x16x32_bf16 v[28:31], v[132:135], v[100:103], v[28:31]
ds_read_b64_tr_b16 v[152:153], v232 offset:36864
v_mfma_f32_16x16x32_bf16 v[52:55], v[132:135], v[104:107], v[52:55]
ds_read_b64_tr_b16 v[154:155], v232 offset:38400
v_mfma_f32_16x16x32_bf16 v[76:79], v[132:135], v[108:111], v[76:79]
ds_read_b64_tr_b16 v[156:157], v233 offset:36864
v_mfma_f32_16x16x32_bf16 v[8:11], v[136:139], v[96:99], v[8:11]
ds_read_b64_tr_b16 v[158:159], v233 offset:38400
v_mfma_f32_16x16x32_bf16 v[32:35], v[136:139], v[100:103], v[32:35]
v_mfma_f32_16x16x32_bf16 v[56:59], v[136:139], v[104:107], v[56:59]
ds_read_b64_tr_b16 v[160:161], v234 offset:36864
v_mfma_f32_16x16x32_bf16 v[80:83], v[136:139], v[108:111], v[80:83]
ds_read_b64_tr_b16 v[162:163], v234 offset:38400
v_mfma_f32_16x16x32_bf16 v[12:15], v[140:143], v[96:99], v[12:15]
ds_read_b64_tr_b16 v[164:165], v235 offset:36864
v_mfma_f32_16x16x32_bf16 v[36:39], v[140:143], v[100:103], v[36:39]
ds_read_b64_tr_b16 v[166:167], v235 offset:38400
v_mfma_f32_16x16x32_bf16 v[60:63], v[140:143], v[104:107], v[60:63]
v_mfma_f32_16x16x32_bf16 v[84:87], v[140:143], v[108:111], v[84:87]
ds_read_b64_tr_b16 v[168:169], v236 offset:36864
v_mfma_f32_16x16x32_bf16 v[16:19], v[144:147], v[96:99], v[16:19]
ds_read_b64_tr_b16 v[170:171], v236 offset:38400
v_mfma_f32_16x16x32_bf16 v[40:43], v[144:147], v[100:103], v[40:43]
ds_read_b64_tr_b16 v[172:173], v237 offset:36864
v_mfma_f32_16x16x32_bf16 v[64:67], v[144:147], v[104:107], v[64:67]
ds_read_b64_tr_b16 v[174:175], v237 offset:38400
v_mfma_f32_16x16x32_bf16 v[88:91], v[144:147], v[108:111], v[88:91]
v_mfma_f32_16x16x32_bf16 v[20:23], v[148:151], v[96:99], v[20:23]
v_mfma_f32_16x16x32_bf16 v[44:47], v[148:151], v[100:103], v[44:47]
v_mfma_f32_16x16x32_bf16 v[68:71], v[148:151], v[104:107], v[68:71]
v_mfma_f32_16x16x32_bf16 v[92:95], v[148:151], v[108:111], v[92:95]
s_waitcnt lgkmcnt(0)
s_barrier
v_mfma_f32_16x16x32_bf16 v[0:3], v[152:155], v[112:115], v[0:3]
ds_read_b128 v[96:99], v224 offset:16384
v_mfma_f32_16x16x32_bf16 v[24:27], v[152:155], v[116:119], v[24:27]
ds_read_b128 v[100:103], v224 offset:18432
v_mfma_f32_16x16x32_bf16 v[48:51], v[152:155], v[120:123], v[48:51]
ds_read_b128 v[104:107], v224 offset:20480
v_mfma_f32_16x16x32_bf16 v[72:75], v[152:155], v[124:127], v[72:75]
ds_read_b128 v[108:111], v224 offset:22528
v_mfma_f32_16x16x32_bf16 v[4:7], v[156:159], v[112:115], v[4:7]
v_mfma_f32_16x16x32_bf16 v[28:31], v[156:159], v[116:119], v[28:31]
ds_read_b64_tr_b16 v[128:129], v226 offset:0
v_mfma_f32_16x16x32_bf16 v[52:55], v[156:159], v[120:123], v[52:55]
ds_read_b64_tr_b16 v[130:131], v226 offset:1536
v_mfma_f32_16x16x32_bf16 v[76:79], v[156:159], v[124:127], v[76:79]
ds_read_b64_tr_b16 v[132:133], v227 offset:0
v_mfma_f32_16x16x32_bf16 v[8:11], v[160:163], v[112:115], v[8:11]
ds_read_b64_tr_b16 v[134:135], v227 offset:1536
v_mfma_f32_16x16x32_bf16 v[32:35], v[160:163], v[116:119], v[32:35]
v_mfma_f32_16x16x32_bf16 v[56:59], v[160:163], v[120:123], v[56:59]
ds_read_b64_tr_b16 v[136:137], v228 offset:0
v_mfma_f32_16x16x32_bf16 v[80:83], v[160:163], v[124:127], v[80:83]
ds_read_b64_tr_b16 v[138:139], v228 offset:1536
v_mfma_f32_16x16x32_bf16 v[12:15], v[164:167], v[112:115], v[12:15]
ds_read_b64_tr_b16 v[140:141], v229 offset:0
v_mfma_f32_16x16x32_bf16 v[36:39], v[164:167], v[116:119], v[36:39]
ds_read_b64_tr_b16 v[142:143], v229 offset:1536
v_mfma_f32_16x16x32_bf16 v[60:63], v[164:167], v[120:123], v[60:63]
v_mfma_f32_16x16x32_bf16 v[84:87], v[164:167], v[124:127], v[84:87]
ds_read_b64_tr_b16 v[144:145], v230 offset:0
v_mfma_f32_16x16x32_bf16 v[16:19], v[168:171], v[112:115], v[16:19]
ds_read_b64_tr_b16 v[146:147], v230 offset:1536
v_mfma_f32_16x16x32_bf16 v[40:43], v[168:171], v[116:119], v[40:43]
ds_read_b64_tr_b16 v[148:149], v231 offset:0
v_mfma_f32_16x16x32_bf16 v[64:67], v[168:171], v[120:123], v[64:67]
ds_read_b64_tr_b16 v[150:151], v231 offset:1536
v_mfma_f32_16x16x32_bf16 v[88:91], v[168:171], v[124:127], v[88:91]
v_mfma_f32_16x16x32_bf16 v[20:23], v[172:175], v[112:115], v[20:23]
v_mfma_f32_16x16x32_bf16 v[44:47], v[172:175], v[116:119], v[44:47]
v_mfma_f32_16x16x32_bf16 v[68:71], v[172:175], v[120:123], v[68:71]
v_mfma_f32_16x16x32_bf16 v[92:95], v[172:175], v[124:127], v[92:95]
s_waitcnt lgkmcnt(0)
v_mfma_f32_16x16x32_bf16 v[0:3], v[128:131], v[96:99], v[0:3]
ds_read_b128 v[112:115], v225 offset:16384
v_mfma_f32_16x16x32_bf16 v[24:27], v[128:131], v[100:103], v[24:27]
ds_read_b128 v[116:119], v225 offset:18432
v_mfma_f32_16x16x32_bf16 v[48:51], v[128:131], v[104:107], v[48:51]
ds_read_b128 v[120:123], v225 offset:20480
v_mfma_f32_16x16x32_bf16 v[72:75], v[128:131], v[108:111], v[72:75]
ds_read_b128 v[124:127], v225 offset:22528
v_mfma_f32_16x16x32_bf16 v[4:7], v[132:135], v[96:99], v[4:7]
v_mfma_f32_16x16x32_bf16 v[28:31], v[132:135], v[100:103], v[28:31]
ds_read_b64_tr_b16 v[152:153], v226 offset:12288
v_mfma_f32_16x16x32_bf16 v[52:55], v[132:135], v[104:107], v[52:55]
ds_read_b64_tr_b16 v[154:155], v226 offset:13824
v_mfma_f32_16x16x32_bf16 v[76:79], v[132:135], v[108:111], v[76:79]
ds_read_b64_tr_b16 v[156:157], v227 offset:12288
v_mfma_f32_16x16x32_bf16 v[8:11], v[136:139], v[96:99], v[8:11]
ds_read_b64_tr_b16 v[158:159], v227 offset:13824
v_mfma_f32_16x16x32_bf16 v[32:35], v[136:139], v[100:103], v[32:35]
v_mfma_f32_16x16x32_bf16 v[56:59], v[136:139], v[104:107], v[56:59]
ds_read_b64_tr_b16 v[160:161], v228 offset:12288
v_mfma_f32_16x16x32_bf16 v[80:83], v[136:139], v[108:111], v[80:83]
ds_read_b64_tr_b16 v[162:163], v228 offset:13824
v_mfma_f32_16x16x32_bf16 v[12:15], v[140:143], v[96:99], v[12:15]
ds_read_b64_tr_b16 v[164:165], v229 offset:12288
v_mfma_f32_16x16x32_bf16 v[36:39], v[140:143], v[100:103], v[36:39]
ds_read_b64_tr_b16 v[166:167], v229 offset:13824
v_mfma_f32_16x16x32_bf16 v[60:63], v[140:143], v[104:107], v[60:63]
v_mfma_f32_16x16x32_bf16 v[84:87], v[140:143], v[108:111], v[84:87]
ds_read_b64_tr_b16 v[168:169], v230 offset:12288
v_mfma_f32_16x16x32_bf16 v[16:19], v[144:147], v[96:99], v[16:19]
ds_read_b64_tr_b16 v[170:171], v230 offset:13824
v_mfma_f32_16x16x32_bf16 v[40:43], v[144:147], v[100:103], v[40:43]
ds_read_b64_tr_b16 v[172:173], v231 offset:12288
v_mfma_f32_16x16x32_bf16 v[64:67], v[144:147], v[104:107], v[64:67]
ds_read_b64_tr_b16 v[174:175], v231 offset:13824
v_mfma_f32_16x16x32_bf16 v[88:91], v[144:147], v[108:111], v[88:91]
v_mfma_f32_16x16x32_bf16 v[20:23], v[148:151], v[96:99], v[20:23]
v_mfma_f32_16x16x32_bf16 v[44:47], v[148:151], v[100:103], v[44:47]
v_mfma_f32_16x16x32_bf16 v[68:71], v[148:151], v[104:107], v[68:71]
v_mfma_f32_16x16x32_bf16 v[92:95], v[148:151], v[108:111], v[92:95]
s_waitcnt lgkmcnt(0)
s_barrier
v_mfma_f32_16x16x32_bf16 v[0:3], v[152:155], v[112:115], v[0:3]
ds_read_b128 v[96:99], v224 offset:32768
v_mfma_f32_16x16x32_bf16 v[24:27], v[152:155], v[116:119], v[24:27]
ds_read_b128 v[100:103], v224 offset:34816
v_mfma_f32_16x16x32_bf16 v[48:51], v[152:155], v[120:123], v[48:51]
ds_read_b128 v[104:107], v224 offset:36864
v_mfma_f32_16x16x32_bf16 v[72:75], v[152:155], v[124:127], v[72:75]
ds_read_b128 v[108:111], v224 offset:38912
v_mfma_f32_16x16x32_bf16 v[4:7], v[156:159], v[112:115], v[4:7]
v_mfma_f32_16x16x32_bf16 v[28:31], v[156:159], v[116:119], v[28:31]
ds_read_b64_tr_b16 v[128:129], v226 offset:24576
v_mfma_f32_16x16x32_bf16 v[52:55], v[156:159], v[120:123], v[52:55]
ds_read_b64_tr_b16 v[130:131], v226 offset:26112
v_mfma_f32_16x16x32_bf16 v[76:79], v[156:159], v[124:127], v[76:79]
ds_read_b64_tr_b16 v[132:133], v227 offset:24576
v_mfma_f32_16x16x32_bf16 v[8:11], v[160:163], v[112:115], v[8:11]
ds_read_b64_tr_b16 v[134:135], v227 offset:26112
v_mfma_f32_16x16x32_bf16 v[32:35], v[160:163], v[116:119], v[32:35]
v_mfma_f32_16x16x32_bf16 v[56:59], v[160:163], v[120:123], v[56:59]
ds_read_b64_tr_b16 v[136:137], v228 offset:24576
v_mfma_f32_16x16x32_bf16 v[80:83], v[160:163], v[124:127], v[80:83]
ds_read_b64_tr_b16 v[138:139], v228 offset:26112
v_mfma_f32_16x16x32_bf16 v[12:15], v[164:167], v[112:115], v[12:15]
ds_read_b64_tr_b16 v[140:141], v229 offset:24576
v_mfma_f32_16x16x32_bf16 v[36:39], v[164:167], v[116:119], v[36:39]
ds_read_b64_tr_b16 v[142:143], v229 offset:26112
v_mfma_f32_16x16x32_bf16 v[60:63], v[164:167], v[120:123], v[60:63]
v_mfma_f32_16x16x32_bf16 v[84:87], v[164:167], v[124:127], v[84:87]
ds_read_b64_tr_b16 v[144:145], v230 offset:24576
v_mfma_f32_16x16x32_bf16 v[16:19], v[168:171], v[112:115], v[16:19]
ds_read_b64_tr_b16 v[146:147], v230 offset:26112
v_mfma_f32_16x16x32_bf16 v[40:43], v[168:171], v[116:119], v[40:43]
ds_read_b64_tr_b16 v[148:149], v231 offset:24576
v_mfma_f32_16x16x32_bf16 v[64:67], v[168:171], v[120:123], v[64:67]
ds_read_b64_tr_b16 v[150:151], v231 offset:26112
v_mfma_f32_16x16x32_bf16 v[88:91], v[168:171], v[124:127], v[88:91]
v_mfma_f32_16x16x32_bf16 v[20:23], v[172:175], v[112:115], v[20:23]
v_mfma_f32_16x16x32_bf16 v[44:47], v[172:175], v[116:119], v[44:47]
v_mfma_f32_16x16x32_bf16 v[68:71], v[172:175], v[120:123], v[68:71]
v_mfma_f32_16x16x32_bf16 v[92:95], v[172:175], v[124:127], v[92:95]
s_waitcnt lgkmcnt(0)
v_mfma_f32_16x16x32_bf16 v[0:3], v[128:131], v[96:99], v[0:3]
ds_read_b128 v[112:115], v225 offset:32768
v_mfma_f32_16x16x32_bf16 v[24:27], v[128:131], v[100:103], v[24:27]
ds_read_b128 v[116:119], v225 offset:34816
v_mfma_f32_16x16x32_bf16 v[48:51], v[128:131], v[104:107], v[48:51]
ds_read_b128 v[120:123], v225 offset:36864
v_mfma_f32_16x16x32_bf16 v[72:75], v[128:131], v[108:111], v[72:75]
ds_read_b128 v[124:127], v225 offset:38912
v_mfma_f32_16x16x32_bf16 v[4:7], v[132:135], v[96:99], v[4:7]
v_mfma_f32_16x16x32_bf16 v[28:31], v[132:135], v[100:103], v[28:31]
ds_read_b64_tr_b16 v[152:153], v226 offset:36864
v_mfma_f32_16x16x32_bf16 v[52:55], v[132:135], v[104:107], v[52:55]
ds_read_b64_tr_b16 v[154:155], v226 offset:38400
v_mfma_f32_16x16x32_bf16 v[76:79], v[132:135], v[108:111], v[76:79]
ds_read_b64_tr_b16 v[156:157], v227 offset:36864
v_mfma_f32_16x16x32_bf16 v[8:11], v[136:139], v[96:99], v[8:11]
ds_read_b64_tr_b16 v[158:159], v227 offset:38400
v_mfma_f32_16x16x32_bf16 v[32:35], v[136:139], v[100:103], v[32:35]
v_mfma_f32_16x16x32_bf16 v[56:59], v[136:139], v[104:107], v[56:59]
ds_read_b64_tr_b16 v[160:161], v228 offset:36864
v_mfma_f32_16x16x32_bf16 v[80:83], v[136:139], v[108:111], v[80:83]
ds_read_b64_tr_b16 v[162:163], v228 offset:38400
v_mfma_f32_16x16x32_bf16 v[12:15], v[140:143], v[96:99], v[12:15]
ds_read_b64_tr_b16 v[164:165], v229 offset:36864
v_mfma_f32_16x16x32_bf16 v[36:39], v[140:143], v[100:103], v[36:39]
ds_read_b64_tr_b16 v[166:167], v229 offset:38400
v_mfma_f32_16x16x32_bf16 v[60:63], v[140:143], v[104:107], v[60:63]
v_mfma_f32_16x16x32_bf16 v[84:87], v[140:143], v[108:111], v[84:87]
ds_read_b64_tr_b16 v[168:169], v230 offset:36864
v_mfma_f32_16x16x32_bf16 v[16:19], v[144:147], v[96:99], v[16:19]
ds_read_b64_tr_b16 v[170:171], v230 offset:38400
v_mfma_f32_16x16x32_bf16 v[40:43], v[144:147], v[100:103], v[40:43]
ds_read_b64_tr_b16 v[172:173], v231 offset:36864
v_mfma_f32_16x16x32_bf16 v[64:67], v[144:147], v[104:107], v[64:67]
ds_read_b64_tr_b16 v[174:175], v231 offset:38400
v_mfma_f32_16x16x32_bf16 v[88:91], v[144:147], v[108:111], v[88:91]
v_mfma_f32_16x16x32_bf16 v[20:23], v[148:151], v[96:99], v[20:23]
v_mfma_f32_16x16x32_bf16 v[44:47], v[148:151], v[100:103], v[44:47]
v_mfma_f32_16x16x32_bf16 v[68:71], v[148:151], v[104:107], v[68:71]
v_mfma_f32_16x16x32_bf16 v[92:95], v[148:151], v[108:111], v[92:95]
s_waitcnt lgkmcnt(0)
s_barrier
v_mfma_f32_16x16x32_bf16 v[0:3], v[152:155], v[112:115], v[0:3]
ds_read_b128 v[128:131], v240 offset:0
v_mfma_f32_16x16x32_bf16 v[24:27], v[152:155], v[116:119], v[24:27]
ds_read_b128 v[132:135], v240 offset:64
v_mfma_f32_16x16x32_bf16 v[48:51], v[152:155], v[120:123], v[48:51]
ds_read_b128 v[136:139], v240 offset:128
v_mfma_f32_16x16x32_bf16 v[72:75], v[152:155], v[124:127], v[72:75]
ds_read_b128 v[140:143], v240 offset:192
v_mfma_f32_16x16x32_bf16 v[4:7], v[156:159], v[112:115], v[4:7]
v_mfma_f32_16x16x32_bf16 v[28:31], v[156:159], v[116:119], v[28:31]
ds_read_b128 v[144:147], v240 offset:256
v_mfma_f32_16x16x32_bf16 v[52:55], v[156:159], v[120:123], v[52:55]
ds_read_b128 v[148:151], v240 offset:320
v_mfma_f32_16x16x32_bf16 v[76:79], v[156:159], v[124:127], v[76:79]
ds_read_b32 v96, v241 offset:0
v_mfma_f32_16x16x32_bf16 v[8:11], v[160:163], v[112:115], v[8:11]
ds_read_b32 v100, v241 offset:512
v_mfma_f32_16x16x32_bf16 v[32:35], v[160:163], v[116:119], v[32:35]
v_mfma_f32_16x16x32_bf16 v[56:59], v[160:163], v[120:123], v[56:59]
ds_read_b32 v97, v241 offset:16
v_mfma_f32_16x16x32_bf16 v[80:83], v[160:163], v[124:127], v[80:83]
ds_read_b32 v101, v241 offset:528
v_mfma_f32_16x16x32_bf16 v[12:15], v[164:167], v[112:115], v[12:15]
ds_read_b32 v98, v241 offset:128
v_mfma_f32_16x16x32_bf16 v[36:39], v[164:167], v[116:119], v[36:39]
ds_read_b32 v102, v241 offset:640
v_mfma_f32_16x16x32_bf16 v[60:63], v[164:167], v[120:123], v[60:63]
v_mfma_f32_16x16x32_bf16 v[84:87], v[164:167], v[124:127], v[84:87]
ds_read_b32 v99, v241 offset:144
v_mfma_f32_16x16x32_bf16 v[16:19], v[168:171], v[112:115], v[16:19]
ds_read_b32 v103, v241 offset:656
v_mfma_f32_16x16x32_bf16 v[40:43], v[168:171], v[116:119], v[40:43]
v_mfma_f32_16x16x32_bf16 v[64:67], v[168:171], v[120:123], v[64:67]
v_mfma_f32_16x16x32_bf16 v[88:91], v[168:171], v[124:127], v[88:91]
v_mfma_f32_16x16x32_bf16 v[20:23], v[172:175], v[112:115], v[20:23]
v_mfma_f32_16x16x32_bf16 v[44:47], v[172:175], v[116:119], v[44:47]
v_mfma_f32_16x16x32_bf16 v[68:71], v[172:175], v[120:123], v[68:71]
v_mfma_f32_16x16x32_bf16 v[92:95], v[172:175], v[124:127], v[92:95]
s_waitcnt lgkmcnt(0)
s_nop 7
v_pk_mul_f32 v[0:1], v[0:1], v[96:97] op_sel:[0,0] op_sel_hi:[1,0]
v_pk_mul_f32 v[2:3], v[2:3], v[96:97] op_sel:[0,0] op_sel_hi:[1,0]
v_pk_mul_f32 v[4:5], v[4:5], v[96:97] op_sel:[0,0] op_sel_hi:[1,0]
v_pk_mul_f32 v[6:7], v[6:7], v[96:97] op_sel:[0,0] op_sel_hi:[1,0]
v_pk_mul_f32 v[24:25], v[24:25], v[96:97] op_sel:[0,1] op_sel_hi:[1,1]
v_pk_mul_f32 v[26:27], v[26:27], v[96:97] op_sel:[0,1] op_sel_hi:[1,1]
v_pk_mul_f32 v[28:29], v[28:29], v[96:97] op_sel:[0,1] op_sel_hi:[1,1]
v_pk_mul_f32 v[30:31], v[30:31], v[96:97] op_sel:[0,1] op_sel_hi:[1,1]
v_pk_fma_f32 v[0:1], v[128:129], v[100:101], v[0:1] op_sel:[0,0,0] op_sel_hi:[1,0,1]
v_pk_fma_f32 v[2:3], v[130:131], v[100:101], v[2:3] op_sel:[0,0,0] op_sel_hi:[1,0,1]
v_pk_fma_f32 v[4:5], v[132:133], v[100:101], v[4:5] op_sel:[0,0,0] op_sel_hi:[1,0,1]
v_pk_fma_f32 v[6:7], v[134:135], v[100:101], v[6:7] op_sel:[0,0,0] op_sel_hi:[1,0,1]
v_pk_fma_f32 v[24:25], v[128:129], v[100:101], v[24:25] op_sel:[0,1,0] op_sel_hi:[1,1,1]
v_pk_fma_f32 v[26:27], v[130:131], v[100:101], v[26:27] op_sel:[0,1,0] op_sel_hi:[1,1,1]
v_pk_fma_f32 v[28:29], v[132:133], v[100:101], v[28:29] op_sel:[0,1,0] op_sel_hi:[1,1,1]
v_pk_fma_f32 v[30:31], v[134:135], v[100:101], v[30:31] op_sel:[0,1,0] op_sel_hi:[1,1,1]
v_pk_fma_f32 v[160:161], v[0:1], v[0:1], v[244:245] op_sel_hi:[1,1,0]
v_pk_fma_f32 v[162:163], v[2:3], v[2:3], v[244:245] op_sel_hi:[1,1,0]
v_pk_fma_f32 v[164:165], v[4:5], v[4:5], v[244:245] op_sel_hi:[1,1,0]
v_pk_fma_f32 v[166:167], v[6:7], v[6:7], v[244:245] op_sel_hi:[1,1,0]
v_pk_fma_f32 v[168:169], v[24:25], v[24:25], v[244:245] op_sel_hi:[1,1,0]
v_pk_fma_f32 v[170:171], v[26:27], v[26:27], v[244:245] op_sel_hi:[1,1,0]
v_pk_fma_f32 v[172:173], v[28:29], v[28:29], v[244:245] op_sel_hi:[1,1,0]
v_pk_fma_f32 v[174:175], v[30:31], v[30:31], v[244:245] op_sel_hi:[1,1,0]
v_pk_mul_f32 v[160:161], v[160:161], v[0:1]
v_pk_mul_f32 v[162:163], v[162:163], v[2:3]
v_pk_mul_f32 v[164:165], v[164:165], v[4:5]
v_pk_mul_f32 v[166:167], v[166:167], v[6:7]
v_pk_mul_f32 v[168:169], v[168:169], v[24:25]
v_pk_mul_f32 v[170:171], v[170:171], v[26:27]
v_pk_mul_f32 v[172:173], v[172:173], v[28:29]
v_pk_mul_f32 v[174:175], v[174:175], v[30:31]
v_exp_f32_e64 v160, -v160
v_exp_f32_e64 v161, -v161
v_exp_f32_e64 v162, -v162
v_exp_f32_e64 v163, -v163
v_exp_f32_e64 v164, -v164
v_exp_f32_e64 v165, -v165
v_exp_f32_e64 v166, -v166
v_exp_f32_e64 v167, -v167
v_exp_f32_e64 v168, -v168
v_exp_f32_e64 v169, -v169
v_exp_f32_e64 v170, -v170
v_exp_f32_e64 v171, -v171
v_exp_f32_e64 v172, -v172
v_exp_f32_e64 v173, -v173
v_exp_f32_e64 v174, -v174
v_exp_f32_e64 v175, -v175
v_pk_add_f32 v[160:161], v[160:161], v[246:247] op_sel_hi:[1,0]
v_pk_add_f32 v[162:163], v[162:163], v[246:247] op_sel_hi:[1,0]
v_pk_add_f32 v[164:165], v[164:165], v[246:247] op_sel_hi:[1,0]
v_pk_add_f32 v[166:167], v[166:167], v[246:247] op_sel_hi:[1,0]
v_pk_add_f32 v[168:169], v[168:169], v[246:247] op_sel_hi:[1,0]
v_pk_add_f32 v[170:171], v[170:171], v[246:247] op_sel_hi:[1,0]
v_pk_add_f32 v[172:173], v[172:173], v[246:247] op_sel_hi:[1,0]
v_pk_add_f32 v[174:175], v[174:175], v[246:247] op_sel_hi:[1,0]
v_rcp_f32 v160, v160
v_rcp_f32 v161, v161
v_rcp_f32 v162, v162
v_rcp_f32 v163, v163
v_rcp_f32 v164, v164
v_rcp_f32 v165, v165
v_rcp_f32 v166, v166
v_rcp_f32 v167, v167
v_rcp_f32 v168, v168
v_rcp_f32 v169, v169
v_rcp_f32 v170, v170
v_rcp_f32 v171, v171
v_rcp_f32 v172, v172
v_rcp_f32 v173, v173
v_rcp_f32 v174, v174
v_rcp_f32 v175, v175
v_pk_mul_f32 v[0:1], v[160:161], v[0:1]
v_pk_mul_f32 v[2:3], v[162:163], v[2:3]
v_pk_mul_f32 v[4:5], v[164:165], v[4:5]
v_pk_mul_f32 v[6:7], v[166:167], v[6:7]
v_pk_mul_f32 v[24:25], v[168:169], v[24:25]
v_pk_mul_f32 v[26:27], v[170:171], v[26:27]
v_pk_mul_f32 v[28:29], v[172:173], v[28:29]
v_pk_mul_f32 v[30:31], v[174:175], v[30:31]
v_cvt_pk_bf16_f32 v176, v0, v1
v_cvt_pk_bf16_f32 v177, v2, v3
v_cvt_pk_bf16_f32 v178, v4, v5
v_cvt_pk_bf16_f32 v179, v6, v7
v_cvt_pk_bf16_f32 v188, v24, v25
v_cvt_pk_bf16_f32 v189, v26, v27
v_cvt_pk_bf16_f32 v190, v28, v29
v_cvt_pk_bf16_f32 v191, v30, v31
v_pk_mul_f32 v[48:49], v[48:49], v[98:99] op_sel:[0,0] op_sel_hi:[1,0]
v_pk_mul_f32 v[50:51], v[50:51], v[98:99] op_sel:[0,0] op_sel_hi:[1,0]
v_pk_mul_f32 v[52:53], v[52:53], v[98:99] op_sel:[0,0] op_sel_hi:[1,0]
v_pk_mul_f32 v[54:55], v[54:55], v[98:99] op_sel:[0,0] op_sel_hi:[1,0]
v_pk_mul_f32 v[72:73], v[72:73], v[98:99] op_sel:[0,1] op_sel_hi:[1,1]
v_pk_mul_f32 v[74:75], v[74:75], v[98:99] op_sel:[0,1] op_sel_hi:[1,1]
v_pk_mul_f32 v[76:77], v[76:77], v[98:99] op_sel:[0,1] op_sel_hi:[1,1]
v_pk_mul_f32 v[78:79], v[78:79], v[98:99] op_sel:[0,1] op_sel_hi:[1,1]
v_pk_fma_f32 v[48:49], v[128:129], v[102:103], v[48:49] op_sel:[0,0,0] op_sel_hi:[1,0,1]
v_pk_fma_f32 v[50:51], v[130:131], v[102:103], v[50:51] op_sel:[0,0,0] op_sel_hi:[1,0,1]
v_pk_fma_f32 v[52:53], v[132:133], v[102:103], v[52:53] op_sel:[0,0,0] op_sel_hi:[1,0,1]
v_pk_fma_f32 v[54:55], v[134:135], v[102:103], v[54:55] op_sel:[0,0,0] op_sel_hi:[1,0,1]
v_pk_fma_f32 v[72:73], v[128:129], v[102:103], v[72:73] op_sel:[0,1,0] op_sel_hi:[1,1,1]
v_pk_fma_f32 v[74:75], v[130:131], v[102:103], v[74:75] op_sel:[0,1,0] op_sel_hi:[1,1,1]
v_pk_fma_f32 v[76:77], v[132:133], v[102:103], v[76:77] op_sel:[0,1,0] op_sel_hi:[1,1,1]
v_pk_fma_f32 v[78:79], v[134:135], v[102:103], v[78:79] op_sel:[0,1,0] op_sel_hi:[1,1,1]
v_pk_fma_f32 v[160:161], v[48:49], v[48:49], v[244:245] op_sel_hi:[1,1,0]
v_pk_fma_f32 v[162:163], v[50:51], v[50:51], v[244:245] op_sel_hi:[1,1,0]
v_pk_fma_f32 v[164:165], v[52:53], v[52:53], v[244:245] op_sel_hi:[1,1,0]
v_pk_fma_f32 v[166:167], v[54:55], v[54:55], v[244:245] op_sel_hi:[1,1,0]
v_pk_fma_f32 v[168:169], v[72:73], v[72:73], v[244:245] op_sel_hi:[1,1,0]
v_pk_fma_f32 v[170:171], v[74:75], v[74:75], v[244:245] op_sel_hi:[1,1,0]
v_pk_fma_f32 v[172:173], v[76:77], v[76:77], v[244:245] op_sel_hi:[1,1,0]
v_pk_fma_f32 v[174:175], v[78:79], v[78:79], v[244:245] op_sel_hi:[1,1,0]
v_pk_mul_f32 v[160:161], v[160:161], v[48:49]
v_pk_mul_f32 v[162:163], v[162:163], v[50:51]
v_pk_mul_f32 v[164:165], v[164:165], v[52:53]
v_pk_mul_f32 v[166:167], v[166:167], v[54:55]
v_pk_mul_f32 v[168:169], v[168:169], v[72:73]
v_pk_mul_f32 v[170:171], v[170:171], v[74:75]
v_pk_mul_f32 v[172:173], v[172:173], v[76:77]
v_pk_mul_f32 v[174:175], v[174:175], v[78:79]
v_exp_f32_e64 v160, -v160
v_exp_f32_e64 v161, -v161
v_exp_f32_e64 v162, -v162
v_exp_f32_e64 v163, -v163
v_exp_f32_e64 v164, -v164
v_exp_f32_e64 v165, -v165
v_exp_f32_e64 v166, -v166
v_exp_f32_e64 v167, -v167
v_exp_f32_e64 v168, -v168
v_exp_f32_e64 v169, -v169
v_exp_f32_e64 v170, -v170
v_exp_f32_e64 v171, -v171
v_exp_f32_e64 v172, -v172
v_exp_f32_e64 v173, -v173
v_exp_f32_e64 v174, -v174
v_exp_f32_e64 v175, -v175
v_pk_add_f32 v[160:161], v[160:161], v[246:247] op_sel_hi:[1,0]
v_pk_add_f32 v[162:163], v[162:163], v[246:247] op_sel_hi:[1,0]
v_pk_add_f32 v[164:165], v[164:165], v[246:247] op_sel_hi:[1,0]
v_pk_add_f32 v[166:167], v[166:167], v[246:247] op_sel_hi:[1,0]
v_pk_add_f32 v[168:169], v[168:169], v[246:247] op_sel_hi:[1,0]
v_pk_add_f32 v[170:171], v[170:171], v[246:247] op_sel_hi:[1,0]
v_pk_add_f32 v[172:173], v[172:173], v[246:247] op_sel_hi:[1,0]
v_pk_add_f32 v[174:175], v[174:175], v[246:247] op_sel_hi:[1,0]
v_rcp_f32 v160, v160
v_rcp_f32 v161, v161
v_rcp_f32 v162, v162
v_rcp_f32 v163, v163
v_rcp_f32 v164, v164
v_rcp_f32 v165, v165
v_rcp_f32 v166, v166
v_rcp_f32 v167, v167
v_rcp_f32 v168, v168
v_rcp_f32 v169, v169
v_rcp_f32 v170, v170
v_rcp_f32 v171, v171
v_rcp_f32 v172, v172
v_rcp_f32 v173, v173
v_rcp_f32 v174, v174
v_rcp_f32 v175, v175
v_pk_mul_f32 v[48:49], v[160:161], v[48:49]
v_pk_mul_f32 v[50:51], v[162:163], v[50:51]
v_pk_mul_f32 v[52:53], v[164:165], v[52:53]
v_pk_mul_f32 v[54:55], v[166:167], v[54:55]
v_pk_mul_f32 v[72:73], v[168:169], v[72:73]
v_pk_mul_f32 v[74:75], v[170:171], v[74:75]
v_pk_mul_f32 v[76:77], v[172:173], v[76:77]
v_pk_mul_f32 v[78:79], v[174:175], v[78:79]
v_cvt_pk_bf16_f32 v200, v48, v49
v_cvt_pk_bf16_f32 v201, v50, v51
v_cvt_pk_bf16_f32 v202, v52, v53
v_cvt_pk_bf16_f32 v203, v54, v55
v_cvt_pk_bf16_f32 v212, v72, v73
v_cvt_pk_bf16_f32 v213, v74, v75
v_cvt_pk_bf16_f32 v214, v76, v77
v_cvt_pk_bf16_f32 v215, v78, v79
v_pk_mul_f32 v[8:9], v[8:9], v[96:97] op_sel:[0,0] op_sel_hi:[1,0]
v_pk_mul_f32 v[10:11], v[10:11], v[96:97] op_sel:[0,0] op_sel_hi:[1,0]
v_pk_mul_f32 v[12:13], v[12:13], v[96:97] op_sel:[0,0] op_sel_hi:[1,0]
v_pk_mul_f32 v[14:15], v[14:15], v[96:97] op_sel:[0,0] op_sel_hi:[1,0]
v_pk_mul_f32 v[32:33], v[32:33], v[96:97] op_sel:[0,1] op_sel_hi:[1,1]
v_pk_mul_f32 v[34:35], v[34:35], v[96:97] op_sel:[0,1] op_sel_hi:[1,1]
v_pk_mul_f32 v[36:37], v[36:37], v[96:97] op_sel:[0,1] op_sel_hi:[1,1]
v_pk_mul_f32 v[38:39], v[38:39], v[96:97] op_sel:[0,1] op_sel_hi:[1,1]
v_pk_fma_f32 v[8:9], v[136:137], v[100:101], v[8:9] op_sel:[0,0,0] op_sel_hi:[1,0,1]
v_pk_fma_f32 v[10:11], v[138:139], v[100:101], v[10:11] op_sel:[0,0,0] op_sel_hi:[1,0,1]
v_pk_fma_f32 v[12:13], v[140:141], v[100:101], v[12:13] op_sel:[0,0,0] op_sel_hi:[1,0,1]
v_pk_fma_f32 v[14:15], v[142:143], v[100:101], v[14:15] op_sel:[0,0,0] op_sel_hi:[1,0,1]
v_pk_fma_f32 v[32:33], v[136:137], v[100:101], v[32:33] op_sel:[0,1,0] op_sel_hi:[1,1,1]
v_pk_fma_f32 v[34:35], v[138:139], v[100:101], v[34:35] op_sel:[0,1,0] op_sel_hi:[1,1,1]
v_pk_fma_f32 v[36:37], v[140:141], v[100:101], v[36:37] op_sel:[0,1,0] op_sel_hi:[1,1,1]
v_pk_fma_f32 v[38:39], v[142:143], v[100:101], v[38:39] op_sel:[0,1,0] op_sel_hi:[1,1,1]
v_pk_fma_f32 v[160:161], v[8:9], v[8:9], v[244:245] op_sel_hi:[1,1,0]
v_pk_fma_f32 v[162:163], v[10:11], v[10:11], v[244:245] op_sel_hi:[1,1,0]
v_pk_fma_f32 v[164:165], v[12:13], v[12:13], v[244:245] op_sel_hi:[1,1,0]
v_pk_fma_f32 v[166:167], v[14:15], v[14:15], v[244:245] op_sel_hi:[1,1,0]
v_pk_fma_f32 v[168:169], v[32:33], v[32:33], v[244:245] op_sel_hi:[1,1,0]
v_pk_fma_f32 v[170:171], v[34:35], v[34:35], v[244:245] op_sel_hi:[1,1,0]
v_pk_fma_f32 v[172:173], v[36:37], v[36:37], v[244:245] op_sel_hi:[1,1,0]
v_pk_fma_f32 v[174:175], v[38:39], v[38:39], v[244:245] op_sel_hi:[1,1,0]
v_pk_mul_f32 v[160:161], v[160:161], v[8:9]
v_pk_mul_f32 v[162:163], v[162:163], v[10:11]
v_pk_mul_f32 v[164:165], v[164:165], v[12:13]
v_pk_mul_f32 v[166:167], v[166:167], v[14:15]
v_pk_mul_f32 v[168:169], v[168:169], v[32:33]
v_pk_mul_f32 v[170:171], v[170:171], v[34:35]
v_pk_mul_f32 v[172:173], v[172:173], v[36:37]
v_pk_mul_f32 v[174:175], v[174:175], v[38:39]
v_exp_f32_e64 v160, -v160
v_exp_f32_e64 v161, -v161
v_exp_f32_e64 v162, -v162
v_exp_f32_e64 v163, -v163
v_exp_f32_e64 v164, -v164
v_exp_f32_e64 v165, -v165
v_exp_f32_e64 v166, -v166
v_exp_f32_e64 v167, -v167
v_exp_f32_e64 v168, -v168
v_exp_f32_e64 v169, -v169
v_exp_f32_e64 v170, -v170
v_exp_f32_e64 v171, -v171
v_exp_f32_e64 v172, -v172
v_exp_f32_e64 v173, -v173
v_exp_f32_e64 v174, -v174
v_exp_f32_e64 v175, -v175
v_pk_add_f32 v[160:161], v[160:161], v[246:247] op_sel_hi:[1,0]
v_pk_add_f32 v[162:163], v[162:163], v[246:247] op_sel_hi:[1,0]
v_pk_add_f32 v[164:165], v[164:165], v[246:247] op_sel_hi:[1,0]
v_pk_add_f32 v[166:167], v[166:167], v[246:247] op_sel_hi:[1,0]
v_pk_add_f32 v[168:169], v[168:169], v[246:247] op_sel_hi:[1,0]
v_pk_add_f32 v[170:171], v[170:171], v[246:247] op_sel_hi:[1,0]
v_pk_add_f32 v[172:173], v[172:173], v[246:247] op_sel_hi:[1,0]
v_pk_add_f32 v[174:175], v[174:175], v[246:247] op_sel_hi:[1,0]
v_rcp_f32 v160, v160
v_rcp_f32 v161, v161
v_rcp_f32 v162, v162
v_rcp_f32 v163, v163
v_rcp_f32 v164, v164
v_rcp_f32 v165, v165
v_rcp_f32 v166, v166
v_rcp_f32 v167, v167
v_rcp_f32 v168, v168
v_rcp_f32 v169, v169
v_rcp_f32 v170, v170
v_rcp_f32 v171, v171
v_rcp_f32 v172, v172
v_rcp_f32 v173, v173
v_rcp_f32 v174, v174
v_rcp_f32 v175, v175
v_pk_mul_f32 v[8:9], v[160:161], v[8:9]
v_pk_mul_f32 v[10:11], v[162:163], v[10:11]
v_pk_mul_f32 v[12:13], v[164:165], v[12:13]
v_pk_mul_f32 v[14:15], v[166:167], v[14:15]
v_pk_mul_f32 v[32:33], v[168:169], v[32:33]
v_pk_mul_f32 v[34:35], v[170:171], v[34:35]
v_pk_mul_f32 v[36:37], v[172:173], v[36:37]
v_pk_mul_f32 v[38:39], v[174:175], v[38:39]
v_cvt_pk_bf16_f32 v180, v8, v9
v_cvt_pk_bf16_f32 v181, v10, v11
v_cvt_pk_bf16_f32 v182, v12, v13
v_cvt_pk_bf16_f32 v183, v14, v15
v_cvt_pk_bf16_f32 v192, v32, v33
v_cvt_pk_bf16_f32 v193, v34, v35
v_cvt_pk_bf16_f32 v194, v36, v37
v_cvt_pk_bf16_f32 v195, v38, v39
v_pk_mul_f32 v[56:57], v[56:57], v[98:99] op_sel:[0,0] op_sel_hi:[1,0]
v_pk_mul_f32 v[58:59], v[58:59], v[98:99] op_sel:[0,0] op_sel_hi:[1,0]
v_pk_mul_f32 v[60:61], v[60:61], v[98:99] op_sel:[0,0] op_sel_hi:[1,0]
v_pk_mul_f32 v[62:63], v[62:63], v[98:99] op_sel:[0,0] op_sel_hi:[1,0]
v_pk_mul_f32 v[80:81], v[80:81], v[98:99] op_sel:[0,1] op_sel_hi:[1,1]
v_pk_mul_f32 v[82:83], v[82:83], v[98:99] op_sel:[0,1] op_sel_hi:[1,1]
v_pk_mul_f32 v[84:85], v[84:85], v[98:99] op_sel:[0,1] op_sel_hi:[1,1]
v_pk_mul_f32 v[86:87], v[86:87], v[98:99] op_sel:[0,1] op_sel_hi:[1,1]
v_pk_fma_f32 v[56:57], v[136:137], v[102:103], v[56:57] op_sel:[0,0,0] op_sel_hi:[1,0,1]
v_pk_fma_f32 v[58:59], v[138:139], v[102:103], v[58:59] op_sel:[0,0,0] op_sel_hi:[1,0,1]
v_pk_fma_f32 v[60:61], v[140:141], v[102:103], v[60:61] op_sel:[0,0,0] op_sel_hi:[1,0,1]
v_pk_fma_f32 v[62:63], v[142:143], v[102:103], v[62:63] op_sel:[0,0,0] op_sel_hi:[1,0,1]
v_pk_fma_f32 v[80:81], v[136:137], v[102:103], v[80:81] op_sel:[0,1,0] op_sel_hi:[1,1,1]
v_pk_fma_f32 v[82:83], v[138:139], v[102:103], v[82:83] op_sel:[0,1,0] op_sel_hi:[1,1,1]
v_pk_fma_f32 v[84:85], v[140:141], v[102:103], v[84:85] op_sel:[0,1,0] op_sel_hi:[1,1,1]
v_pk_fma_f32 v[86:87], v[142:143], v[102:103], v[86:87] op_sel:[0,1,0] op_sel_hi:[1,1,1]
v_pk_fma_f32 v[160:161], v[56:57], v[56:57], v[244:245] op_sel_hi:[1,1,0]
v_pk_fma_f32 v[162:163], v[58:59], v[58:59], v[244:245] op_sel_hi:[1,1,0]
v_pk_fma_f32 v[164:165], v[60:61], v[60:61], v[244:245] op_sel_hi:[1,1,0]
v_pk_fma_f32 v[166:167], v[62:63], v[62:63], v[244:245] op_sel_hi:[1,1,0]
v_pk_fma_f32 v[168:169], v[80:81], v[80:81], v[244:245] op_sel_hi:[1,1,0]
v_pk_fma_f32 v[170:171], v[82:83], v[82:83], v[244:245] op_sel_hi:[1,1,0]
v_pk_fma_f32 v[172:173], v[84:85], v[84:85], v[244:245] op_sel_hi:[1,1,0]
v_pk_fma_f32 v[174:175], v[86:87], v[86:87], v[244:245] op_sel_hi:[1,1,0]
v_pk_mul_f32 v[160:161], v[160:161], v[56:57]
v_pk_mul_f32 v[162:163], v[162:163], v[58:59]
v_pk_mul_f32 v[164:165], v[164:165], v[60:61]
v_pk_mul_f32 v[166:167], v[166:167], v[62:63]
v_pk_mul_f32 v[168:169], v[168:169], v[80:81]
v_pk_mul_f32 v[170:171], v[170:171], v[82:83]
v_pk_mul_f32 v[172:173], v[172:173], v[84:85]
v_pk_mul_f32 v[174:175], v[174:175], v[86:87]
v_exp_f32_e64 v160, -v160
v_exp_f32_e64 v161, -v161
v_exp_f32_e64 v162, -v162
v_exp_f32_e64 v163, -v163
v_exp_f32_e64 v164, -v164
v_exp_f32_e64 v165, -v165
v_exp_f32_e64 v166, -v166
v_exp_f32_e64 v167, -v167
v_exp_f32_e64 v168, -v168
v_exp_f32_e64 v169, -v169
v_exp_f32_e64 v170, -v170
v_exp_f32_e64 v171, -v171
v_exp_f32_e64 v172, -v172
v_exp_f32_e64 v173, -v173
v_exp_f32_e64 v174, -v174
v_exp_f32_e64 v175, -v175
v_pk_add_f32 v[160:161], v[160:161], v[246:247] op_sel_hi:[1,0]
v_pk_add_f32 v[162:163], v[162:163], v[246:247] op_sel_hi:[1,0]
v_pk_add_f32 v[164:165], v[164:165], v[246:247] op_sel_hi:[1,0]
v_pk_add_f32 v[166:167], v[166:167], v[246:247] op_sel_hi:[1,0]
v_pk_add_f32 v[168:169], v[168:169], v[246:247] op_sel_hi:[1,0]
v_pk_add_f32 v[170:171], v[170:171], v[246:247] op_sel_hi:[1,0]
v_pk_add_f32 v[172:173], v[172:173], v[246:247] op_sel_hi:[1,0]
v_pk_add_f32 v[174:175], v[174:175], v[246:247] op_sel_hi:[1,0]
v_rcp_f32 v160, v160
v_rcp_f32 v161, v161
v_rcp_f32 v162, v162
v_rcp_f32 v163, v163
v_rcp_f32 v164, v164
v_rcp_f32 v165, v165
v_rcp_f32 v166, v166
v_rcp_f32 v167, v167
v_rcp_f32 v168, v168
v_rcp_f32 v169, v169
v_rcp_f32 v170, v170
v_rcp_f32 v171, v171
v_rcp_f32 v172, v172
v_rcp_f32 v173, v173
v_rcp_f32 v174, v174
v_rcp_f32 v175, v175
v_pk_mul_f32 v[56:57], v[160:161], v[56:57]
v_pk_mul_f32 v[58:59], v[162:163], v[58:59]
v_pk_mul_f32 v[60:61], v[164:165], v[60:61]
v_pk_mul_f32 v[62:63], v[166:167], v[62:63]
v_pk_mul_f32 v[80:81], v[168:169], v[80:81]
v_pk_mul_f32 v[82:83], v[170:171], v[82:83]
v_pk_mul_f32 v[84:85], v[172:173], v[84:85]
v_pk_mul_f32 v[86:87], v[174:175], v[86:87]
v_cvt_pk_bf16_f32 v204, v56, v57
v_cvt_pk_bf16_f32 v205, v58, v59
v_cvt_pk_bf16_f32 v206, v60, v61
v_cvt_pk_bf16_f32 v207, v62, v63
v_cvt_pk_bf16_f32 v216, v80, v81
v_cvt_pk_bf16_f32 v217, v82, v83
v_cvt_pk_bf16_f32 v218, v84, v85
v_cvt_pk_bf16_f32 v219, v86, v87
v_pk_mul_f32 v[16:17], v[16:17], v[96:97] op_sel:[0,0] op_sel_hi:[1,0]
v_pk_mul_f32 v[18:19], v[18:19], v[96:97] op_sel:[0,0] op_sel_hi:[1,0]
v_pk_mul_f32 v[20:21], v[20:21], v[96:97] op_sel:[0,0] op_sel_hi:[1,0]
v_pk_mul_f32 v[22:23], v[22:23], v[96:97] op_sel:[0,0] op_sel_hi:[1,0]
v_pk_mul_f32 v[40:41], v[40:41], v[96:97] op_sel:[0,1] op_sel_hi:[1,1]
v_pk_mul_f32 v[42:43], v[42:43], v[96:97] op_sel:[0,1] op_sel_hi:[1,1]
v_pk_mul_f32 v[44:45], v[44:45], v[96:97] op_sel:[0,1] op_sel_hi:[1,1]
v_pk_mul_f32 v[46:47], v[46:47], v[96:97] op_sel:[0,1] op_sel_hi:[1,1]
v_pk_fma_f32 v[16:17], v[144:145], v[100:101], v[16:17] op_sel:[0,0,0] op_sel_hi:[1,0,1]
v_pk_fma_f32 v[18:19], v[146:147], v[100:101], v[18:19] op_sel:[0,0,0] op_sel_hi:[1,0,1]
v_pk_fma_f32 v[20:21], v[148:149], v[100:101], v[20:21] op_sel:[0,0,0] op_sel_hi:[1,0,1]
v_pk_fma_f32 v[22:23], v[150:151], v[100:101], v[22:23] op_sel:[0,0,0] op_sel_hi:[1,0,1]
v_pk_fma_f32 v[40:41], v[144:145], v[100:101], v[40:41] op_sel:[0,1,0] op_sel_hi:[1,1,1]
v_pk_fma_f32 v[42:43], v[146:147], v[100:101], v[42:43] op_sel:[0,1,0] op_sel_hi:[1,1,1]
v_pk_fma_f32 v[44:45], v[148:149], v[100:101], v[44:45] op_sel:[0,1,0] op_sel_hi:[1,1,1]
v_pk_fma_f32 v[46:47], v[150:151], v[100:101], v[46:47] op_sel:[0,1,0] op_sel_hi:[1,1,1]
v_pk_fma_f32 v[160:161], v[16:17], v[16:17], v[244:245] op_sel_hi:[1,1,0]
v_pk_fma_f32 v[162:163], v[18:19], v[18:19], v[244:245] op_sel_hi:[1,1,0]
v_pk_fma_f32 v[164:165], v[20:21], v[20:21], v[244:245] op_sel_hi:[1,1,0]
v_pk_fma_f32 v[166:167], v[22:23], v[22:23], v[244:245] op_sel_hi:[1,1,0]
v_pk_fma_f32 v[168:169], v[40:41], v[40:41], v[244:245] op_sel_hi:[1,1,0]
v_pk_fma_f32 v[170:171], v[42:43], v[42:43], v[244:245] op_sel_hi:[1,1,0]
v_pk_fma_f32 v[172:173], v[44:45], v[44:45], v[244:245] op_sel_hi:[1,1,0]
v_pk_fma_f32 v[174:175], v[46:47], v[46:47], v[244:245] op_sel_hi:[1,1,0]
v_pk_mul_f32 v[160:161], v[160:161], v[16:17]
v_pk_mul_f32 v[162:163], v[162:163], v[18:19]
v_pk_mul_f32 v[164:165], v[164:165], v[20:21]
v_pk_mul_f32 v[166:167], v[166:167], v[22:23]
v_pk_mul_f32 v[168:169], v[168:169], v[40:41]
v_pk_mul_f32 v[170:171], v[170:171], v[42:43]
v_pk_mul_f32 v[172:173], v[172:173], v[44:45]
v_pk_mul_f32 v[174:175], v[174:175], v[46:47]
v_exp_f32_e64 v160, -v160
v_exp_f32_e64 v161, -v161
v_exp_f32_e64 v162, -v162
v_exp_f32_e64 v163, -v163
v_exp_f32_e64 v164, -v164
v_exp_f32_e64 v165, -v165
v_exp_f32_e64 v166, -v166
v_exp_f32_e64 v167, -v167
v_exp_f32_e64 v168, -v168
v_exp_f32_e64 v169, -v169
v_exp_f32_e64 v170, -v170
v_exp_f32_e64 v171, -v171
v_exp_f32_e64 v172, -v172
v_exp_f32_e64 v173, -v173
v_exp_f32_e64 v174, -v174
v_exp_f32_e64 v175, -v175
v_pk_add_f32 v[160:161], v[160:161], v[246:247] op_sel_hi:[1,0]
v_pk_add_f32 v[162:163], v[162:163], v[246:247] op_sel_hi:[1,0]
v_pk_add_f32 v[164:165], v[164:165], v[246:247] op_sel_hi:[1,0]
v_pk_add_f32 v[166:167], v[166:167], v[246:247] op_sel_hi:[1,0]
v_pk_add_f32 v[168:169], v[168:169], v[246:247] op_sel_hi:[1,0]
v_pk_add_f32 v[170:171], v[170:171], v[246:247] op_sel_hi:[1,0]
v_pk_add_f32 v[172:173], v[172:173], v[246:247] op_sel_hi:[1,0]
v_pk_add_f32 v[174:175], v[174:175], v[246:247] op_sel_hi:[1,0]
v_rcp_f32 v160, v160
v_rcp_f32 v161, v161
v_rcp_f32 v162, v162
v_rcp_f32 v163, v163
v_rcp_f32 v164, v164
v_rcp_f32 v165, v165
v_rcp_f32 v166, v166
v_rcp_f32 v167, v167
v_rcp_f32 v168, v168
v_rcp_f32 v169, v169
v_rcp_f32 v170, v170
v_rcp_f32 v171, v171
v_rcp_f32 v172, v172
v_rcp_f32 v173, v173
v_rcp_f32 v174, v174
v_rcp_f32 v175, v175
v_pk_mul_f32 v[16:17], v[160:161], v[16:17]
v_pk_mul_f32 v[18:19], v[162:163], v[18:19]
v_pk_mul_f32 v[20:21], v[164:165], v[20:21]
v_pk_mul_f32 v[22:23], v[166:167], v[22:23]
v_pk_mul_f32 v[40:41], v[168:169], v[40:41]
v_pk_mul_f32 v[42:43], v[170:171], v[42:43]
v_pk_mul_f32 v[44:45], v[172:173], v[44:45]
v_pk_mul_f32 v[46:47], v[174:175], v[46:47]
v_cvt_pk_bf16_f32 v184, v16, v17
v_cvt_pk_bf16_f32 v185, v18, v19
v_cvt_pk_bf16_f32 v186, v20, v21
v_cvt_pk_bf16_f32 v187, v22, v23
v_cvt_pk_bf16_f32 v196, v40, v41
v_cvt_pk_bf16_f32 v197, v42, v43
v_cvt_pk_bf16_f32 v198, v44, v45
v_cvt_pk_bf16_f32 v199, v46, v47
v_pk_mul_f32 v[64:65], v[64:65], v[98:99] op_sel:[0,0] op_sel_hi:[1,0]
v_pk_mul_f32 v[66:67], v[66:67], v[98:99] op_sel:[0,0] op_sel_hi:[1,0]
v_pk_mul_f32 v[68:69], v[68:69], v[98:99] op_sel:[0,0] op_sel_hi:[1,0]
v_pk_mul_f32 v[70:71], v[70:71], v[98:99] op_sel:[0,0] op_sel_hi:[1,0]
v_pk_mul_f32 v[88:89], v[88:89], v[98:99] op_sel:[0,1] op_sel_hi:[1,1]
v_pk_mul_f32 v[90:91], v[90:91], v[98:99] op_sel:[0,1] op_sel_hi:[1,1]
v_pk_mul_f32 v[92:93], v[92:93], v[98:99] op_sel:[0,1] op_sel_hi:[1,1]
v_pk_mul_f32 v[94:95], v[94:95], v[98:99] op_sel:[0,1] op_sel_hi:[1,1]
v_pk_fma_f32 v[64:65], v[144:145], v[102:103], v[64:65] op_sel:[0,0,0] op_sel_hi:[1,0,1]
v_pk_fma_f32 v[66:67], v[146:147], v[102:103], v[66:67] op_sel:[0,0,0] op_sel_hi:[1,0,1]
v_pk_fma_f32 v[68:69], v[148:149], v[102:103], v[68:69] op_sel:[0,0,0] op_sel_hi:[1,0,1]
v_pk_fma_f32 v[70:71], v[150:151], v[102:103], v[70:71] op_sel:[0,0,0] op_sel_hi:[1,0,1]
v_pk_fma_f32 v[88:89], v[144:145], v[102:103], v[88:89] op_sel:[0,1,0] op_sel_hi:[1,1,1]
v_pk_fma_f32 v[90:91], v[146:147], v[102:103], v[90:91] op_sel:[0,1,0] op_sel_hi:[1,1,1]
v_pk_fma_f32 v[92:93], v[148:149], v[102:103], v[92:93] op_sel:[0,1,0] op_sel_hi:[1,1,1]
v_pk_fma_f32 v[94:95], v[150:151], v[102:103], v[94:95] op_sel:[0,1,0] op_sel_hi:[1,1,1]
v_cvt_pk_bf16_f32 v208, v64, v65
v_cvt_pk_bf16_f32 v209, v66, v67
v_cvt_pk_bf16_f32 v210, v68, v69
v_cvt_pk_bf16_f32 v211, v70, v71
v_cvt_pk_bf16_f32 v220, v88, v89
v_cvt_pk_bf16_f32 v221, v90, v91
v_cvt_pk_bf16_f32 v222, v92, v93
v_cvt_pk_bf16_f32 v223, v94, v95
s_mul_i32 s31, s26, 6144
s_add_u32 s31, s31, 65536
v_add_u32 v226, s31, v238
v_add_u32 v227, 49152, v226
s_mov_b32 s57, 0x40088e99
s_mov_b32 s58, 0xffff0000
v_mov_b32 v244, s57
v_lshlrev_b32 v248, 16, v248
v_lshlrev_b32 v249, 16, v249
v_lshlrev_b32 v250, 16, v250
v_lshlrev_b32 v251, 16, v251
v_mul_f32 v248, s57, v248
v_mul_f32 v249, s57, v249
v_mul_f32 v250, s57, v250
v_mul_f32 v251, s57, v251
s_barrier
ds_read_b128 v[96:99], v224 offset:0
ds_read_b128 v[100:103], v224 offset:2048
ds_read_b128 v[104:107], v224 offset:4096
ds_read_b128 v[108:111], v224 offset:6144
ds_read_b128 v[128:131], v226 offset:0
ds_read_b128 v[132:135], v226 offset:1024
ds_read_b128 v[136:139], v226 offset:2048
ds_read_b128 v[140:143], v226 offset:3072
ds_read_b128 v[144:147], v226 offset:4096
ds_read_b128 v[148:151], v226 offset:5120
s_mov_b32 s50, 0x409d30fc
s_waitcnt lgkmcnt(0)
v_mfma_f32_16x16x32_bf16 v[0:3], v[128:131], v[96:99], 0
ds_read_b128 v[112:115], v225 offset:0
v_mfma_f32_16x16x32_bf16 v[24:27], v[128:131], v[100:103], 0
v_lshlrev_b32 v228, 16, v208
v_mfma_f32_16x16x32_bf16 v[48:51], v[128:131], v[104:107], 0
ds_read_b128 v[116:119], v225 offset:2048
v_mfma_f32_16x16x32_bf16 v[72:75], v[128:131], v[108:111], 0
v_and_b32 v229, s58, v208
v_mfma_f32_16x16x32_bf16 v[4:7], v[132:135], v[96:99], 0
ds_read_b128 v[120:123], v225 offset:4096
v_mfma_f32_16x16x32_bf16 v[28:31], v[132:135], v[100:103], 0
v_lshlrev_b32 v230, 16, v209
v_mfma_f32_16x16x32_bf16 v[52:55], v[132:135], v[104:107], 0
ds_read_b128 v[124:127], v225 offset:6144
v_mfma_f32_16x16x32_bf16 v[76:79], v[132:135], v[108:111], 0
v_and_b32 v231, s58, v209
v_mfma_f32_16x16x32_bf16 v[8:11], v[136:139], v[96:99], 0
ds_read_b128 v[152:155], v226 offset:12288
v_mfma_f32_16x16x32_bf16 v[32:35], v[136:139], v[100:103], 0
v_fma_f32 v232, v228, v228, s50
v_mfma_f32_16x16x32_bf16 v[56:59], v[136:139], v[104:107], 0
ds_read_b128 v[156:159], v226 offset:13312
v_mfma_f32_16x16x32_bf16 v[80:83], v[136:139], v[108:111], 0
v_fma_f32 v233, v229, v229, s50
v_mfma_f32_16x16x32_bf16 v[12:15], v[140:143], v[96:99], 0
ds_read_b128 v[160:163], v226 offset:14336
v_mfma_f32_16x16x32_bf16 v[36:39], v[140:143], v[100:103], 0
v_fma_f32 v234, v230, v230, s50
v_mfma_f32_16x16x32_bf16 v[60:63], v[140:143], v[104:107], 0
ds_read_b128 v[164:167], v226 offset:15360
v_mfma_f32_16x16x32_bf16 v[84:87], v[140:143], v[108:111], 0
v_fma_f32 v235, v231, v231, s50
v_mfma_f32_16x16x32_bf16 v[16:19], v[144:147], v[96:99], 0
ds_read_b128 v[168:171], v226 offset:16384
v_mfma_f32_16x16x32_bf16 v[40:43], v[144:147], v[100:103], 0
v_mul_f32 v232, v232, v228
v_mfma_f32_16x16x32_bf16 v[64:67], v[144:147], v[104:107], 0
ds_read_b128 v[172:175], v226 offset:17408
v_mfma_f32_16x16x32_bf16 v[88:91], v[144:147], v[108:111], 0
v_mul_f32 v233, v233, v229
v_mfma_f32_16x16x32_bf16 v[20:23], v[148:151], v[96:99], 0
v_mul_f32 v234, v234, v230
v_mfma_f32_16x16x32_bf16 v[44:47], v[148:151], v[100:103], 0
v_mul_f32 v235, v235, v231
v_mfma_f32_16x16x32_bf16 v[68:71], v[148:151], v[104:107], 0
v_mfma_f32_16x16x32_bf16 v[92:95], v[148:151], v[108:111], 0
s_waitcnt lgkmcnt(0)
s_barrier
v_mfma_f32_16x16x32_bf16 v[0:3], v[152:155], v[112:115], v[0:3]
ds_read_b128 v[96:99], v224 offset:16384
v_mfma_f32_16x16x32_bf16 v[24:27], v[152:155], v[116:119], v[24:27]
v_exp_f32_e64 v232, -v232
v_mfma_f32_16x16x32_bf16 v[48:51], v[152:155], v[120:123], v[48:51]
ds_read_b128 v[100:103], v224 offset:18432
v_mfma_f32_16x16x32_bf16 v[72:75], v[152:155], v[124:127], v[72:75]
v_exp_f32_e64 v233, -v233
v_mfma_f32_16x16x32_bf16 v[4:7], v[156:159], v[112:115], v[4:7]
ds_read_b128 v[104:107], v224 offset:20480
v_mfma_f32_16x16x32_bf16 v[28:31], v[156:159], v[116:119], v[28:31]
v_exp_f32_e64 v234, -v234
v_mfma_f32_16x16x32_bf16 v[52:55], v[156:159], v[120:123], v[52:55]
ds_read_b128 v[108:111], v224 offset:22528
v_mfma_f32_16x16x32_bf16 v[76:79], v[156:159], v[124:127], v[76:79]
v_exp_f32_e64 v235, -v235
v_mfma_f32_16x16x32_bf16 v[8:11], v[160:163], v[112:115], v[8:11]
ds_read_b128 v[128:131], v226 offset:24576
v_mfma_f32_16x16x32_bf16 v[32:35], v[160:163], v[116:119], v[32:35]
v_add_f32 v232, 1.0, v232
v_mfma_f32_16x16x32_bf16 v[56:59], v[160:163], v[120:123], v[56:59]
ds_read_b128 v[132:135], v226 offset:25600
v_mfma_f32_16x16x32_bf16 v[80:83], v[160:163], v[124:127], v[80:83]
v_add_f32 v233, 1.0, v233
v_mfma_f32_16x16x32_bf16 v[12:15], v[164:167], v[112:115], v[12:15]
ds_read_b128 v[136:139], v226 offset:26624
v_mfma_f32_16x16x32_bf16 v[36:39], v[164:167], v[116:119], v[36:39]
v_add_f32 v234, 1.0, v234
v_mfma_f32_16x16x32_bf16 v[60:63], v[164:167], v[120:123], v[60:63]
ds_read_b128 v[140:143], v226 offset:27648
v_mfma_f32_16x16x32_bf16 v[84:87], v[164:167], v[124:127], v[84:87]
v_add_f32 v235, 1.0, v235
v_mfma_f32_16x16x32_bf16 v[16:19], v[168:171], v[112:115], v[16:19]
ds_read_b128 v[144:147], v226 offset:28672
v_mfma_f32_16x16x32_bf16 v[40:43], v[168:171], v[116:119], v[40:43]
v_rcp_f32 v232, v232
v_mfma_f32_16x16x32_bf16 v[64:67], v[168:171], v[120:123], v[64:67]
ds_read_b128 v[148:151], v226 offset:29696
v_mfma_f32_16x16x32_bf16 v[88:91], v[168:171], v[124:127], v[88:91]
v_rcp_f32 v233, v233
v_mfma_f32_16x16x32_bf16 v[20:23], v[172:175], v[112:115], v[20:23]
v_rcp_f32 v234, v234
v_mfma_f32_16x16x32_bf16 v[44:47], v[172:175], v[116:119], v[44:47]
v_rcp_f32 v235, v235
v_mfma_f32_16x16x32_bf16 v[68:71], v[172:175], v[120:123], v[68:71]
v_mfma_f32_16x16x32_bf16 v[92:95], v[172:175], v[124:127], v[92:95]
s_waitcnt lgkmcnt(0)
v_mfma_f32_16x16x32_bf16 v[0:3], v[128:131], v[96:99], v[0:3]
ds_read_b128 v[112:115], v225 offset:16384
v_mfma_f32_16x16x32_bf16 v[24:27], v[128:131], v[100:103], v[24:27]
v_mul_f32 v232, v232, v228
v_mfma_f32_16x16x32_bf16 v[48:51], v[128:131], v[104:107], v[48:51]
ds_read_b128 v[116:119], v225 offset:18432
v_mfma_f32_16x16x32_bf16 v[72:75], v[128:131], v[108:111], v[72:75]
v_mul_f32 v233, v233, v229
v_mfma_f32_16x16x32_bf16 v[4:7], v[132:135], v[96:99], v[4:7]
ds_read_b128 v[120:123], v225 offset:20480
v_mfma_f32_16x16x32_bf16 v[28:31], v[132:135], v[100:103], v[28:31]
v_mul_f32 v234, v234, v230
v_mfma_f32_16x16x32_bf16 v[52:55], v[132:135], v[104:107], v[52:55]
ds_read_b128 v[124:127], v225 offset:22528
v_mfma_f32_16x16x32_bf16 v[76:79], v[132:135], v[108:111], v[76:79]
v_mul_f32 v235, v235, v231
v_mfma_f32_16x16x32_bf16 v[8:11], v[136:139], v[96:99], v[8:11]
ds_read_b128 v[152:155], v226 offset:36864
v_mfma_f32_16x16x32_bf16 v[32:35], v[136:139], v[100:103], v[32:35]
v_cvt_pk_bf16_f32 v208, v232, v233
v_mfma_f32_16x16x32_bf16 v[56:59], v[136:139], v[104:107], v[56:59]
ds_read_b128 v[156:159], v226 offset:37888
v_mfma_f32_16x16x32_bf16 v[80:83], v[136:139], v[108:111], v[80:83]
v_cvt_pk_bf16_f32 v209, v234, v235
v_mfma_f32_16x16x32_bf16 v[12:15], v[140:143], v[96:99], v[12:15]
ds_read_b128 v[160:163], v226 offset:38912
v_mfma_f32_16x16x32_bf16 v[36:39], v[140:143], v[100:103], v[36:39]
v_lshlrev_b32 v228, 16, v210
v_mfma_f32_16x16x32_bf16 v[60:63], v[140:143], v[104:107], v[60:63]
ds_read_b128 v[164:167], v226 offset:39936
v_mfma_f32_16x16x32_bf16 v[84:87], v[140:143], v[108:111], v[84:87]
v_and_b32 v229, s58, v210
v_mfma_f32_16x16x32_bf16 v[16:19], v[144:147], v[96:99], v[16:19]
ds_read_b128 v[168:171], v226 offset:40960
v_mfma_f32_16x16x32_bf16 v[40:43], v[144:147], v[100:103], v[40:43]
v_lshlrev_b32 v230, 16, v211
v_mfma_f32_16x16x32_bf16 v[64:67], v[144:147], v[104:107], v[64:67]
ds_read_b128 v[172:175], v226 offset:41984
v_mfma_f32_16x16x32_bf16 v[88:91], v[144:147], v[108:111], v[88:91]
v_and_b32 v231, s58, v211
v_mfma_f32_16x16x32_bf16 v[20:23], v[148:151], v[96:99], v[20:23]
v_fma_f32 v232, v228, v228, s50
v_mfma_f32_16x16x32_bf16 v[44:47], v[148:151], v[100:103], v[44:47]
v_fma_f32 v233, v229, v229, s50
v_mfma_f32_16x16x32_bf16 v[68:71], v[148:151], v[104:107], v[68:71]
v_mfma_f32_16x16x32_bf16 v[92:95], v[148:151], v[108:111], v[92:95]
s_waitcnt lgkmcnt(0)
s_barrier
v_mfma_f32_16x16x32_bf16 v[0:3], v[152:155], v[112:115], v[0:3]
ds_read_b128 v[96:99], v224 offset:32768
v_mfma_f32_16x16x32_bf16 v[24:27], v[152:155], v[116:119], v[24:27]
v_fma_f32 v234, v230, v230, s50
v_mfma_f32_16x16x32_bf16 v[48:51], v[152:155], v[120:123], v[48:51]
ds_read_b128 v[100:103], v224 offset:34816
v_mfma_f32_16x16x32_bf16 v[72:75], v[152:155], v[124:127], v[72:75]
v_fma_f32 v235, v231, v231, s50
v_mfma_f32_16x16x32_bf16 v[4:7], v[156:159], v[112:115], v[4:7]
ds_read_b128 v[104:107], v224 offset:36864
v_mfma_f32_16x16x32_bf16 v[28:31], v[156:159], v[116:119], v[28:31]
v_mul_f32 v232, v232, v228
v_mfma_f32_16x16x32_bf16 v[52:55], v[156:159], v[120:123], v[52:55]
ds_read_b128 v[108:111], v224 offset:38912
v_mfma_f32_16x16x32_bf16 v[76:79], v[156:159], v[124:127], v[76:79]
v_mul_f32 v233, v233, v229
v_mfma_f32_16x16x32_bf16 v[8:11], v[160:163], v[112:115], v[8:11]
ds_read_b128 v[128:131], v227 offset:0
v_mfma_f32_16x16x32_bf16 v[32:35], v[160:163], v[116:119], v[32:35]
v_mul_f32 v234, v234, v230
v_mfma_f32_16x16x32_bf16 v[56:59], v[160:163], v[120:123], v[56:59]
ds_read_b128 v[132:135], v227 offset:1024
v_mfma_f32_16x16x32_bf16 v[80:83], v[160:163], v[124:127], v[80:83]
v_mul_f32 v235, v235, v231
v_mfma_f32_16x16x32_bf16 v[12:15], v[164:167], v[112:115], v[12:15]
ds_read_b128 v[136:139], v227 offset:2048
v_mfma_f32_16x16x32_bf16 v[36:39], v[164:167], v[116:119], v[36:39]
v_exp_f32_e64 v232, -v232
v_mfma_f32_16x16x32_bf16 v[60:63], v[164:167], v[120:123], v[60:63]
ds_read_b128 v[140:143], v227 offset:3072
v_mfma_f32_16x16x32_bf16 v[84:87], v[164:167], v[124:127], v[84:87]
v_exp_f32_e64 v233, -v233
v_mfma_f32_16x16x32_bf16 v[16:19], v[168:171], v[112:115], v[16:19]
ds_read_b128 v[144:147], v227 offset:4096
v_mfma_f32_16x16x32_bf16 v[40:43], v[168:171], v[116:119], v[40:43]
v_exp_f32_e64 v234, -v234
v_mfma_f32_16x16x32_bf16 v[64:67], v[168:171], v[120:123], v[64:67]
ds_read_b128 v[148:151], v227 offset:5120
v_mfma_f32_16x16x32_bf16 v[88:91], v[168:171], v[124:127], v[88:91]
v_exp_f32_e64 v235, -v235
v_mfma_f32_16x16x32_bf16 v[20:23], v[172:175], v[112:115], v[20:23]
v_add_f32 v232, 1.0, v232
v_mfma_f32_16x16x32_bf16 v[44:47], v[172:175], v[116:119], v[44:47]
v_add_f32 v233, 1.0, v233
v_mfma_f32_16x16x32_bf16 v[68:71], v[172:175], v[120:123], v[68:71]
v_mfma_f32_16x16x32_bf16 v[92:95], v[172:175], v[124:127], v[92:95]
s_waitcnt lgkmcnt(0)
v_mfma_f32_16x16x32_bf16 v[0:3], v[128:131], v[96:99], v[0:3]
ds_read_b128 v[112:115], v225 offset:32768
v_mfma_f32_16x16x32_bf16 v[24:27], v[128:131], v[100:103], v[24:27]
v_add_f32 v234, 1.0, v234
v_mfma_f32_16x16x32_bf16 v[48:51], v[128:131], v[104:107], v[48:51]
ds_read_b128 v[116:119], v225 offset:34816
v_mfma_f32_16x16x32_bf16 v[72:75], v[128:131], v[108:111], v[72:75]
v_add_f32 v235, 1.0, v235
v_mfma_f32_16x16x32_bf16 v[4:7], v[132:135], v[96:99], v[4:7]
ds_read_b128 v[120:123], v225 offset:36864
v_mfma_f32_16x16x32_bf16 v[28:31], v[132:135], v[100:103], v[28:31]
v_rcp_f32 v232, v232
v_mfma_f32_16x16x32_bf16 v[52:55], v[132:135], v[104:107], v[52:55]
ds_read_b128 v[124:127], v225 offset:38912
v_mfma_f32_16x16x32_bf16 v[76:79], v[132:135], v[108:111], v[76:79]
v_rcp_f32 v233, v233
v_mfma_f32_16x16x32_bf16 v[8:11], v[136:139], v[96:99], v[8:11]
ds_read_b128 v[152:155], v227 offset:12288
v_mfma_f32_16x16x32_bf16 v[32:35], v[136:139], v[100:103], v[32:35]
v_rcp_f32 v234, v234
v_mfma_f32_16x16x32_bf16 v[56:59], v[136:139], v[104:107], v[56:59]
ds_read_b128 v[156:159], v227 offset:13312
v_mfma_f32_16x16x32_bf16 v[80:83], v[136:139], v[108:111], v[80:83]
v_rcp_f32 v235, v235
v_mfma_f32_16x16x32_bf16 v[12:15], v[140:143], v[96:99], v[12:15]
ds_read_b128 v[160:163], v227 offset:14336
v_mfma_f32_16x16x32_bf16 v[36:39], v[140:143], v[100:103], v[36:39]
v_mul_f32 v232, v232, v228
v_mfma_f32_16x16x32_bf16 v[60:63], v[140:143], v[104:107], v[60:63]
ds_read_b128 v[164:167], v227 offset:15360
v_mfma_f32_16x16x32_bf16 v[84:87], v[140:143], v[108:111], v[84:87]
v_mul_f32 v233, v233, v229
v_mfma_f32_16x16x32_bf16 v[16:19], v[144:147], v[96:99], v[16:19]
ds_read_b128 v[168:171], v227 offset:16384
v_mfma_f32_16x16x32_bf16 v[40:43], v[144:147], v[100:103], v[40:43]
v_mul_f32 v234, v234, v230
v_mfma_f32_16x16x32_bf16 v[64:67], v[144:147], v[104:107], v[64:67]
ds_read_b128 v[172:175], v227 offset:17408
v_mfma_f32_16x16x32_bf16 v[88:91], v[144:147], v[108:111], v[88:91]
v_mul_f32 v235, v235, v231
v_mfma_f32_16x16x32_bf16 v[20:23], v[148:151], v[96:99], v[20:23]
v_cvt_pk_bf16_f32 v210, v232, v233
v_mfma_f32_16x16x32_bf16 v[44:47], v[148:151], v[100:103], v[44:47]
v_cvt_pk_bf16_f32 v211, v234, v235
v_mfma_f32_16x16x32_bf16 v[68:71], v[148:151], v[104:107], v[68:71]
v_mfma_f32_16x16x32_bf16 v[92:95], v[148:151], v[108:111], v[92:95]
s_waitcnt lgkmcnt(0)
s_barrier
v_mfma_f32_16x16x32_bf16 v[0:3], v[152:155], v[112:115], v[0:3]
ds_read_b128 v[96:99], v224 offset:49152
v_mfma_f32_16x16x32_bf16 v[24:27], v[152:155], v[116:119], v[24:27]
v_lshlrev_b32 v228, 16, v220
v_mfma_f32_16x16x32_bf16 v[48:51], v[152:155], v[120:123], v[48:51]
ds_read_b128 v[100:103], v224 offset:51200
v_mfma_f32_16x16x32_bf16 v[72:75], v[152:155], v[124:127], v[72:75]
v_and_b32 v229, s58, v220
v_mfma_f32_16x16x32_bf16 v[4:7], v[156:159], v[112:115], v[4:7]
ds_read_b128 v[104:107], v224 offset:53248
v_mfma_f32_16x16x32_bf16 v[28:31], v[156:159], v[116:119], v[28:31]
v_lshlrev_b32 v230, 16, v221
v_mfma_f32_16x16x32_bf16 v[52:55], v[156:159], v[120:123], v[52:55]
ds_read_b128 v[108:111], v224 offset:55296
v_mfma_f32_16x16x32_bf16 v[76:79], v[156:159], v[124:127], v[76:79]
v_and_b32 v231, s58, v221
v_mfma_f32_16x16x32_bf16 v[8:11], v[160:163], v[112:115], v[8:11]
ds_read_b128 v[128:131], v227 offset:24576
v_mfma_f32_16x16x32_bf16 v[32:35], v[160:163], v[116:119], v[32:35]
v_fma_f32 v232, v228, v228, s50
v_mfma_f32_16x16x32_bf16 v[56:59], v[160:163], v[120:123], v[56:59]
ds_read_b128 v[132:135], v227 offset:25600
v_mfma_f32_16x16x32_bf16 v[80:83], v[160:163], v[124:127], v[80:83]
v_fma_f32 v233, v229, v229, s50
v_mfma_f32_16x16x32_bf16 v[12:15], v[164:167], v[112:115], v[12:15]
ds_read_b128 v[136:139], v227 offset:26624
v_mfma_f32_16x16x32_bf16 v[36:39], v[164:167], v[116:119], v[36:39]
v_fma_f32 v234, v230, v230, s50
v_mfma_f32_16x16x32_bf16 v[60:63], v[164:167], v[120:123], v[60:63]
ds_read_b128 v[140:143], v227 offset:27648
v_mfma_f32_16x16x32_bf16 v[84:87], v[164:167], v[124:127], v[84:87]
v_fma_f32 v235, v231, v231, s50
v_mfma_f32_16x16x32_bf16 v[16:19], v[168:171], v[112:115], v[16:19]
ds_read_b128 v[144:147], v227 offset:28672
v_mfma_f32_16x16x32_bf16 v[40:43], v[168:171], v[116:119], v[40:43]
v_mul_f32 v232, v232, v228
v_mfma_f32_16x16x32_bf16 v[64:67], v[168:171], v[120:123], v[64:67]
ds_read_b128 v[148:151], v227 offset:29696
v_mfma_f32_16x16x32_bf16 v[88:91], v[168:171], v[124:127], v[88:91]
v_mul_f32 v233, v233, v229
v_mfma_f32_16x16x32_bf16 v[20:23], v[172:175], v[112:115], v[20:23]
v_mul_f32 v234, v234, v230
v_mfma_f32_16x16x32_bf16 v[44:47], v[172:175], v[116:119], v[44:47]
v_mul_f32 v235, v235, v231
v_mfma_f32_16x16x32_bf16 v[68:71], v[172:175], v[120:123], v[68:71]
v_mfma_f32_16x16x32_bf16 v[92:95], v[172:175], v[124:127], v[92:95]
s_waitcnt lgkmcnt(0)
v_mfma_f32_16x16x32_bf16 v[0:3], v[128:131], v[96:99], v[0:3]
ds_read_b128 v[112:115], v225 offset:49152
v_mfma_f32_16x16x32_bf16 v[24:27], v[128:131], v[100:103], v[24:27]
v_exp_f32_e64 v232, -v232
v_mfma_f32_16x16x32_bf16 v[48:51], v[128:131], v[104:107], v[48:51]
ds_read_b128 v[116:119], v225 offset:51200
v_mfma_f32_16x16x32_bf16 v[72:75], v[128:131], v[108:111], v[72:75]
v_exp_f32_e64 v233, -v233
v_mfma_f32_16x16x32_bf16 v[4:7], v[132:135], v[96:99], v[4:7]
ds_read_b128 v[120:123], v225 offset:53248
v_mfma_f32_16x16x32_bf16 v[28:31], v[132:135], v[100:103], v[28:31]
v_exp_f32_e64 v234, -v234
v_mfma_f32_16x16x32_bf16 v[52:55], v[132:135], v[104:107], v[52:55]
ds_read_b128 v[124:127], v225 offset:55296
v_mfma_f32_16x16x32_bf16 v[76:79], v[132:135], v[108:111], v[76:79]
v_exp_f32_e64 v235, -v235
v_mfma_f32_16x16x32_bf16 v[8:11], v[136:139], v[96:99], v[8:11]
ds_read_b128 v[152:155], v227 offset:36864
v_mfma_f32_16x16x32_bf16 v[32:35], v[136:139], v[100:103], v[32:35]
v_add_f32 v232, 1.0, v232
v_mfma_f32_16x16x32_bf16 v[56:59], v[136:139], v[104:107], v[56:59]
ds_read_b128 v[156:159], v227 offset:37888
v_mfma_f32_16x16x32_bf16 v[80:83], v[136:139], v[108:111], v[80:83]
v_add_f32 v233, 1.0, v233
v_mfma_f32_16x16x32_bf16 v[12:15], v[140:143], v[96:99], v[12:15]
ds_read_b128 v[160:163], v227 offset:38912
v_mfma_f32_16x16x32_bf16 v[36:39], v[140:143], v[100:103], v[36:39]
v_add_f32 v234, 1.0, v234
v_mfma_f32_16x16x32_bf16 v[60:63], v[140:143], v[104:107], v[60:63]
ds_read_b128 v[164:167], v227 offset:39936
v_mfma_f32_16x16x32_bf16 v[84:87], v[140:143], v[108:111], v[84:87]
v_add_f32 v235, 1.0, v235
v_mfma_f32_16x16x32_bf16 v[16:19], v[144:147], v[96:99], v[16:19]
ds_read_b128 v[168:171], v227 offset:40960
v_mfma_f32_16x16x32_bf16 v[40:43], v[144:147], v[100:103], v[40:43]
v_rcp_f32 v232, v232
v_mfma_f32_16x16x32_bf16 v[64:67], v[144:147], v[104:107], v[64:67]
ds_read_b128 v[172:175], v227 offset:41984
v_mfma_f32_16x16x32_bf16 v[88:91], v[144:147], v[108:111], v[88:91]
v_rcp_f32 v233, v233
v_mfma_f32_16x16x32_bf16 v[20:23], v[148:151], v[96:99], v[20:23]
v_rcp_f32 v234, v234
v_mfma_f32_16x16x32_bf16 v[44:47], v[148:151], v[100:103], v[44:47]
v_rcp_f32 v235, v235
v_mfma_f32_16x16x32_bf16 v[68:71], v[148:151], v[104:107], v[68:71]
v_mfma_f32_16x16x32_bf16 v[92:95], v[148:151], v[108:111], v[92:95]
s_waitcnt lgkmcnt(0)
s_barrier
v_mfma_f32_16x16x32_bf16 v[0:3], v[152:155], v[112:115], v[0:3]
ds_read_b128 v[96:99], v224 offset:0
v_mfma_f32_16x16x32_bf16 v[24:27], v[152:155], v[116:119], v[24:27]
v_mul_f32 v232, v232, v228
v_mfma_f32_16x16x32_bf16 v[48:51], v[152:155], v[120:123], v[48:51]
ds_read_b128 v[100:103], v224 offset:2048
v_mfma_f32_16x16x32_bf16 v[72:75], v[152:155], v[124:127], v[72:75]
v_mul_f32 v233, v233, v229
v_mfma_f32_16x16x32_bf16 v[4:7], v[156:159], v[112:115], v[4:7]
ds_read_b128 v[104:107], v224 offset:4096
v_mfma_f32_16x16x32_bf16 v[28:31], v[156:159], v[116:119], v[28:31]
v_mul_f32 v234, v234, v230
v_mfma_f32_16x16x32_bf16 v[52:55], v[156:159], v[120:123], v[52:55]
ds_read_b128 v[108:111], v224 offset:6144
v_mfma_f32_16x16x32_bf16 v[76:79], v[156:159], v[124:127], v[76:79]
v_mul_f32 v235, v235, v231
v_mfma_f32_16x16x32_bf16 v[8:11], v[160:163], v[112:115], v[8:11]
ds_read_b128 v[128:131], v226 offset:0
v_mfma_f32_16x16x32_bf16 v[32:35], v[160:163], v[116:119], v[32:35]
v_cvt_pk_bf16_f32 v220, v232, v233
v_mfma_f32_16x16x32_bf16 v[56:59], v[160:163], v[120:123], v[56:59]
ds_read_b128 v[132:135], v226 offset:1024
v_mfma_f32_16x16x32_bf16 v[80:83], v[160:163], v[124:127], v[80:83]
v_cvt_pk_bf16_f32 v221, v234, v235
v_mfma_f32_16x16x32_bf16 v[12:15], v[164:167], v[112:115], v[12:15]
ds_read_b128 v[136:139], v226 offset:2048
v_mfma_f32_16x16x32_bf16 v[36:39], v[164:167], v[116:119], v[36:39]
v_lshlrev_b32 v228, 16, v222
v_mfma_f32_16x16x32_bf16 v[60:63], v[164:167], v[120:123], v[60:63]
ds_read_b128 v[140:143], v226 offset:3072
v_mfma_f32_16x16x32_bf16 v[84:87], v[164:167], v[124:127], v[84:87]
v_and_b32 v229, s58, v222
v_mfma_f32_16x16x32_bf16 v[16:19], v[168:171], v[112:115], v[16:19]
ds_read_b128 v[144:147], v226 offset:4096
v_mfma_f32_16x16x32_bf16 v[40:43], v[168:171], v[116:119], v[40:43]
v_lshlrev_b32 v230, 16, v223
v_mfma_f32_16x16x32_bf16 v[64:67], v[168:171], v[120:123], v[64:67]
ds_read_b128 v[148:151], v226 offset:5120
v_mfma_f32_16x16x32_bf16 v[88:91], v[168:171], v[124:127], v[88:91]
v_and_b32 v231, s58, v223
v_mfma_f32_16x16x32_bf16 v[20:23], v[172:175], v[112:115], v[20:23]
v_fma_f32 v232, v228, v228, s50
v_mfma_f32_16x16x32_bf16 v[44:47], v[172:175], v[116:119], v[44:47]
v_fma_f32 v233, v229, v229, s50
v_mfma_f32_16x16x32_bf16 v[68:71], v[172:175], v[120:123], v[68:71]
v_mfma_f32_16x16x32_bf16 v[92:95], v[172:175], v[124:127], v[92:95]
s_waitcnt lgkmcnt(0)
v_mfma_f32_16x16x32_bf16 v[0:3], v[128:131], v[96:99], v[0:3]
ds_read_b128 v[112:115], v225 offset:0
v_mfma_f32_16x16x32_bf16 v[24:27], v[128:131], v[100:103], v[24:27]
v_fma_f32 v234, v230, v230, s50
v_mfma_f32_16x16x32_bf16 v[48:51], v[128:131], v[104:107], v[48:51]
ds_read_b128 v[116:119], v225 offset:2048
v_mfma_f32_16x16x32_bf16 v[72:75], v[128:131], v[108:111], v[72:75]
v_fma_f32 v235, v231, v231, s50
v_mfma_f32_16x16x32_bf16 v[4:7], v[132:135], v[96:99], v[4:7]
ds_read_b128 v[120:123], v225 offset:4096
v_mfma_f32_16x16x32_bf16 v[28:31], v[132:135], v[100:103], v[28:31]
v_mul_f32 v232, v232, v228
v_mfma_f32_16x16x32_bf16 v[52:55], v[132:135], v[104:107], v[52:55]
ds_read_b128 v[124:127], v225 offset:6144
v_mfma_f32_16x16x32_bf16 v[76:79], v[132:135], v[108:111], v[76:79]
v_mul_f32 v233, v233, v229
v_mfma_f32_16x16x32_bf16 v[8:11], v[136:139], v[96:99], v[8:11]
ds_read_b128 v[152:155], v226 offset:12288
v_mfma_f32_16x16x32_bf16 v[32:35], v[136:139], v[100:103], v[32:35]
v_mul_f32 v234, v234, v230
v_mfma_f32_16x16x32_bf16 v[56:59], v[136:139], v[104:107], v[56:59]
ds_read_b128 v[156:159], v226 offset:13312
v_mfma_f32_16x16x32_bf16 v[80:83], v[136:139], v[108:111], v[80:83]
v_mul_f32 v235, v235, v231
v_mfma_f32_16x16x32_bf16 v[12:15], v[140:143], v[96:99], v[12:15]
ds_read_b128 v[160:163], v226 offset:14336
v_mfma_f32_16x16x32_bf16 v[36:39], v[140:143], v[100:103], v[36:39]
v_exp_f32_e64 v232, -v232
v_mfma_f32_16x16x32_bf16 v[60:63], v[140:143], v[104:107], v[60:63]
ds_read_b128 v[164:167], v226 offset:15360
v_mfma_f32_16x16x32_bf16 v[84:87], v[140:143], v[108:111], v[84:87]
v_exp_f32_e64 v233, -v233
v_mfma_f32_16x16x32_bf16 v[16:19], v[144:147], v[96:99], v[16:19]
ds_read_b128 v[168:171], v226 offset:16384
v_mfma_f32_16x16x32_bf16 v[40:43], v[144:147], v[100:103], v[40:43]
v_exp_f32_e64 v234, -v234
v_mfma_f32_16x16x32_bf16 v[64:67], v[144:147], v[104:107], v[64:67]
ds_read_b128 v[172:175], v226 offset:17408
v_mfma_f32_16x16x32_bf16 v[88:91], v[144:147], v[108:111], v[88:91]
v_exp_f32_e64 v235, -v235
v_mfma_f32_16x16x32_bf16 v[20:23], v[148:151], v[96:99], v[20:23]
v_add_f32 v232, 1.0, v232
v_mfma_f32_16x16x32_bf16 v[44:47], v[148:151], v[100:103], v[44:47]
v_add_f32 v233, 1.0, v233
v_mfma_f32_16x16x32_bf16 v[68:71], v[148:151], v[104:107], v[68:71]
v_mfma_f32_16x16x32_bf16 v[92:95], v[148:151], v[108:111], v[92:95]
s_waitcnt lgkmcnt(0)
s_barrier
v_mfma_f32_16x16x32_bf16 v[0:3], v[152:155], v[112:115], v[0:3]
ds_read_b128 v[96:99], v224 offset:16384
v_mfma_f32_16x16x32_bf16 v[24:27], v[152:155], v[116:119], v[24:27]
v_add_f32 v234, 1.0, v234
v_mfma_f32_16x16x32_bf16 v[48:51], v[152:155], v[120:123], v[48:51]
ds_read_b128 v[100:103], v224 offset:18432
v_mfma_f32_16x16x32_bf16 v[72:75], v[152:155], v[124:127], v[72:75]
v_add_f32 v235, 1.0, v235
v_mfma_f32_16x16x32_bf16 v[4:7], v[156:159], v[112:115], v[4:7]
ds_read_b128 v[104:107], v224 offset:20480
v_mfma_f32_16x16x32_bf16 v[28:31], v[156:159], v[116:119], v[28:31]
v_rcp_f32 v232, v232
v_mfma_f32_16x16x32_bf16 v[52:55], v[156:159], v[120:123], v[52:55]
ds_read_b128 v[108:111], v224 offset:22528
v_mfma_f32_16x16x32_bf16 v[76:79], v[156:159], v[124:127], v[76:79]
v_rcp_f32 v233, v233
v_mfma_f32_16x16x32_bf16 v[8:11], v[160:163], v[112:115], v[8:11]
ds_read_b128 v[128:131], v226 offset:24576
v_mfma_f32_16x16x32_bf16 v[32:35], v[160:163], v[116:119], v[32:35]
v_rcp_f32 v234, v234
v_mfma_f32_16x16x32_bf16 v[56:59], v[160:163], v[120:123], v[56:59]
ds_read_b128 v[132:135], v226 offset:25600
v_mfma_f32_16x16x32_bf16 v[80:83], v[160:163], v[124:127], v[80:83]
v_rcp_f32 v235, v235
v_mfma_f32_16x16x32_bf16 v[12:15], v[164:167], v[112:115], v[12:15]
ds_read_b128 v[136:139], v226 offset:26624
v_mfma_f32_16x16x32_bf16 v[36:39], v[164:167], v[116:119], v[36:39]
v_mul_f32 v232, v232, v228
v_mfma_f32_16x16x32_bf16 v[60:63], v[164:167], v[120:123], v[60:63]
ds_read_b128 v[140:143], v226 offset:27648
v_mfma_f32_16x16x32_bf16 v[84:87], v[164:167], v[124:127], v[84:87]
v_mul_f32 v233, v233, v229
v_mfma_f32_16x16x32_bf16 v[16:19], v[168:171], v[112:115], v[16:19]
ds_read_b128 v[144:147], v226 offset:28672
v_mfma_f32_16x16x32_bf16 v[40:43], v[168:171], v[116:119], v[40:43]
v_mul_f32 v234, v234, v230
v_mfma_f32_16x16x32_bf16 v[64:67], v[168:171], v[120:123], v[64:67]
ds_read_b128 v[148:151], v226 offset:29696
v_mfma_f32_16x16x32_bf16 v[88:91], v[168:171], v[124:127], v[88:91]
v_mul_f32 v235, v235, v231
v_mfma_f32_16x16x32_bf16 v[20:23], v[172:175], v[112:115], v[20:23]
v_cvt_pk_bf16_f32 v222, v232, v233
v_mfma_f32_16x16x32_bf16 v[44:47], v[172:175], v[116:119], v[44:47]
v_cvt_pk_bf16_f32 v223, v234, v235
v_mfma_f32_16x16x32_bf16 v[68:71], v[172:175], v[120:123], v[68:71]
v_mfma_f32_16x16x32_bf16 v[92:95], v[172:175], v[124:127], v[92:95]
s_waitcnt lgkmcnt(0)
v_mfma_f32_16x16x32_bf16 v[0:3], v[128:131], v[96:99], v[0:3]
ds_read_b128 v[112:115], v225 offset:16384
v_mfma_f32_16x16x32_bf16 v[24:27], v[128:131], v[100:103], v[24:27]
v_mfma_f32_16x16x32_bf16 v[48:51], v[128:131], v[104:107], v[48:51]
ds_read_b128 v[116:119], v225 offset:18432
v_mfma_f32_16x16x32_bf16 v[72:75], v[128:131], v[108:111], v[72:75]
v_mfma_f32_16x16x32_bf16 v[4:7], v[132:135], v[96:99], v[4:7]
ds_read_b128 v[120:123], v225 offset:20480
v_mfma_f32_16x16x32_bf16 v[28:31], v[132:135], v[100:103], v[28:31]
v_mfma_f32_16x16x32_bf16 v[52:55], v[132:135], v[104:107], v[52:55]
ds_read_b128 v[124:127], v225 offset:22528
v_mfma_f32_16x16x32_bf16 v[76:79], v[132:135], v[108:111], v[76:79]
v_mfma_f32_16x16x32_bf16 v[8:11], v[136:139], v[96:99], v[8:11]
ds_read_b128 v[152:155], v226 offset:36864
v_mfma_f32_16x16x32_bf16 v[32:35], v[136:139], v[100:103], v[32:35]
v_mfma_f32_16x16x32_bf16 v[56:59], v[136:139], v[104:107], v[56:59]
ds_read_b128 v[156:159], v226 offset:37888
v_mfma_f32_16x16x32_bf16 v[80:83], v[136:139], v[108:111], v[80:83]
v_mfma_f32_16x16x32_bf16 v[12:15], v[140:143], v[96:99], v[12:15]
ds_read_b128 v[160:163], v226 offset:38912
v_mfma_f32_16x16x32_bf16 v[36:39], v[140:143], v[100:103], v[36:39]
v_mfma_f32_16x16x32_bf16 v[60:63], v[140:143], v[104:107], v[60:63]
ds_read_b128 v[164:167], v226 offset:39936
v_mfma_f32_16x16x32_bf16 v[84:87], v[140:143], v[108:111], v[84:87]
v_mfma_f32_16x16x32_bf16 v[16:19], v[144:147], v[96:99], v[16:19]
ds_read_b128 v[168:171], v226 offset:40960
v_mfma_f32_16x16x32_bf16 v[40:43], v[144:147], v[100:103], v[40:43]
v_mfma_f32_16x16x32_bf16 v[64:67], v[144:147], v[104:107], v[64:67]
ds_read_b128 v[172:175], v226 offset:41984
v_mfma_f32_16x16x32_bf16 v[88:91], v[144:147], v[108:111], v[88:91]
v_mfma_f32_16x16x32_bf16 v[20:23], v[148:151], v[96:99], v[20:23]
v_mfma_f32_16x16x32_bf16 v[44:47], v[148:151], v[100:103], v[44:47]
v_mfma_f32_16x16x32_bf16 v[68:71], v[148:151], v[104:107], v[68:71]
v_mfma_f32_16x16x32_bf16 v[92:95], v[148:151], v[108:111], v[92:95]
s_waitcnt lgkmcnt(0)
s_barrier
v_mfma_f32_16x16x32_bf16 v[0:3], v[152:155], v[112:115], v[0:3]
ds_read_b128 v[96:99], v224 offset:32768
v_mfma_f32_16x16x32_bf16 v[24:27], v[152:155], v[116:119], v[24:27]
v_mfma_f32_16x16x32_bf16 v[48:51], v[152:155], v[120:123], v[48:51]
ds_read_b128 v[100:103], v224 offset:34816
v_mfma_f32_16x16x32_bf16 v[72:75], v[152:155], v[124:127], v[72:75]
v_mfma_f32_16x16x32_bf16 v[4:7], v[156:159], v[112:115], v[4:7]
ds_read_b128 v[104:107], v224 offset:36864
v_mfma_f32_16x16x32_bf16 v[28:31], v[156:159], v[116:119], v[28:31]
v_mfma_f32_16x16x32_bf16 v[52:55], v[156:159], v[120:123], v[52:55]
ds_read_b128 v[108:111], v224 offset:38912
v_mfma_f32_16x16x32_bf16 v[76:79], v[156:159], v[124:127], v[76:79]
v_mfma_f32_16x16x32_bf16 v[8:11], v[160:163], v[112:115], v[8:11]
ds_read_b128 v[128:131], v227 offset:0
v_mfma_f32_16x16x32_bf16 v[32:35], v[160:163], v[116:119], v[32:35]
v_mfma_f32_16x16x32_bf16 v[56:59], v[160:163], v[120:123], v[56:59]
ds_read_b128 v[132:135], v227 offset:1024
v_mfma_f32_16x16x32_bf16 v[80:83], v[160:163], v[124:127], v[80:83]
v_mfma_f32_16x16x32_bf16 v[12:15], v[164:167], v[112:115], v[12:15]
ds_read_b128 v[136:139], v227 offset:2048
v_mfma_f32_16x16x32_bf16 v[36:39], v[164:167], v[116:119], v[36:39]
v_mfma_f32_16x16x32_bf16 v[60:63], v[164:167], v[120:123], v[60:63]
ds_read_b128 v[140:143], v227 offset:3072
v_mfma_f32_16x16x32_bf16 v[84:87], v[164:167], v[124:127], v[84:87]
v_mfma_f32_16x16x32_bf16 v[16:19], v[168:171], v[112:115], v[16:19]
ds_read_b128 v[144:147], v227 offset:4096
v_mfma_f32_16x16x32_bf16 v[40:43], v[168:171], v[116:119], v[40:43]
v_mfma_f32_16x16x32_bf16 v[64:67], v[168:171], v[120:123], v[64:67]
ds_read_b128 v[148:151], v227 offset:5120
v_mfma_f32_16x16x32_bf16 v[88:91], v[168:171], v[124:127], v[88:91]
v_mfma_f32_16x16x32_bf16 v[20:23], v[172:175], v[112:115], v[20:23]
v_mfma_f32_16x16x32_bf16 v[44:47], v[172:175], v[116:119], v[44:47]
v_mfma_f32_16x16x32_bf16 v[68:71], v[172:175], v[120:123], v[68:71]
v_mfma_f32_16x16x32_bf16 v[92:95], v[172:175], v[124:127], v[92:95]
s_waitcnt lgkmcnt(0)
v_mfma_f32_16x16x32_bf16 v[0:3], v[128:131], v[96:99], v[0:3]
ds_read_b128 v[112:115], v225 offset:32768
v_mfma_f32_16x16x32_bf16 v[24:27], v[128:131], v[100:103], v[24:27]
v_mfma_f32_16x16x32_bf16 v[48:51], v[128:131], v[104:107], v[48:51]
ds_read_b128 v[116:119], v225 offset:34816
v_mfma_f32_16x16x32_bf16 v[72:75], v[128:131], v[108:111], v[72:75]
v_mfma_f32_16x16x32_bf16 v[4:7], v[132:135], v[96:99], v[4:7]
ds_read_b128 v[120:123], v225 offset:36864
v_mfma_f32_16x16x32_bf16 v[28:31], v[132:135], v[100:103], v[28:31]
v_mfma_f32_16x16x32_bf16 v[52:55], v[132:135], v[104:107], v[52:55]
ds_read_b128 v[124:127], v225 offset:38912
v_mfma_f32_16x16x32_bf16 v[76:79], v[132:135], v[108:111], v[76:79]
v_mfma_f32_16x16x32_bf16 v[8:11], v[136:139], v[96:99], v[8:11]
ds_read_b128 v[152:155], v227 offset:12288
v_mfma_f32_16x16x32_bf16 v[32:35], v[136:139], v[100:103], v[32:35]
v_mfma_f32_16x16x32_bf16 v[56:59], v[136:139], v[104:107], v[56:59]
ds_read_b128 v[156:159], v227 offset:13312
v_mfma_f32_16x16x32_bf16 v[80:83], v[136:139], v[108:111], v[80:83]
v_mfma_f32_16x16x32_bf16 v[12:15], v[140:143], v[96:99], v[12:15]
ds_read_b128 v[160:163], v227 offset:14336
v_mfma_f32_16x16x32_bf16 v[36:39], v[140:143], v[100:103], v[36:39]
v_mfma_f32_16x16x32_bf16 v[60:63], v[140:143], v[104:107], v[60:63]
ds_read_b128 v[164:167], v227 offset:15360
v_mfma_f32_16x16x32_bf16 v[84:87], v[140:143], v[108:111], v[84:87]
v_mfma_f32_16x16x32_bf16 v[16:19], v[144:147], v[96:99], v[16:19]
ds_read_b128 v[168:171], v227 offset:16384
v_mfma_f32_16x16x32_bf16 v[40:43], v[144:147], v[100:103], v[40:43]
v_mfma_f32_16x16x32_bf16 v[64:67], v[144:147], v[104:107], v[64:67]
ds_read_b128 v[172:175], v227 offset:17408
v_mfma_f32_16x16x32_bf16 v[88:91], v[144:147], v[108:111], v[88:91]
v_mfma_f32_16x16x32_bf16 v[20:23], v[148:151], v[96:99], v[20:23]
v_mfma_f32_16x16x32_bf16 v[44:47], v[148:151], v[100:103], v[44:47]
v_mfma_f32_16x16x32_bf16 v[68:71], v[148:151], v[104:107], v[68:71]
v_mfma_f32_16x16x32_bf16 v[92:95], v[148:151], v[108:111], v[92:95]
s_waitcnt lgkmcnt(0)
s_barrier
v_mfma_f32_16x16x32_bf16 v[0:3], v[152:155], v[112:115], v[0:3]
ds_read_b128 v[96:99], v224 offset:49152
v_mfma_f32_16x16x32_bf16 v[24:27], v[152:155], v[116:119], v[24:27]
v_mfma_f32_16x16x32_bf16 v[48:51], v[152:155], v[120:123], v[48:51]
ds_read_b128 v[100:103], v224 offset:51200
v_mfma_f32_16x16x32_bf16 v[72:75], v[152:155], v[124:127], v[72:75]
v_mfma_f32_16x16x32_bf16 v[4:7], v[156:159], v[112:115], v[4:7]
ds_read_b128 v[104:107], v224 offset:53248
v_mfma_f32_16x16x32_bf16 v[28:31], v[156:159], v[116:119], v[28:31]
v_mfma_f32_16x16x32_bf16 v[52:55], v[156:159], v[120:123], v[52:55]
ds_read_b128 v[108:111], v224 offset:55296
v_mfma_f32_16x16x32_bf16 v[76:79], v[156:159], v[124:127], v[76:79]
v_mfma_f32_16x16x32_bf16 v[8:11], v[160:163], v[112:115], v[8:11]
ds_read_b128 v[128:131], v227 offset:24576
v_mfma_f32_16x16x32_bf16 v[32:35], v[160:163], v[116:119], v[32:35]
v_mfma_f32_16x16x32_bf16 v[56:59], v[160:163], v[120:123], v[56:59]
ds_read_b128 v[132:135], v227 offset:25600
v_mfma_f32_16x16x32_bf16 v[80:83], v[160:163], v[124:127], v[80:83]
v_mfma_f32_16x16x32_bf16 v[12:15], v[164:167], v[112:115], v[12:15]
ds_read_b128 v[136:139], v227 offset:26624
v_mfma_f32_16x16x32_bf16 v[36:39], v[164:167], v[116:119], v[36:39]
v_mfma_f32_16x16x32_bf16 v[60:63], v[164:167], v[120:123], v[60:63]
ds_read_b128 v[140:143], v227 offset:27648
v_mfma_f32_16x16x32_bf16 v[84:87], v[164:167], v[124:127], v[84:87]
v_mfma_f32_16x16x32_bf16 v[16:19], v[168:171], v[112:115], v[16:19]
ds_read_b128 v[144:147], v227 offset:28672
v_mfma_f32_16x16x32_bf16 v[40:43], v[168:171], v[116:119], v[40:43]
v_mfma_f32_16x16x32_bf16 v[64:67], v[168:171], v[120:123], v[64:67]
ds_read_b128 v[148:151], v227 offset:29696
v_mfma_f32_16x16x32_bf16 v[88:91], v[168:171], v[124:127], v[88:91]
v_mfma_f32_16x16x32_bf16 v[20:23], v[172:175], v[112:115], v[20:23]
v_mfma_f32_16x16x32_bf16 v[44:47], v[172:175], v[116:119], v[44:47]
v_mfma_f32_16x16x32_bf16 v[68:71], v[172:175], v[120:123], v[68:71]
v_mfma_f32_16x16x32_bf16 v[92:95], v[172:175], v[124:127], v[92:95]
s_waitcnt lgkmcnt(0)
v_mfma_f32_16x16x32_bf16 v[0:3], v[128:131], v[96:99], v[0:3]
ds_read_b128 v[112:115], v225 offset:49152
v_mfma_f32_16x16x32_bf16 v[24:27], v[128:131], v[100:103], v[24:27]
v_mfma_f32_16x16x32_bf16 v[48:51], v[128:131], v[104:107], v[48:51]
ds_read_b128 v[116:119], v225 offset:51200
v_mfma_f32_16x16x32_bf16 v[72:75], v[128:131], v[108:111], v[72:75]
v_mfma_f32_16x16x32_bf16 v[4:7], v[132:135], v[96:99], v[4:7]
ds_read_b128 v[120:123], v225 offset:53248
v_mfma_f32_16x16x32_bf16 v[28:31], v[132:135], v[100:103], v[28:31]
v_mfma_f32_16x16x32_bf16 v[52:55], v[132:135], v[104:107], v[52:55]
ds_read_b128 v[124:127], v225 offset:55296
v_mfma_f32_16x16x32_bf16 v[76:79], v[132:135], v[108:111], v[76:79]
v_mfma_f32_16x16x32_bf16 v[8:11], v[136:139], v[96:99], v[8:11]
ds_read_b128 v[152:155], v227 offset:36864
v_mfma_f32_16x16x32_bf16 v[32:35], v[136:139], v[100:103], v[32:35]
v_mfma_f32_16x16x32_bf16 v[56:59], v[136:139], v[104:107], v[56:59]
ds_read_b128 v[156:159], v227 offset:37888
v_mfma_f32_16x16x32_bf16 v[80:83], v[136:139], v[108:111], v[80:83]
v_mfma_f32_16x16x32_bf16 v[12:15], v[140:143], v[96:99], v[12:15]
ds_read_b128 v[160:163], v227 offset:38912
v_mfma_f32_16x16x32_bf16 v[36:39], v[140:143], v[100:103], v[36:39]
v_mfma_f32_16x16x32_bf16 v[60:63], v[140:143], v[104:107], v[60:63]
ds_read_b128 v[164:167], v227 offset:39936
v_mfma_f32_16x16x32_bf16 v[84:87], v[140:143], v[108:111], v[84:87]
v_mfma_f32_16x16x32_bf16 v[16:19], v[144:147], v[96:99], v[16:19]
ds_read_b128 v[168:171], v227 offset:40960
v_mfma_f32_16x16x32_bf16 v[40:43], v[144:147], v[100:103], v[40:43]
v_mfma_f32_16x16x32_bf16 v[64:67], v[144:147], v[104:107], v[64:67]
ds_read_b128 v[172:175], v227 offset:41984
v_mfma_f32_16x16x32_bf16 v[88:91], v[144:147], v[108:111], v[88:91]
v_mfma_f32_16x16x32_bf16 v[20:23], v[148:151], v[96:99], v[20:23]
v_mfma_f32_16x16x32_bf16 v[44:47], v[148:151], v[100:103], v[44:47]
v_mfma_f32_16x16x32_bf16 v[68:71], v[148:151], v[104:107], v[68:71]
v_mfma_f32_16x16x32_bf16 v[92:95], v[148:151], v[108:111], v[92:95]
s_waitcnt lgkmcnt(0)
s_barrier
v_mfma_f32_16x16x32_bf16 v[0:3], v[152:155], v[112:115], v[0:3]
ds_read_b128 v[96:99], v224 offset:0
v_mfma_f32_16x16x32_bf16 v[24:27], v[152:155], v[116:119], v[24:27]
v_mfma_f32_16x16x32_bf16 v[48:51], v[152:155], v[120:123], v[48:51]
ds_read_b128 v[100:103], v224 offset:2048
v_mfma_f32_16x16x32_bf16 v[72:75], v[152:155], v[124:127], v[72:75]
v_mfma_f32_16x16x32_bf16 v[4:7], v[156:159], v[112:115], v[4:7]
ds_read_b128 v[104:107], v224 offset:4096
v_mfma_f32_16x16x32_bf16 v[28:31], v[156:159], v[116:119], v[28:31]
v_mfma_f32_16x16x32_bf16 v[52:55], v[156:159], v[120:123], v[52:55]
ds_read_b128 v[108:111], v224 offset:6144
v_mfma_f32_16x16x32_bf16 v[76:79], v[156:159], v[124:127], v[76:79]
v_mfma_f32_16x16x32_bf16 v[8:11], v[160:163], v[112:115], v[8:11]
ds_read_b128 v[128:131], v226 offset:0
v_mfma_f32_16x16x32_bf16 v[32:35], v[160:163], v[116:119], v[32:35]
v_mfma_f32_16x16x32_bf16 v[56:59], v[160:163], v[120:123], v[56:59]
ds_read_b128 v[132:135], v226 offset:1024
v_mfma_f32_16x16x32_bf16 v[80:83], v[160:163], v[124:127], v[80:83]
v_mfma_f32_16x16x32_bf16 v[12:15], v[164:167], v[112:115], v[12:15]
ds_read_b128 v[136:139], v226 offset:2048
v_mfma_f32_16x16x32_bf16 v[36:39], v[164:167], v[116:119], v[36:39]
v_mfma_f32_16x16x32_bf16 v[60:63], v[164:167], v[120:123], v[60:63]
ds_read_b128 v[140:143], v226 offset:3072
v_mfma_f32_16x16x32_bf16 v[84:87], v[164:167], v[124:127], v[84:87]
v_mfma_f32_16x16x32_bf16 v[16:19], v[168:171], v[112:115], v[16:19]
ds_read_b128 v[144:147], v226 offset:4096
v_mfma_f32_16x16x32_bf16 v[40:43], v[168:171], v[116:119], v[40:43]
v_mfma_f32_16x16x32_bf16 v[64:67], v[168:171], v[120:123], v[64:67]
ds_read_b128 v[148:151], v226 offset:5120
v_mfma_f32_16x16x32_bf16 v[88:91], v[168:171], v[124:127], v[88:91]
v_mfma_f32_16x16x32_bf16 v[20:23], v[172:175], v[112:115], v[20:23]
v_mfma_f32_16x16x32_bf16 v[44:47], v[172:175], v[116:119], v[44:47]
v_mfma_f32_16x16x32_bf16 v[68:71], v[172:175], v[120:123], v[68:71]
v_mfma_f32_16x16x32_bf16 v[92:95], v[172:175], v[124:127], v[92:95]
s_mov_b32 s44, 5
.p2align 6
L_loop:
s_waitcnt lgkmcnt(0)
v_mfma_f32_16x16x32_bf16 v[0:3], v[128:131], v[96:99], v[0:3]
ds_read_b128 v[112:115], v225 offset:0
v_mfma_f32_16x16x32_bf16 v[24:27], v[128:131], v[100:103], v[24:27]
v_mfma_f32_16x16x32_bf16 v[48:51], v[128:131], v[104:107], v[48:51]
ds_read_b128 v[116:119], v225 offset:2048
v_mfma_f32_16x16x32_bf16 v[72:75], v[128:131], v[108:111], v[72:75]
v_mfma_f32_16x16x32_bf16 v[4:7], v[132:135], v[96:99], v[4:7]
ds_read_b128 v[120:123], v225 offset:4096
v_mfma_f32_16x16x32_bf16 v[28:31], v[132:135], v[100:103], v[28:31]
v_mfma_f32_16x16x32_bf16 v[52:55], v[132:135], v[104:107], v[52:55]
ds_read_b128 v[124:127], v225 offset:6144
v_mfma_f32_16x16x32_bf16 v[76:79], v[132:135], v[108:111], v[76:79]
v_mfma_f32_16x16x32_bf16 v[8:11], v[136:139], v[96:99], v[8:11]
ds_read_b128 v[152:155], v226 offset:12288
v_mfma_f32_16x16x32_bf16 v[32:35], v[136:139], v[100:103], v[32:35]
v_mfma_f32_16x16x32_bf16 v[56:59], v[136:139], v[104:107], v[56:59]
ds_read_b128 v[156:159], v226 offset:13312
v_mfma_f32_16x16x32_bf16 v[80:83], v[136:139], v[108:111], v[80:83]
v_mfma_f32_16x16x32_bf16 v[12:15], v[140:143], v[96:99], v[12:15]
ds_read_b128 v[160:163], v226 offset:14336
v_mfma_f32_16x16x32_bf16 v[36:39], v[140:143], v[100:103], v[36:39]
v_mfma_f32_16x16x32_bf16 v[60:63], v[140:143], v[104:107], v[60:63]
ds_read_b128 v[164:167], v226 offset:15360
v_mfma_f32_16x16x32_bf16 v[84:87], v[140:143], v[108:111], v[84:87]
v_mfma_f32_16x16x32_bf16 v[16:19], v[144:147], v[96:99], v[16:19]
ds_read_b128 v[168:171], v226 offset:16384
v_mfma_f32_16x16x32_bf16 v[40:43], v[144:147], v[100:103], v[40:43]
v_mfma_f32_16x16x32_bf16 v[64:67], v[144:147], v[104:107], v[64:67]
ds_read_b128 v[172:175], v226 offset:17408
v_mfma_f32_16x16x32_bf16 v[88:91], v[144:147], v[108:111], v[88:91]
v_mfma_f32_16x16x32_bf16 v[20:23], v[148:151], v[96:99], v[20:23]
v_mfma_f32_16x16x32_bf16 v[44:47], v[148:151], v[100:103], v[44:47]
v_mfma_f32_16x16x32_bf16 v[68:71], v[148:151], v[104:107], v[68:71]
v_mfma_f32_16x16x32_bf16 v[92:95], v[148:151], v[108:111], v[92:95]
s_waitcnt lgkmcnt(0)
s_barrier
v_mfma_f32_16x16x32_bf16 v[0:3], v[152:155], v[112:115], v[0:3]
ds_read_b128 v[96:99], v224 offset:16384
v_mfma_f32_16x16x32_bf16 v[24:27], v[152:155], v[116:119], v[24:27]
v_mfma_f32_16x16x32_bf16 v[48:51], v[152:155], v[120:123], v[48:51]
ds_read_b128 v[100:103], v224 offset:18432
v_mfma_f32_16x16x32_bf16 v[72:75], v[152:155], v[124:127], v[72:75]
v_mfma_f32_16x16x32_bf16 v[4:7], v[156:159], v[112:115], v[4:7]
ds_read_b128 v[104:107], v224 offset:20480
v_mfma_f32_16x16x32_bf16 v[28:31], v[156:159], v[116:119], v[28:31]
v_mfma_f32_16x16x32_bf16 v[52:55], v[156:159], v[120:123], v[52:55]
ds_read_b128 v[108:111], v224 offset:22528
v_mfma_f32_16x16x32_bf16 v[76:79], v[156:159], v[124:127], v[76:79]
v_mfma_f32_16x16x32_bf16 v[8:11], v[160:163], v[112:115], v[8:11]
ds_read_b128 v[128:131], v226 offset:24576
v_mfma_f32_16x16x32_bf16 v[32:35], v[160:163], v[116:119], v[32:35]
v_mfma_f32_16x16x32_bf16 v[56:59], v[160:163], v[120:123], v[56:59]
ds_read_b128 v[132:135], v226 offset:25600
v_mfma_f32_16x16x32_bf16 v[80:83], v[160:163], v[124:127], v[80:83]
v_mfma_f32_16x16x32_bf16 v[12:15], v[164:167], v[112:115], v[12:15]
ds_read_b128 v[136:139], v226 offset:26624
v_mfma_f32_16x16x32_bf16 v[36:39], v[164:167], v[116:119], v[36:39]
v_mfma_f32_16x16x32_bf16 v[60:63], v[164:167], v[120:123], v[60:63]
ds_read_b128 v[140:143], v226 offset:27648
v_mfma_f32_16x16x32_bf16 v[84:87], v[164:167], v[124:127], v[84:87]
v_mfma_f32_16x16x32_bf16 v[16:19], v[168:171], v[112:115], v[16:19]
ds_read_b128 v[144:147], v226 offset:28672
v_mfma_f32_16x16x32_bf16 v[40:43], v[168:171], v[116:119], v[40:43]
v_mfma_f32_16x16x32_bf16 v[64:67], v[168:171], v[120:123], v[64:67]
ds_read_b128 v[148:151], v226 offset:29696
v_mfma_f32_16x16x32_bf16 v[88:91], v[168:171], v[124:127], v[88:91]
v_mfma_f32_16x16x32_bf16 v[20:23], v[172:175], v[112:115], v[20:23]
v_mfma_f32_16x16x32_bf16 v[44:47], v[172:175], v[116:119], v[44:47]
v_mfma_f32_16x16x32_bf16 v[68:71], v[172:175], v[120:123], v[68:71]
v_mfma_f32_16x16x32_bf16 v[92:95], v[172:175], v[124:127], v[92:95]
s_waitcnt lgkmcnt(0)
v_mfma_f32_16x16x32_bf16 v[0:3], v[128:131], v[96:99], v[0:3]
ds_read_b128 v[112:115], v225 offset:16384
v_mfma_f32_16x16x32_bf16 v[24:27], v[128:131], v[100:103], v[24:27]
v_mfma_f32_16x16x32_bf16 v[48:51], v[128:131], v[104:107], v[48:51]
ds_read_b128 v[116:119], v225 offset:18432
v_mfma_f32_16x16x32_bf16 v[72:75], v[128:131], v[108:111], v[72:75]
v_mfma_f32_16x16x32_bf16 v[4:7], v[132:135], v[96:99], v[4:7]
ds_read_b128 v[120:123], v225 offset:20480
v_mfma_f32_16x16x32_bf16 v[28:31], v[132:135], v[100:103], v[28:31]
v_mfma_f32_16x16x32_bf16 v[52:55], v[132:135], v[104:107], v[52:55]
ds_read_b128 v[124:127], v225 offset:22528
v_mfma_f32_16x16x32_bf16 v[76:79], v[132:135], v[108:111], v[76:79]
v_mfma_f32_16x16x32_bf16 v[8:11], v[136:139], v[96:99], v[8:11]
ds_read_b128 v[152:155], v226 offset:36864
v_mfma_f32_16x16x32_bf16 v[32:35], v[136:139], v[100:103], v[32:35]
v_mfma_f32_16x16x32_bf16 v[56:59], v[136:139], v[104:107], v[56:59]
ds_read_b128 v[156:159], v226 offset:37888
v_mfma_f32_16x16x32_bf16 v[80:83], v[136:139], v[108:111], v[80:83]
v_mfma_f32_16x16x32_bf16 v[12:15], v[140:143], v[96:99], v[12:15]
ds_read_b128 v[160:163], v226 offset:38912
v_mfma_f32_16x16x32_bf16 v[36:39], v[140:143], v[100:103], v[36:39]
v_mfma_f32_16x16x32_bf16 v[60:63], v[140:143], v[104:107], v[60:63]
ds_read_b128 v[164:167], v226 offset:39936
v_mfma_f32_16x16x32_bf16 v[84:87], v[140:143], v[108:111], v[84:87]
v_mfma_f32_16x16x32_bf16 v[16:19], v[144:147], v[96:99], v[16:19]
ds_read_b128 v[168:171], v226 offset:40960
v_mfma_f32_16x16x32_bf16 v[40:43], v[144:147], v[100:103], v[40:43]
v_mfma_f32_16x16x32_bf16 v[64:67], v[144:147], v[104:107], v[64:67]
ds_read_b128 v[172:175], v226 offset:41984
v_mfma_f32_16x16x32_bf16 v[88:91], v[144:147], v[108:111], v[88:91]
v_mfma_f32_16x16x32_bf16 v[20:23], v[148:151], v[96:99], v[20:23]
v_mfma_f32_16x16x32_bf16 v[44:47], v[148:151], v[100:103], v[44:47]
v_mfma_f32_16x16x32_bf16 v[68:71], v[148:151], v[104:107], v[68:71]
v_mfma_f32_16x16x32_bf16 v[92:95], v[148:151], v[108:111], v[92:95]
s_waitcnt lgkmcnt(0)
s_barrier
v_mfma_f32_16x16x32_bf16 v[0:3], v[152:155], v[112:115], v[0:3]
ds_read_b128 v[96:99], v224 offset:32768
v_mfma_f32_16x16x32_bf16 v[24:27], v[152:155], v[116:119], v[24:27]
v_mfma_f32_16x16x32_bf16 v[48:51], v[152:155], v[120:123], v[48:51]
ds_read_b128 v[100:103], v224 offset:34816
v_mfma_f32_16x16x32_bf16 v[72:75], v[152:155], v[124:127], v[72:75]
v_mfma_f32_16x16x32_bf16 v[4:7], v[156:159], v[112:115], v[4:7]
ds_read_b128 v[104:107], v224 offset:36864
v_mfma_f32_16x16x32_bf16 v[28:31], v[156:159], v[116:119], v[28:31]
v_mfma_f32_16x16x32_bf16 v[52:55], v[156:159], v[120:123], v[52:55]
ds_read_b128 v[108:111], v224 offset:38912
v_mfma_f32_16x16x32_bf16 v[76:79], v[156:159], v[124:127], v[76:79]
v_mfma_f32_16x16x32_bf16 v[8:11], v[160:163], v[112:115], v[8:11]
ds_read_b128 v[128:131], v227 offset:0
v_mfma_f32_16x16x32_bf16 v[32:35], v[160:163], v[116:119], v[32:35]
v_mfma_f32_16x16x32_bf16 v[56:59], v[160:163], v[120:123], v[56:59]
ds_read_b128 v[132:135], v227 offset:1024
v_mfma_f32_16x16x32_bf16 v[80:83], v[160:163], v[124:127], v[80:83]
v_mfma_f32_16x16x32_bf16 v[12:15], v[164:167], v[112:115], v[12:15]
ds_read_b128 v[136:139], v227 offset:2048
v_mfma_f32_16x16x32_bf16 v[36:39], v[164:167], v[116:119], v[36:39]
v_mfma_f32_16x16x32_bf16 v[60:63], v[164:167], v[120:123], v[60:63]
ds_read_b128 v[140:143], v227 offset:3072
v_mfma_f32_16x16x32_bf16 v[84:87], v[164:167], v[124:127], v[84:87]
v_mfma_f32_16x16x32_bf16 v[16:19], v[168:171], v[112:115], v[16:19]
ds_read_b128 v[144:147], v227 offset:4096
v_mfma_f32_16x16x32_bf16 v[40:43], v[168:171], v[116:119], v[40:43]
v_mfma_f32_16x16x32_bf16 v[64:67], v[168:171], v[120:123], v[64:67]
ds_read_b128 v[148:151], v227 offset:5120
v_mfma_f32_16x16x32_bf16 v[88:91], v[168:171], v[124:127], v[88:91]
v_mfma_f32_16x16x32_bf16 v[20:23], v[172:175], v[112:115], v[20:23]
v_mfma_f32_16x16x32_bf16 v[44:47], v[172:175], v[116:119], v[44:47]
v_mfma_f32_16x16x32_bf16 v[68:71], v[172:175], v[120:123], v[68:71]
v_mfma_f32_16x16x32_bf16 v[92:95], v[172:175], v[124:127], v[92:95]
s_waitcnt lgkmcnt(0)
v_mfma_f32_16x16x32_bf16 v[0:3], v[128:131], v[96:99], v[0:3]
ds_read_b128 v[112:115], v225 offset:32768
v_mfma_f32_16x16x32_bf16 v[24:27], v[128:131], v[100:103], v[24:27]
v_mfma_f32_16x16x32_bf16 v[48:51], v[128:131], v[104:107], v[48:51]
ds_read_b128 v[116:119], v225 offset:34816
v_mfma_f32_16x16x32_bf16 v[72:75], v[128:131], v[108:111], v[72:75]
v_mfma_f32_16x16x32_bf16 v[4:7], v[132:135], v[96:99], v[4:7]
ds_read_b128 v[120:123], v225 offset:36864
v_mfma_f32_16x16x32_bf16 v[28:31], v[132:135], v[100:103], v[28:31]
v_mfma_f32_16x16x32_bf16 v[52:55], v[132:135], v[104:107], v[52:55]
ds_read_b128 v[124:127], v225 offset:38912
v_mfma_f32_16x16x32_bf16 v[76:79], v[132:135], v[108:111], v[76:79]
v_mfma_f32_16x16x32_bf16 v[8:11], v[136:139], v[96:99], v[8:11]
ds_read_b128 v[152:155], v227 offset:12288
v_mfma_f32_16x16x32_bf16 v[32:35], v[136:139], v[100:103], v[32:35]
v_mfma_f32_16x16x32_bf16 v[56:59], v[136:139], v[104:107], v[56:59]
ds_read_b128 v[156:159], v227 offset:13312
v_mfma_f32_16x16x32_bf16 v[80:83], v[136:139], v[108:111], v[80:83]
v_mfma_f32_16x16x32_bf16 v[12:15], v[140:143], v[96:99], v[12:15]
ds_read_b128 v[160:163], v227 offset:14336
v_mfma_f32_16x16x32_bf16 v[36:39], v[140:143], v[100:103], v[36:39]
v_mfma_f32_16x16x32_bf16 v[60:63], v[140:143], v[104:107], v[60:63]
ds_read_b128 v[164:167], v227 offset:15360
v_mfma_f32_16x16x32_bf16 v[84:87], v[140:143], v[108:111], v[84:87]
v_mfma_f32_16x16x32_bf16 v[16:19], v[144:147], v[96:99], v[16:19]
ds_read_b128 v[168:171], v227 offset:16384
v_mfma_f32_16x16x32_bf16 v[40:43], v[144:147], v[100:103], v[40:43]
v_mfma_f32_16x16x32_bf16 v[64:67], v[144:147], v[104:107], v[64:67]
ds_read_b128 v[172:175], v227 offset:17408
v_mfma_f32_16x16x32_bf16 v[88:91], v[144:147], v[108:111], v[88:91]
v_mfma_f32_16x16x32_bf16 v[20:23], v[148:151], v[96:99], v[20:23]
v_mfma_f32_16x16x32_bf16 v[44:47], v[148:151], v[100:103], v[44:47]
v_mfma_f32_16x16x32_bf16 v[68:71], v[148:151], v[104:107], v[68:71]
v_mfma_f32_16x16x32_bf16 v[92:95], v[148:151], v[108:111], v[92:95]
s_waitcnt lgkmcnt(0)
s_barrier
v_mfma_f32_16x16x32_bf16 v[0:3], v[152:155], v[112:115], v[0:3]
ds_read_b128 v[96:99], v224 offset:49152
v_mfma_f32_16x16x32_bf16 v[24:27], v[152:155], v[116:119], v[24:27]
v_mfma_f32_16x16x32_bf16 v[48:51], v[152:155], v[120:123], v[48:51]
ds_read_b128 v[100:103], v224 offset:51200
v_mfma_f32_16x16x32_bf16 v[72:75], v[152:155], v[124:127], v[72:75]
v_mfma_f32_16x16x32_bf16 v[4:7], v[156:159], v[112:115], v[4:7]
ds_read_b128 v[104:107], v224 offset:53248
v_mfma_f32_16x16x32_bf16 v[28:31], v[156:159], v[116:119], v[28:31]
v_mfma_f32_16x16x32_bf16 v[52:55], v[156:159], v[120:123], v[52:55]
ds_read_b128 v[108:111], v224 offset:55296
v_mfma_f32_16x16x32_bf16 v[76:79], v[156:159], v[124:127], v[76:79]
v_mfma_f32_16x16x32_bf16 v[8:11], v[160:163], v[112:115], v[8:11]
ds_read_b128 v[128:131], v227 offset:24576
v_mfma_f32_16x16x32_bf16 v[32:35], v[160:163], v[116:119], v[32:35]
v_mfma_f32_16x16x32_bf16 v[56:59], v[160:163], v[120:123], v[56:59]
ds_read_b128 v[132:135], v227 offset:25600
v_mfma_f32_16x16x32_bf16 v[80:83], v[160:163], v[124:127], v[80:83]
v_mfma_f32_16x16x32_bf16 v[12:15], v[164:167], v[112:115], v[12:15]
ds_read_b128 v[136:139], v227 offset:26624
v_mfma_f32_16x16x32_bf16 v[36:39], v[164:167], v[116:119], v[36:39]
v_mfma_f32_16x16x32_bf16 v[60:63], v[164:167], v[120:123], v[60:63]
ds_read_b128 v[140:143], v227 offset:27648
v_mfma_f32_16x16x32_bf16 v[84:87], v[164:167], v[124:127], v[84:87]
v_mfma_f32_16x16x32_bf16 v[16:19], v[168:171], v[112:115], v[16:19]
ds_read_b128 v[144:147], v227 offset:28672
v_mfma_f32_16x16x32_bf16 v[40:43], v[168:171], v[116:119], v[40:43]
v_mfma_f32_16x16x32_bf16 v[64:67], v[168:171], v[120:123], v[64:67]
ds_read_b128 v[148:151], v227 offset:29696
v_mfma_f32_16x16x32_bf16 v[88:91], v[168:171], v[124:127], v[88:91]
v_mfma_f32_16x16x32_bf16 v[20:23], v[172:175], v[112:115], v[20:23]
v_mfma_f32_16x16x32_bf16 v[44:47], v[172:175], v[116:119], v[44:47]
v_mfma_f32_16x16x32_bf16 v[68:71], v[172:175], v[120:123], v[68:71]
v_mfma_f32_16x16x32_bf16 v[92:95], v[172:175], v[124:127], v[92:95]
s_waitcnt lgkmcnt(0)
v_mfma_f32_16x16x32_bf16 v[0:3], v[128:131], v[96:99], v[0:3]
ds_read_b128 v[112:115], v225 offset:49152
v_mfma_f32_16x16x32_bf16 v[24:27], v[128:131], v[100:103], v[24:27]
v_mfma_f32_16x16x32_bf16 v[48:51], v[128:131], v[104:107], v[48:51]
ds_read_b128 v[116:119], v225 offset:51200
v_mfma_f32_16x16x32_bf16 v[72:75], v[128:131], v[108:111], v[72:75]
v_mfma_f32_16x16x32_bf16 v[4:7], v[132:135], v[96:99], v[4:7]
ds_read_b128 v[120:123], v225 offset:53248
v_mfma_f32_16x16x32_bf16 v[28:31], v[132:135], v[100:103], v[28:31]
v_mfma_f32_16x16x32_bf16 v[52:55], v[132:135], v[104:107], v[52:55]
ds_read_b128 v[124:127], v225 offset:55296
v_mfma_f32_16x16x32_bf16 v[76:79], v[132:135], v[108:111], v[76:79]
v_mfma_f32_16x16x32_bf16 v[8:11], v[136:139], v[96:99], v[8:11]
ds_read_b128 v[152:155], v227 offset:36864
v_mfma_f32_16x16x32_bf16 v[32:35], v[136:139], v[100:103], v[32:35]
v_mfma_f32_16x16x32_bf16 v[56:59], v[136:139], v[104:107], v[56:59]
ds_read_b128 v[156:159], v227 offset:37888
v_mfma_f32_16x16x32_bf16 v[80:83], v[136:139], v[108:111], v[80:83]
v_mfma_f32_16x16x32_bf16 v[12:15], v[140:143], v[96:99], v[12:15]
ds_read_b128 v[160:163], v227 offset:38912
v_mfma_f32_16x16x32_bf16 v[36:39], v[140:143], v[100:103], v[36:39]
v_mfma_f32_16x16x32_bf16 v[60:63], v[140:143], v[104:107], v[60:63]
ds_read_b128 v[164:167], v227 offset:39936
v_mfma_f32_16x16x32_bf16 v[84:87], v[140:143], v[108:111], v[84:87]
v_mfma_f32_16x16x32_bf16 v[16:19], v[144:147], v[96:99], v[16:19]
ds_read_b128 v[168:171], v227 offset:40960
v_mfma_f32_16x16x32_bf16 v[40:43], v[144:147], v[100:103], v[40:43]
v_mfma_f32_16x16x32_bf16 v[64:67], v[144:147], v[104:107], v[64:67]
ds_read_b128 v[172:175], v227 offset:41984
v_mfma_f32_16x16x32_bf16 v[88:91], v[144:147], v[108:111], v[88:91]
v_mfma_f32_16x16x32_bf16 v[20:23], v[148:151], v[96:99], v[20:23]
v_mfma_f32_16x16x32_bf16 v[44:47], v[148:151], v[100:103], v[44:47]
v_mfma_f32_16x16x32_bf16 v[68:71], v[148:151], v[104:107], v[68:71]
v_mfma_f32_16x16x32_bf16 v[92:95], v[148:151], v[108:111], v[92:95]
s_waitcnt lgkmcnt(0)
s_barrier
v_mfma_f32_16x16x32_bf16 v[0:3], v[152:155], v[112:115], v[0:3]
ds_read_b128 v[96:99], v224 offset:0
v_mfma_f32_16x16x32_bf16 v[24:27], v[152:155], v[116:119], v[24:27]
v_mfma_f32_16x16x32_bf16 v[48:51], v[152:155], v[120:123], v[48:51]
ds_read_b128 v[100:103], v224 offset:2048
v_mfma_f32_16x16x32_bf16 v[72:75], v[152:155], v[124:127], v[72:75]
v_mfma_f32_16x16x32_bf16 v[4:7], v[156:159], v[112:115], v[4:7]
ds_read_b128 v[104:107], v224 offset:4096
v_mfma_f32_16x16x32_bf16 v[28:31], v[156:159], v[116:119], v[28:31]
v_mfma_f32_16x16x32_bf16 v[52:55], v[156:159], v[120:123], v[52:55]
ds_read_b128 v[108:111], v224 offset:6144
v_mfma_f32_16x16x32_bf16 v[76:79], v[156:159], v[124:127], v[76:79]
v_mfma_f32_16x16x32_bf16 v[8:11], v[160:163], v[112:115], v[8:11]
ds_read_b128 v[128:131], v226 offset:0
v_mfma_f32_16x16x32_bf16 v[32:35], v[160:163], v[116:119], v[32:35]
v_mfma_f32_16x16x32_bf16 v[56:59], v[160:163], v[120:123], v[56:59]
ds_read_b128 v[132:135], v226 offset:1024
v_mfma_f32_16x16x32_bf16 v[80:83], v[160:163], v[124:127], v[80:83]
v_mfma_f32_16x16x32_bf16 v[12:15], v[164:167], v[112:115], v[12:15]
ds_read_b128 v[136:139], v226 offset:2048
v_mfma_f32_16x16x32_bf16 v[36:39], v[164:167], v[116:119], v[36:39]
v_mfma_f32_16x16x32_bf16 v[60:63], v[164:167], v[120:123], v[60:63]
ds_read_b128 v[140:143], v226 offset:3072
v_mfma_f32_16x16x32_bf16 v[84:87], v[164:167], v[124:127], v[84:87]
v_mfma_f32_16x16x32_bf16 v[16:19], v[168:171], v[112:115], v[16:19]
ds_read_b128 v[144:147], v226 offset:4096
v_mfma_f32_16x16x32_bf16 v[40:43], v[168:171], v[116:119], v[40:43]
v_mfma_f32_16x16x32_bf16 v[64:67], v[168:171], v[120:123], v[64:67]
ds_read_b128 v[148:151], v226 offset:5120
v_mfma_f32_16x16x32_bf16 v[88:91], v[168:171], v[124:127], v[88:91]
v_mfma_f32_16x16x32_bf16 v[20:23], v[172:175], v[112:115], v[20:23]
v_mfma_f32_16x16x32_bf16 v[44:47], v[172:175], v[116:119], v[44:47]
v_mfma_f32_16x16x32_bf16 v[68:71], v[172:175], v[120:123], v[68:71]
s_sub_u32 s44, s44, 1
v_mfma_f32_16x16x32_bf16 v[92:95], v[172:175], v[124:127], v[92:95]
s_cmp_lg_u32 s44, 0
s_cbranch_scc1 L_loop
s_waitcnt lgkmcnt(0)
v_mfma_f32_16x16x32_bf16 v[0:3], v[128:131], v[96:99], v[0:3]
ds_read_b128 v[112:115], v225 offset:0
v_mfma_f32_16x16x32_bf16 v[24:27], v[128:131], v[100:103], v[24:27]
v_mfma_f32_16x16x32_bf16 v[48:51], v[128:131], v[104:107], v[48:51]
ds_read_b128 v[116:119], v225 offset:2048
v_mfma_f32_16x16x32_bf16 v[72:75], v[128:131], v[108:111], v[72:75]
v_mfma_f32_16x16x32_bf16 v[4:7], v[132:135], v[96:99], v[4:7]
ds_read_b128 v[120:123], v225 offset:4096
v_mfma_f32_16x16x32_bf16 v[28:31], v[132:135], v[100:103], v[28:31]
v_mfma_f32_16x16x32_bf16 v[52:55], v[132:135], v[104:107], v[52:55]
ds_read_b128 v[124:127], v225 offset:6144
v_mfma_f32_16x16x32_bf16 v[76:79], v[132:135], v[108:111], v[76:79]
v_mfma_f32_16x16x32_bf16 v[8:11], v[136:139], v[96:99], v[8:11]
ds_read_b128 v[152:155], v226 offset:12288
v_mfma_f32_16x16x32_bf16 v[32:35], v[136:139], v[100:103], v[32:35]
v_mfma_f32_16x16x32_bf16 v[56:59], v[136:139], v[104:107], v[56:59]
ds_read_b128 v[156:159], v226 offset:13312
v_mfma_f32_16x16x32_bf16 v[80:83], v[136:139], v[108:111], v[80:83]
v_mfma_f32_16x16x32_bf16 v[12:15], v[140:143], v[96:99], v[12:15]
ds_read_b128 v[160:163], v226 offset:14336
v_mfma_f32_16x16x32_bf16 v[36:39], v[140:143], v[100:103], v[36:39]
v_mfma_f32_16x16x32_bf16 v[60:63], v[140:143], v[104:107], v[60:63]
ds_read_b128 v[164:167], v226 offset:15360
v_mfma_f32_16x16x32_bf16 v[84:87], v[140:143], v[108:111], v[84:87]
v_mfma_f32_16x16x32_bf16 v[16:19], v[144:147], v[96:99], v[16:19]
ds_read_b128 v[168:171], v226 offset:16384
v_mfma_f32_16x16x32_bf16 v[40:43], v[144:147], v[100:103], v[40:43]
v_mfma_f32_16x16x32_bf16 v[64:67], v[144:147], v[104:107], v[64:67]
ds_read_b128 v[172:175], v226 offset:17408
v_mfma_f32_16x16x32_bf16 v[88:91], v[144:147], v[108:111], v[88:91]
v_mfma_f32_16x16x32_bf16 v[20:23], v[148:151], v[96:99], v[20:23]
v_mfma_f32_16x16x32_bf16 v[44:47], v[148:151], v[100:103], v[44:47]
v_mfma_f32_16x16x32_bf16 v[68:71], v[148:151], v[104:107], v[68:71]
v_mfma_f32_16x16x32_bf16 v[92:95], v[148:151], v[108:111], v[92:95]
s_waitcnt lgkmcnt(0)
s_barrier
v_mfma_f32_16x16x32_bf16 v[0:3], v[152:155], v[112:115], v[0:3]
ds_read_b128 v[96:99], v224 offset:16384
v_mfma_f32_16x16x32_bf16 v[24:27], v[152:155], v[116:119], v[24:27]
v_mfma_f32_16x16x32_bf16 v[48:51], v[152:155], v[120:123], v[48:51]
ds_read_b128 v[100:103], v224 offset:18432
v_mfma_f32_16x16x32_bf16 v[72:75], v[152:155], v[124:127], v[72:75]
v_mfma_f32_16x16x32_bf16 v[4:7], v[156:159], v[112:115], v[4:7]
ds_read_b128 v[104:107], v224 offset:20480
v_mfma_f32_16x16x32_bf16 v[28:31], v[156:159], v[116:119], v[28:31]
v_mfma_f32_16x16x32_bf16 v[52:55], v[156:159], v[120:123], v[52:55]
ds_read_b128 v[108:111], v224 offset:22528
v_mfma_f32_16x16x32_bf16 v[76:79], v[156:159], v[124:127], v[76:79]
v_mfma_f32_16x16x32_bf16 v[8:11], v[160:163], v[112:115], v[8:11]
ds_read_b128 v[128:131], v226 offset:24576
v_mfma_f32_16x16x32_bf16 v[32:35], v[160:163], v[116:119], v[32:35]
v_mfma_f32_16x16x32_bf16 v[56:59], v[160:163], v[120:123], v[56:59]
ds_read_b128 v[132:135], v226 offset:25600
v_mfma_f32_16x16x32_bf16 v[80:83], v[160:163], v[124:127], v[80:83]
v_mfma_f32_16x16x32_bf16 v[12:15], v[164:167], v[112:115], v[12:15]
ds_read_b128 v[136:139], v226 offset:26624
v_mfma_f32_16x16x32_bf16 v[36:39], v[164:167], v[116:119], v[36:39]
v_mfma_f32_16x16x32_bf16 v[60:63], v[164:167], v[120:123], v[60:63]
ds_read_b128 v[140:143], v226 offset:27648
v_mfma_f32_16x16x32_bf16 v[84:87], v[164:167], v[124:127], v[84:87]
v_mfma_f32_16x16x32_bf16 v[16:19], v[168:171], v[112:115], v[16:19]
ds_read_b128 v[144:147], v226 offset:28672
v_mfma_f32_16x16x32_bf16 v[40:43], v[168:171], v[116:119], v[40:43]
v_mfma_f32_16x16x32_bf16 v[64:67], v[168:171], v[120:123], v[64:67]
ds_read_b128 v[148:151], v226 offset:29696
v_mfma_f32_16x16x32_bf16 v[88:91], v[168:171], v[124:127], v[88:91]
v_mfma_f32_16x16x32_bf16 v[20:23], v[172:175], v[112:115], v[20:23]
v_mfma_f32_16x16x32_bf16 v[44:47], v[172:175], v[116:119], v[44:47]
v_mfma_f32_16x16x32_bf16 v[68:71], v[172:175], v[120:123], v[68:71]
v_mfma_f32_16x16x32_bf16 v[92:95], v[172:175], v[124:127], v[92:95]
s_waitcnt lgkmcnt(0)
v_mfma_f32_16x16x32_bf16 v[0:3], v[128:131], v[96:99], v[0:3]
ds_read_b128 v[112:115], v225 offset:16384
v_mfma_f32_16x16x32_bf16 v[24:27], v[128:131], v[100:103], v[24:27]
v_mfma_f32_16x16x32_bf16 v[48:51], v[128:131], v[104:107], v[48:51]
ds_read_b128 v[116:119], v225 offset:18432
v_mfma_f32_16x16x32_bf16 v[72:75], v[128:131], v[108:111], v[72:75]
v_mfma_f32_16x16x32_bf16 v[4:7], v[132:135], v[96:99], v[4:7]
ds_read_b128 v[120:123], v225 offset:20480
v_mfma_f32_16x16x32_bf16 v[28:31], v[132:135], v[100:103], v[28:31]
v_mfma_f32_16x16x32_bf16 v[52:55], v[132:135], v[104:107], v[52:55]
ds_read_b128 v[124:127], v225 offset:22528
v_mfma_f32_16x16x32_bf16 v[76:79], v[132:135], v[108:111], v[76:79]
v_mfma_f32_16x16x32_bf16 v[8:11], v[136:139], v[96:99], v[8:11]
ds_read_b128 v[152:155], v226 offset:36864
v_mfma_f32_16x16x32_bf16 v[32:35], v[136:139], v[100:103], v[32:35]
v_mfma_f32_16x16x32_bf16 v[56:59], v[136:139], v[104:107], v[56:59]
ds_read_b128 v[156:159], v226 offset:37888
v_mfma_f32_16x16x32_bf16 v[80:83], v[136:139], v[108:111], v[80:83]
v_mfma_f32_16x16x32_bf16 v[12:15], v[140:143], v[96:99], v[12:15]
ds_read_b128 v[160:163], v226 offset:38912
v_mfma_f32_16x16x32_bf16 v[36:39], v[140:143], v[100:103], v[36:39]
v_mfma_f32_16x16x32_bf16 v[60:63], v[140:143], v[104:107], v[60:63]
ds_read_b128 v[164:167], v226 offset:39936
v_mfma_f32_16x16x32_bf16 v[84:87], v[140:143], v[108:111], v[84:87]
v_mfma_f32_16x16x32_bf16 v[16:19], v[144:147], v[96:99], v[16:19]
ds_read_b128 v[168:171], v226 offset:40960
v_mfma_f32_16x16x32_bf16 v[40:43], v[144:147], v[100:103], v[40:43]
v_mfma_f32_16x16x32_bf16 v[64:67], v[144:147], v[104:107], v[64:67]
ds_read_b128 v[172:175], v226 offset:41984
v_mfma_f32_16x16x32_bf16 v[88:91], v[144:147], v[108:111], v[88:91]
v_mfma_f32_16x16x32_bf16 v[20:23], v[148:151], v[96:99], v[20:23]
v_mfma_f32_16x16x32_bf16 v[44:47], v[148:151], v[100:103], v[44:47]
v_mfma_f32_16x16x32_bf16 v[68:71], v[148:151], v[104:107], v[68:71]
v_mfma_f32_16x16x32_bf16 v[92:95], v[148:151], v[108:111], v[92:95]
s_waitcnt lgkmcnt(0)
s_barrier
v_mfma_f32_16x16x32_bf16 v[0:3], v[152:155], v[112:115], v[0:3]
ds_read_b128 v[96:99], v224 offset:32768
v_mfma_f32_16x16x32_bf16 v[24:27], v[152:155], v[116:119], v[24:27]
v_mfma_f32_16x16x32_bf16 v[48:51], v[152:155], v[120:123], v[48:51]
ds_read_b128 v[100:103], v224 offset:34816
v_mfma_f32_16x16x32_bf16 v[72:75], v[152:155], v[124:127], v[72:75]
v_mfma_f32_16x16x32_bf16 v[4:7], v[156:159], v[112:115], v[4:7]
ds_read_b128 v[104:107], v224 offset:36864
v_mfma_f32_16x16x32_bf16 v[28:31], v[156:159], v[116:119], v[28:31]
v_mfma_f32_16x16x32_bf16 v[52:55], v[156:159], v[120:123], v[52:55]
ds_read_b128 v[108:111], v224 offset:38912
v_mfma_f32_16x16x32_bf16 v[76:79], v[156:159], v[124:127], v[76:79]
v_mfma_f32_16x16x32_bf16 v[8:11], v[160:163], v[112:115], v[8:11]
ds_read_b128 v[128:131], v227 offset:0
v_mfma_f32_16x16x32_bf16 v[32:35], v[160:163], v[116:119], v[32:35]
v_mfma_f32_16x16x32_bf16 v[56:59], v[160:163], v[120:123], v[56:59]
ds_read_b128 v[132:135], v227 offset:1024
v_mfma_f32_16x16x32_bf16 v[80:83], v[160:163], v[124:127], v[80:83]
v_mfma_f32_16x16x32_bf16 v[12:15], v[164:167], v[112:115], v[12:15]
ds_read_b128 v[136:139], v227 offset:2048
v_mfma_f32_16x16x32_bf16 v[36:39], v[164:167], v[116:119], v[36:39]
v_mfma_f32_16x16x32_bf16 v[60:63], v[164:167], v[120:123], v[60:63]
ds_read_b128 v[140:143], v227 offset:3072
v_mfma_f32_16x16x32_bf16 v[84:87], v[164:167], v[124:127], v[84:87]
v_mfma_f32_16x16x32_bf16 v[16:19], v[168:171], v[112:115], v[16:19]
ds_read_b128 v[144:147], v227 offset:4096
v_mfma_f32_16x16x32_bf16 v[40:43], v[168:171], v[116:119], v[40:43]
v_mfma_f32_16x16x32_bf16 v[64:67], v[168:171], v[120:123], v[64:67]
ds_read_b128 v[148:151], v227 offset:5120
v_mfma_f32_16x16x32_bf16 v[88:91], v[168:171], v[124:127], v[88:91]
v_mfma_f32_16x16x32_bf16 v[20:23], v[172:175], v[112:115], v[20:23]
v_mfma_f32_16x16x32_bf16 v[44:47], v[172:175], v[116:119], v[44:47]
v_mfma_f32_16x16x32_bf16 v[68:71], v[172:175], v[120:123], v[68:71]
v_mfma_f32_16x16x32_bf16 v[92:95], v[172:175], v[124:127], v[92:95]
s_waitcnt lgkmcnt(0)
v_mfma_f32_16x16x32_bf16 v[0:3], v[128:131], v[96:99], v[0:3]
ds_read_b128 v[112:115], v225 offset:32768
v_mfma_f32_16x16x32_bf16 v[24:27], v[128:131], v[100:103], v[24:27]
v_mfma_f32_16x16x32_bf16 v[48:51], v[128:131], v[104:107], v[48:51]
ds_read_b128 v[116:119], v225 offset:34816
v_mfma_f32_16x16x32_bf16 v[72:75], v[128:131], v[108:111], v[72:75]
v_mfma_f32_16x16x32_bf16 v[4:7], v[132:135], v[96:99], v[4:7]
ds_read_b128 v[120:123], v225 offset:36864
v_mfma_f32_16x16x32_bf16 v[28:31], v[132:135], v[100:103], v[28:31]
v_mfma_f32_16x16x32_bf16 v[52:55], v[132:135], v[104:107], v[52:55]
ds_read_b128 v[124:127], v225 offset:38912
v_mfma_f32_16x16x32_bf16 v[76:79], v[132:135], v[108:111], v[76:79]
v_mfma_f32_16x16x32_bf16 v[8:11], v[136:139], v[96:99], v[8:11]
ds_read_b128 v[152:155], v227 offset:12288
v_mfma_f32_16x16x32_bf16 v[32:35], v[136:139], v[100:103], v[32:35]
v_mfma_f32_16x16x32_bf16 v[56:59], v[136:139], v[104:107], v[56:59]
ds_read_b128 v[156:159], v227 offset:13312
v_mfma_f32_16x16x32_bf16 v[80:83], v[136:139], v[108:111], v[80:83]
v_mfma_f32_16x16x32_bf16 v[12:15], v[140:143], v[96:99], v[12:15]
ds_read_b128 v[160:163], v227 offset:14336
v_mfma_f32_16x16x32_bf16 v[36:39], v[140:143], v[100:103], v[36:39]
v_mfma_f32_16x16x32_bf16 v[60:63], v[140:143], v[104:107], v[60:63]
ds_read_b128 v[164:167], v227 offset:15360
v_mfma_f32_16x16x32_bf16 v[84:87], v[140:143], v[108:111], v[84:87]
v_mfma_f32_16x16x32_bf16 v[16:19], v[144:147], v[96:99], v[16:19]
ds_read_b128 v[168:171], v227 offset:16384
v_mfma_f32_16x16x32_bf16 v[40:43], v[144:147], v[100:103], v[40:43]
v_mfma_f32_16x16x32_bf16 v[64:67], v[144:147], v[104:107], v[64:67]
ds_read_b128 v[172:175], v227 offset:17408
v_mfma_f32_16x16x32_bf16 v[88:91], v[144:147], v[108:111], v[88:91]
v_mfma_f32_16x16x32_bf16 v[20:23], v[148:151], v[96:99], v[20:23]
v_mfma_f32_16x16x32_bf16 v[44:47], v[148:151], v[100:103], v[44:47]
v_mfma_f32_16x16x32_bf16 v[68:71], v[148:151], v[104:107], v[68:71]
v_mfma_f32_16x16x32_bf16 v[92:95], v[148:151], v[108:111], v[92:95]
s_waitcnt lgkmcnt(0)
s_barrier
v_mfma_f32_16x16x32_bf16 v[0:3], v[152:155], v[112:115], v[0:3]
ds_read_b128 v[96:99], v224 offset:49152
v_mfma_f32_16x16x32_bf16 v[24:27], v[152:155], v[116:119], v[24:27]
v_mfma_f32_16x16x32_bf16 v[48:51], v[152:155], v[120:123], v[48:51]
ds_read_b128 v[100:103], v224 offset:51200
v_mfma_f32_16x16x32_bf16 v[72:75], v[152:155], v[124:127], v[72:75]
v_mfma_f32_16x16x32_bf16 v[4:7], v[156:159], v[112:115], v[4:7]
ds_read_b128 v[104:107], v224 offset:53248
v_mfma_f32_16x16x32_bf16 v[28:31], v[156:159], v[116:119], v[28:31]
v_mfma_f32_16x16x32_bf16 v[52:55], v[156:159], v[120:123], v[52:55]
ds_read_b128 v[108:111], v224 offset:55296
v_mfma_f32_16x16x32_bf16 v[76:79], v[156:159], v[124:127], v[76:79]
v_mfma_f32_16x16x32_bf16 v[8:11], v[160:163], v[112:115], v[8:11]
ds_read_b128 v[128:131], v227 offset:24576
v_mfma_f32_16x16x32_bf16 v[32:35], v[160:163], v[116:119], v[32:35]
v_mfma_f32_16x16x32_bf16 v[56:59], v[160:163], v[120:123], v[56:59]
ds_read_b128 v[132:135], v227 offset:25600
v_mfma_f32_16x16x32_bf16 v[80:83], v[160:163], v[124:127], v[80:83]
v_mfma_f32_16x16x32_bf16 v[12:15], v[164:167], v[112:115], v[12:15]
ds_read_b128 v[136:139], v227 offset:26624
v_mfma_f32_16x16x32_bf16 v[36:39], v[164:167], v[116:119], v[36:39]
v_mfma_f32_16x16x32_bf16 v[60:63], v[164:167], v[120:123], v[60:63]
ds_read_b128 v[140:143], v227 offset:27648
v_mfma_f32_16x16x32_bf16 v[84:87], v[164:167], v[124:127], v[84:87]
v_mfma_f32_16x16x32_bf16 v[16:19], v[168:171], v[112:115], v[16:19]
ds_read_b128 v[144:147], v227 offset:28672
v_mfma_f32_16x16x32_bf16 v[40:43], v[168:171], v[116:119], v[40:43]
v_mfma_f32_16x16x32_bf16 v[64:67], v[168:171], v[120:123], v[64:67]
ds_read_b128 v[148:151], v227 offset:29696
v_mfma_f32_16x16x32_bf16 v[88:91], v[168:171], v[124:127], v[88:91]
v_mfma_f32_16x16x32_bf16 v[20:23], v[172:175], v[112:115], v[20:23]
v_mfma_f32_16x16x32_bf16 v[44:47], v[172:175], v[116:119], v[44:47]
v_mfma_f32_16x16x32_bf16 v[68:71], v[172:175], v[120:123], v[68:71]
v_mfma_f32_16x16x32_bf16 v[92:95], v[172:175], v[124:127], v[92:95]
s_waitcnt lgkmcnt(0)
v_mfma_f32_16x16x32_bf16 v[0:3], v[128:131], v[96:99], v[0:3]
ds_read_b128 v[112:115], v225 offset:49152
v_mfma_f32_16x16x32_bf16 v[24:27], v[128:131], v[100:103], v[24:27]
v_mfma_f32_16x16x32_bf16 v[48:51], v[128:131], v[104:107], v[48:51]
ds_read_b128 v[116:119], v225 offset:51200
v_mfma_f32_16x16x32_bf16 v[72:75], v[128:131], v[108:111], v[72:75]
v_mfma_f32_16x16x32_bf16 v[4:7], v[132:135], v[96:99], v[4:7]
ds_read_b128 v[120:123], v225 offset:53248
v_mfma_f32_16x16x32_bf16 v[28:31], v[132:135], v[100:103], v[28:31]
v_mfma_f32_16x16x32_bf16 v[52:55], v[132:135], v[104:107], v[52:55]
ds_read_b128 v[124:127], v225 offset:55296
v_mfma_f32_16x16x32_bf16 v[76:79], v[132:135], v[108:111], v[76:79]
v_mfma_f32_16x16x32_bf16 v[8:11], v[136:139], v[96:99], v[8:11]
ds_read_b128 v[152:155], v227 offset:36864
v_mfma_f32_16x16x32_bf16 v[32:35], v[136:139], v[100:103], v[32:35]
v_mfma_f32_16x16x32_bf16 v[56:59], v[136:139], v[104:107], v[56:59]
ds_read_b128 v[156:159], v227 offset:37888
v_mfma_f32_16x16x32_bf16 v[80:83], v[136:139], v[108:111], v[80:83]
v_mfma_f32_16x16x32_bf16 v[12:15], v[140:143], v[96:99], v[12:15]
ds_read_b128 v[160:163], v227 offset:38912
v_mfma_f32_16x16x32_bf16 v[36:39], v[140:143], v[100:103], v[36:39]
v_mfma_f32_16x16x32_bf16 v[60:63], v[140:143], v[104:107], v[60:63]
ds_read_b128 v[164:167], v227 offset:39936
v_mfma_f32_16x16x32_bf16 v[84:87], v[140:143], v[108:111], v[84:87]
v_mfma_f32_16x16x32_bf16 v[16:19], v[144:147], v[96:99], v[16:19]
ds_read_b128 v[168:171], v227 offset:40960
v_mfma_f32_16x16x32_bf16 v[40:43], v[144:147], v[100:103], v[40:43]
v_mfma_f32_16x16x32_bf16 v[64:67], v[144:147], v[104:107], v[64:67]
ds_read_b128 v[172:175], v227 offset:41984
v_mfma_f32_16x16x32_bf16 v[88:91], v[144:147], v[108:111], v[88:91]
v_mfma_f32_16x16x32_bf16 v[20:23], v[148:151], v[96:99], v[20:23]
v_mfma_f32_16x16x32_bf16 v[44:47], v[148:151], v[100:103], v[44:47]
v_mfma_f32_16x16x32_bf16 v[68:71], v[148:151], v[104:107], v[68:71]
v_mfma_f32_16x16x32_bf16 v[92:95], v[148:151], v[108:111], v[92:95]
s_waitcnt lgkmcnt(0)
s_barrier
v_mfma_f32_16x16x32_bf16 v[0:3], v[152:155], v[112:115], v[0:3]
v_mfma_f32_16x16x32_bf16 v[24:27], v[152:155], v[116:119], v[24:27]
v_mfma_f32_16x16x32_bf16 v[48:51], v[152:155], v[120:123], v[48:51]
v_mfma_f32_16x16x32_bf16 v[72:75], v[152:155], v[124:127], v[72:75]
v_mfma_f32_16x16x32_bf16 v[4:7], v[156:159], v[112:115], v[4:7]
v_mfma_f32_16x16x32_bf16 v[28:31], v[156:159], v[116:119], v[28:31]
v_mfma_f32_16x16x32_bf16 v[52:55], v[156:159], v[120:123], v[52:55]
v_mfma_f32_16x16x32_bf16 v[76:79], v[156:159], v[124:127], v[76:79]
v_mfma_f32_16x16x32_bf16 v[8:11], v[160:163], v[112:115], v[8:11]
v_mfma_f32_16x16x32_bf16 v[32:35], v[160:163], v[116:119], v[32:35]
v_mfma_f32_16x16x32_bf16 v[56:59], v[160:163], v[120:123], v[56:59]
v_mfma_f32_16x16x32_bf16 v[80:83], v[160:163], v[124:127], v[80:83]
v_mfma_f32_16x16x32_bf16 v[12:15], v[164:167], v[112:115], v[12:15]
v_mfma_f32_16x16x32_bf16 v[36:39], v[164:167], v[116:119], v[36:39]
v_mfma_f32_16x16x32_bf16 v[60:63], v[164:167], v[120:123], v[60:63]
v_mfma_f32_16x16x32_bf16 v[84:87], v[164:167], v[124:127], v[84:87]
v_mfma_f32_16x16x32_bf16 v[16:19], v[168:171], v[112:115], v[16:19]
v_mfma_f32_16x16x32_bf16 v[40:43], v[168:171], v[116:119], v[40:43]
v_mfma_f32_16x16x32_bf16 v[64:67], v[168:171], v[120:123], v[64:67]
v_mfma_f32_16x16x32_bf16 v[88:91], v[168:171], v[124:127], v[88:91]
v_mfma_f32_16x16x32_bf16 v[20:23], v[172:175], v[112:115], v[20:23]
v_mfma_f32_16x16x32_bf16 v[44:47], v[172:175], v[116:119], v[44:47]
v_mfma_f32_16x16x32_bf16 v[68:71], v[172:175], v[120:123], v[68:71]
v_mfma_f32_16x16x32_bf16 v[92:95], v[172:175], v[124:127], v[92:95]
v_lshlrev_b32 v96, 16, v176
v_and_b32 v97, s58, v176
v_lshlrev_b32 v98, 16, v177
v_and_b32 v99, s58, v177
v_lshlrev_b32 v100, 16, v178
v_and_b32 v101, s58, v178
v_lshlrev_b32 v102, 16, v179
v_and_b32 v103, s58, v179
v_pk_fma_f32 v[0:1], v[0:1], v[244:245], v[248:249] op_sel:[0,0,0] op_sel_hi:[1,0,0]
v_pk_fma_f32 v[2:3], v[2:3], v[244:245], v[248:249] op_sel:[0,0,0] op_sel_hi:[1,0,0]
v_pk_fma_f32 v[4:5], v[4:5], v[244:245], v[248:249] op_sel:[0,0,0] op_sel_hi:[1,0,0]
v_pk_fma_f32 v[6:7], v[6:7], v[244:245], v[248:249] op_sel:[0,0,0] op_sel_hi:[1,0,0]
v_pk_mul_f32 v[0:1], v[0:1], v[96:97]
v_pk_mul_f32 v[2:3], v[2:3], v[98:99]
v_pk_mul_f32 v[4:5], v[4:5], v[100:101]
v_pk_mul_f32 v[6:7], v[6:7], v[102:103]
v_cvt_pk_bf16_f32 v112, v0, v1
v_cvt_pk_bf16_f32 v113, v2, v3
v_cvt_pk_bf16_f32 v114, v4, v5
v_cvt_pk_bf16_f32 v115, v6, v7
buffer_store_dwordx4 v[112:115], v238, s[36:39], s60 offen offset:0 sc1
v_lshlrev_b32 v104, 16, v188
v_and_b32 v105, s58, v188
v_lshlrev_b32 v106, 16, v189
v_and_b32 v107, s58, v189
v_lshlrev_b32 v108, 16, v190
v_and_b32 v109, s58, v190
v_lshlrev_b32 v110, 16, v191
v_and_b32 v111, s58, v191
v_pk_fma_f32 v[24:25], v[24:25], v[244:245], v[248:249] op_sel:[0,0,1] op_sel_hi:[1,0,1]
v_pk_fma_f32 v[26:27], v[26:27], v[244:245], v[248:249] op_sel:[0,0,1] op_sel_hi:[1,0,1]
v_pk_fma_f32 v[28:29], v[28:29], v[244:245], v[248:249] op_sel:[0,0,1] op_sel_hi:[1,0,1]
v_pk_fma_f32 v[30:31], v[30:31], v[244:245], v[248:249] op_sel:[0,0,1] op_sel_hi:[1,0,1]
v_pk_mul_f32 v[24:25], v[24:25], v[104:105]
v_pk_mul_f32 v[26:27], v[26:27], v[106:107]
v_pk_mul_f32 v[28:29], v[28:29], v[108:109]
v_pk_mul_f32 v[30:31], v[30:31], v[110:111]
v_cvt_pk_bf16_f32 v124, v24, v25
v_cvt_pk_bf16_f32 v125, v26, v27
v_cvt_pk_bf16_f32 v126, v28, v29
v_cvt_pk_bf16_f32 v127, v30, v31
buffer_store_dwordx4 v[124:127], v238, s[36:39], s61 offen offset:0 sc1
v_lshlrev_b32 v96, 16, v200
v_and_b32 v97, s58, v200
v_lshlrev_b32 v98, 16, v201
v_and_b32 v99, s58, v201
v_lshlrev_b32 v100, 16, v202
v_and_b32 v101, s58, v202
v_lshlrev_b32 v102, 16, v203
v_and_b32 v103, s58, v203
v_pk_fma_f32 v[48:49], v[48:49], v[244:245], v[250:251] op_sel:[0,0,0] op_sel_hi:[1,0,0]
v_pk_fma_f32 v[50:51], v[50:51], v[244:245], v[250:251] op_sel:[0,0,0] op_sel_hi:[1,0,0]
v_pk_fma_f32 v[52:53], v[52:53], v[244:245], v[250:251] op_sel:[0,0,0] op_sel_hi:[1,0,0]
v_pk_fma_f32 v[54:55], v[54:55], v[244:245], v[250:251] op_sel:[0,0,0] op_sel_hi:[1,0,0]
v_pk_mul_f32 v[48:49], v[48:49], v[96:97]
v_pk_mul_f32 v[50:51], v[50:51], v[98:99]
v_pk_mul_f32 v[52:53], v[52:53], v[100:101]
v_pk_mul_f32 v[54:55], v[54:55], v[102:103]
v_cvt_pk_bf16_f32 v136, v48, v49
v_cvt_pk_bf16_f32 v137, v50, v51
v_cvt_pk_bf16_f32 v138, v52, v53
v_cvt_pk_bf16_f32 v139, v54, v55
buffer_store_dwordx4 v[136:139], v238, s[36:39], s62 offen offset:0 sc1
v_lshlrev_b32 v104, 16, v212
v_and_b32 v105, s58, v212
v_lshlrev_b32 v106, 16, v213
v_and_b32 v107, s58, v213
v_lshlrev_b32 v108, 16, v214
v_and_b32 v109, s58, v214
v_lshlrev_b32 v110, 16, v215
v_and_b32 v111, s58, v215
v_pk_fma_f32 v[72:73], v[72:73], v[244:245], v[250:251] op_sel:[0,0,1] op_sel_hi:[1,0,1]
v_pk_fma_f32 v[74:75], v[74:75], v[244:245], v[250:251] op_sel:[0,0,1] op_sel_hi:[1,0,1]
v_pk_fma_f32 v[76:77], v[76:77], v[244:245], v[250:251] op_sel:[0,0,1] op_sel_hi:[1,0,1]
v_pk_fma_f32 v[78:79], v[78:79], v[244:245], v[250:251] op_sel:[0,0,1] op_sel_hi:[1,0,1]
v_pk_mul_f32 v[72:73], v[72:73], v[104:105]
v_pk_mul_f32 v[74:75], v[74:75], v[106:107]
v_pk_mul_f32 v[76:77], v[76:77], v[108:109]
v_pk_mul_f32 v[78:79], v[78:79], v[110:111]
v_cvt_pk_bf16_f32 v148, v72, v73
v_cvt_pk_bf16_f32 v149, v74, v75
v_cvt_pk_bf16_f32 v150, v76, v77
v_cvt_pk_bf16_f32 v151, v78, v79
buffer_store_dwordx4 v[148:151], v238, s[36:39], s63 offen offset:0 sc1
v_lshlrev_b32 v96, 16, v180
v_and_b32 v97, s58, v180
v_lshlrev_b32 v98, 16, v181
v_and_b32 v99, s58, v181
v_lshlrev_b32 v100, 16, v182
v_and_b32 v101, s58, v182
v_lshlrev_b32 v102, 16, v183
v_and_b32 v103, s58, v183
v_pk_fma_f32 v[8:9], v[8:9], v[244:245], v[248:249] op_sel:[0,0,0] op_sel_hi:[1,0,0]
v_pk_fma_f32 v[10:11], v[10:11], v[244:245], v[248:249] op_sel:[0,0,0] op_sel_hi:[1,0,0]
v_pk_fma_f32 v[12:13], v[12:13], v[244:245], v[248:249] op_sel:[0,0,0] op_sel_hi:[1,0,0]
v_pk_fma_f32 v[14:15], v[14:15], v[244:245], v[248:249] op_sel:[0,0,0] op_sel_hi:[1,0,0]
v_pk_mul_f32 v[8:9], v[8:9], v[96:97]
v_pk_mul_f32 v[10:11], v[10:11], v[98:99]
v_pk_mul_f32 v[12:13], v[12:13], v[100:101]
v_pk_mul_f32 v[14:15], v[14:15], v[102:103]
v_cvt_pk_bf16_f32 v116, v8, v9
v_cvt_pk_bf16_f32 v117, v10, v11
v_cvt_pk_bf16_f32 v118, v12, v13
v_cvt_pk_bf16_f32 v119, v14, v15
buffer_store_dwordx4 v[116:119], v238, s[36:39], s60 offen offset:1024 sc1
v_lshlrev_b32 v104, 16, v192
v_and_b32 v105, s58, v192
v_lshlrev_b32 v106, 16, v193
v_and_b32 v107, s58, v193
v_lshlrev_b32 v108, 16, v194
v_and_b32 v109, s58, v194
v_lshlrev_b32 v110, 16, v195
v_and_b32 v111, s58, v195
v_pk_fma_f32 v[32:33], v[32:33], v[244:245], v[248:249] op_sel:[0,0,1] op_sel_hi:[1,0,1]
v_pk_fma_f32 v[34:35], v[34:35], v[244:245], v[248:249] op_sel:[0,0,1] op_sel_hi:[1,0,1]
v_pk_fma_f32 v[36:37], v[36:37], v[244:245], v[248:249] op_sel:[0,0,1] op_sel_hi:[1,0,1]
v_pk_fma_f32 v[38:39], v[38:39], v[244:245], v[248:249] op_sel:[0,0,1] op_sel_hi:[1,0,1]
v_pk_mul_f32 v[32:33], v[32:33], v[104:105]
v_pk_mul_f32 v[34:35], v[34:35], v[106:107]
v_pk_mul_f32 v[36:37], v[36:37], v[108:109]
v_pk_mul_f32 v[38:39], v[38:39], v[110:111]
v_cvt_pk_bf16_f32 v128, v32, v33
v_cvt_pk_bf16_f32 v129, v34, v35
v_cvt_pk_bf16_f32 v130, v36, v37
v_cvt_pk_bf16_f32 v131, v38, v39
buffer_store_dwordx4 v[128:131], v238, s[36:39], s61 offen offset:1024 sc1
v_lshlrev_b32 v96, 16, v204
v_and_b32 v97, s58, v204
v_lshlrev_b32 v98, 16, v205
v_and_b32 v99, s58, v205
v_lshlrev_b32 v100, 16, v206
v_and_b32 v101, s58, v206
v_lshlrev_b32 v102, 16, v207
v_and_b32 v103, s58, v207
v_pk_fma_f32 v[56:57], v[56:57], v[244:245], v[250:251] op_sel:[0,0,0] op_sel_hi:[1,0,0]
v_pk_fma_f32 v[58:59], v[58:59], v[244:245], v[250:251] op_sel:[0,0,0] op_sel_hi:[1,0,0]
v_pk_fma_f32 v[60:61], v[60:61], v[244:245], v[250:251] op_sel:[0,0,0] op_sel_hi:[1,0,0]
v_pk_fma_f32 v[62:63], v[62:63], v[244:245], v[250:251] op_sel:[0,0,0] op_sel_hi:[1,0,0]
v_pk_mul_f32 v[56:57], v[56:57], v[96:97]
v_pk_mul_f32 v[58:59], v[58:59], v[98:99]
v_pk_mul_f32 v[60:61], v[60:61], v[100:101]
v_pk_mul_f32 v[62:63], v[62:63], v[102:103]
v_cvt_pk_bf16_f32 v140, v56, v57
v_cvt_pk_bf16_f32 v141, v58, v59
v_cvt_pk_bf16_f32 v142, v60, v61
v_cvt_pk_bf16_f32 v143, v62, v63
buffer_store_dwordx4 v[140:143], v238, s[36:39], s62 offen offset:1024 sc1
v_lshlrev_b32 v104, 16, v216
v_and_b32 v105, s58, v216
v_lshlrev_b32 v106, 16, v217
v_and_b32 v107, s58, v217
v_lshlrev_b32 v108, 16, v218
v_and_b32 v109, s58, v218
v_lshlrev_b32 v110, 16, v219
v_and_b32 v111, s58, v219
v_pk_fma_f32 v[80:81], v[80:81], v[244:245], v[250:251] op_sel:[0,0,1] op_sel_hi:[1,0,1]
v_pk_fma_f32 v[82:83], v[82:83], v[244:245], v[250:251] op_sel:[0,0,1] op_sel_hi:[1,0,1]
v_pk_fma_f32 v[84:85], v[84:85], v[244:245], v[250:251] op_sel:[0,0,1] op_sel_hi:[1,0,1]
v_pk_fma_f32 v[86:87], v[86:87], v[244:245], v[250:251] op_sel:[0,0,1] op_sel_hi:[1,0,1]
v_pk_mul_f32 v[80:81], v[80:81], v[104:105]
v_pk_mul_f32 v[82:83], v[82:83], v[106:107]
v_pk_mul_f32 v[84:85], v[84:85], v[108:109]
v_pk_mul_f32 v[86:87], v[86:87], v[110:111]
v_cvt_pk_bf16_f32 v152, v80, v81
v_cvt_pk_bf16_f32 v153, v82, v83
v_cvt_pk_bf16_f32 v154, v84, v85
v_cvt_pk_bf16_f32 v155, v86, v87
buffer_store_dwordx4 v[152:155], v238, s[36:39], s63 offen offset:1024 sc1
v_lshlrev_b32 v96, 16, v184
v_and_b32 v97, s58, v184
v_lshlrev_b32 v98, 16, v185
v_and_b32 v99, s58, v185
v_lshlrev_b32 v100, 16, v186
v_and_b32 v101, s58, v186
v_lshlrev_b32 v102, 16, v187
v_and_b32 v103, s58, v187
v_pk_fma_f32 v[16:17], v[16:17], v[244:245], v[248:249] op_sel:[0,0,0] op_sel_hi:[1,0,0]
v_pk_fma_f32 v[18:19], v[18:19], v[244:245], v[248:249] op_sel:[0,0,0] op_sel_hi:[1,0,0]
v_pk_fma_f32 v[20:21], v[20:21], v[244:245], v[248:249] op_sel:[0,0,0] op_sel_hi:[1,0,0]
v_pk_fma_f32 v[22:23], v[22:23], v[244:245], v[248:249] op_sel:[0,0,0] op_sel_hi:[1,0,0]
v_pk_mul_f32 v[16:17], v[16:17], v[96:97]
v_pk_mul_f32 v[18:19], v[18:19], v[98:99]
v_pk_mul_f32 v[20:21], v[20:21], v[100:101]
v_pk_mul_f32 v[22:23], v[22:23], v[102:103]
v_cvt_pk_bf16_f32 v120, v16, v17
v_cvt_pk_bf16_f32 v121, v18, v19
v_cvt_pk_bf16_f32 v122, v20, v21
v_cvt_pk_bf16_f32 v123, v22, v23
buffer_store_dwordx4 v[120:123], v238, s[36:39], s60 offen offset:2048 sc1
v_lshlrev_b32 v104, 16, v196
v_and_b32 v105, s58, v196
v_lshlrev_b32 v106, 16, v197
v_and_b32 v107, s58, v197
v_lshlrev_b32 v108, 16, v198
v_and_b32 v109, s58, v198
v_lshlrev_b32 v110, 16, v199
v_and_b32 v111, s58, v199
v_pk_fma_f32 v[40:41], v[40:41], v[244:245], v[248:249] op_sel:[0,0,1] op_sel_hi:[1,0,1]
v_pk_fma_f32 v[42:43], v[42:43], v[244:245], v[248:249] op_sel:[0,0,1] op_sel_hi:[1,0,1]
v_pk_fma_f32 v[44:45], v[44:45], v[244:245], v[248:249] op_sel:[0,0,1] op_sel_hi:[1,0,1]
v_pk_fma_f32 v[46:47], v[46:47], v[244:245], v[248:249] op_sel:[0,0,1] op_sel_hi:[1,0,1]
v_pk_mul_f32 v[40:41], v[40:41], v[104:105]
v_pk_mul_f32 v[42:43], v[42:43], v[106:107]
v_pk_mul_f32 v[44:45], v[44:45], v[108:109]
v_pk_mul_f32 v[46:47], v[46:47], v[110:111]
v_cvt_pk_bf16_f32 v132, v40, v41
v_cvt_pk_bf16_f32 v133, v42, v43
v_cvt_pk_bf16_f32 v134, v44, v45
v_cvt_pk_bf16_f32 v135, v46, v47
buffer_store_dwordx4 v[132:135], v238, s[36:39], s61 offen offset:2048 sc1
v_lshlrev_b32 v96, 16, v208
v_and_b32 v97, s58, v208
v_lshlrev_b32 v98, 16, v209
v_and_b32 v99, s58, v209
v_lshlrev_b32 v100, 16, v210
v_and_b32 v101, s58, v210
v_lshlrev_b32 v102, 16, v211
v_and_b32 v103, s58, v211
v_pk_fma_f32 v[64:65], v[64:65], v[244:245], v[250:251] op_sel:[0,0,0] op_sel_hi:[1,0,0]
v_pk_fma_f32 v[66:67], v[66:67], v[244:245], v[250:251] op_sel:[0,0,0] op_sel_hi:[1,0,0]
v_pk_fma_f32 v[68:69], v[68:69], v[244:245], v[250:251] op_sel:[0,0,0] op_sel_hi:[1,0,0]
v_pk_fma_f32 v[70:71], v[70:71], v[244:245], v[250:251] op_sel:[0,0,0] op_sel_hi:[1,0,0]
v_pk_mul_f32 v[64:65], v[64:65], v[96:97]
v_pk_mul_f32 v[66:67], v[66:67], v[98:99]
v_pk_mul_f32 v[68:69], v[68:69], v[100:101]
v_pk_mul_f32 v[70:71], v[70:71], v[102:103]
v_cvt_pk_bf16_f32 v144, v64, v65
v_cvt_pk_bf16_f32 v145, v66, v67
v_cvt_pk_bf16_f32 v146, v68, v69
v_cvt_pk_bf16_f32 v147, v70, v71
buffer_store_dwordx4 v[144:147], v238, s[36:39], s62 offen offset:2048 sc1
v_lshlrev_b32 v104, 16, v220
v_and_b32 v105, s58, v220
v_lshlrev_b32 v106, 16, v221
v_and_b32 v107, s58, v221
v_lshlrev_b32 v108, 16, v222
v_and_b32 v109, s58, v222
v_lshlrev_b32 v110, 16, v223
v_and_b32 v111, s58, v223
v_pk_fma_f32 v[88:89], v[88:89], v[244:245], v[250:251] op_sel:[0,0,1] op_sel_hi:[1,0,1]
v_pk_fma_f32 v[90:91], v[90:91], v[244:245], v[250:251] op_sel:[0,0,1] op_sel_hi:[1,0,1]
v_pk_fma_f32 v[92:93], v[92:93], v[244:245], v[250:251] op_sel:[0,0,1] op_sel_hi:[1,0,1]
v_pk_fma_f32 v[94:95], v[94:95], v[244:245], v[250:251] op_sel:[0,0,1] op_sel_hi:[1,0,1]
v_pk_mul_f32 v[88:89], v[88:89], v[104:105]
v_pk_mul_f32 v[90:91], v[90:91], v[106:107]
v_pk_mul_f32 v[92:93], v[92:93], v[108:109]
v_pk_mul_f32 v[94:95], v[94:95], v[110:111]
v_cvt_pk_bf16_f32 v156, v88, v89
v_cvt_pk_bf16_f32 v157, v90, v91
v_cvt_pk_bf16_f32 v158, v92, v93
v_cvt_pk_bf16_f32 v159, v94, v95
buffer_store_dwordx4 v[156:159], v238, s[36:39], s63 offen offset:2048 sc1
s_load_dwordx4 s[80:83], s[0:1], 80
s_load_dwordx2 s[84:85], s[0:1], 0
s_load_dwordx2 s[86:87], s[0:1], 96
s_barrier
v_mov_b32 v96, s64
s_mov_b32 s55, s59
s_add_u32 s30, s17, 8
s_and_b32 s29, s16, 1
s_mul_i32 s25, s30, 43
s_lshr_b32 s25, s25, 7
s_mul_i32 s31, s25, 3
s_sub_u32 s31, s30, s31
s_mov_b32 s35, s31
s_cmp_lt_u32 s31, 2
s_cselect_b32 s28, 5, 4
s_mul_i32 s24, s29, 18
s_mul_i32 s31, s31, 5
s_add_u32 s24, s24, s31
s_sub_u32 s31, s30, 27
s_lshl_b32 s31, s31, 1
s_add_u32 s31, s31, s29
s_cmp_ge_u32 s30, 27
s_cselect_b32 s25, s31, s25
s_cselect_b32 s24, 14, s24
s_cselect_b32 s28, 4, s28
s_lshr_b32 s31, s16, 1
s_lshl_b32 s31, s31, 5
s_add_u32 s24, s24, s31
s_mul_i32 s35, s35, 0
s_mul_i32 s30, s25, 0
s_add_u32 s35, s35, s30
s_mul_i32 s30, s35, 57
s_lshr_b32 s30, s30, 9
s_mul_i32 s30, s30, 9
s_sub_u32 s35, s35, s30
s_lshl_b32 s65, s35, 10
s_add_u32 s66, s65, 1024
s_cmp_eq_u32 s66, 9216
s_cselect_b32 s66, 0, s66
s_add_u32 s67, s66, 1024
s_cmp_eq_u32 s67, 9216
s_cselect_b32 s67, 0, s67
s_add_u32 s68, s67, 1024
s_cmp_eq_u32 s68, 9216
s_cselect_b32 s68, 0, s68
s_add_u32 s69, s68, 1024
s_cmp_eq_u32 s69, 9216
s_cselect_b32 s69, 0, s69
s_add_u32 s70, s69, 1024
s_cmp_eq_u32 s70, 9216
s_cselect_b32 s70, 0, s70
s_add_u32 s71, s70, 1024
s_cmp_eq_u32 s71, 9216
s_cselect_b32 s71, 0, s71
s_add_u32 s72, s71, 1024
s_cmp_eq_u32 s72, 9216
s_cselect_b32 s72, 0, s72
s_add_u32 s73, s72, 1024
s_cmp_eq_u32 s73, 9216
s_cselect_b32 s73, 0, s73
v_lshrrev_b32 v234, 3, v255
v_and_b32 v235, 6, v234
v_and_b32 v236, 7, v255
v_xor_b32 v235, v235, v236
v_mul_u32_u24 v234, 1152, v234
v_lshl_add_u32 v234, v235, 4, v234
s_lshl_b32 s30, s25, 7
s_mul_i32 s31, s27, 331776
s_add_u32 s30, s30, s31
v_add_u32 v229, s30, v234
s_mul_i32 s50, s29, 1327104
s_xor_b32 s31, s29, 1
s_mul_i32 s51, s31, 1327104
s_mul_i32 s52, s29, 36864
s_mul_i32 s53, s31, 36864
s_mul_i32 s26, s27, 32768
s_waitcnt lgkmcnt(0)
s_mov_b32 s56, s80
s_and_b32 s57, s81, 0xffff
s_mov_b32 s58, 2654208
s_mov_b32 s59, 0x20000
s_waitcnt vmcnt(0)
s_mov_b64 exec, 1
buffer_store_dword v96, off, s[20:23], s55 sc0 sc1
s_mov_b64 exec, -1
s_cmp_ge_u32 s25, 9
s_cbranch_scc1 L_fin
L_p3b:
s_mov_b32 s8, s86
s_and_b32 s9, s87, 0xffff
s_mov_b32 s10, 256
s_mov_b32 s11, 0x20000
buffer_load_dword v221, off, s[8:11], 0 offset:132 sc1
s_mul_i32 s33, s68, 36
s_add_u32 s33, s33, s51
s_add_u32 s34, s33, 0
buffer_load_dwordx4 v[0:3], v229, s[56:59], s34 offen
s_add_u32 s34, s33, 9216
buffer_load_dwordx4 v[4:7], v229, s[56:59], s34 offen
s_add_u32 s34, s33, 18432
buffer_load_dwordx4 v[8:11], v229, s[56:59], s34 offen
s_add_u32 s34, s33, 27648
buffer_load_dwordx4 v[12:15], v229, s[56:59], s34 offen
s_mov_b32 s16, s82
s_and_b32 s17, s83, 0xffff
s_mov_b32 s18, 2359296
s_mov_b32 s19, 0x20000
s_mov_b32 s44, s84
s_and_b32 s45, s85, 0xffff
s_mov_b32 s46, 2359296
s_mov_b32 s47, 0x20000
s_add_u32 s12, s6, 37748736
s_addc_u32 s13, s7, 0
s_and_b32 s13, s13, 0xffff
s_mov_b32 s14, 2359296
s_mov_b32 s15, 0x20000
s_add_u32 s40, s27, 0
s_lshr_b32 s33, s40, 1
s_add_u32 s31, s33, s24
s_lshr_b32 s32, s31, 1
s_lshl_b32 s32, s32, 5
s_and_b32 s31, s31, 1
s_lshl_b32 s31, s31, 2
s_add_u32 s32, s32, s31
s_and_b32 s31, s40, 1
s_lshl_b32 s31, s31, 4
s_add_u32 s32, s32, s31
s_cmp_lt_u32 s33, s28
s_cselect_b32 s32, s32, 0x100000
v_lshrrev_b32 v212, 5, v255
v_bfe_u32 v213, v255, 3, 2
v_lshl_add_u32 v212, v212, 3, v213
v_add_u32 v212, s32, v212
v_lshlrev_b32 v192, 4, v212
v_mul_u32_u24 v212, 1152, v212
v_and_b32 v214, 7, v255
v_lshl_add_u32 v212, v214, 4, v212
s_lshl_b32 s30, s25, 7
v_add_u32 v236, s30, v212
s_lshl_b32 s30, s40, 6
v_add_u32 v212, s30, v255
v_mul_u32_u24 v213, 5462, v212
v_lshrrev_b32 v213, 16, v213
v_mul_u32_u24 v213, 3904, v213
v_lshl_add_u32 v196, v212, 4, v213
s_add_u32 s41, s27, 4
s_lshr_b32 s33, s41, 1
s_add_u32 s31, s33, s24
s_lshr_b32 s32, s31, 1
s_lshl_b32 s32, s32, 5
s_and_b32 s31, s31, 1
s_lshl_b32 s31, s31, 2
s_add_u32 s32, s32, s31
s_and_b32 s31, s41, 1
s_lshl_b32 s31, s31, 4
s_add_u32 s32, s32, s31
s_cmp_lt_u32 s33, s28
s_cselect_b32 s32, s32, 0x100000
v_lshrrev_b32 v212, 5, v255
v_bfe_u32 v213, v255, 3, 2
v_lshl_add_u32 v212, v212, 3, v213
v_add_u32 v212, s32, v212
v_lshlrev_b32 v193, 4, v212
v_mul_u32_u24 v212, 1152, v212
v_and_b32 v214, 7, v255
v_lshl_add_u32 v212, v214, 4, v212
s_lshl_b32 s30, s25, 7
v_add_u32 v237, s30, v212
s_lshl_b32 s30, s41, 6
v_add_u32 v212, s30, v255
v_mul_u32_u24 v213, 5462, v212
v_lshrrev_b32 v213, 16, v213
v_mul_u32_u24 v213, 3904, v213
v_lshl_add_u32 v197, v212, 4, v213
s_add_u32 s42, s27, 8
s_lshr_b32 s33, s42, 1
s_add_u32 s31, s33, s24
s_lshr_b32 s32, s31, 1
s_lshl_b32 s32, s32, 5
s_and_b32 s31, s31, 1
s_lshl_b32 s31, s31, 2
s_add_u32 s32, s32, s31
s_and_b32 s31, s42, 1
s_lshl_b32 s31, s31, 4
s_add_u32 s32, s32, s31
s_cmp_lt_u32 s33, s28
s_cselect_b32 s32, s32, 0x100000
v_lshrrev_b32 v212, 5, v255
v_bfe_u32 v213, v255, 3, 2
v_lshl_add_u32 v212, v212, 3, v213
v_add_u32 v212, s32, v212
v_lshlrev_b32 v194, 4, v212
v_mul_u32_u24 v212, 1152, v212
v_and_b32 v214, 7, v255
v_lshl_add_u32 v212, v214, 4, v212
s_lshl_b32 s30, s25, 7
v_add_u32 v238, s30, v212
s_lshl_b32 s30, s42, 6
v_add_u32 v212, s30, v255
v_mul_u32_u24 v213, 5462, v212
v_lshrrev_b32 v213, 16, v213
v_mul_u32_u24 v213, 3904, v213
v_lshl_add_u32 v198, v212, 4, v213
s_lshr_b32 s38, s24, 1
s_lshl_b32 s38, s38, 6
s_lshl_b32 s35, s25, 18
s_add_u32 s38, s38, s35
s_lshl_b32 s39, s27, 10
s_add_u32 s39, s39, 131072
s_mov_b32 s37, 1048576
s_mov_b32 s54, 0xffff0000
v_lshrrev_b32 v212, 2, v255
v_mul_u32_u24 v212, 192, v212
v_and_b32 v213, 3, v255
v_lshl_add_u32 v212, v213, 4, v212
s_mul_i32 s33, s27, 2304
s_add_u32 s33, s33, 143360
v_and_b32 v214, 15, v255
v_mul_u32_u24 v214, 144, v214
v_lshrrev_b32 v215, 4, v255
v_lshl_add_u32 v214, v215, 3, v214
v_add_u32 v214, s33, v214
v_lshrrev_b32 v215, 3, v255
v_and_b32 v216, 7, v255
v_mul_u32_u24 v217, 144, v215
v_lshl_add_u32 v217, v216, 4, v217
s_and_b32 s30, s27, 1
s_mul_i32 s30, s30, 1152
s_add_u32 s33, s33, s30
v_add_u32 v217, s33, v217
v_mul_u32_u24 v218, 272, v215
v_lshl_add_u32 v218, v216, 5, v218
v_lshl_add_u32 v220, v255, 4, s26
s_mul_i32 s33, s69, 36
s_add_u32 s33, s33, s51
s_add_u32 s34, s33, 0
buffer_load_dwordx4 v[16:19], v229, s[56:59], s34 offen
s_add_u32 s34, s33, 9216
buffer_load_dwordx4 v[20:23], v229, s[56:59], s34 offen
s_add_u32 s34, s33, 18432
buffer_load_dwordx4 v[24:27], v229, s[56:59], s34 offen
s_add_u32 s34, s33, 27648
buffer_load_dwordx4 v[28:31], v229, s[56:59], s34 offen
s_mul_i32 s33, s70, 36
s_add_u32 s33, s33, s51
s_add_u32 s34, s33, 0
buffer_load_dwordx4 v[32:35], v229, s[56:59], s34 offen
s_add_u32 s34, s33, 9216
buffer_load_dwordx4 v[36:39], v229, s[56:59], s34 offen
s_add_u32 s34, s33, 18432
buffer_load_dwordx4 v[40:43], v229, s[56:59], s34 offen
s_add_u32 s34, s33, 27648
buffer_load_dwordx4 v[44:47], v229, s[56:59], s34 offen
s_mul_i32 s33, s71, 36
s_add_u32 s33, s33, s51
s_add_u32 s34, s33, 0
buffer_load_dwordx4 v[48:51], v229, s[56:59], s34 offen
s_add_u32 s34, s33, 9216
buffer_load_dwordx4 v[52:55], v229, s[56:59], s34 offen
s_add_u32 s34, s33, 18432
buffer_load_dwordx4 v[56:59], v229, s[56:59], s34 offen
s_add_u32 s34, s33, 27648
buffer_load_dwordx4 v[60:63], v229, s[56:59], s34 offen
s_mul_i32 s33, s72, 36
s_add_u32 s33, s33, s51
s_add_u32 s34, s33, 0
buffer_load_dwordx4 v[64:67], v229, s[56:59], s34 offen
s_add_u32 s34, s33, 9216
buffer_load_dwordx4 v[68:71], v229, s[56:59], s34 offen
s_add_u32 s34, s33, 18432
buffer_load_dwordx4 v[72:75], v229, s[56:59], s34 offen
s_add_u32 s34, s33, 27648
buffer_load_dwordx4 v[76:79], v229, s[56:59], s34 offen
s_mul_i32 s33, s73, 36
s_add_u32 s33, s33, s51
s_add_u32 s34, s33, 0
buffer_load_dwordx4 v[80:83], v229, s[56:59], s34 offen
s_add_u32 s34, s33, 9216
buffer_load_dwordx4 v[84:87], v229, s[56:59], s34 offen
s_add_u32 s34, s33, 18432
buffer_load_dwordx4 v[88:91], v229, s[56:59], s34 offen
s_add_u32 s34, s33, 27648
buffer_load_dwordx4 v[92:95], v229, s[56:59], s34 offen
s_barrier
s_waitcnt vmcnt(12)
ds_write_b128 v220, v[0:3] offset:16384
ds_write_b128 v220, v[4:7] offset:17408
ds_write_b128 v220, v[8:11] offset:18432
ds_write_b128 v220, v[12:15] offset:19456
ds_write_b128 v220, v[16:19] offset:20480
ds_write_b128 v220, v[20:23] offset:21504
ds_write_b128 v220, v[24:27] offset:22528
ds_write_b128 v220, v[28:31] offset:23552
ds_write_b128 v220, v[32:35] offset:24576
ds_write_b128 v220, v[36:39] offset:25600
ds_write_b128 v220, v[40:43] offset:26624
ds_write_b128 v220, v[44:47] offset:27648
s_waitcnt lgkmcnt(0)
buffer_load_dwordx4 v[96:99], v236, s[44:47], 0 offen
buffer_load_dwordx4 v[108:111], v192, s[20:23], s37 offen sc1
buffer_load_dwordx4 v[100:103], v237, s[44:47], 0 offen
buffer_load_dwordx4 v[112:115], v193, s[20:23], s37 offen sc1
buffer_load_dwordx4 v[104:107], v238, s[44:47], 0 offen
buffer_load_dwordx4 v[116:119], v194, s[20:23], s37 offen sc1
s_waitcnt vmcnt(30)
s_mov_b32 s78, 0x20000
L_gb_yc:
v_readfirstlane_b32 s30, v221
s_nop 1
s_cmp_lt_u32 s30, 64
s_cbranch_scc1 L_gb_yl
L_gb_yo:
s_add_u32 m0, s39, 0
s_nop 0
buffer_load_dwordx4 v196, s[12:15], s38 offen sc1 lds
s_add_u32 m0, s39, 4096
s_nop 0
buffer_load_dwordx4 v197, s[12:15], s38 offen sc1 lds
s_add_u32 m0, s39, 8192
s_nop 0
buffer_load_dwordx4 v198, s[12:15], s38 offen sc1 lds
s_barrier
s_waitcnt vmcnt(9)
ds_write_b128 v220, v[48:51] offset:28672
ds_write_b128 v220, v[52:55] offset:29696
ds_write_b128 v220, v[56:59] offset:30720
ds_write_b128 v220, v[60:63] offset:31744
ds_write_b128 v220, v[64:67] offset:0
ds_write_b128 v220, v[68:71] offset:1024
ds_write_b128 v220, v[72:75] offset:2048
ds_write_b128 v220, v[76:79] offset:3072
ds_write_b128 v220, v[80:83] offset:4096
ds_write_b128 v220, v[84:87] offset:5120
ds_write_b128 v220, v[88:91] offset:6144
ds_write_b128 v220, v[92:95] offset:7168
s_waitcnt lgkmcnt(0)
s_waitcnt vmcnt(0)
s_barrier
s_lshr_b32 s30, s40, 1
s_min_u32 s30, s30, 4
s_and_b32 s31, s24, 1
s_add_u32 s31, s31, s30
s_lshr_b32 s30, s31, 1
s_lshl_b32 s30, s30, 6
s_and_b32 s31, s31, 1
s_lshl_b32 s31, s31, 3
s_add_u32 s30, s30, s31
s_add_u32 s30, s30, 131072
v_add_u32 v213, s30, v212
ds_read_b64_tr_b16 v[144:145], v213 offset:0
ds_read_b64_tr_b16 v[146:147], v213 offset:3072
ds_read_b64_tr_b16 v[148:149], v213 offset:6144
ds_read_b64_tr_b16 v[150:151], v213 offset:9216
s_waitcnt lgkmcnt(0)
ds_write_b64 v214, v[144:145] offset:0
ds_write_b64 v214, v[146:147] offset:32
ds_write_b64 v214, v[148:149] offset:64
ds_write_b64 v214, v[150:151] offset:96
ds_read_b128 v[152:155], v217
v_lshlrev_b32 v120, 16, v96
v_and_b32 v121, s54, v96
v_lshlrev_b32 v122, 16, v97
v_and_b32 v123, s54, v97
v_lshlrev_b32 v124, 16, v98
v_and_b32 v125, s54, v98
v_lshlrev_b32 v126, 16, v99
v_and_b32 v127, s54, v99
v_sub_f32 v160, v120, v108
v_sub_f32 v161, v121, v108
v_sub_f32 v162, v122, v108
v_sub_f32 v163, v123, v108
v_sub_f32 v164, v124, v108
v_sub_f32 v165, v125, v108
v_sub_f32 v166, v126, v108
v_sub_f32 v167, v127, v108
v_mul_f32 v160, v160, v110
v_mul_f32 v161, v161, v110
v_mul_f32 v162, v162, v110
v_mul_f32 v163, v163, v110
v_mul_f32 v164, v164, v110
v_mul_f32 v165, v165, v110
v_mul_f32 v166, v166, v110
v_mul_f32 v167, v167, v110
s_waitcnt lgkmcnt(0)
v_lshlrev_b32 v168, 16, v152
v_and_b32 v169, s54, v152
v_lshlrev_b32 v170, 16, v153
v_and_b32 v171, s54, v153
v_lshlrev_b32 v172, 16, v154
v_and_b32 v173, s54, v154
v_lshlrev_b32 v174, 16, v155
v_and_b32 v175, s54, v155
v_fmac_f32 v120, v160, v168
v_fmac_f32 v121, v161, v169
v_fmac_f32 v122, v162, v170
v_fmac_f32 v123, v163, v171
v_fmac_f32 v124, v164, v172
v_fmac_f32 v125, v165, v173
v_fmac_f32 v126, v166, v174
v_fmac_f32 v127, v167, v175
s_lshr_b32 s30, s41, 1
s_min_u32 s30, s30, 4
s_and_b32 s31, s24, 1
s_add_u32 s31, s31, s30
s_lshr_b32 s30, s31, 1
s_lshl_b32 s30, s30, 6
s_and_b32 s31, s31, 1
s_lshl_b32 s31, s31, 3
s_add_u32 s30, s30, s31
s_add_u32 s30, s30, 131072
v_add_u32 v213, s30, v212
ds_read_b64_tr_b16 v[144:145], v213 offset:0
ds_read_b64_tr_b16 v[146:147], v213 offset:3072
ds_read_b64_tr_b16 v[148:149], v213 offset:6144
ds_read_b64_tr_b16 v[150:151], v213 offset:9216
s_waitcnt lgkmcnt(0)
ds_write_b64 v214, v[144:145] offset:0
ds_write_b64 v214, v[146:147] offset:32
ds_write_b64 v214, v[148:149] offset:64
ds_write_b64 v214, v[150:151] offset:96
ds_read_b128 v[152:155], v217
v_lshlrev_b32 v128, 16, v100
v_and_b32 v129, s54, v100
v_lshlrev_b32 v130, 16, v101
v_and_b32 v131, s54, v101
v_lshlrev_b32 v132, 16, v102
v_and_b32 v133, s54, v102
v_lshlrev_b32 v134, 16, v103
v_and_b32 v135, s54, v103
v_sub_f32 v160, v128, v112
v_sub_f32 v161, v129, v112
v_sub_f32 v162, v130, v112
v_sub_f32 v163, v131, v112
v_sub_f32 v164, v132, v112
v_sub_f32 v165, v133, v112
v_sub_f32 v166, v134, v112
v_sub_f32 v167, v135, v112
v_mul_f32 v160, v160, v114
v_mul_f32 v161, v161, v114
v_mul_f32 v162, v162, v114
v_mul_f32 v163, v163, v114
v_mul_f32 v164, v164, v114
v_mul_f32 v165, v165, v114
v_mul_f32 v166, v166, v114
v_mul_f32 v167, v167, v114
s_waitcnt lgkmcnt(0)
v_lshlrev_b32 v168, 16, v152
v_and_b32 v169, s54, v152
v_lshlrev_b32 v170, 16, v153
v_and_b32 v171, s54, v153
v_lshlrev_b32 v172, 16, v154
v_and_b32 v173, s54, v154
v_lshlrev_b32 v174, 16, v155
v_and_b32 v175, s54, v155
v_fmac_f32 v128, v160, v168
v_fmac_f32 v129, v161, v169
v_fmac_f32 v130, v162, v170
v_fmac_f32 v131, v163, v171
v_fmac_f32 v132, v164, v172
v_fmac_f32 v133, v165, v173
v_fmac_f32 v134, v166, v174
v_fmac_f32 v135, v167, v175
s_lshr_b32 s30, s42, 1
s_min_u32 s30, s30, 4
s_and_b32 s31, s24, 1
s_add_u32 s31, s31, s30
s_lshr_b32 s30, s31, 1
s_lshl_b32 s30, s30, 6
s_and_b32 s31, s31, 1
s_lshl_b32 s31, s31, 3
s_add_u32 s30, s30, s31
s_add_u32 s30, s30, 131072
v_add_u32 v213, s30, v212
ds_read_b64_tr_b16 v[144:145], v213 offset:0
ds_read_b64_tr_b16 v[146:147], v213 offset:3072
ds_read_b64_tr_b16 v[148:149], v213 offset:6144
ds_read_b64_tr_b16 v[150:151], v213 offset:9216
s_waitcnt lgkmcnt(0)
ds_write_b64 v214, v[144:145] offset:0
ds_write_b64 v214, v[146:147] offset:32
ds_write_b64 v214, v[148:149] offset:64
ds_write_b64 v214, v[150:151] offset:96
ds_read_b128 v[152:155], v217
v_lshlrev_b32 v136, 16, v104
v_and_b32 v137, s54, v104
v_lshlrev_b32 v138, 16, v105
v_and_b32 v139, s54, v105
v_lshlrev_b32 v140, 16, v106
v_and_b32 v141, s54, v106
v_lshlrev_b32 v142, 16, v107
v_and_b32 v143, s54, v107
v_sub_f32 v160, v136, v116
v_sub_f32 v161, v137, v116
v_sub_f32 v162, v138, v116
v_sub_f32 v163, v139, v116
v_sub_f32 v164, v140, v116
v_sub_f32 v165, v141, v116
v_sub_f32 v166, v142, v116
v_sub_f32 v167, v143, v116
v_mul_f32 v160, v160, v118
v_mul_f32 v161, v161, v118
v_mul_f32 v162, v162, v118
v_mul_f32 v163, v163, v118
v_mul_f32 v164, v164, v118
v_mul_f32 v165, v165, v118
v_mul_f32 v166, v166, v118
v_mul_f32 v167, v167, v118
s_waitcnt lgkmcnt(0)
v_lshlrev_b32 v168, 16, v152
v_and_b32 v169, s54, v152
v_lshlrev_b32 v170, 16, v153
v_and_b32 v171, s54, v153
v_lshlrev_b32 v172, 16, v154
v_and_b32 v173, s54, v154
v_lshlrev_b32 v174, 16, v155
v_and_b32 v175, s54, v155
v_fmac_f32 v136, v160, v168
v_fmac_f32 v137, v161, v169
v_fmac_f32 v138, v162, v170
v_fmac_f32 v139, v163, v171
v_fmac_f32 v140, v164, v172
v_fmac_f32 v141, v165, v173
v_fmac_f32 v142, v166, v174
v_fmac_f32 v143, v167, v175
s_mul_i32 s30, s27, 2176
v_add_u32 v218, s30, v218
v_add_u32 v219, 65536, v218
s_barrier
ds_read_b128 v[0:3], v218 offset:0
ds_read_b128 v[4:7], v218 offset:16
ds_read_b128 v[8:11], v218 offset:32768
ds_read_b128 v[12:15], v218 offset:32784
ds_read_b128 v[16:19], v219 offset:0
ds_read_b128 v[20:23], v219 offset:16
ds_read_b128 v[24:27], v219 offset:32768
ds_read_b128 v[28:31], v219 offset:32784
ds_read_b128 v[32:35], v218 offset:8704
ds_read_b128 v[36:39], v218 offset:8720
ds_read_b128 v[40:43], v218 offset:41472
ds_read_b128 v[44:47], v218 offset:41488
ds_read_b128 v[48:51], v219 offset:8704
ds_read_b128 v[52:55], v219 offset:8720
ds_read_b128 v[56:59], v219 offset:41472
ds_read_b128 v[60:63], v219 offset:41488
ds_read_b128 v[64:67], v218 offset:17408
ds_read_b128 v[68:71], v218 offset:17424
ds_read_b128 v[72:75], v218 offset:50176
ds_read_b128 v[76:79], v218 offset:50192
ds_read_b128 v[80:83], v219 offset:17408
ds_read_b128 v[84:87], v219 offset:17424
ds_read_b128 v[88:91], v219 offset:50176
ds_read_b128 v[92:95], v219 offset:50192
s_waitcnt lgkmcnt(15)
v_pk_add_f32 v[0:1], v[0:1], v[8:9]
v_pk_add_f32 v[2:3], v[2:3], v[10:11]
v_pk_add_f32 v[4:5], v[4:5], v[12:13]
v_pk_add_f32 v[6:7], v[6:7], v[14:15]
v_pk_add_f32 v[16:17], v[16:17], v[24:25]
v_pk_add_f32 v[18:19], v[18:19], v[26:27]
v_pk_add_f32 v[20:21], v[20:21], v[28:29]
v_pk_add_f32 v[22:23], v[22:23], v[30:31]
v_pk_add_f32 v[120:121], v[120:121], v[0:1]
v_pk_add_f32 v[122:123], v[122:123], v[2:3]
v_pk_add_f32 v[124:125], v[124:125], v[4:5]
v_pk_add_f32 v[126:127], v[126:127], v[6:7]
v_pk_add_f32 v[120:121], v[120:121], v[16:17]
v_pk_add_f32 v[122:123], v[122:123], v[18:19]
v_pk_add_f32 v[124:125], v[124:125], v[20:21]
v_pk_add_f32 v[126:127], v[126:127], v[22:23]
v_cvt_pk_bf16_f32 v176, v120, v121
v_cvt_pk_bf16_f32 v177, v122, v123
v_cvt_pk_bf16_f32 v178, v124, v125
v_cvt_pk_bf16_f32 v179, v126, v127
buffer_store_dwordx4 v[176:179], v236, s[16:19], 0 offen nt
s_waitcnt lgkmcnt(8)
v_pk_add_f32 v[32:33], v[32:33], v[40:41]
v_pk_add_f32 v[34:35], v[34:35], v[42:43]
v_pk_add_f32 v[36:37], v[36:37], v[44:45]
v_pk_add_f32 v[38:39], v[38:39], v[46:47]
v_pk_add_f32 v[48:49], v[48:49], v[56:57]
v_pk_add_f32 v[50:51], v[50:51], v[58:59]
v_pk_add_f32 v[52:53], v[52:53], v[60:61]
v_pk_add_f32 v[54:55], v[54:55], v[62:63]
v_pk_add_f32 v[128:129], v[128:129], v[32:33]
v_pk_add_f32 v[130:131], v[130:131], v[34:35]
v_pk_add_f32 v[132:133], v[132:133], v[36:37]
v_pk_add_f32 v[134:135], v[134:135], v[38:39]
v_pk_add_f32 v[128:129], v[128:129], v[48:49]
v_pk_add_f32 v[130:131], v[130:131], v[50:51]
v_pk_add_f32 v[132:133], v[132:133], v[52:53]
v_pk_add_f32 v[134:135], v[134:135], v[54:55]
v_cvt_pk_bf16_f32 v180, v128, v129
v_cvt_pk_bf16_f32 v181, v130, v131
v_cvt_pk_bf16_f32 v182, v132, v133
v_cvt_pk_bf16_f32 v183, v134, v135
buffer_store_dwordx4 v[180:183], v237, s[16:19], 0 offen nt
s_waitcnt lgkmcnt(0)
v_pk_add_f32 v[64:65], v[64:65], v[72:73]
v_pk_add_f32 v[66:67], v[66:67], v[74:75]
v_pk_add_f32 v[68:69], v[68:69], v[76:77]
v_pk_add_f32 v[70:71], v[70:71], v[78:79]
v_pk_add_f32 v[80:81], v[80:81], v[88:89]
v_pk_add_f32 v[82:83], v[82:83], v[90:91]
v_pk_add_f32 v[84:85], v[84:85], v[92:93]
v_pk_add_f32 v[86:87], v[86:87], v[94:95]
v_pk_add_f32 v[136:137], v[136:137], v[64:65]
v_pk_add_f32 v[138:139], v[138:139], v[66:67]
v_pk_add_f32 v[140:141], v[140:141], v[68:69]
v_pk_add_f32 v[142:143], v[142:143], v[70:71]
v_pk_add_f32 v[136:137], v[136:137], v[80:81]
v_pk_add_f32 v[138:139], v[138:139], v[82:83]
v_pk_add_f32 v[140:141], v[140:141], v[84:85]
v_pk_add_f32 v[142:143], v[142:143], v[86:87]
v_cvt_pk_bf16_f32 v184, v136, v137
v_cvt_pk_bf16_f32 v185, v138, v139
v_cvt_pk_bf16_f32 v186, v140, v141
v_cvt_pk_bf16_f32 v187, v142, v143
buffer_store_dwordx4 v[184:187], v238, s[16:19], 0 offen nt
s_branch L_fin
L_A:
s_lshl_b32 s30, s17, 2
s_add_u32 s30, s30, s27
s_lshl_b32 s30, s30, 7
v_mul_u32_u24 v245, 12288, v255
v_add_u32 v245, s30, v245
v_min_u32 v245, code_end-parallel_sum__ssm_conv_h3__mixer_gmlp__prompt_kernel-4, v245
s_mov_b64 exec, 0xff
global_load_dword v243, v245, s[4:5]
s_mov_b64 exec, -1
s_lshl_b32 s24, s18, 7
s_lshl_b32 s30, s27, 5
s_add_u32 s24, s24, s30
v_lshrrev_b32 v210, 5, v255
v_lshlrev_b32 v210, 3, v210
v_bfe_u32 v211, v255, 3, 2
v_add3_u32 v208, v210, v211, s24
v_and_b32 v211, 7, v255
v_lshrrev_b32 v212, 4, v255
v_xor_b32 v211, v211, v212
v_lshlrev_b32 v209, 4, v211
v_mul_u32_u24 v210, 1152, v208
v_add_u32 v200, v210, v209
v_xor_b32 v201, 64, v200
v_add_u32 v201, 18432, v201
s_mul_i32 s30, s27, 147456
s_mul_i32 s31, s19, 384
s_add_u32 s30, s30, s31
v_add_u32 v210, 0, v255
v_mul_u32_u24 v211, 2731, v210
v_lshrrev_b32 v211, 16, v211
v_mul_u32_u24 v212, 24, v211
v_sub_u32 v210, v210, v212
v_and_b32 v212, 2, v211
v_xor_b32 v210, v210, v212
v_mul_u32_u24 v211, 9216, v211
v_lshl_add_u32 v211, v210, 4, v211
v_add_u32 v202, s30, v211
v_xor_b32 v205, 64, v202
v_add_u32 v205, 73728, v205
v_add_u32 v210, 64, v255
v_mul_u32_u24 v211, 2731, v210
v_lshrrev_b32 v211, 16, v211
v_mul_u32_u24 v212, 24, v211
v_sub_u32 v210, v210, v212
v_and_b32 v212, 2, v211
v_xor_b32 v210, v210, v212
v_mul_u32_u24 v211, 9216, v211
v_lshl_add_u32 v211, v210, 4, v211
v_add_u32 v203, s30, v211
v_xor_b32 v206, 64, v203
v_add_u32 v206, 73728, v206
v_add_u32 v210, 128, v255
v_mul_u32_u24 v211, 2731, v210
v_lshrrev_b32 v211, 16, v211
v_mul_u32_u24 v212, 24, v211
v_sub_u32 v210, v210, v212
v_and_b32 v212, 2, v211
v_xor_b32 v210, v210, v212
v_mul_u32_u24 v211, 9216, v211
v_lshl_add_u32 v211, v210, 4, v211
v_add_u32 v204, s30, v211
v_xor_b32 v207, 64, v204
v_add_u32 v207, 73728, v207
s_add_u32 s46, s98, s99
s_and_b32 s46, s46, 1
s_lshl_b32 s46, s46, 2
s_add_u32 s40, s46, 3
s_mul_i32 s31, s40, 57
s_lshr_b32 s31, s31, 9
s_mul_i32 s31, s31, 9
s_sub_u32 s40, s40, s31
s_add_u32 s41, s46, 4
s_mul_i32 s31, s41, 57
s_lshr_b32 s31, s31, 9
s_mul_i32 s31, s31, 9
s_sub_u32 s41, s41, s31
s_lshl_b32 s40, s40, 7
s_add_u32 s42, s40, 4608
s_mul_i32 s41, s41, 589824
s_add_u32 s43, s41, 4608
s_mul_i32 s47, s27, 6144
s_add_u32 s47, s47, 49152
s_lshl_b32 s48, s27, 12
s_mov_b32 s10, 2359296
s_mov_b32 s11, 0x20000
s_mov_b32 s14, 5308416
s_mov_b32 s15, 0x20000
s_waitcnt lgkmcnt(0)
s_mov_b32 s8, s52
s_and_b32 s9, s53, 0xffff
s_mov_b32 s12, s60
s_and_b32 s13, s61, 0xffff
v_and_b32 v239, 15, v255
v_lshrrev_b32 v240, 1, v239
v_lshrrev_b32 v241, 4, v255
v_xor_b32 v240, v240, v241
v_lshlrev_b32 v240, 4, v240
s_lshl_b32 s31, s25, 13
v_lshl_add_u32 v224, v239, 7, v240
v_add_u32 v224, s31, v224
v_xor_b32 v225, 64, v224
v_bfe_u32 v239, v255, 2, 2
v_lshl_add_u32 v239, v241, 3, v239
v_mul_u32_u24 v239, 384, v239
v_and_b32 v240, 3, v255
v_lshl_add_u32 v239, v240, 3, v239
v_add_u32 v239, 49152, v239
v_bfe_u32 v240, v255, 3, 2
s_mul_i32 s30, s26, 6
s_add_u32 s31, s30, 0
v_xor_b32 v242, s31, v240
v_lshl_add_u32 v226, v242, 5, v239
v_add_u32 v232, 49152, v226
s_add_u32 s31, s30, 1
v_xor_b32 v242, s31, v240
v_lshl_add_u32 v227, v242, 5, v239
v_add_u32 v233, 49152, v227
s_add_u32 s31, s30, 2
v_xor_b32 v242, s31, v240
v_lshl_add_u32 v228, v242, 5, v239
v_add_u32 v234, 49152, v228
s_add_u32 s31, s30, 3
v_xor_b32 v242, s31, v240
v_lshl_add_u32 v229, v242, 5, v239
v_add_u32 v235, 49152, v229
s_add_u32 s31, s30, 4
v_xor_b32 v242, s31, v240
v_lshl_add_u32 v230, v242, 5, v239
v_add_u32 v236, 49152, v230
s_add_u32 s31, s30, 5
v_xor_b32 v242, s31, v240
v_lshl_add_u32 v231, v242, 5, v239
v_add_u32 v237, 49152, v231
v_mov_b32 v244, 0x409d30fc
v_mov_b32 v246, 1.0
s_mov_b32 s6, s66
s_mov_b32 s7, s67
s_mov_b32 s68, s64
s_and_b32 s69, s65, 0xffff
s_mov_b32 s70, 256
s_mov_b32 s71, 0x20000
s_add_u32 s20, s6, 41943040
s_addc_u32 s21, s7, 0
s_and_b32 s21, s21, 0xffff
s_mov_b32 s22, 1409024
s_mov_b32 s23, 0x20000
v_lshlrev_b32 v176, 2, v255
v_lshlrev_b32 v177, 3, v255
v_lshlrev_b32 v238, 4, v255
s_mul_i32 s36, s19, 1536
s_mul_i32 s31, s27, 384
s_add_u32 s36, s36, s31
s_add_u32 s36, s36, 1081344
s_lshl_b32 s30, s27, 7
s_add_u32 s30, s30, 147456
v_add_u32 v188, s30, v176
s_mul_i32 s30, s27, 192
s_add_u32 s30, s30, 148480
v_add_u32 v189, s30, v176
v_min_u32 v181, 47, v255
v_lshlrev_b32 v181, 3, v181
s_add_u32 s72, s6, 0
s_addc_u32 s73, s7, 0
s_and_b32 s73, s73, 0xffff
s_mov_b32 s74, 9437184
s_mov_b32 s75, 0x20000
v_lshrrev_b32 v239, 4, v255
v_lshlrev_b32 v239, 5, v239
s_lshl_b32 s31, s25, 8
s_add_u32 s31, s31, 147456
v_add_u32 v239, s31, v239
v_and_b32 v240, 15, v255
s_mul_i32 s31, s26, 384
s_add_u32 s31, s31, 148480
v_lshl_add_u32 v240, v240, 2, s31
v_mov_b32 v241, 153088
v_mov_b32 v242, 0
ds_write_b32 v241, v242
s_lshl_b32 s32, s18, 2
s_lshl_b32 s33, s25, 1
s_add_u32 s32, s32, s33
s_mul_i32 s52, s32, 12288
s_mul_i32 s33, s19, 786432
s_add_u32 s52, s52, s33
s_mul_i32 s33, s26, 6144
s_add_u32 s52, s52, s33
s_add_u32 s53, s52, 4096
s_add_u32 s54, s52, 12288
s_add_u32 s55, s52, 16384
s_lshl_b32 s34, s18, 2
s_add_u32 s34, s34, s27
s_mul_i32 s34, s34, 6144
s_lshl_b32 s37, s19, 9
s_add_u32 s37, s37, s34
s_add_u32 s35, s34, 4096
v_lshrrev_b32 v191, 1, v255
v_and_b32 v192, 1, v255
v_lshlrev_b32 v192, 9, v192
v_lshl_add_u32 v191, v191, 2, v192
s_lshl_b32 s30, s27, 7
s_add_u32 s30, s30, 150016
v_add_u32 v191, s30, v191
v_bfe_u32 v190, v255, 3, 1
v_lshl_add_u32 v190, v190, 7, v239
v_bfe_u32 v192, v255, 2, 1
v_lshl_add_u32 v190, v192, 4, v190
s_lshl_b32 s31, s26, 10
v_add_u32 v190, s31, v190
v_lshl_add_u32 v214, v208, 12, v209
v_xor_b32 v215, 64, v214
v_add_u32 v215, 65536, v215
s_mul_i32 s30, s27, 6144
v_lshl_add_u32 v216, v255, 4, s30
v_and_b32 v179, 15, v255
v_lshlrev_b32 v179, 7, v179
v_and_b32 v178, 3, v255
s_and_b32 s30, s18, 12
v_add_u32 v178, s30, v178
v_and_b32 v178, 15, v178
v_lshlrev_b32 v178, 7, v178
v_mov_b32 v217, 1
s_mul_i32 s30, s25, 24576
s_mul_i32 s31, s26, 6144
s_add_u32 s30, s30, s31
s_add_u32 s30, s30, 65536
v_lshl_add_u32 v218, v255, 4, s30
s_lshl_b32 s38, s19, 11
s_add_u32 s38, s38, 1179648
s_lshl_b32 s30, s18, 7
s_add_u32 s39, s38, s30
v_mov_b32 v2, 0
v_mov_b32 v3, 0
buffer_store_dwordx2 v[2:3], v177, s[20:23], s37 offen sc0 sc1
s_lshl_b32 s30, s19, 4
s_add_u32 s30, s30, s18
s_lshl_b32 s30, s30, 7
s_add_u32 s30, s30, 1179648
s_cmp_eq_u32 s27, 0
s_cselect_b32 s30, s30, 0x40000000
s_mov_b32 exec_hi, 0
buffer_store_dword v2, v176, s[20:23], s30 offen sc0 sc1
s_mov_b32 exec_hi, -1
s_waitcnt lgkmcnt(0)
s_barrier
ds_read_b128 v[96:99], v224 offset:0
ds_read_b128 v[100:103], v224 offset:2048
ds_read_b128 v[104:107], v224 offset:4096
ds_read_b128 v[108:111], v224 offset:6144
ds_read_b64_tr_b16 v[128:129], v226 offset:0
ds_read_b64_tr_b16 v[130:131], v226 offset:1536
ds_read_b64_tr_b16 v[132:133], v227 offset:0
ds_read_b64_tr_b16 v[134:135], v227 offset:1536
ds_read_b64_tr_b16 v[136:137], v228 offset:0
ds_read_b64_tr_b16 v[138:139], v228 offset:1536
ds_read_b64_tr_b16 v[140:141], v229 offset:0
ds_read_b64_tr_b16 v[142:143], v229 offset:1536
ds_read_b64_tr_b16 v[144:145], v230 offset:0
ds_read_b64_tr_b16 v[146:147], v230 offset:1536
ds_read_b64_tr_b16 v[148:149], v231 offset:0
ds_read_b64_tr_b16 v[150:151], v231 offset:1536
s_waitcnt lgkmcnt(0)
v_mfma_f32_16x16x32_bf16 v[0:3], v[96:99], v[128:131], 0
ds_read_b128 v[112:115], v225 offset:0
v_mfma_f32_16x16x32_bf16 v[24:27], v[100:103], v[128:131], 0
ds_read_b128 v[116:119], v225 offset:2048
v_mfma_f32_16x16x32_bf16 v[48:51], v[104:107], v[128:131], 0
ds_read_b128 v[120:123], v225 offset:4096
v_mfma_f32_16x16x32_bf16 v[72:75], v[108:111], v[128:131], 0
ds_read_b128 v[124:127], v225 offset:6144
v_mfma_f32_16x16x32_bf16 v[4:7], v[96:99], v[132:135], 0
v_mfma_f32_16x16x32_bf16 v[28:31], v[100:103], v[132:135], 0
ds_read_b64_tr_b16 v[152:153], v226 offset:12288
v_mfma_f32_16x16x32_bf16 v[52:55], v[104:107], v[132:135], 0
ds_read_b64_tr_b16 v[154:155], v226 offset:13824
v_mfma_f32_16x16x32_bf16 v[76:79], v[108:111], v[132:135], 0
ds_read_b64_tr_b16 v[156:157], v227 offset:12288
v_mfma_f32_16x16x32_bf16 v[8:11], v[96:99], v[136:139], 0
ds_read_b64_tr_b16 v[158:159], v227 offset:13824
v_mfma_f32_16x16x32_bf16 v[32:35], v[100:103], v[136:139], 0
v_mfma_f32_16x16x32_bf16 v[56:59], v[104:107], v[136:139], 0
ds_read_b64_tr_b16 v[160:161], v228 offset:12288
v_mfma_f32_16x16x32_bf16 v[80:83], v[108:111], v[136:139], 0
ds_read_b64_tr_b16 v[162:163], v228 offset:13824
v_mfma_f32_16x16x32_bf16 v[12:15], v[96:99], v[140:143], 0
ds_read_b64_tr_b16 v[164:165], v229 offset:12288
v_mfma_f32_16x16x32_bf16 v[36:39], v[100:103], v[140:143], 0
ds_read_b64_tr_b16 v[166:167], v229 offset:13824
v_mfma_f32_16x16x32_bf16 v[60:63], v[104:107], v[140:143], 0
v_mfma_f32_16x16x32_bf16 v[84:87], v[108:111], v[140:143], 0
ds_read_b64_tr_b16 v[168:169], v230 offset:12288
v_mfma_f32_16x16x32_bf16 v[16:19], v[96:99], v[144:147], 0
ds_read_b64_tr_b16 v[170:171], v230 offset:13824
v_mfma_f32_16x16x32_bf16 v[40:43], v[100:103], v[144:147], 0
ds_read_b64_tr_b16 v[172:173], v231 offset:12288
v_mfma_f32_16x16x32_bf16 v[64:67], v[104:107], v[144:147], 0
ds_read_b64_tr_b16 v[174:175], v231 offset:13824
v_mfma_f32_16x16x32_bf16 v[88:91], v[108:111], v[144:147], 0
v_mfma_f32_16x16x32_bf16 v[20:23], v[96:99], v[148:151], 0
v_mfma_f32_16x16x32_bf16 v[44:47], v[100:103], v[148:151], 0
v_mfma_f32_16x16x32_bf16 v[68:71], v[104:107], v[148:151], 0
v_mfma_f32_16x16x32_bf16 v[92:95], v[108:111], v[148:151], 0
s_waitcnt lgkmcnt(0)
s_barrier
v_mfma_f32_16x16x32_bf16 v[0:3], v[112:115], v[152:155], v[0:3]
ds_read_b128 v[96:99], v224 offset:16384
v_mfma_f32_16x16x32_bf16 v[24:27], v[116:119], v[152:155], v[24:27]
ds_read_b128 v[100:103], v224 offset:18432
v_mfma_f32_16x16x32_bf16 v[48:51], v[120:123], v[152:155], v[48:51]
ds_read_b128 v[104:107], v224 offset:20480
v_mfma_f32_16x16x32_bf16 v[72:75], v[124:127], v[152:155], v[72:75]
ds_read_b128 v[108:111], v224 offset:22528
v_mfma_f32_16x16x32_bf16 v[4:7], v[112:115], v[156:159], v[4:7]
v_mfma_f32_16x16x32_bf16 v[28:31], v[116:119], v[156:159], v[28:31]
ds_read_b64_tr_b16 v[128:129], v226 offset:24576
v_mfma_f32_16x16x32_bf16 v[52:55], v[120:123], v[156:159], v[52:55]
ds_read_b64_tr_b16 v[130:131], v226 offset:26112
v_mfma_f32_16x16x32_bf16 v[76:79], v[124:127], v[156:159], v[76:79]
ds_read_b64_tr_b16 v[132:133], v227 offset:24576
v_mfma_f32_16x16x32_bf16 v[8:11], v[112:115], v[160:163], v[8:11]
ds_read_b64_tr_b16 v[134:135], v227 offset:26112
v_mfma_f32_16x16x32_bf16 v[32:35], v[116:119], v[160:163], v[32:35]
v_mfma_f32_16x16x32_bf16 v[56:59], v[120:123], v[160:163], v[56:59]
ds_read_b64_tr_b16 v[136:137], v228 offset:24576
v_mfma_f32_16x16x32_bf16 v[80:83], v[124:127], v[160:163], v[80:83]
ds_read_b64_tr_b16 v[138:139], v228 offset:26112
v_mfma_f32_16x16x32_bf16 v[12:15], v[112:115], v[164:167], v[12:15]
ds_read_b64_tr_b16 v[140:141], v229 offset:24576
v_mfma_f32_16x16x32_bf16 v[36:39], v[116:119], v[164:167], v[36:39]
ds_read_b64_tr_b16 v[142:143], v229 offset:26112
v_mfma_f32_16x16x32_bf16 v[60:63], v[120:123], v[164:167], v[60:63]
v_mfma_f32_16x16x32_bf16 v[84:87], v[124:127], v[164:167], v[84:87]
ds_read_b64_tr_b16 v[144:145], v230 offset:24576
v_mfma_f32_16x16x32_bf16 v[16:19], v[112:115], v[168:171], v[16:19]
ds_read_b64_tr_b16 v[146:147], v230 offset:26112
v_mfma_f32_16x16x32_bf16 v[40:43], v[116:119], v[168:171], v[40:43]
ds_read_b64_tr_b16 v[148:149], v231 offset:24576
v_mfma_f32_16x16x32_bf16 v[64:67], v[120:123], v[168:171], v[64:67]
ds_read_b64_tr_b16 v[150:151], v231 offset:26112
v_mfma_f32_16x16x32_bf16 v[88:91], v[124:127], v[168:171], v[88:91]
v_mfma_f32_16x16x32_bf16 v[20:23], v[112:115], v[172:175], v[20:23]
v_mfma_f32_16x16x32_bf16 v[44:47], v[116:119], v[172:175], v[44:47]
v_mfma_f32_16x16x32_bf16 v[68:71], v[120:123], v[172:175], v[68:71]
v_mfma_f32_16x16x32_bf16 v[92:95], v[124:127], v[172:175], v[92:95]
s_waitcnt lgkmcnt(0)
v_mfma_f32_16x16x32_bf16 v[0:3], v[96:99], v[128:131], v[0:3]
ds_read_b128 v[112:115], v225 offset:16384
v_mfma_f32_16x16x32_bf16 v[24:27], v[100:103], v[128:131], v[24:27]
ds_read_b128 v[116:119], v225 offset:18432
v_mfma_f32_16x16x32_bf16 v[48:51], v[104:107], v[128:131], v[48:51]
ds_read_b128 v[120:123], v225 offset:20480
v_mfma_f32_16x16x32_bf16 v[72:75], v[108:111], v[128:131], v[72:75]
ds_read_b128 v[124:127], v225 offset:22528
v_mfma_f32_16x16x32_bf16 v[4:7], v[96:99], v[132:135], v[4:7]
v_mfma_f32_16x16x32_bf16 v[28:31], v[100:103], v[132:135], v[28:31]
ds_read_b64_tr_b16 v[152:153], v226 offset:36864
v_mfma_f32_16x16x32_bf16 v[52:55], v[104:107], v[132:135], v[52:55]
ds_read_b64_tr_b16 v[154:155], v226 offset:38400
v_mfma_f32_16x16x32_bf16 v[76:79], v[108:111], v[132:135], v[76:79]
ds_read_b64_tr_b16 v[156:157], v227 offset:36864
v_mfma_f32_16x16x32_bf16 v[8:11], v[96:99], v[136:139], v[8:11]
ds_read_b64_tr_b16 v[158:159], v227 offset:38400
v_mfma_f32_16x16x32_bf16 v[32:35], v[100:103], v[136:139], v[32:35]
v_mfma_f32_16x16x32_bf16 v[56:59], v[104:107], v[136:139], v[56:59]
ds_read_b64_tr_b16 v[160:161], v228 offset:36864
v_mfma_f32_16x16x32_bf16 v[80:83], v[108:111], v[136:139], v[80:83]
ds_read_b64_tr_b16 v[162:163], v228 offset:38400
v_mfma_f32_16x16x32_bf16 v[12:15], v[96:99], v[140:143], v[12:15]
ds_read_b64_tr_b16 v[164:165], v229 offset:36864
v_mfma_f32_16x16x32_bf16 v[36:39], v[100:103], v[140:143], v[36:39]
ds_read_b64_tr_b16 v[166:167], v229 offset:38400
v_mfma_f32_16x16x32_bf16 v[60:63], v[104:107], v[140:143], v[60:63]
v_mfma_f32_16x16x32_bf16 v[84:87], v[108:111], v[140:143], v[84:87]
ds_read_b64_tr_b16 v[168:169], v230 offset:36864
v_mfma_f32_16x16x32_bf16 v[16:19], v[96:99], v[144:147], v[16:19]
ds_read_b64_tr_b16 v[170:171], v230 offset:38400
v_mfma_f32_16x16x32_bf16 v[40:43], v[100:103], v[144:147], v[40:43]
ds_read_b64_tr_b16 v[172:173], v231 offset:36864
v_mfma_f32_16x16x32_bf16 v[64:67], v[104:107], v[144:147], v[64:67]
ds_read_b64_tr_b16 v[174:175], v231 offset:38400
v_mfma_f32_16x16x32_bf16 v[88:91], v[108:111], v[144:147], v[88:91]
v_mfma_f32_16x16x32_bf16 v[20:23], v[96:99], v[148:151], v[20:23]
v_mfma_f32_16x16x32_bf16 v[44:47], v[100:103], v[148:151], v[44:47]
v_mfma_f32_16x16x32_bf16 v[68:71], v[104:107], v[148:151], v[68:71]
v_mfma_f32_16x16x32_bf16 v[92:95], v[108:111], v[148:151], v[92:95]
s_waitcnt lgkmcnt(0)
s_barrier
v_mfma_f32_16x16x32_bf16 v[0:3], v[112:115], v[152:155], v[0:3]
ds_read_b128 v[96:99], v224 offset:32768
v_mfma_f32_16x16x32_bf16 v[24:27], v[116:119], v[152:155], v[24:27]
ds_read_b128 v[100:103], v224 offset:34816
v_mfma_f32_16x16x32_bf16 v[48:51], v[120:123], v[152:155], v[48:51]
ds_read_b128 v[104:107], v224 offset:36864
v_mfma_f32_16x16x32_bf16 v[72:75], v[124:127], v[152:155], v[72:75]
ds_read_b128 v[108:111], v224 offset:38912
v_mfma_f32_16x16x32_bf16 v[4:7], v[112:115], v[156:159], v[4:7]
v_mfma_f32_16x16x32_bf16 v[28:31], v[116:119], v[156:159], v[28:31]
ds_read_b64_tr_b16 v[128:129], v232 offset:0
v_mfma_f32_16x16x32_bf16 v[52:55], v[120:123], v[156:159], v[52:55]
ds_read_b64_tr_b16 v[130:131], v232 offset:1536
v_mfma_f32_16x16x32_bf16 v[76:79], v[124:127], v[156:159], v[76:79]
ds_read_b64_tr_b16 v[132:133], v233 offset:0
v_mfma_f32_16x16x32_bf16 v[8:11], v[112:115], v[160:163], v[8:11]
ds_read_b64_tr_b16 v[134:135], v233 offset:1536
v_mfma_f32_16x16x32_bf16 v[32:35], v[116:119], v[160:163], v[32:35]
v_mfma_f32_16x16x32_bf16 v[56:59], v[120:123], v[160:163], v[56:59]
ds_read_b64_tr_b16 v[136:137], v234 offset:0
v_mfma_f32_16x16x32_bf16 v[80:83], v[124:127], v[160:163], v[80:83]
ds_read_b64_tr_b16 v[138:139], v234 offset:1536
v_mfma_f32_16x16x32_bf16 v[12:15], v[112:115], v[164:167], v[12:15]
ds_read_b64_tr_b16 v[140:141], v235 offset:0
v_mfma_f32_16x16x32_bf16 v[36:39], v[116:119], v[164:167], v[36:39]
ds_read_b64_tr_b16 v[142:143], v235 offset:1536
v_mfma_f32_16x16x32_bf16 v[60:63], v[120:123], v[164:167], v[60:63]
v_mfma_f32_16x16x32_bf16 v[84:87], v[124:127], v[164:167], v[84:87]
ds_read_b64_tr_b16 v[144:145], v236 offset:0
v_mfma_f32_16x16x32_bf16 v[16:19], v[112:115], v[168:171], v[16:19]
ds_read_b64_tr_b16 v[146:147], v236 offset:1536
v_mfma_f32_16x16x32_bf16 v[40:43], v[116:119], v[168:171], v[40:43]
ds_read_b64_tr_b16 v[148:149], v237 offset:0
v_mfma_f32_16x16x32_bf16 v[64:67], v[120:123], v[168:171], v[64:67]
ds_read_b64_tr_b16 v[150:151], v237 offset:1536
v_mfma_f32_16x16x32_bf16 v[88:91], v[124:127], v[168:171], v[88:91]
v_mfma_f32_16x16x32_bf16 v[20:23], v[112:115], v[172:175], v[20:23]
v_mfma_f32_16x16x32_bf16 v[44:47], v[116:119], v[172:175], v[44:47]
v_mfma_f32_16x16x32_bf16 v[68:71], v[120:123], v[172:175], v[68:71]
v_mfma_f32_16x16x32_bf16 v[92:95], v[124:127], v[172:175], v[92:95]
s_waitcnt lgkmcnt(0)
v_mfma_f32_16x16x32_bf16 v[0:3], v[96:99], v[128:131], v[0:3]
ds_read_b128 v[112:115], v225 offset:32768
v_mfma_f32_16x16x32_bf16 v[24:27], v[100:103], v[128:131], v[24:27]
ds_read_b128 v[116:119], v225 offset:34816
v_mfma_f32_16x16x32_bf16 v[48:51], v[104:107], v[128:131], v[48:51]
ds_read_b128 v[120:123], v225 offset:36864
v_mfma_f32_16x16x32_bf16 v[72:75], v[108:111], v[128:131], v[72:75]
ds_read_b128 v[124:127], v225 offset:38912
v_mfma_f32_16x16x32_bf16 v[4:7], v[96:99], v[132:135], v[4:7]
v_mfma_f32_16x16x32_bf16 v[28:31], v[100:103], v[132:135], v[28:31]
ds_read_b64_tr_b16 v[152:153], v232 offset:12288
v_mfma_f32_16x16x32_bf16 v[52:55], v[104:107], v[132:135], v[52:55]
ds_read_b64_tr_b16 v[154:155], v232 offset:13824
v_mfma_f32_16x16x32_bf16 v[76:79], v[108:111], v[132:135], v[76:79]
ds_read_b64_tr_b16 v[156:157], v233 offset:12288
v_mfma_f32_16x16x32_bf16 v[8:11], v[96:99], v[136:139], v[8:11]
ds_read_b64_tr_b16 v[158:159], v233 offset:13824
v_mfma_f32_16x16x32_bf16 v[32:35], v[100:103], v[136:139], v[32:35]
v_mfma_f32_16x16x32_bf16 v[56:59], v[104:107], v[136:139], v[56:59]
ds_read_b64_tr_b16 v[160:161], v234 offset:12288
v_mfma_f32_16x16x32_bf16 v[80:83], v[108:111], v[136:139], v[80:83]
ds_read_b64_tr_b16 v[162:163], v234 offset:13824
v_mfma_f32_16x16x32_bf16 v[12:15], v[96:99], v[140:143], v[12:15]
ds_read_b64_tr_b16 v[164:165], v235 offset:12288
v_mfma_f32_16x16x32_bf16 v[36:39], v[100:103], v[140:143], v[36:39]
ds_read_b64_tr_b16 v[166:167], v235 offset:13824
v_mfma_f32_16x16x32_bf16 v[60:63], v[104:107], v[140:143], v[60:63]
v_mfma_f32_16x16x32_bf16 v[84:87], v[108:111], v[140:143], v[84:87]
ds_read_b64_tr_b16 v[168:169], v236 offset:12288
v_mfma_f32_16x16x32_bf16 v[16:19], v[96:99], v[144:147], v[16:19]
ds_read_b64_tr_b16 v[170:171], v236 offset:13824
v_mfma_f32_16x16x32_bf16 v[40:43], v[100:103], v[144:147], v[40:43]
ds_read_b64_tr_b16 v[172:173], v237 offset:12288
v_mfma_f32_16x16x32_bf16 v[64:67], v[104:107], v[144:147], v[64:67]
ds_read_b64_tr_b16 v[174:175], v237 offset:13824
v_mfma_f32_16x16x32_bf16 v[88:91], v[108:111], v[144:147], v[88:91]
v_mfma_f32_16x16x32_bf16 v[20:23], v[96:99], v[148:151], v[20:23]
v_mfma_f32_16x16x32_bf16 v[44:47], v[100:103], v[148:151], v[44:47]
v_mfma_f32_16x16x32_bf16 v[68:71], v[104:107], v[148:151], v[68:71]
v_mfma_f32_16x16x32_bf16 v[92:95], v[108:111], v[148:151], v[92:95]
s_waitcnt lgkmcnt(0)
s_barrier
v_mfma_f32_16x16x32_bf16 v[0:3], v[112:115], v[152:155], v[0:3]
ds_read_b128 v[96:99], v224 offset:0
v_mfma_f32_16x16x32_bf16 v[24:27], v[116:119], v[152:155], v[24:27]
ds_read_b128 v[100:103], v224 offset:2048
v_mfma_f32_16x16x32_bf16 v[48:51], v[120:123], v[152:155], v[48:51]
ds_read_b128 v[104:107], v224 offset:4096
v_mfma_f32_16x16x32_bf16 v[72:75], v[124:127], v[152:155], v[72:75]
ds_read_b128 v[108:111], v224 offset:6144
v_mfma_f32_16x16x32_bf16 v[4:7], v[112:115], v[156:159], v[4:7]
v_mfma_f32_16x16x32_bf16 v[28:31], v[116:119], v[156:159], v[28:31]
ds_read_b64_tr_b16 v[128:129], v232 offset:24576
v_mfma_f32_16x16x32_bf16 v[52:55], v[120:123], v[156:159], v[52:55]
ds_read_b64_tr_b16 v[130:131], v232 offset:26112
v_mfma_f32_16x16x32_bf16 v[76:79], v[124:127], v[156:159], v[76:79]
ds_read_b64_tr_b16 v[132:133], v233 offset:24576
v_mfma_f32_16x16x32_bf16 v[8:11], v[112:115], v[160:163], v[8:11]
ds_read_b64_tr_b16 v[134:135], v233 offset:26112
v_mfma_f32_16x16x32_bf16 v[32:35], v[116:119], v[160:163], v[32:35]
v_mfma_f32_16x16x32_bf16 v[56:59], v[120:123], v[160:163], v[56:59]
ds_read_b64_tr_b16 v[136:137], v234 offset:24576
v_mfma_f32_16x16x32_bf16 v[80:83], v[124:127], v[160:163], v[80:83]
ds_read_b64_tr_b16 v[138:139], v234 offset:26112
v_mfma_f32_16x16x32_bf16 v[12:15], v[112:115], v[164:167], v[12:15]
ds_read_b64_tr_b16 v[140:141], v235 offset:24576
v_mfma_f32_16x16x32_bf16 v[36:39], v[116:119], v[164:167], v[36:39]
ds_read_b64_tr_b16 v[142:143], v235 offset:26112
v_mfma_f32_16x16x32_bf16 v[60:63], v[120:123], v[164:167], v[60:63]
v_mfma_f32_16x16x32_bf16 v[84:87], v[124:127], v[164:167], v[84:87]
ds_read_b64_tr_b16 v[144:145], v236 offset:24576
v_mfma_f32_16x16x32_bf16 v[16:19], v[112:115], v[168:171], v[16:19]
ds_read_b64_tr_b16 v[146:147], v236 offset:26112
v_mfma_f32_16x16x32_bf16 v[40:43], v[116:119], v[168:171], v[40:43]
ds_read_b64_tr_b16 v[148:149], v237 offset:24576
v_mfma_f32_16x16x32_bf16 v[64:67], v[120:123], v[168:171], v[64:67]
ds_read_b64_tr_b16 v[150:151], v237 offset:26112
v_mfma_f32_16x16x32_bf16 v[88:91], v[124:127], v[168:171], v[88:91]
v_mfma_f32_16x16x32_bf16 v[20:23], v[112:115], v[172:175], v[20:23]
v_mfma_f32_16x16x32_bf16 v[44:47], v[116:119], v[172:175], v[44:47]
v_mfma_f32_16x16x32_bf16 v[68:71], v[120:123], v[172:175], v[68:71]
v_mfma_f32_16x16x32_bf16 v[92:95], v[124:127], v[172:175], v[92:95]
s_waitcnt lgkmcnt(0)
v_mfma_f32_16x16x32_bf16 v[0:3], v[96:99], v[128:131], v[0:3]
ds_read_b128 v[112:115], v225 offset:0
v_mfma_f32_16x16x32_bf16 v[24:27], v[100:103], v[128:131], v[24:27]
ds_read_b128 v[116:119], v225 offset:2048
v_mfma_f32_16x16x32_bf16 v[48:51], v[104:107], v[128:131], v[48:51]
ds_read_b128 v[120:123], v225 offset:4096
v_mfma_f32_16x16x32_bf16 v[72:75], v[108:111], v[128:131], v[72:75]
ds_read_b128 v[124:127], v225 offset:6144
v_mfma_f32_16x16x32_bf16 v[4:7], v[96:99], v[132:135], v[4:7]
v_mfma_f32_16x16x32_bf16 v[28:31], v[100:103], v[132:135], v[28:31]
ds_read_b64_tr_b16 v[152:153], v232 offset:36864
v_mfma_f32_16x16x32_bf16 v[52:55], v[104:107], v[132:135], v[52:55]
ds_read_b64_tr_b16 v[154:155], v232 offset:38400
v_mfma_f32_16x16x32_bf16 v[76:79], v[108:111], v[132:135], v[76:79]
ds_read_b64_tr_b16 v[156:157], v233 offset:36864
v_mfma_f32_16x16x32_bf16 v[8:11], v[96:99], v[136:139], v[8:11]
ds_read_b64_tr_b16 v[158:159], v233 offset:38400
v_mfma_f32_16x16x32_bf16 v[32:35], v[100:103], v[136:139], v[32:35]
v_mfma_f32_16x16x32_bf16 v[56:59], v[104:107], v[136:139], v[56:59]
ds_read_b64_tr_b16 v[160:161], v234 offset:36864
v_mfma_f32_16x16x32_bf16 v[80:83], v[108:111], v[136:139], v[80:83]
ds_read_b64_tr_b16 v[162:163], v234 offset:38400
v_mfma_f32_16x16x32_bf16 v[12:15], v[96:99], v[140:143], v[12:15]
ds_read_b64_tr_b16 v[164:165], v235 offset:36864
v_mfma_f32_16x16x32_bf16 v[36:39], v[100:103], v[140:143], v[36:39]
ds_read_b64_tr_b16 v[166:167], v235 offset:38400
v_mfma_f32_16x16x32_bf16 v[60:63], v[104:107], v[140:143], v[60:63]
v_mfma_f32_16x16x32_bf16 v[84:87], v[108:111], v[140:143], v[84:87]
ds_read_b64_tr_b16 v[168:169], v236 offset:36864
v_mfma_f32_16x16x32_bf16 v[16:19], v[96:99], v[144:147], v[16:19]
ds_read_b64_tr_b16 v[170:171], v236 offset:38400
v_mfma_f32_16x16x32_bf16 v[40:43], v[100:103], v[144:147], v[40:43]
ds_read_b64_tr_b16 v[172:173], v237 offset:36864
v_mfma_f32_16x16x32_bf16 v[64:67], v[104:107], v[144:147], v[64:67]
ds_read_b64_tr_b16 v[174:175], v237 offset:38400
v_mfma_f32_16x16x32_bf16 v[88:91], v[108:111], v[144:147], v[88:91]
v_mfma_f32_16x16x32_bf16 v[20:23], v[96:99], v[148:151], v[20:23]
v_mfma_f32_16x16x32_bf16 v[44:47], v[100:103], v[148:151], v[44:47]
v_mfma_f32_16x16x32_bf16 v[68:71], v[104:107], v[148:151], v[68:71]
v_mfma_f32_16x16x32_bf16 v[92:95], v[108:111], v[148:151], v[92:95]
s_waitcnt lgkmcnt(0)
s_barrier
v_mfma_f32_16x16x32_bf16 v[0:3], v[112:115], v[152:155], v[0:3]
ds_read_b128 v[96:99], v224 offset:16384
v_mfma_f32_16x16x32_bf16 v[24:27], v[116:119], v[152:155], v[24:27]
ds_read_b128 v[100:103], v224 offset:18432
v_mfma_f32_16x16x32_bf16 v[48:51], v[120:123], v[152:155], v[48:51]
ds_read_b128 v[104:107], v224 offset:20480
v_mfma_f32_16x16x32_bf16 v[72:75], v[124:127], v[152:155], v[72:75]
ds_read_b128 v[108:111], v224 offset:22528
v_mfma_f32_16x16x32_bf16 v[4:7], v[112:115], v[156:159], v[4:7]
v_mfma_f32_16x16x32_bf16 v[28:31], v[116:119], v[156:159], v[28:31]
ds_read_b64_tr_b16 v[128:129], v226 offset:0
v_mfma_f32_16x16x32_bf16 v[52:55], v[120:123], v[156:159], v[52:55]
ds_read_b64_tr_b16 v[130:131], v226 offset:1536
v_mfma_f32_16x16x32_bf16 v[76:79], v[124:127], v[156:159], v[76:79]
ds_read_b64_tr_b16 v[132:133], v227 offset:0
v_mfma_f32_16x16x32_bf16 v[8:11], v[112:115], v[160:163], v[8:11]
ds_read_b64_tr_b16 v[134:135], v227 offset:1536
v_mfma_f32_16x16x32_bf16 v[32:35], v[116:119], v[160:163], v[32:35]
v_mfma_f32_16x16x32_bf16 v[56:59], v[120:123], v[160:163], v[56:59]
ds_read_b64_tr_b16 v[136:137], v228 offset:0
v_mfma_f32_16x16x32_bf16 v[80:83], v[124:127], v[160:163], v[80:83]
ds_read_b64_tr_b16 v[138:139], v228 offset:1536
v_mfma_f32_16x16x32_bf16 v[12:15], v[112:115], v[164:167], v[12:15]
ds_read_b64_tr_b16 v[140:141], v229 offset:0
v_mfma_f32_16x16x32_bf16 v[36:39], v[116:119], v[164:167], v[36:39]
ds_read_b64_tr_b16 v[142:143], v229 offset:1536
v_mfma_f32_16x16x32_bf16 v[60:63], v[120:123], v[164:167], v[60:63]
v_mfma_f32_16x16x32_bf16 v[84:87], v[124:127], v[164:167], v[84:87]
ds_read_b64_tr_b16 v[144:145], v230 offset:0
v_mfma_f32_16x16x32_bf16 v[16:19], v[112:115], v[168:171], v[16:19]
ds_read_b64_tr_b16 v[146:147], v230 offset:1536
v_mfma_f32_16x16x32_bf16 v[40:43], v[116:119], v[168:171], v[40:43]
ds_read_b64_tr_b16 v[148:149], v231 offset:0
v_mfma_f32_16x16x32_bf16 v[64:67], v[120:123], v[168:171], v[64:67]
ds_read_b64_tr_b16 v[150:151], v231 offset:1536
v_mfma_f32_16x16x32_bf16 v[88:91], v[124:127], v[168:171], v[88:91]
v_mfma_f32_16x16x32_bf16 v[20:23], v[112:115], v[172:175], v[20:23]
v_mfma_f32_16x16x32_bf16 v[44:47], v[116:119], v[172:175], v[44:47]
v_mfma_f32_16x16x32_bf16 v[68:71], v[120:123], v[172:175], v[68:71]
v_mfma_f32_16x16x32_bf16 v[92:95], v[124:127], v[172:175], v[92:95]
s_waitcnt lgkmcnt(0)
v_mfma_f32_16x16x32_bf16 v[0:3], v[96:99], v[128:131], v[0:3]
ds_read_b128 v[112:115], v225 offset:16384
v_mfma_f32_16x16x32_bf16 v[24:27], v[100:103], v[128:131], v[24:27]
ds_read_b128 v[116:119], v225 offset:18432
v_mfma_f32_16x16x32_bf16 v[48:51], v[104:107], v[128:131], v[48:51]
ds_read_b128 v[120:123], v225 offset:20480
v_mfma_f32_16x16x32_bf16 v[72:75], v[108:111], v[128:131], v[72:75]
ds_read_b128 v[124:127], v225 offset:22528
v_mfma_f32_16x16x32_bf16 v[4:7], v[96:99], v[132:135], v[4:7]
v_mfma_f32_16x16x32_bf16 v[28:31], v[100:103], v[132:135], v[28:31]
ds_read_b64_tr_b16 v[152:153], v226 offset:12288
v_mfma_f32_16x16x32_bf16 v[52:55], v[104:107], v[132:135], v[52:55]
ds_read_b64_tr_b16 v[154:155], v226 offset:13824
v_mfma_f32_16x16x32_bf16 v[76:79], v[108:111], v[132:135], v[76:79]
ds_read_b64_tr_b16 v[156:157], v227 offset:12288
v_mfma_f32_16x16x32_bf16 v[8:11], v[96:99], v[136:139], v[8:11]
ds_read_b64_tr_b16 v[158:159], v227 offset:13824
v_mfma_f32_16x16x32_bf16 v[32:35], v[100:103], v[136:139], v[32:35]
v_mfma_f32_16x16x32_bf16 v[56:59], v[104:107], v[136:139], v[56:59]
ds_read_b64_tr_b16 v[160:161], v228 offset:12288
v_mfma_f32_16x16x32_bf16 v[80:83], v[108:111], v[136:139], v[80:83]
ds_read_b64_tr_b16 v[162:163], v228 offset:13824
v_mfma_f32_16x16x32_bf16 v[12:15], v[96:99], v[140:143], v[12:15]
ds_read_b64_tr_b16 v[164:165], v229 offset:12288
v_mfma_f32_16x16x32_bf16 v[36:39], v[100:103], v[140:143], v[36:39]
ds_read_b64_tr_b16 v[166:167], v229 offset:13824
v_mfma_f32_16x16x32_bf16 v[60:63], v[104:107], v[140:143], v[60:63]
v_mfma_f32_16x16x32_bf16 v[84:87], v[108:111], v[140:143], v[84:87]
ds_read_b64_tr_b16 v[168:169], v230 offset:12288
v_mfma_f32_16x16x32_bf16 v[16:19], v[96:99], v[144:147], v[16:19]
ds_read_b64_tr_b16 v[170:171], v230 offset:13824
v_mfma_f32_16x16x32_bf16 v[40:43], v[100:103], v[144:147], v[40:43]
ds_read_b64_tr_b16 v[172:173], v231 offset:12288
v_mfma_f32_16x16x32_bf16 v[64:67], v[104:107], v[144:147], v[64:67]
ds_read_b64_tr_b16 v[174:175], v231 offset:13824
v_mfma_f32_16x16x32_bf16 v[88:91], v[108:111], v[144:147], v[88:91]
v_mfma_f32_16x16x32_bf16 v[20:23], v[96:99], v[148:151], v[20:23]
v_mfma_f32_16x16x32_bf16 v[44:47], v[100:103], v[148:151], v[44:47]
v_mfma_f32_16x16x32_bf16 v[68:71], v[104:107], v[148:151], v[68:71]
v_mfma_f32_16x16x32_bf16 v[92:95], v[108:111], v[148:151], v[92:95]
s_waitcnt lgkmcnt(0)
s_barrier
v_mfma_f32_16x16x32_bf16 v[0:3], v[112:115], v[152:155], v[0:3]
ds_read_b128 v[96:99], v224 offset:32768
v_mfma_f32_16x16x32_bf16 v[24:27], v[116:119], v[152:155], v[24:27]
ds_read_b128 v[100:103], v224 offset:34816
v_mfma_f32_16x16x32_bf16 v[48:51], v[120:123], v[152:155], v[48:51]
ds_read_b128 v[104:107], v224 offset:36864
v_mfma_f32_16x16x32_bf16 v[72:75], v[124:127], v[152:155], v[72:75]
ds_read_b128 v[108:111], v224 offset:38912
v_mfma_f32_16x16x32_bf16 v[4:7], v[112:115], v[156:159], v[4:7]
v_mfma_f32_16x16x32_bf16 v[28:31], v[116:119], v[156:159], v[28:31]
ds_read_b64_tr_b16 v[128:129], v226 offset:24576
v_mfma_f32_16x16x32_bf16 v[52:55], v[120:123], v[156:159], v[52:55]
ds_read_b64_tr_b16 v[130:131], v226 offset:26112
v_mfma_f32_16x16x32_bf16 v[76:79], v[124:127], v[156:159], v[76:79]
ds_read_b64_tr_b16 v[132:133], v227 offset:24576
v_mfma_f32_16x16x32_bf16 v[8:11], v[112:115], v[160:163], v[8:11]
ds_read_b64_tr_b16 v[134:135], v227 offset:26112
v_mfma_f32_16x16x32_bf16 v[32:35], v[116:119], v[160:163], v[32:35]
v_mfma_f32_16x16x32_bf16 v[56:59], v[120:123], v[160:163], v[56:59]
ds_read_b64_tr_b16 v[136:137], v228 offset:24576
v_mfma_f32_16x16x32_bf16 v[80:83], v[124:127], v[160:163], v[80:83]
ds_read_b64_tr_b16 v[138:139], v228 offset:26112
v_mfma_f32_16x16x32_bf16 v[12:15], v[112:115], v[164:167], v[12:15]
ds_read_b64_tr_b16 v[140:141], v229 offset:24576
v_mfma_f32_16x16x32_bf16 v[36:39], v[116:119], v[164:167], v[36:39]
ds_read_b64_tr_b16 v[142:143], v229 offset:26112
v_mfma_f32_16x16x32_bf16 v[60:63], v[120:123], v[164:167], v[60:63]
v_mfma_f32_16x16x32_bf16 v[84:87], v[124:127], v[164:167], v[84:87]
ds_read_b64_tr_b16 v[144:145], v230 offset:24576
v_mfma_f32_16x16x32_bf16 v[16:19], v[112:115], v[168:171], v[16:19]
ds_read_b64_tr_b16 v[146:147], v230 offset:26112
v_mfma_f32_16x16x32_bf16 v[40:43], v[116:119], v[168:171], v[40:43]
ds_read_b64_tr_b16 v[148:149], v231 offset:24576
v_mfma_f32_16x16x32_bf16 v[64:67], v[120:123], v[168:171], v[64:67]
ds_read_b64_tr_b16 v[150:151], v231 offset:26112
v_mfma_f32_16x16x32_bf16 v[88:91], v[124:127], v[168:171], v[88:91]
v_mfma_f32_16x16x32_bf16 v[20:23], v[112:115], v[172:175], v[20:23]
v_mfma_f32_16x16x32_bf16 v[44:47], v[116:119], v[172:175], v[44:47]
v_mfma_f32_16x16x32_bf16 v[68:71], v[120:123], v[172:175], v[68:71]
v_mfma_f32_16x16x32_bf16 v[92:95], v[124:127], v[172:175], v[92:95]
s_waitcnt lgkmcnt(0)
v_mfma_f32_16x16x32_bf16 v[0:3], v[96:99], v[128:131], v[0:3]
ds_read_b128 v[112:115], v225 offset:32768
v_mfma_f32_16x16x32_bf16 v[24:27], v[100:103], v[128:131], v[24:27]
ds_read_b128 v[116:119], v225 offset:34816
v_mfma_f32_16x16x32_bf16 v[48:51], v[104:107], v[128:131], v[48:51]
ds_read_b128 v[120:123], v225 offset:36864
v_mfma_f32_16x16x32_bf16 v[72:75], v[108:111], v[128:131], v[72:75]
ds_read_b128 v[124:127], v225 offset:38912
v_mfma_f32_16x16x32_bf16 v[4:7], v[96:99], v[132:135], v[4:7]
v_mfma_f32_16x16x32_bf16 v[28:31], v[100:103], v[132:135], v[28:31]
ds_read_b64_tr_b16 v[152:153], v226 offset:36864
v_mfma_f32_16x16x32_bf16 v[52:55], v[104:107], v[132:135], v[52:55]
ds_read_b64_tr_b16 v[154:155], v226 offset:38400
v_mfma_f32_16x16x32_bf16 v[76:79], v[108:111], v[132:135], v[76:79]
ds_read_b64_tr_b16 v[156:157], v227 offset:36864
v_mfma_f32_16x16x32_bf16 v[8:11], v[96:99], v[136:139], v[8:11]
ds_read_b64_tr_b16 v[158:159], v227 offset:38400
v_mfma_f32_16x16x32_bf16 v[32:35], v[100:103], v[136:139], v[32:35]
v_mfma_f32_16x16x32_bf16 v[56:59], v[104:107], v[136:139], v[56:59]
ds_read_b64_tr_b16 v[160:161], v228 offset:36864
v_mfma_f32_16x16x32_bf16 v[80:83], v[108:111], v[136:139], v[80:83]
ds_read_b64_tr_b16 v[162:163], v228 offset:38400
v_mfma_f32_16x16x32_bf16 v[12:15], v[96:99], v[140:143], v[12:15]
ds_read_b64_tr_b16 v[164:165], v229 offset:36864
v_mfma_f32_16x16x32_bf16 v[36:39], v[100:103], v[140:143], v[36:39]
ds_read_b64_tr_b16 v[166:167], v229 offset:38400
v_mfma_f32_16x16x32_bf16 v[60:63], v[104:107], v[140:143], v[60:63]
v_mfma_f32_16x16x32_bf16 v[84:87], v[108:111], v[140:143], v[84:87]
ds_read_b64_tr_b16 v[168:169], v230 offset:36864
v_mfma_f32_16x16x32_bf16 v[16:19], v[96:99], v[144:147], v[16:19]
ds_read_b64_tr_b16 v[170:171], v230 offset:38400
v_mfma_f32_16x16x32_bf16 v[40:43], v[100:103], v[144:147], v[40:43]
ds_read_b64_tr_b16 v[172:173], v231 offset:36864
v_mfma_f32_16x16x32_bf16 v[64:67], v[104:107], v[144:147], v[64:67]
ds_read_b64_tr_b16 v[174:175], v231 offset:38400
v_mfma_f32_16x16x32_bf16 v[88:91], v[108:111], v[144:147], v[88:91]
v_mfma_f32_16x16x32_bf16 v[20:23], v[96:99], v[148:151], v[20:23]
v_mfma_f32_16x16x32_bf16 v[44:47], v[100:103], v[148:151], v[44:47]
v_mfma_f32_16x16x32_bf16 v[68:71], v[104:107], v[148:151], v[68:71]
v_mfma_f32_16x16x32_bf16 v[92:95], v[108:111], v[148:151], v[92:95]
s_waitcnt lgkmcnt(0)
s_barrier
v_mfma_f32_16x16x32_bf16 v[0:3], v[112:115], v[152:155], v[0:3]
ds_read_b128 v[96:99], v224 offset:0
v_mfma_f32_16x16x32_bf16 v[24:27], v[116:119], v[152:155], v[24:27]
ds_read_b128 v[100:103], v224 offset:2048
v_mfma_f32_16x16x32_bf16 v[48:51], v[120:123], v[152:155], v[48:51]
ds_read_b128 v[104:107], v224 offset:4096
v_mfma_f32_16x16x32_bf16 v[72:75], v[124:127], v[152:155], v[72:75]
ds_read_b128 v[108:111], v224 offset:6144
v_mfma_f32_16x16x32_bf16 v[4:7], v[112:115], v[156:159], v[4:7]
v_mfma_f32_16x16x32_bf16 v[28:31], v[116:119], v[156:159], v[28:31]
ds_read_b64_tr_b16 v[128:129], v232 offset:0
v_mfma_f32_16x16x32_bf16 v[52:55], v[120:123], v[156:159], v[52:55]
ds_read_b64_tr_b16 v[130:131], v232 offset:1536
v_mfma_f32_16x16x32_bf16 v[76:79], v[124:127], v[156:159], v[76:79]
ds_read_b64_tr_b16 v[132:133], v233 offset:0
v_mfma_f32_16x16x32_bf16 v[8:11], v[112:115], v[160:163], v[8:11]
ds_read_b64_tr_b16 v[134:135], v233 offset:1536
v_mfma_f32_16x16x32_bf16 v[32:35], v[116:119], v[160:163], v[32:35]
v_mfma_f32_16x16x32_bf16 v[56:59], v[120:123], v[160:163], v[56:59]
ds_read_b64_tr_b16 v[136:137], v234 offset:0
v_mfma_f32_16x16x32_bf16 v[80:83], v[124:127], v[160:163], v[80:83]
ds_read_b64_tr_b16 v[138:139], v234 offset:1536
v_mfma_f32_16x16x32_bf16 v[12:15], v[112:115], v[164:167], v[12:15]
ds_read_b64_tr_b16 v[140:141], v235 offset:0
v_mfma_f32_16x16x32_bf16 v[36:39], v[116:119], v[164:167], v[36:39]
ds_read_b64_tr_b16 v[142:143], v235 offset:1536
v_mfma_f32_16x16x32_bf16 v[60:63], v[120:123], v[164:167], v[60:63]
v_mfma_f32_16x16x32_bf16 v[84:87], v[124:127], v[164:167], v[84:87]
ds_read_b64_tr_b16 v[144:145], v236 offset:0
v_mfma_f32_16x16x32_bf16 v[16:19], v[112:115], v[168:171], v[16:19]
ds_read_b64_tr_b16 v[146:147], v236 offset:1536
v_mfma_f32_16x16x32_bf16 v[40:43], v[116:119], v[168:171], v[40:43]
ds_read_b64_tr_b16 v[148:149], v237 offset:0
v_mfma_f32_16x16x32_bf16 v[64:67], v[120:123], v[168:171], v[64:67]
ds_read_b64_tr_b16 v[150:151], v237 offset:1536
v_mfma_f32_16x16x32_bf16 v[88:91], v[124:127], v[168:171], v[88:91]
v_mfma_f32_16x16x32_bf16 v[20:23], v[112:115], v[172:175], v[20:23]
v_mfma_f32_16x16x32_bf16 v[44:47], v[116:119], v[172:175], v[44:47]
v_mfma_f32_16x16x32_bf16 v[68:71], v[120:123], v[172:175], v[68:71]
v_mfma_f32_16x16x32_bf16 v[92:95], v[124:127], v[172:175], v[92:95]
s_waitcnt lgkmcnt(0)
v_mfma_f32_16x16x32_bf16 v[0:3], v[96:99], v[128:131], v[0:3]
ds_read_b128 v[112:115], v225 offset:0
v_mfma_f32_16x16x32_bf16 v[24:27], v[100:103], v[128:131], v[24:27]
ds_read_b128 v[116:119], v225 offset:2048
v_mfma_f32_16x16x32_bf16 v[48:51], v[104:107], v[128:131], v[48:51]
ds_read_b128 v[120:123], v225 offset:4096
v_mfma_f32_16x16x32_bf16 v[72:75], v[108:111], v[128:131], v[72:75]
ds_read_b128 v[124:127], v225 offset:6144
v_mfma_f32_16x16x32_bf16 v[4:7], v[96:99], v[132:135], v[4:7]
v_mfma_f32_16x16x32_bf16 v[28:31], v[100:103], v[132:135], v[28:31]
ds_read_b64_tr_b16 v[152:153], v232 offset:12288
v_mfma_f32_16x16x32_bf16 v[52:55], v[104:107], v[132:135], v[52:55]
ds_read_b64_tr_b16 v[154:155], v232 offset:13824
v_mfma_f32_16x16x32_bf16 v[76:79], v[108:111], v[132:135], v[76:79]
ds_read_b64_tr_b16 v[156:157], v233 offset:12288
v_mfma_f32_16x16x32_bf16 v[8:11], v[96:99], v[136:139], v[8:11]
ds_read_b64_tr_b16 v[158:159], v233 offset:13824
v_mfma_f32_16x16x32_bf16 v[32:35], v[100:103], v[136:139], v[32:35]
v_mfma_f32_16x16x32_bf16 v[56:59], v[104:107], v[136:139], v[56:59]
ds_read_b64_tr_b16 v[160:161], v234 offset:12288
v_mfma_f32_16x16x32_bf16 v[80:83], v[108:111], v[136:139], v[80:83]
ds_read_b64_tr_b16 v[162:163], v234 offset:13824
v_mfma_f32_16x16x32_bf16 v[12:15], v[96:99], v[140:143], v[12:15]
ds_read_b64_tr_b16 v[164:165], v235 offset:12288
v_mfma_f32_16x16x32_bf16 v[36:39], v[100:103], v[140:143], v[36:39]
ds_read_b64_tr_b16 v[166:167], v235 offset:13824
v_mfma_f32_16x16x32_bf16 v[60:63], v[104:107], v[140:143], v[60:63]
v_mfma_f32_16x16x32_bf16 v[84:87], v[108:111], v[140:143], v[84:87]
ds_read_b64_tr_b16 v[168:169], v236 offset:12288
v_mfma_f32_16x16x32_bf16 v[16:19], v[96:99], v[144:147], v[16:19]
ds_read_b64_tr_b16 v[170:171], v236 offset:13824
v_mfma_f32_16x16x32_bf16 v[40:43], v[100:103], v[144:147], v[40:43]
ds_read_b64_tr_b16 v[172:173], v237 offset:12288
v_mfma_f32_16x16x32_bf16 v[64:67], v[104:107], v[144:147], v[64:67]
ds_read_b64_tr_b16 v[174:175], v237 offset:13824
v_mfma_f32_16x16x32_bf16 v[88:91], v[108:111], v[144:147], v[88:91]
v_mfma_f32_16x16x32_bf16 v[20:23], v[96:99], v[148:151], v[20:23]
v_mfma_f32_16x16x32_bf16 v[44:47], v[100:103], v[148:151], v[44:47]
v_mfma_f32_16x16x32_bf16 v[68:71], v[104:107], v[148:151], v[68:71]
v_mfma_f32_16x16x32_bf16 v[92:95], v[108:111], v[148:151], v[92:95]
s_waitcnt lgkmcnt(0)
s_barrier
v_mfma_f32_16x16x32_bf16 v[0:3], v[112:115], v[152:155], v[0:3]
ds_read_b128 v[96:99], v224 offset:16384
v_mfma_f32_16x16x32_bf16 v[24:27], v[116:119], v[152:155], v[24:27]
ds_read_b128 v[100:103], v224 offset:18432
v_mfma_f32_16x16x32_bf16 v[48:51], v[120:123], v[152:155], v[48:51]
ds_read_b128 v[104:107], v224 offset:20480
v_mfma_f32_16x16x32_bf16 v[72:75], v[124:127], v[152:155], v[72:75]
ds_read_b128 v[108:111], v224 offset:22528
v_mfma_f32_16x16x32_bf16 v[4:7], v[112:115], v[156:159], v[4:7]
v_mfma_f32_16x16x32_bf16 v[28:31], v[116:119], v[156:159], v[28:31]
ds_read_b64_tr_b16 v[128:129], v232 offset:24576
v_mfma_f32_16x16x32_bf16 v[52:55], v[120:123], v[156:159], v[52:55]
ds_read_b64_tr_b16 v[130:131], v232 offset:26112
v_mfma_f32_16x16x32_bf16 v[76:79], v[124:127], v[156:159], v[76:79]
ds_read_b64_tr_b16 v[132:133], v233 offset:24576
v_mfma_f32_16x16x32_bf16 v[8:11], v[112:115], v[160:163], v[8:11]
ds_read_b64_tr_b16 v[134:135], v233 offset:26112
v_mfma_f32_16x16x32_bf16 v[32:35], v[116:119], v[160:163], v[32:35]
v_mfma_f32_16x16x32_bf16 v[56:59], v[120:123], v[160:163], v[56:59]
ds_read_b64_tr_b16 v[136:137], v234 offset:24576
v_mfma_f32_16x16x32_bf16 v[80:83], v[124:127], v[160:163], v[80:83]
ds_read_b64_tr_b16 v[138:139], v234 offset:26112
v_mfma_f32_16x16x32_bf16 v[12:15], v[112:115], v[164:167], v[12:15]
ds_read_b64_tr_b16 v[140:141], v235 offset:24576
v_mfma_f32_16x16x32_bf16 v[36:39], v[116:119], v[164:167], v[36:39]
ds_read_b64_tr_b16 v[142:143], v235 offset:26112
v_mfma_f32_16x16x32_bf16 v[60:63], v[120:123], v[164:167], v[60:63]
v_mfma_f32_16x16x32_bf16 v[84:87], v[124:127], v[164:167], v[84:87]
ds_read_b64_tr_b16 v[144:145], v236 offset:24576
v_mfma_f32_16x16x32_bf16 v[16:19], v[112:115], v[168:171], v[16:19]
ds_read_b64_tr_b16 v[146:147], v236 offset:26112
v_mfma_f32_16x16x32_bf16 v[40:43], v[116:119], v[168:171], v[40:43]
ds_read_b64_tr_b16 v[148:149], v237 offset:24576
v_mfma_f32_16x16x32_bf16 v[64:67], v[120:123], v[168:171], v[64:67]
ds_read_b64_tr_b16 v[150:151], v237 offset:26112
v_mfma_f32_16x16x32_bf16 v[88:91], v[124:127], v[168:171], v[88:91]
v_mfma_f32_16x16x32_bf16 v[20:23], v[112:115], v[172:175], v[20:23]
v_mfma_f32_16x16x32_bf16 v[44:47], v[116:119], v[172:175], v[44:47]
v_mfma_f32_16x16x32_bf16 v[68:71], v[120:123], v[172:175], v[68:71]
v_mfma_f32_16x16x32_bf16 v[92:95], v[124:127], v[172:175], v[92:95]
s_waitcnt lgkmcnt(0)
v_mfma_f32_16x16x32_bf16 v[0:3], v[96:99], v[128:131], v[0:3]
ds_read_b128 v[112:115], v225 offset:16384
v_mfma_f32_16x16x32_bf16 v[24:27], v[100:103], v[128:131], v[24:27]
ds_read_b128 v[116:119], v225 offset:18432
v_mfma_f32_16x16x32_bf16 v[48:51], v[104:107], v[128:131], v[48:51]
ds_read_b128 v[120:123], v225 offset:20480
v_mfma_f32_16x16x32_bf16 v[72:75], v[108:111], v[128:131], v[72:75]
ds_read_b128 v[124:127], v225 offset:22528
v_mfma_f32_16x16x32_bf16 v[4:7], v[96:99], v[132:135], v[4:7]
v_mfma_f32_16x16x32_bf16 v[28:31], v[100:103], v[132:135], v[28:31]
ds_read_b64_tr_b16 v[152:153], v232 offset:36864
v_mfma_f32_16x16x32_bf16 v[52:55], v[104:107], v[132:135], v[52:55]
ds_read_b64_tr_b16 v[154:155], v232 offset:38400
v_mfma_f32_16x16x32_bf16 v[76:79], v[108:111], v[132:135], v[76:79]
ds_read_b64_tr_b16 v[156:157], v233 offset:36864
v_mfma_f32_16x16x32_bf16 v[8:11], v[96:99], v[136:139], v[8:11]
ds_read_b64_tr_b16 v[158:159], v233 offset:38400
v_mfma_f32_16x16x32_bf16 v[32:35], v[100:103], v[136:139], v[32:35]
v_mfma_f32_16x16x32_bf16 v[56:59], v[104:107], v[136:139], v[56:59]
ds_read_b64_tr_b16 v[160:161], v234 offset:36864
v_mfma_f32_16x16x32_bf16 v[80:83], v[108:111], v[136:139], v[80:83]
ds_read_b64_tr_b16 v[162:163], v234 offset:38400
v_mfma_f32_16x16x32_bf16 v[12:15], v[96:99], v[140:143], v[12:15]
ds_read_b64_tr_b16 v[164:165], v235 offset:36864
v_mfma_f32_16x16x32_bf16 v[36:39], v[100:103], v[140:143], v[36:39]
ds_read_b64_tr_b16 v[166:167], v235 offset:38400
v_mfma_f32_16x16x32_bf16 v[60:63], v[104:107], v[140:143], v[60:63]
v_mfma_f32_16x16x32_bf16 v[84:87], v[108:111], v[140:143], v[84:87]
ds_read_b64_tr_b16 v[168:169], v236 offset:36864
v_mfma_f32_16x16x32_bf16 v[16:19], v[96:99], v[144:147], v[16:19]
ds_read_b64_tr_b16 v[170:171], v236 offset:38400
v_mfma_f32_16x16x32_bf16 v[40:43], v[100:103], v[144:147], v[40:43]
ds_read_b64_tr_b16 v[172:173], v237 offset:36864
v_mfma_f32_16x16x32_bf16 v[64:67], v[104:107], v[144:147], v[64:67]
ds_read_b64_tr_b16 v[174:175], v237 offset:38400
v_mfma_f32_16x16x32_bf16 v[88:91], v[108:111], v[144:147], v[88:91]
v_mfma_f32_16x16x32_bf16 v[20:23], v[96:99], v[148:151], v[20:23]
v_mfma_f32_16x16x32_bf16 v[44:47], v[100:103], v[148:151], v[44:47]
v_mfma_f32_16x16x32_bf16 v[68:71], v[104:107], v[148:151], v[68:71]
v_mfma_f32_16x16x32_bf16 v[92:95], v[108:111], v[148:151], v[92:95]
s_waitcnt lgkmcnt(0)
s_barrier
v_mfma_f32_16x16x32_bf16 v[0:3], v[112:115], v[152:155], v[0:3]
ds_read_b128 v[96:99], v224 offset:32768
v_mfma_f32_16x16x32_bf16 v[24:27], v[116:119], v[152:155], v[24:27]
ds_read_b128 v[100:103], v224 offset:34816
v_mfma_f32_16x16x32_bf16 v[48:51], v[120:123], v[152:155], v[48:51]
ds_read_b128 v[104:107], v224 offset:36864
v_mfma_f32_16x16x32_bf16 v[72:75], v[124:127], v[152:155], v[72:75]
ds_read_b128 v[108:111], v224 offset:38912
v_mfma_f32_16x16x32_bf16 v[4:7], v[112:115], v[156:159], v[4:7]
v_mfma_f32_16x16x32_bf16 v[28:31], v[116:119], v[156:159], v[28:31]
ds_read_b64_tr_b16 v[128:129], v226 offset:0
v_mfma_f32_16x16x32_bf16 v[52:55], v[120:123], v[156:159], v[52:55]
ds_read_b64_tr_b16 v[130:131], v226 offset:1536
v_mfma_f32_16x16x32_bf16 v[76:79], v[124:127], v[156:159], v[76:79]
ds_read_b64_tr_b16 v[132:133], v227 offset:0
v_mfma_f32_16x16x32_bf16 v[8:11], v[112:115], v[160:163], v[8:11]
ds_read_b64_tr_b16 v[134:135], v227 offset:1536
v_mfma_f32_16x16x32_bf16 v[32:35], v[116:119], v[160:163], v[32:35]
v_mfma_f32_16x16x32_bf16 v[56:59], v[120:123], v[160:163], v[56:59]
ds_read_b64_tr_b16 v[136:137], v228 offset:0
v_mfma_f32_16x16x32_bf16 v[80:83], v[124:127], v[160:163], v[80:83]
ds_read_b64_tr_b16 v[138:139], v228 offset:1536
v_mfma_f32_16x16x32_bf16 v[12:15], v[112:115], v[164:167], v[12:15]
ds_read_b64_tr_b16 v[140:141], v229 offset:0
v_mfma_f32_16x16x32_bf16 v[36:39], v[116:119], v[164:167], v[36:39]
ds_read_b64_tr_b16 v[142:143], v229 offset:1536
v_mfma_f32_16x16x32_bf16 v[60:63], v[120:123], v[164:167], v[60:63]
v_mfma_f32_16x16x32_bf16 v[84:87], v[124:127], v[164:167], v[84:87]
ds_read_b64_tr_b16 v[144:145], v230 offset:0
v_mfma_f32_16x16x32_bf16 v[16:19], v[112:115], v[168:171], v[16:19]
ds_read_b64_tr_b16 v[146:147], v230 offset:1536
v_mfma_f32_16x16x32_bf16 v[40:43], v[116:119], v[168:171], v[40:43]
ds_read_b64_tr_b16 v[148:149], v231 offset:0
v_mfma_f32_16x16x32_bf16 v[64:67], v[120:123], v[168:171], v[64:67]
ds_read_b64_tr_b16 v[150:151], v231 offset:1536
v_mfma_f32_16x16x32_bf16 v[88:91], v[124:127], v[168:171], v[88:91]
v_mfma_f32_16x16x32_bf16 v[20:23], v[112:115], v[172:175], v[20:23]
v_mfma_f32_16x16x32_bf16 v[44:47], v[116:119], v[172:175], v[44:47]
v_mfma_f32_16x16x32_bf16 v[68:71], v[120:123], v[172:175], v[68:71]
v_mfma_f32_16x16x32_bf16 v[92:95], v[124:127], v[172:175], v[92:95]
s_waitcnt lgkmcnt(0)
v_mfma_f32_16x16x32_bf16 v[0:3], v[96:99], v[128:131], v[0:3]
ds_read_b128 v[112:115], v225 offset:32768
v_mfma_f32_16x16x32_bf16 v[24:27], v[100:103], v[128:131], v[24:27]
ds_read_b128 v[116:119], v225 offset:34816
v_mfma_f32_16x16x32_bf16 v[48:51], v[104:107], v[128:131], v[48:51]
ds_read_b128 v[120:123], v225 offset:36864
v_mfma_f32_16x16x32_bf16 v[72:75], v[108:111], v[128:131], v[72:75]
ds_read_b128 v[124:127], v225 offset:38912
v_mfma_f32_16x16x32_bf16 v[4:7], v[96:99], v[132:135], v[4:7]
v_mfma_f32_16x16x32_bf16 v[28:31], v[100:103], v[132:135], v[28:31]
ds_read_b64_tr_b16 v[152:153], v226 offset:12288
v_mfma_f32_16x16x32_bf16 v[52:55], v[104:107], v[132:135], v[52:55]
ds_read_b64_tr_b16 v[154:155], v226 offset:13824
v_mfma_f32_16x16x32_bf16 v[76:79], v[108:111], v[132:135], v[76:79]
ds_read_b64_tr_b16 v[156:157], v227 offset:12288
v_mfma_f32_16x16x32_bf16 v[8:11], v[96:99], v[136:139], v[8:11]
ds_read_b64_tr_b16 v[158:159], v227 offset:13824
v_mfma_f32_16x16x32_bf16 v[32:35], v[100:103], v[136:139], v[32:35]
v_mfma_f32_16x16x32_bf16 v[56:59], v[104:107], v[136:139], v[56:59]
ds_read_b64_tr_b16 v[160:161], v228 offset:12288
v_mfma_f32_16x16x32_bf16 v[80:83], v[108:111], v[136:139], v[80:83]
ds_read_b64_tr_b16 v[162:163], v228 offset:13824
v_mfma_f32_16x16x32_bf16 v[12:15], v[96:99], v[140:143], v[12:15]
ds_read_b64_tr_b16 v[164:165], v229 offset:12288
v_mfma_f32_16x16x32_bf16 v[36:39], v[100:103], v[140:143], v[36:39]
ds_read_b64_tr_b16 v[166:167], v229 offset:13824
v_mfma_f32_16x16x32_bf16 v[60:63], v[104:107], v[140:143], v[60:63]
v_mfma_f32_16x16x32_bf16 v[84:87], v[108:111], v[140:143], v[84:87]
ds_read_b64_tr_b16 v[168:169], v230 offset:12288
v_mfma_f32_16x16x32_bf16 v[16:19], v[96:99], v[144:147], v[16:19]
ds_read_b64_tr_b16 v[170:171], v230 offset:13824
v_mfma_f32_16x16x32_bf16 v[40:43], v[100:103], v[144:147], v[40:43]
ds_read_b64_tr_b16 v[172:173], v231 offset:12288
v_mfma_f32_16x16x32_bf16 v[64:67], v[104:107], v[144:147], v[64:67]
ds_read_b64_tr_b16 v[174:175], v231 offset:13824
v_mfma_f32_16x16x32_bf16 v[88:91], v[108:111], v[144:147], v[88:91]
v_mfma_f32_16x16x32_bf16 v[20:23], v[96:99], v[148:151], v[20:23]
v_mfma_f32_16x16x32_bf16 v[44:47], v[100:103], v[148:151], v[44:47]
v_mfma_f32_16x16x32_bf16 v[68:71], v[104:107], v[148:151], v[68:71]
v_mfma_f32_16x16x32_bf16 v[92:95], v[108:111], v[148:151], v[92:95]
s_waitcnt lgkmcnt(0)
s_barrier
v_mfma_f32_16x16x32_bf16 v[0:3], v[112:115], v[152:155], v[0:3]
ds_read_b128 v[96:99], v239 offset:0
v_mfma_f32_16x16x32_bf16 v[24:27], v[116:119], v[152:155], v[24:27]
ds_read_b128 v[128:131], v239 offset:512
v_mfma_f32_16x16x32_bf16 v[48:51], v[120:123], v[152:155], v[48:51]
ds_read_b128 v[100:103], v239 offset:16
v_mfma_f32_16x16x32_bf16 v[72:75], v[124:127], v[152:155], v[72:75]
ds_read_b128 v[132:135], v239 offset:528
v_mfma_f32_16x16x32_bf16 v[4:7], v[112:115], v[156:159], v[4:7]
v_mfma_f32_16x16x32_bf16 v[28:31], v[116:119], v[156:159], v[28:31]
ds_read_b128 v[104:107], v239 offset:128
v_mfma_f32_16x16x32_bf16 v[52:55], v[120:123], v[156:159], v[52:55]
ds_read_b128 v[136:139], v239 offset:640
v_mfma_f32_16x16x32_bf16 v[76:79], v[124:127], v[156:159], v[76:79]
ds_read_b128 v[108:111], v239 offset:144
v_mfma_f32_16x16x32_bf16 v[8:11], v[112:115], v[160:163], v[8:11]
ds_read_b128 v[140:143], v239 offset:656
v_mfma_f32_16x16x32_bf16 v[32:35], v[116:119], v[160:163], v[32:35]
v_mfma_f32_16x16x32_bf16 v[56:59], v[120:123], v[160:163], v[56:59]
ds_read_b32 v248, v240 offset:0
v_mfma_f32_16x16x32_bf16 v[80:83], v[124:127], v[160:163], v[80:83]
ds_read_b32 v249, v240 offset:64
v_mfma_f32_16x16x32_bf16 v[12:15], v[112:115], v[164:167], v[12:15]
ds_read_b32 v250, v240 offset:128
v_mfma_f32_16x16x32_bf16 v[36:39], v[116:119], v[164:167], v[36:39]
ds_read_b32 v251, v240 offset:192
v_mfma_f32_16x16x32_bf16 v[60:63], v[120:123], v[164:167], v[60:63]
v_mfma_f32_16x16x32_bf16 v[84:87], v[124:127], v[164:167], v[84:87]
ds_read_b32 v252, v240 offset:256
v_mfma_f32_16x16x32_bf16 v[16:19], v[112:115], v[168:171], v[16:19]
ds_read_b32 v253, v240 offset:320
v_mfma_f32_16x16x32_bf16 v[40:43], v[116:119], v[168:171], v[40:43]
ds_read_b32 v193, v241 offset:4
v_mfma_f32_16x16x32_bf16 v[64:67], v[120:123], v[168:171], v[64:67]
v_mfma_f32_16x16x32_bf16 v[88:91], v[124:127], v[168:171], v[88:91]
v_mfma_f32_16x16x32_bf16 v[20:23], v[112:115], v[172:175], v[20:23]
v_mfma_f32_16x16x32_bf16 v[44:47], v[116:119], v[172:175], v[44:47]
v_mfma_f32_16x16x32_bf16 v[68:71], v[120:123], v[172:175], v[68:71]
v_mfma_f32_16x16x32_bf16 v[92:95], v[124:127], v[172:175], v[92:95]
s_waitcnt lgkmcnt(0)
s_nop 7
v_pk_mul_f32 v[0:1], v[0:1], v[96:97]
v_pk_mul_f32 v[2:3], v[2:3], v[98:99]
v_pk_mul_f32 v[24:25], v[24:25], v[100:101]
v_pk_mul_f32 v[26:27], v[26:27], v[102:103]
v_pk_mul_f32 v[48:49], v[48:49], v[104:105]
v_pk_mul_f32 v[50:51], v[50:51], v[106:107]
v_pk_mul_f32 v[72:73], v[72:73], v[108:109]
v_pk_mul_f32 v[74:75], v[74:75], v[110:111]
v_pk_fma_f32 v[0:1], v[128:129], v[248:249], v[0:1] op_sel:[0,0,0] op_sel_hi:[1,0,1]
v_pk_fma_f32 v[2:3], v[130:131], v[248:249], v[2:3] op_sel:[0,0,0] op_sel_hi:[1,0,1]
v_pk_fma_f32 v[24:25], v[132:133], v[248:249], v[24:25] op_sel:[0,0,0] op_sel_hi:[1,0,1]
v_pk_fma_f32 v[26:27], v[134:135], v[248:249], v[26:27] op_sel:[0,0,0] op_sel_hi:[1,0,1]
v_pk_fma_f32 v[48:49], v[136:137], v[248:249], v[48:49] op_sel:[0,0,0] op_sel_hi:[1,0,1]
v_pk_fma_f32 v[50:51], v[138:139], v[248:249], v[50:51] op_sel:[0,0,0] op_sel_hi:[1,0,1]
v_pk_fma_f32 v[72:73], v[140:141], v[248:249], v[72:73] op_sel:[0,0,0] op_sel_hi:[1,0,1]
v_pk_fma_f32 v[74:75], v[142:143], v[248:249], v[74:75] op_sel:[0,0,0] op_sel_hi:[1,0,1]
v_pk_fma_f32 v[160:161], v[0:1], v[0:1], v[244:245] op_sel_hi:[1,1,0]
v_pk_fma_f32 v[162:163], v[2:3], v[2:3], v[244:245] op_sel_hi:[1,1,0]
v_pk_fma_f32 v[164:165], v[24:25], v[24:25], v[244:245] op_sel_hi:[1,1,0]
v_pk_fma_f32 v[166:167], v[26:27], v[26:27], v[244:245] op_sel_hi:[1,1,0]
v_pk_fma_f32 v[168:169], v[48:49], v[48:49], v[244:245] op_sel_hi:[1,1,0]
v_pk_fma_f32 v[170:171], v[50:51], v[50:51], v[244:245] op_sel_hi:[1,1,0]
v_pk_fma_f32 v[172:173], v[72:73], v[72:73], v[244:245] op_sel_hi:[1,1,0]
v_pk_fma_f32 v[174:175], v[74:75], v[74:75], v[244:245] op_sel_hi:[1,1,0]
v_pk_mul_f32 v[160:161], v[160:161], v[0:1]
v_pk_mul_f32 v[162:163], v[162:163], v[2:3]
v_pk_mul_f32 v[164:165], v[164:165], v[24:25]
v_pk_mul_f32 v[166:167], v[166:167], v[26:27]
v_pk_mul_f32 v[168:169], v[168:169], v[48:49]
v_pk_mul_f32 v[170:171], v[170:171], v[50:51]
v_pk_mul_f32 v[172:173], v[172:173], v[72:73]
v_pk_mul_f32 v[174:175], v[174:175], v[74:75]
v_exp_f32_e64 v160, -v160
v_exp_f32_e64 v161, -v161
v_exp_f32_e64 v162, -v162
v_exp_f32_e64 v163, -v163
v_exp_f32_e64 v164, -v164
v_exp_f32_e64 v165, -v165
v_exp_f32_e64 v166, -v166
v_exp_f32_e64 v167, -v167
v_exp_f32_e64 v168, -v168
v_exp_f32_e64 v169, -v169
v_exp_f32_e64 v170, -v170
v_exp_f32_e64 v171, -v171
v_exp_f32_e64 v172, -v172
v_exp_f32_e64 v173, -v173
v_exp_f32_e64 v174, -v174
v_exp_f32_e64 v175, -v175
v_pk_add_f32 v[160:161], v[160:161], v[246:247] op_sel_hi:[1,0]
v_pk_add_f32 v[162:163], v[162:163], v[246:247] op_sel_hi:[1,0]
v_pk_add_f32 v[164:165], v[164:165], v[246:247] op_sel_hi:[1,0]
v_pk_add_f32 v[166:167], v[166:167], v[246:247] op_sel_hi:[1,0]
v_pk_add_f32 v[168:169], v[168:169], v[246:247] op_sel_hi:[1,0]
v_pk_add_f32 v[170:171], v[170:171], v[246:247] op_sel_hi:[1,0]
v_pk_add_f32 v[172:173], v[172:173], v[246:247] op_sel_hi:[1,0]
v_pk_add_f32 v[174:175], v[174:175], v[246:247] op_sel_hi:[1,0]
v_rcp_f32 v160, v160
v_rcp_f32 v161, v161
v_rcp_f32 v162, v162
v_rcp_f32 v163, v163
v_rcp_f32 v164, v164
v_rcp_f32 v165, v165
v_rcp_f32 v166, v166
v_rcp_f32 v167, v167
v_rcp_f32 v168, v168
v_rcp_f32 v169, v169
v_rcp_f32 v170, v170
v_rcp_f32 v171, v171
v_rcp_f32 v172, v172
v_rcp_f32 v173, v173
v_rcp_f32 v174, v174
v_rcp_f32 v175, v175
v_pk_mul_f32 v[0:1], v[160:161], v[0:1]
v_pk_mul_f32 v[2:3], v[162:163], v[2:3]
v_pk_mul_f32 v[24:25], v[164:165], v[24:25]
v_pk_mul_f32 v[26:27], v[166:167], v[26:27]
v_pk_mul_f32 v[48:49], v[168:169], v[48:49]
v_pk_mul_f32 v[50:51], v[170:171], v[50:51]
v_pk_mul_f32 v[72:73], v[172:173], v[72:73]
v_pk_mul_f32 v[74:75], v[174:175], v[74:75]
v_pk_mul_f32 v[144:145], v[0:1], v[0:1]
v_pk_mul_f32 v[146:147], v[2:3], v[2:3]
v_pk_mul_f32 v[148:149], v[24:25], v[24:25]
v_pk_mul_f32 v[150:151], v[26:27], v[26:27]
v_pk_mul_f32 v[152:153], v[48:49], v[48:49]
v_pk_mul_f32 v[154:155], v[50:51], v[50:51]
v_pk_mul_f32 v[156:157], v[72:73], v[72:73]
v_pk_mul_f32 v[158:159], v[74:75], v[74:75]
v_pk_mul_f32 v[4:5], v[4:5], v[96:97]
v_pk_mul_f32 v[6:7], v[6:7], v[98:99]
v_pk_mul_f32 v[28:29], v[28:29], v[100:101]
v_pk_mul_f32 v[30:31], v[30:31], v[102:103]
v_pk_mul_f32 v[52:53], v[52:53], v[104:105]
v_pk_mul_f32 v[54:55], v[54:55], v[106:107]
v_pk_mul_f32 v[76:77], v[76:77], v[108:109]
v_pk_mul_f32 v[78:79], v[78:79], v[110:111]
v_pk_fma_f32 v[4:5], v[128:129], v[248:249], v[4:5] op_sel:[0,1,0] op_sel_hi:[1,1,1]
v_pk_fma_f32 v[6:7], v[130:131], v[248:249], v[6:7] op_sel:[0,1,0] op_sel_hi:[1,1,1]
v_pk_fma_f32 v[28:29], v[132:133], v[248:249], v[28:29] op_sel:[0,1,0] op_sel_hi:[1,1,1]
v_pk_fma_f32 v[30:31], v[134:135], v[248:249], v[30:31] op_sel:[0,1,0] op_sel_hi:[1,1,1]
v_pk_fma_f32 v[52:53], v[136:137], v[248:249], v[52:53] op_sel:[0,1,0] op_sel_hi:[1,1,1]
v_pk_fma_f32 v[54:55], v[138:139], v[248:249], v[54:55] op_sel:[0,1,0] op_sel_hi:[1,1,1]
v_pk_fma_f32 v[76:77], v[140:141], v[248:249], v[76:77] op_sel:[0,1,0] op_sel_hi:[1,1,1]
v_pk_fma_f32 v[78:79], v[142:143], v[248:249], v[78:79] op_sel:[0,1,0] op_sel_hi:[1,1,1]
v_pk_fma_f32 v[160:161], v[4:5], v[4:5], v[244:245] op_sel_hi:[1,1,0]
v_pk_fma_f32 v[162:163], v[6:7], v[6:7], v[244:245] op_sel_hi:[1,1,0]
v_pk_fma_f32 v[164:165], v[28:29], v[28:29], v[244:245] op_sel_hi:[1,1,0]
v_pk_fma_f32 v[166:167], v[30:31], v[30:31], v[244:245] op_sel_hi:[1,1,0]
v_pk_fma_f32 v[168:169], v[52:53], v[52:53], v[244:245] op_sel_hi:[1,1,0]
v_pk_fma_f32 v[170:171], v[54:55], v[54:55], v[244:245] op_sel_hi:[1,1,0]
v_pk_fma_f32 v[172:173], v[76:77], v[76:77], v[244:245] op_sel_hi:[1,1,0]
v_pk_fma_f32 v[174:175], v[78:79], v[78:79], v[244:245] op_sel_hi:[1,1,0]
v_pk_mul_f32 v[160:161], v[160:161], v[4:5]
v_pk_mul_f32 v[162:163], v[162:163], v[6:7]
v_pk_mul_f32 v[164:165], v[164:165], v[28:29]
v_pk_mul_f32 v[166:167], v[166:167], v[30:31]
v_pk_mul_f32 v[168:169], v[168:169], v[52:53]
v_pk_mul_f32 v[170:171], v[170:171], v[54:55]
v_pk_mul_f32 v[172:173], v[172:173], v[76:77]
v_pk_mul_f32 v[174:175], v[174:175], v[78:79]
v_exp_f32_e64 v160, -v160
v_exp_f32_e64 v161, -v161
v_exp_f32_e64 v162, -v162
v_exp_f32_e64 v163, -v163
v_exp_f32_e64 v164, -v164
v_exp_f32_e64 v165, -v165
v_exp_f32_e64 v166, -v166
v_exp_f32_e64 v167, -v167
v_exp_f32_e64 v168, -v168
v_exp_f32_e64 v169, -v169
v_exp_f32_e64 v170, -v170
v_exp_f32_e64 v171, -v171
v_exp_f32_e64 v172, -v172
v_exp_f32_e64 v173, -v173
v_exp_f32_e64 v174, -v174
v_exp_f32_e64 v175, -v175
v_pk_add_f32 v[160:161], v[160:161], v[246:247] op_sel_hi:[1,0]
v_pk_add_f32 v[162:163], v[162:163], v[246:247] op_sel_hi:[1,0]
v_pk_add_f32 v[164:165], v[164:165], v[246:247] op_sel_hi:[1,0]
v_pk_add_f32 v[166:167], v[166:167], v[246:247] op_sel_hi:[1,0]
v_pk_add_f32 v[168:169], v[168:169], v[246:247] op_sel_hi:[1,0]
v_pk_add_f32 v[170:171], v[170:171], v[246:247] op_sel_hi:[1,0]
v_pk_add_f32 v[172:173], v[172:173], v[246:247] op_sel_hi:[1,0]
v_pk_add_f32 v[174:175], v[174:175], v[246:247] op_sel_hi:[1,0]
v_rcp_f32 v160, v160
v_rcp_f32 v161, v161
v_rcp_f32 v162, v162
v_rcp_f32 v163, v163
v_rcp_f32 v164, v164
v_rcp_f32 v165, v165
v_rcp_f32 v166, v166
v_rcp_f32 v167, v167
v_rcp_f32 v168, v168
v_rcp_f32 v169, v169
v_rcp_f32 v170, v170
v_rcp_f32 v171, v171
v_rcp_f32 v172, v172
v_rcp_f32 v173, v173
v_rcp_f32 v174, v174
v_rcp_f32 v175, v175
v_pk_mul_f32 v[4:5], v[160:161], v[4:5]
v_pk_mul_f32 v[6:7], v[162:163], v[6:7]
v_pk_mul_f32 v[28:29], v[164:165], v[28:29]
v_pk_mul_f32 v[30:31], v[166:167], v[30:31]
v_pk_mul_f32 v[52:53], v[168:169], v[52:53]
v_pk_mul_f32 v[54:55], v[170:171], v[54:55]
v_pk_mul_f32 v[76:77], v[172:173], v[76:77]
v_pk_mul_f32 v[78:79], v[174:175], v[78:79]
v_pk_fma_f32 v[144:145], v[4:5], v[4:5], v[144:145]
v_pk_fma_f32 v[146:147], v[6:7], v[6:7], v[146:147]
v_pk_fma_f32 v[148:149], v[28:29], v[28:29], v[148:149]
v_pk_fma_f32 v[150:151], v[30:31], v[30:31], v[150:151]
v_pk_fma_f32 v[152:153], v[52:53], v[52:53], v[152:153]
v_pk_fma_f32 v[154:155], v[54:55], v[54:55], v[154:155]
v_pk_fma_f32 v[156:157], v[76:77], v[76:77], v[156:157]
v_pk_fma_f32 v[158:159], v[78:79], v[78:79], v[158:159]
v_pk_add_f32 v[112:113], v[4:5], v[0:1]
v_pk_add_f32 v[114:115], v[6:7], v[2:3]
v_pk_add_f32 v[116:117], v[28:29], v[24:25]
v_pk_add_f32 v[118:119], v[30:31], v[26:27]
v_pk_add_f32 v[120:121], v[52:53], v[48:49]
v_pk_add_f32 v[122:123], v[54:55], v[50:51]
v_pk_add_f32 v[124:125], v[76:77], v[72:73]
v_pk_add_f32 v[126:127], v[78:79], v[74:75]
v_pk_mul_f32 v[8:9], v[8:9], v[96:97]
v_pk_mul_f32 v[10:11], v[10:11], v[98:99]
v_pk_mul_f32 v[32:33], v[32:33], v[100:101]
v_pk_mul_f32 v[34:35], v[34:35], v[102:103]
v_pk_mul_f32 v[56:57], v[56:57], v[104:105]
v_pk_mul_f32 v[58:59], v[58:59], v[106:107]
v_pk_mul_f32 v[80:81], v[80:81], v[108:109]
v_pk_mul_f32 v[82:83], v[82:83], v[110:111]
v_pk_fma_f32 v[8:9], v[128:129], v[250:251], v[8:9] op_sel:[0,0,0] op_sel_hi:[1,0,1]
v_pk_fma_f32 v[10:11], v[130:131], v[250:251], v[10:11] op_sel:[0,0,0] op_sel_hi:[1,0,1]
v_pk_fma_f32 v[32:33], v[132:133], v[250:251], v[32:33] op_sel:[0,0,0] op_sel_hi:[1,0,1]
v_pk_fma_f32 v[34:35], v[134:135], v[250:251], v[34:35] op_sel:[0,0,0] op_sel_hi:[1,0,1]
v_pk_fma_f32 v[56:57], v[136:137], v[250:251], v[56:57] op_sel:[0,0,0] op_sel_hi:[1,0,1]
v_pk_fma_f32 v[58:59], v[138:139], v[250:251], v[58:59] op_sel:[0,0,0] op_sel_hi:[1,0,1]
v_pk_fma_f32 v[80:81], v[140:141], v[250:251], v[80:81] op_sel:[0,0,0] op_sel_hi:[1,0,1]
v_pk_fma_f32 v[82:83], v[142:143], v[250:251], v[82:83] op_sel:[0,0,0] op_sel_hi:[1,0,1]
v_pk_fma_f32 v[160:161], v[8:9], v[8:9], v[244:245] op_sel_hi:[1,1,0]
v_pk_fma_f32 v[162:163], v[10:11], v[10:11], v[244:245] op_sel_hi:[1,1,0]
v_pk_fma_f32 v[164:165], v[32:33], v[32:33], v[244:245] op_sel_hi:[1,1,0]
v_pk_fma_f32 v[166:167], v[34:35], v[34:35], v[244:245] op_sel_hi:[1,1,0]
v_pk_fma_f32 v[168:169], v[56:57], v[56:57], v[244:245] op_sel_hi:[1,1,0]
v_pk_fma_f32 v[170:171], v[58:59], v[58:59], v[244:245] op_sel_hi:[1,1,0]
v_pk_fma_f32 v[172:173], v[80:81], v[80:81], v[244:245] op_sel_hi:[1,1,0]
v_pk_fma_f32 v[174:175], v[82:83], v[82:83], v[244:245] op_sel_hi:[1,1,0]
v_pk_mul_f32 v[160:161], v[160:161], v[8:9]
v_pk_mul_f32 v[162:163], v[162:163], v[10:11]
v_pk_mul_f32 v[164:165], v[164:165], v[32:33]
v_pk_mul_f32 v[166:167], v[166:167], v[34:35]
v_pk_mul_f32 v[168:169], v[168:169], v[56:57]
v_pk_mul_f32 v[170:171], v[170:171], v[58:59]
v_pk_mul_f32 v[172:173], v[172:173], v[80:81]
v_pk_mul_f32 v[174:175], v[174:175], v[82:83]
v_exp_f32_e64 v160, -v160
v_exp_f32_e64 v161, -v161
v_exp_f32_e64 v162, -v162
v_exp_f32_e64 v163, -v163
v_exp_f32_e64 v164, -v164
v_exp_f32_e64 v165, -v165
v_exp_f32_e64 v166, -v166
v_exp_f32_e64 v167, -v167
v_exp_f32_e64 v168, -v168
v_exp_f32_e64 v169, -v169
v_exp_f32_e64 v170, -v170
v_exp_f32_e64 v171, -v171
v_exp_f32_e64 v172, -v172
v_exp_f32_e64 v173, -v173
v_exp_f32_e64 v174, -v174
v_exp_f32_e64 v175, -v175
v_pk_add_f32 v[160:161], v[160:161], v[246:247] op_sel_hi:[1,0]
v_pk_add_f32 v[162:163], v[162:163], v[246:247] op_sel_hi:[1,0]
v_pk_add_f32 v[164:165], v[164:165], v[246:247] op_sel_hi:[1,0]
v_pk_add_f32 v[166:167], v[166:167], v[246:247] op_sel_hi:[1,0]
v_pk_add_f32 v[168:169], v[168:169], v[246:247] op_sel_hi:[1,0]
v_pk_add_f32 v[170:171], v[170:171], v[246:247] op_sel_hi:[1,0]
v_pk_add_f32 v[172:173], v[172:173], v[246:247] op_sel_hi:[1,0]
v_pk_add_f32 v[174:175], v[174:175], v[246:247] op_sel_hi:[1,0]
v_rcp_f32 v160, v160
v_rcp_f32 v161, v161
v_rcp_f32 v162, v162
v_rcp_f32 v163, v163
v_rcp_f32 v164, v164
v_rcp_f32 v165, v165
v_rcp_f32 v166, v166
v_rcp_f32 v167, v167
v_rcp_f32 v168, v168
v_rcp_f32 v169, v169
v_rcp_f32 v170, v170
v_rcp_f32 v171, v171
v_rcp_f32 v172, v172
v_rcp_f32 v173, v173
v_rcp_f32 v174, v174
v_rcp_f32 v175, v175
v_pk_mul_f32 v[8:9], v[160:161], v[8:9]
v_pk_mul_f32 v[10:11], v[162:163], v[10:11]
v_pk_mul_f32 v[32:33], v[164:165], v[32:33]
v_pk_mul_f32 v[34:35], v[166:167], v[34:35]
v_pk_mul_f32 v[56:57], v[168:169], v[56:57]
v_pk_mul_f32 v[58:59], v[170:171], v[58:59]
v_pk_mul_f32 v[80:81], v[172:173], v[80:81]
v_pk_mul_f32 v[82:83], v[174:175], v[82:83]
v_pk_fma_f32 v[144:145], v[8:9], v[8:9], v[144:145]
v_pk_fma_f32 v[146:147], v[10:11], v[10:11], v[146:147]
v_pk_fma_f32 v[148:149], v[32:33], v[32:33], v[148:149]
v_pk_fma_f32 v[150:151], v[34:35], v[34:35], v[150:151]
v_pk_fma_f32 v[152:153], v[56:57], v[56:57], v[152:153]
v_pk_fma_f32 v[154:155], v[58:59], v[58:59], v[154:155]
v_pk_fma_f32 v[156:157], v[80:81], v[80:81], v[156:157]
v_pk_fma_f32 v[158:159], v[82:83], v[82:83], v[158:159]
v_pk_add_f32 v[112:113], v[8:9], v[112:113]
v_pk_add_f32 v[114:115], v[10:11], v[114:115]
v_pk_add_f32 v[116:117], v[32:33], v[116:117]
v_pk_add_f32 v[118:119], v[34:35], v[118:119]
v_pk_add_f32 v[120:121], v[56:57], v[120:121]
v_pk_add_f32 v[122:123], v[58:59], v[122:123]
v_pk_add_f32 v[124:125], v[80:81], v[124:125]
v_pk_add_f32 v[126:127], v[82:83], v[126:127]
v_pk_mul_f32 v[12:13], v[12:13], v[96:97]
v_pk_mul_f32 v[14:15], v[14:15], v[98:99]
v_pk_mul_f32 v[36:37], v[36:37], v[100:101]
v_pk_mul_f32 v[38:39], v[38:39], v[102:103]
v_pk_mul_f32 v[60:61], v[60:61], v[104:105]
v_pk_mul_f32 v[62:63], v[62:63], v[106:107]
v_pk_mul_f32 v[84:85], v[84:85], v[108:109]
v_pk_mul_f32 v[86:87], v[86:87], v[110:111]
v_pk_fma_f32 v[12:13], v[128:129], v[250:251], v[12:13] op_sel:[0,1,0] op_sel_hi:[1,1,1]
v_pk_fma_f32 v[14:15], v[130:131], v[250:251], v[14:15] op_sel:[0,1,0] op_sel_hi:[1,1,1]
v_pk_fma_f32 v[36:37], v[132:133], v[250:251], v[36:37] op_sel:[0,1,0] op_sel_hi:[1,1,1]
v_pk_fma_f32 v[38:39], v[134:135], v[250:251], v[38:39] op_sel:[0,1,0] op_sel_hi:[1,1,1]
v_pk_fma_f32 v[60:61], v[136:137], v[250:251], v[60:61] op_sel:[0,1,0] op_sel_hi:[1,1,1]
v_pk_fma_f32 v[62:63], v[138:139], v[250:251], v[62:63] op_sel:[0,1,0] op_sel_hi:[1,1,1]
v_pk_fma_f32 v[84:85], v[140:141], v[250:251], v[84:85] op_sel:[0,1,0] op_sel_hi:[1,1,1]
v_pk_fma_f32 v[86:87], v[142:143], v[250:251], v[86:87] op_sel:[0,1,0] op_sel_hi:[1,1,1]
v_pk_fma_f32 v[160:161], v[12:13], v[12:13], v[244:245] op_sel_hi:[1,1,0]
v_pk_fma_f32 v[162:163], v[14:15], v[14:15], v[244:245] op_sel_hi:[1,1,0]
v_pk_fma_f32 v[164:165], v[36:37], v[36:37], v[244:245] op_sel_hi:[1,1,0]
v_pk_fma_f32 v[166:167], v[38:39], v[38:39], v[244:245] op_sel_hi:[1,1,0]
v_pk_fma_f32 v[168:169], v[60:61], v[60:61], v[244:245] op_sel_hi:[1,1,0]
v_pk_fma_f32 v[170:171], v[62:63], v[62:63], v[244:245] op_sel_hi:[1,1,0]
v_pk_fma_f32 v[172:173], v[84:85], v[84:85], v[244:245] op_sel_hi:[1,1,0]
v_pk_fma_f32 v[174:175], v[86:87], v[86:87], v[244:245] op_sel_hi:[1,1,0]
v_pk_mul_f32 v[160:161], v[160:161], v[12:13]
v_pk_mul_f32 v[162:163], v[162:163], v[14:15]
v_pk_mul_f32 v[164:165], v[164:165], v[36:37]
v_pk_mul_f32 v[166:167], v[166:167], v[38:39]
v_pk_mul_f32 v[168:169], v[168:169], v[60:61]
v_pk_mul_f32 v[170:171], v[170:171], v[62:63]
v_pk_mul_f32 v[172:173], v[172:173], v[84:85]
v_pk_mul_f32 v[174:175], v[174:175], v[86:87]
v_exp_f32_e64 v160, -v160
v_exp_f32_e64 v161, -v161
v_exp_f32_e64 v162, -v162
v_exp_f32_e64 v163, -v163
v_exp_f32_e64 v164, -v164
v_exp_f32_e64 v165, -v165
v_exp_f32_e64 v166, -v166
v_exp_f32_e64 v167, -v167
v_exp_f32_e64 v168, -v168
v_exp_f32_e64 v169, -v169
v_exp_f32_e64 v170, -v170
v_exp_f32_e64 v171, -v171
v_exp_f32_e64 v172, -v172
v_exp_f32_e64 v173, -v173
v_exp_f32_e64 v174, -v174
v_exp_f32_e64 v175, -v175
v_pk_add_f32 v[160:161], v[160:161], v[246:247] op_sel_hi:[1,0]
v_pk_add_f32 v[162:163], v[162:163], v[246:247] op_sel_hi:[1,0]
v_pk_add_f32 v[164:165], v[164:165], v[246:247] op_sel_hi:[1,0]
v_pk_add_f32 v[166:167], v[166:167], v[246:247] op_sel_hi:[1,0]
v_pk_add_f32 v[168:169], v[168:169], v[246:247] op_sel_hi:[1,0]
v_pk_add_f32 v[170:171], v[170:171], v[246:247] op_sel_hi:[1,0]
v_pk_add_f32 v[172:173], v[172:173], v[246:247] op_sel_hi:[1,0]
v_pk_add_f32 v[174:175], v[174:175], v[246:247] op_sel_hi:[1,0]
v_rcp_f32 v160, v160
v_rcp_f32 v161, v161
v_rcp_f32 v162, v162
v_rcp_f32 v163, v163
v_rcp_f32 v164, v164
v_rcp_f32 v165, v165
v_rcp_f32 v166, v166
v_rcp_f32 v167, v167
v_rcp_f32 v168, v168
v_rcp_f32 v169, v169
v_rcp_f32 v170, v170
v_rcp_f32 v171, v171
v_rcp_f32 v172, v172
v_rcp_f32 v173, v173
v_rcp_f32 v174, v174
v_rcp_f32 v175, v175
v_pk_mul_f32 v[12:13], v[160:161], v[12:13]
v_pk_mul_f32 v[14:15], v[162:163], v[14:15]
v_pk_mul_f32 v[36:37], v[164:165], v[36:37]
v_pk_mul_f32 v[38:39], v[166:167], v[38:39]
v_pk_mul_f32 v[60:61], v[168:169], v[60:61]
v_pk_mul_f32 v[62:63], v[170:171], v[62:63]
v_pk_mul_f32 v[84:85], v[172:173], v[84:85]
v_pk_mul_f32 v[86:87], v[174:175], v[86:87]
v_pk_fma_f32 v[144:145], v[12:13], v[12:13], v[144:145]
v_pk_fma_f32 v[146:147], v[14:15], v[14:15], v[146:147]
v_pk_fma_f32 v[148:149], v[36:37], v[36:37], v[148:149]
v_pk_fma_f32 v[150:151], v[38:39], v[38:39], v[150:151]
v_pk_fma_f32 v[152:153], v[60:61], v[60:61], v[152:153]
v_pk_fma_f32 v[154:155], v[62:63], v[62:63], v[154:155]
v_pk_fma_f32 v[156:157], v[84:85], v[84:85], v[156:157]
v_pk_fma_f32 v[158:159], v[86:87], v[86:87], v[158:159]
v_pk_add_f32 v[112:113], v[12:13], v[112:113]
v_pk_add_f32 v[114:115], v[14:15], v[114:115]
v_pk_add_f32 v[116:117], v[36:37], v[116:117]
v_pk_add_f32 v[118:119], v[38:39], v[118:119]
v_pk_add_f32 v[120:121], v[60:61], v[120:121]
v_pk_add_f32 v[122:123], v[62:63], v[122:123]
v_pk_add_f32 v[124:125], v[84:85], v[124:125]
v_pk_add_f32 v[126:127], v[86:87], v[126:127]
v_pk_mul_f32 v[16:17], v[16:17], v[96:97]
v_pk_mul_f32 v[18:19], v[18:19], v[98:99]
v_pk_mul_f32 v[40:41], v[40:41], v[100:101]
v_pk_mul_f32 v[42:43], v[42:43], v[102:103]
v_pk_mul_f32 v[64:65], v[64:65], v[104:105]
v_pk_mul_f32 v[66:67], v[66:67], v[106:107]
v_pk_mul_f32 v[88:89], v[88:89], v[108:109]
v_pk_mul_f32 v[90:91], v[90:91], v[110:111]
v_pk_fma_f32 v[16:17], v[128:129], v[252:253], v[16:17] op_sel:[0,0,0] op_sel_hi:[1,0,1]
v_pk_fma_f32 v[18:19], v[130:131], v[252:253], v[18:19] op_sel:[0,0,0] op_sel_hi:[1,0,1]
v_pk_fma_f32 v[40:41], v[132:133], v[252:253], v[40:41] op_sel:[0,0,0] op_sel_hi:[1,0,1]
v_pk_fma_f32 v[42:43], v[134:135], v[252:253], v[42:43] op_sel:[0,0,0] op_sel_hi:[1,0,1]
v_pk_fma_f32 v[64:65], v[136:137], v[252:253], v[64:65] op_sel:[0,0,0] op_sel_hi:[1,0,1]
v_pk_fma_f32 v[66:67], v[138:139], v[252:253], v[66:67] op_sel:[0,0,0] op_sel_hi:[1,0,1]
v_pk_fma_f32 v[88:89], v[140:141], v[252:253], v[88:89] op_sel:[0,0,0] op_sel_hi:[1,0,1]
v_pk_fma_f32 v[90:91], v[142:143], v[252:253], v[90:91] op_sel:[0,0,0] op_sel_hi:[1,0,1]
v_pk_fma_f32 v[160:161], v[16:17], v[16:17], v[244:245] op_sel_hi:[1,1,0]
v_pk_fma_f32 v[162:163], v[18:19], v[18:19], v[244:245] op_sel_hi:[1,1,0]
v_pk_fma_f32 v[164:165], v[40:41], v[40:41], v[244:245] op_sel_hi:[1,1,0]
v_pk_fma_f32 v[166:167], v[42:43], v[42:43], v[244:245] op_sel_hi:[1,1,0]
v_pk_fma_f32 v[168:169], v[64:65], v[64:65], v[244:245] op_sel_hi:[1,1,0]
v_pk_fma_f32 v[170:171], v[66:67], v[66:67], v[244:245] op_sel_hi:[1,1,0]
v_pk_fma_f32 v[172:173], v[88:89], v[88:89], v[244:245] op_sel_hi:[1,1,0]
v_pk_fma_f32 v[174:175], v[90:91], v[90:91], v[244:245] op_sel_hi:[1,1,0]
v_pk_mul_f32 v[160:161], v[160:161], v[16:17]
v_pk_mul_f32 v[162:163], v[162:163], v[18:19]
v_pk_mul_f32 v[164:165], v[164:165], v[40:41]
v_pk_mul_f32 v[166:167], v[166:167], v[42:43]
v_pk_mul_f32 v[168:169], v[168:169], v[64:65]
v_pk_mul_f32 v[170:171], v[170:171], v[66:67]
v_pk_mul_f32 v[172:173], v[172:173], v[88:89]
v_pk_mul_f32 v[174:175], v[174:175], v[90:91]
v_exp_f32_e64 v160, -v160
v_exp_f32_e64 v161, -v161
v_exp_f32_e64 v162, -v162
v_exp_f32_e64 v163, -v163
v_exp_f32_e64 v164, -v164
v_exp_f32_e64 v165, -v165
v_exp_f32_e64 v166, -v166
v_exp_f32_e64 v167, -v167
v_exp_f32_e64 v168, -v168
v_exp_f32_e64 v169, -v169
v_exp_f32_e64 v170, -v170
v_exp_f32_e64 v171, -v171
v_exp_f32_e64 v172, -v172
v_exp_f32_e64 v173, -v173
v_exp_f32_e64 v174, -v174
v_exp_f32_e64 v175, -v175
v_pk_add_f32 v[160:161], v[160:161], v[246:247] op_sel_hi:[1,0]
v_pk_add_f32 v[162:163], v[162:163], v[246:247] op_sel_hi:[1,0]
v_pk_add_f32 v[164:165], v[164:165], v[246:247] op_sel_hi:[1,0]
v_pk_add_f32 v[166:167], v[166:167], v[246:247] op_sel_hi:[1,0]
v_pk_add_f32 v[168:169], v[168:169], v[246:247] op_sel_hi:[1,0]
v_pk_add_f32 v[170:171], v[170:171], v[246:247] op_sel_hi:[1,0]
v_pk_add_f32 v[172:173], v[172:173], v[246:247] op_sel_hi:[1,0]
v_pk_add_f32 v[174:175], v[174:175], v[246:247] op_sel_hi:[1,0]
v_rcp_f32 v160, v160
v_rcp_f32 v161, v161
v_rcp_f32 v162, v162
v_rcp_f32 v163, v163
v_rcp_f32 v164, v164
v_rcp_f32 v165, v165
v_rcp_f32 v166, v166
v_rcp_f32 v167, v167
v_rcp_f32 v168, v168
v_rcp_f32 v169, v169
v_rcp_f32 v170, v170
v_rcp_f32 v171, v171
v_rcp_f32 v172, v172
v_rcp_f32 v173, v173
v_rcp_f32 v174, v174
v_rcp_f32 v175, v175
v_pk_mul_f32 v[16:17], v[160:161], v[16:17]
v_pk_mul_f32 v[18:19], v[162:163], v[18:19]
v_pk_mul_f32 v[40:41], v[164:165], v[40:41]
v_pk_mul_f32 v[42:43], v[166:167], v[42:43]
v_pk_mul_f32 v[64:65], v[168:169], v[64:65]
v_pk_mul_f32 v[66:67], v[170:171], v[66:67]
v_pk_mul_f32 v[88:89], v[172:173], v[88:89]
v_pk_mul_f32 v[90:91], v[174:175], v[90:91]
v_pk_fma_f32 v[144:145], v[16:17], v[16:17], v[144:145]
v_pk_fma_f32 v[146:147], v[18:19], v[18:19], v[146:147]
v_pk_fma_f32 v[148:149], v[40:41], v[40:41], v[148:149]
v_pk_fma_f32 v[150:151], v[42:43], v[42:43], v[150:151]
v_pk_fma_f32 v[152:153], v[64:65], v[64:65], v[152:153]
v_pk_fma_f32 v[154:155], v[66:67], v[66:67], v[154:155]
v_pk_fma_f32 v[156:157], v[88:89], v[88:89], v[156:157]
v_pk_fma_f32 v[158:159], v[90:91], v[90:91], v[158:159]
v_pk_add_f32 v[112:113], v[16:17], v[112:113]
v_pk_add_f32 v[114:115], v[18:19], v[114:115]
v_pk_add_f32 v[116:117], v[40:41], v[116:117]
v_pk_add_f32 v[118:119], v[42:43], v[118:119]
v_pk_add_f32 v[120:121], v[64:65], v[120:121]
v_pk_add_f32 v[122:123], v[66:67], v[122:123]
v_pk_add_f32 v[124:125], v[88:89], v[124:125]
v_pk_add_f32 v[126:127], v[90:91], v[126:127]
v_pk_mul_f32 v[20:21], v[20:21], v[96:97]
v_pk_mul_f32 v[22:23], v[22:23], v[98:99]
v_pk_mul_f32 v[44:45], v[44:45], v[100:101]
v_pk_mul_f32 v[46:47], v[46:47], v[102:103]
v_pk_mul_f32 v[68:69], v[68:69], v[104:105]
v_pk_mul_f32 v[70:71], v[70:71], v[106:107]
v_pk_mul_f32 v[92:93], v[92:93], v[108:109]
v_pk_mul_f32 v[94:95], v[94:95], v[110:111]
v_pk_fma_f32 v[20:21], v[128:129], v[252:253], v[20:21] op_sel:[0,1,0] op_sel_hi:[1,1,1]
v_pk_fma_f32 v[22:23], v[130:131], v[252:253], v[22:23] op_sel:[0,1,0] op_sel_hi:[1,1,1]
v_pk_fma_f32 v[44:45], v[132:133], v[252:253], v[44:45] op_sel:[0,1,0] op_sel_hi:[1,1,1]
v_pk_fma_f32 v[46:47], v[134:135], v[252:253], v[46:47] op_sel:[0,1,0] op_sel_hi:[1,1,1]
v_pk_fma_f32 v[68:69], v[136:137], v[252:253], v[68:69] op_sel:[0,1,0] op_sel_hi:[1,1,1]
v_pk_fma_f32 v[70:71], v[138:139], v[252:253], v[70:71] op_sel:[0,1,0] op_sel_hi:[1,1,1]
v_pk_fma_f32 v[92:93], v[140:141], v[252:253], v[92:93] op_sel:[0,1,0] op_sel_hi:[1,1,1]
v_pk_fma_f32 v[94:95], v[142:143], v[252:253], v[94:95] op_sel:[0,1,0] op_sel_hi:[1,1,1]
v_pk_fma_f32 v[160:161], v[20:21], v[20:21], v[244:245] op_sel_hi:[1,1,0]
v_pk_fma_f32 v[162:163], v[22:23], v[22:23], v[244:245] op_sel_hi:[1,1,0]
v_pk_fma_f32 v[164:165], v[44:45], v[44:45], v[244:245] op_sel_hi:[1,1,0]
v_pk_fma_f32 v[166:167], v[46:47], v[46:47], v[244:245] op_sel_hi:[1,1,0]
v_pk_fma_f32 v[168:169], v[68:69], v[68:69], v[244:245] op_sel_hi:[1,1,0]
v_pk_fma_f32 v[170:171], v[70:71], v[70:71], v[244:245] op_sel_hi:[1,1,0]
v_pk_fma_f32 v[172:173], v[92:93], v[92:93], v[244:245] op_sel_hi:[1,1,0]
v_pk_fma_f32 v[174:175], v[94:95], v[94:95], v[244:245] op_sel_hi:[1,1,0]
v_pk_mul_f32 v[160:161], v[160:161], v[20:21]
v_pk_mul_f32 v[162:163], v[162:163], v[22:23]
v_pk_mul_f32 v[164:165], v[164:165], v[44:45]
v_pk_mul_f32 v[166:167], v[166:167], v[46:47]
v_pk_mul_f32 v[168:169], v[168:169], v[68:69]
v_pk_mul_f32 v[170:171], v[170:171], v[70:71]
v_pk_mul_f32 v[172:173], v[172:173], v[92:93]
v_pk_mul_f32 v[174:175], v[174:175], v[94:95]
v_exp_f32_e64 v160, -v160
v_exp_f32_e64 v161, -v161
v_exp_f32_e64 v162, -v162
v_exp_f32_e64 v163, -v163
v_exp_f32_e64 v164, -v164
v_exp_f32_e64 v165, -v165
v_exp_f32_e64 v166, -v166
v_exp_f32_e64 v167, -v167
v_exp_f32_e64 v168, -v168
v_exp_f32_e64 v169, -v169
v_exp_f32_e64 v170, -v170
v_exp_f32_e64 v171, -v171
v_exp_f32_e64 v172, -v172
v_exp_f32_e64 v173, -v173
v_exp_f32_e64 v174, -v174
v_exp_f32_e64 v175, -v175
v_pk_add_f32 v[160:161], v[160:161], v[246:247] op_sel_hi:[1,0]
v_pk_add_f32 v[162:163], v[162:163], v[246:247] op_sel_hi:[1,0]
v_pk_add_f32 v[164:165], v[164:165], v[246:247] op_sel_hi:[1,0]
v_pk_add_f32 v[166:167], v[166:167], v[246:247] op_sel_hi:[1,0]
v_pk_add_f32 v[168:169], v[168:169], v[246:247] op_sel_hi:[1,0]
v_pk_add_f32 v[170:171], v[170:171], v[246:247] op_sel_hi:[1,0]
v_pk_add_f32 v[172:173], v[172:173], v[246:247] op_sel_hi:[1,0]
v_pk_add_f32 v[174:175], v[174:175], v[246:247] op_sel_hi:[1,0]
v_rcp_f32 v160, v160
v_rcp_f32 v161, v161
v_rcp_f32 v162, v162
v_rcp_f32 v163, v163
v_rcp_f32 v164, v164
v_rcp_f32 v165, v165
v_rcp_f32 v166, v166
v_rcp_f32 v167, v167
v_rcp_f32 v168, v168
v_rcp_f32 v169, v169
v_rcp_f32 v170, v170
v_rcp_f32 v171, v171
v_rcp_f32 v172, v172
v_rcp_f32 v173, v173
v_rcp_f32 v174, v174
v_rcp_f32 v175, v175
v_pk_mul_f32 v[20:21], v[160:161], v[20:21]
v_pk_mul_f32 v[22:23], v[162:163], v[22:23]
v_pk_mul_f32 v[44:45], v[164:165], v[44:45]
v_pk_mul_f32 v[46:47], v[166:167], v[46:47]
v_pk_mul_f32 v[68:69], v[168:169], v[68:69]
v_pk_mul_f32 v[70:71], v[170:171], v[70:71]
v_pk_mul_f32 v[92:93], v[172:173], v[92:93]
v_pk_mul_f32 v[94:95], v[174:175], v[94:95]
v_pk_fma_f32 v[144:145], v[20:21], v[20:21], v[144:145]
v_pk_fma_f32 v[146:147], v[22:23], v[22:23], v[146:147]
v_pk_fma_f32 v[148:149], v[44:45], v[44:45], v[148:149]
v_pk_fma_f32 v[150:151], v[46:47], v[46:47], v[150:151]
v_pk_fma_f32 v[152:153], v[68:69], v[68:69], v[152:153]
v_pk_fma_f32 v[154:155], v[70:71], v[70:71], v[154:155]
v_pk_fma_f32 v[156:157], v[92:93], v[92:93], v[156:157]
v_pk_fma_f32 v[158:159], v[94:95], v[94:95], v[158:159]
v_pk_add_f32 v[112:113], v[20:21], v[112:113]
v_pk_add_f32 v[114:115], v[22:23], v[114:115]
v_pk_add_f32 v[116:117], v[44:45], v[116:117]
v_pk_add_f32 v[118:119], v[46:47], v[118:119]
v_pk_add_f32 v[120:121], v[68:69], v[120:121]
v_pk_add_f32 v[122:123], v[70:71], v[122:123]
v_pk_add_f32 v[124:125], v[92:93], v[124:125]
v_pk_add_f32 v[126:127], v[94:95], v[126:127]
s_setprio 1
s_waitcnt vmcnt(0)
s_barrier
v_add_f32_dpp v144, v144, v144 row_ror:8 row_mask:0xf bank_mask:0xf
v_add_f32_dpp v145, v145, v145 row_ror:8 row_mask:0xf bank_mask:0xf
v_add_f32_dpp v146, v146, v146 row_ror:8 row_mask:0xf bank_mask:0xf
v_add_f32_dpp v147, v147, v147 row_ror:8 row_mask:0xf bank_mask:0xf
v_add_f32_dpp v148, v148, v148 row_ror:8 row_mask:0xf bank_mask:0xf
v_add_f32_dpp v149, v149, v149 row_ror:8 row_mask:0xf bank_mask:0xf
v_add_f32_dpp v150, v150, v150 row_ror:8 row_mask:0xf bank_mask:0xf
v_add_f32_dpp v151, v151, v151 row_ror:8 row_mask:0xf bank_mask:0xf
v_add_f32_dpp v112, v112, v112 row_ror:8 row_mask:0xf bank_mask:0xf
v_add_f32_dpp v113, v113, v113 row_ror:8 row_mask:0xf bank_mask:0xf
v_add_f32_dpp v114, v114, v114 row_ror:8 row_mask:0xf bank_mask:0xf
v_add_f32_dpp v115, v115, v115 row_ror:8 row_mask:0xf bank_mask:0xf
v_add_f32_dpp v116, v116, v116 row_ror:8 row_mask:0xf bank_mask:0xf
v_add_f32_dpp v117, v117, v117 row_ror:8 row_mask:0xf bank_mask:0xf
v_add_f32_dpp v118, v118, v118 row_ror:8 row_mask:0xf bank_mask:0xf
v_add_f32_dpp v119, v119, v119 row_ror:8 row_mask:0xf bank_mask:0xf
v_add_f32_dpp v144, v152, v152 row_ror:8 row_mask:0xf bank_mask:0xc
v_add_f32_dpp v145, v153, v153 row_ror:8 row_mask:0xf bank_mask:0xc
v_add_f32_dpp v146, v154, v154 row_ror:8 row_mask:0xf bank_mask:0xc
v_add_f32_dpp v147, v155, v155 row_ror:8 row_mask:0xf bank_mask:0xc
v_add_f32_dpp v148, v156, v156 row_ror:8 row_mask:0xf bank_mask:0xc
v_add_f32_dpp v149, v157, v157 row_ror:8 row_mask:0xf bank_mask:0xc
v_add_f32_dpp v150, v158, v158 row_ror:8 row_mask:0xf bank_mask:0xc
v_add_f32_dpp v151, v159, v159 row_ror:8 row_mask:0xf bank_mask:0xc
v_add_f32_dpp v112, v120, v120 row_ror:8 row_mask:0xf bank_mask:0xc
v_add_f32_dpp v113, v121, v121 row_ror:8 row_mask:0xf bank_mask:0xc
v_add_f32_dpp v114, v122, v122 row_ror:8 row_mask:0xf bank_mask:0xc
v_add_f32_dpp v115, v123, v123 row_ror:8 row_mask:0xf bank_mask:0xc
v_add_f32_dpp v116, v124, v124 row_ror:8 row_mask:0xf bank_mask:0xc
v_add_f32_dpp v117, v125, v125 row_ror:8 row_mask:0xf bank_mask:0xc
v_add_f32_dpp v118, v126, v126 row_ror:8 row_mask:0xf bank_mask:0xc
v_add_f32_dpp v119, v127, v127 row_ror:8 row_mask:0xf bank_mask:0xc
v_add_f32_dpp v144, v144, v144 row_half_mirror row_mask:0xf bank_mask:0xf
v_add_f32_dpp v145, v145, v145 row_half_mirror row_mask:0xf bank_mask:0xf
v_add_f32_dpp v146, v146, v146 row_half_mirror row_mask:0xf bank_mask:0xf
v_add_f32_dpp v147, v147, v147 row_half_mirror row_mask:0xf bank_mask:0xf
v_add_f32_dpp v112, v112, v112 row_half_mirror row_mask:0xf bank_mask:0xf
v_add_f32_dpp v113, v113, v113 row_half_mirror row_mask:0xf bank_mask:0xf
v_add_f32_dpp v114, v114, v114 row_half_mirror row_mask:0xf bank_mask:0xf
v_add_f32_dpp v115, v115, v115 row_half_mirror row_mask:0xf bank_mask:0xf
v_add_f32_dpp v144, v148, v148 row_half_mirror row_mask:0xf bank_mask:0xa
v_add_f32_dpp v145, v149, v149 row_half_mirror row_mask:0xf bank_mask:0xa
v_add_f32_dpp v146, v150, v150 row_half_mirror row_mask:0xf bank_mask:0xa
v_add_f32_dpp v147, v151, v151 row_half_mirror row_mask:0xf bank_mask:0xa
v_add_f32_dpp v112, v116, v116 row_half_mirror row_mask:0xf bank_mask:0xa
v_add_f32_dpp v113, v117, v117 row_half_mirror row_mask:0xf bank_mask:0xa
v_add_f32_dpp v114, v118, v118 row_half_mirror row_mask:0xf bank_mask:0xa
v_add_f32_dpp v115, v119, v119 row_half_mirror row_mask:0xf bank_mask:0xa
v_add_f32_dpp v144, v144, v144 quad_perm:[1,0,3,2] row_mask:0xf bank_mask:0xf
v_add_f32_dpp v145, v145, v145 quad_perm:[1,0,3,2] row_mask:0xf bank_mask:0xf
v_add_f32_dpp v146, v146, v146 quad_perm:[1,0,3,2] row_mask:0xf bank_mask:0xf
v_add_f32_dpp v147, v147, v147 quad_perm:[1,0,3,2] row_mask:0xf bank_mask:0xf
v_add_f32_dpp v112, v112, v112 quad_perm:[1,0,3,2] row_mask:0xf bank_mask:0xf
v_add_f32_dpp v113, v113, v113 quad_perm:[1,0,3,2] row_mask:0xf bank_mask:0xf
v_add_f32_dpp v114, v114, v114 quad_perm:[1,0,3,2] row_mask:0xf bank_mask:0xf
v_add_f32_dpp v115, v115, v115 quad_perm:[1,0,3,2] row_mask:0xf bank_mask:0xf
v_add_f32_dpp v144, v144, v144 quad_perm:[2,3,0,1] row_mask:0xf bank_mask:0xf
v_add_f32_dpp v145, v145, v145 quad_perm:[2,3,0,1] row_mask:0xf bank_mask:0xf
v_add_f32_dpp v146, v146, v146 quad_perm:[2,3,0,1] row_mask:0xf bank_mask:0xf
v_add_f32_dpp v147, v147, v147 quad_perm:[2,3,0,1] row_mask:0xf bank_mask:0xf
v_add_f32_dpp v112, v112, v112 quad_perm:[2,3,0,1] row_mask:0xf bank_mask:0xf
v_add_f32_dpp v113, v113, v113 quad_perm:[2,3,0,1] row_mask:0xf bank_mask:0xf
v_add_f32_dpp v114, v114, v114 quad_perm:[2,3,0,1] row_mask:0xf bank_mask:0xf
v_add_f32_dpp v115, v115, v115 quad_perm:[2,3,0,1] row_mask:0xf bank_mask:0xf
ds_write_b128 v190, v[112:115] offset:2560
ds_write_b128 v190, v[144:147] offset:3072
s_waitcnt lgkmcnt(0)
s_barrier
ds_read_b32 v192, v191
ds_read_b32 v194, v191 offset:1024
s_waitcnt lgkmcnt(0)
v_add_f32 v192, v192, v194
buffer_store_dwordx2 v[192:193], v177, s[20:23], s37 offen sc0 sc1
s_add_u32 m0, s48, 0
s_nop 0
buffer_load_dwordx4 v200, s[8:11], s40 offen lds
s_add_u32 m0, s48, 1024
s_nop 0
buffer_load_dwordx4 v201, s[8:11], s40 offen lds
s_add_u32 m0, s48, 2048
s_nop 0
buffer_load_dwordx4 v200, s[8:11], s42 offen lds
s_add_u32 m0, s48, 3072
s_nop 0
buffer_load_dwordx4 v201, s[8:11], s42 offen lds
s_add_u32 s40, s40, 128
s_cmp_eq_u32 s40, 1152
s_cselect_b32 s40, 0, s40
s_add_u32 s42, s40, 4608
s_add_u32 m0, s47, 24576
s_nop 0
buffer_load_dwordx4 v202, s[12:15], s41 offen lds
s_add_u32 m0, s47, 25600
s_nop 0
buffer_load_dwordx4 v203, s[12:15], s41 offen lds
s_add_u32 m0, s47, 26624
s_nop 0
buffer_load_dwordx4 v204, s[12:15], s41 offen lds
s_add_u32 m0, s47, 27648
s_nop 0
buffer_load_dwordx4 v205, s[12:15], s41 offen lds
s_add_u32 m0, s47, 28672
s_nop 0
buffer_load_dwordx4 v206, s[12:15], s41 offen lds
s_add_u32 m0, s47, 29696
s_nop 0
buffer_load_dwordx4 v207, s[12:15], s41 offen lds
s_add_u32 s41, s41, 589824
s_cmp_eq_u32 s41, 5308416
s_cselect_b32 s41, 0, s41
s_add_u32 s43, s41, 4608
s_barrier
s_add_u32 m0, s48, 16384
s_nop 0
buffer_load_dwordx4 v200, s[8:11], s40 offen lds
s_add_u32 m0, s48, 17408
s_nop 0
buffer_load_dwordx4 v201, s[8:11], s40 offen lds
s_add_u32 m0, s48, 18432
s_nop 0
buffer_load_dwordx4 v200, s[8:11], s42 offen lds
s_add_u32 m0, s48, 19456
s_nop 0
buffer_load_dwordx4 v201, s[8:11], s42 offen lds
s_add_u32 s40, s40, 128
s_cmp_eq_u32 s40, 1152
s_cselect_b32 s40, 0, s40
s_add_u32 s42, s40, 4608
s_add_u32 m0, s47, 49152
s_nop 0
buffer_load_dwordx4 v202, s[12:15], s41 offen lds
s_add_u32 m0, s47, 50176
s_nop 0
buffer_load_dwordx4 v203, s[12:15], s41 offen lds
s_add_u32 m0, s47, 51200
s_nop 0
buffer_load_dwordx4 v204, s[12:15], s41 offen lds
s_add_u32 m0, s47, 52224
s_nop 0
buffer_load_dwordx4 v205, s[12:15], s41 offen lds
s_add_u32 m0, s47, 53248
s_nop 0
buffer_load_dwordx4 v206, s[12:15], s41 offen lds
s_add_u32 m0, s47, 54272
s_nop 0
buffer_load_dwordx4 v207, s[12:15], s41 offen lds
s_add_u32 s41, s41, 589824
s_cmp_eq_u32 s41, 5308416
s_cselect_b32 s41, 0, s41
s_add_u32 s43, s41, 4608
buffer_load_dwordx2 v[186:187], v181, s[20:23], s36 offen sc0 sc1
s_waitcnt vmcnt(17)
s_barrier
s_add_u32 m0, s48, 32768
s_nop 0
buffer_load_dwordx4 v200, s[8:11], s40 offen lds
s_add_u32 m0, s48, 33792
s_nop 0
buffer_load_dwordx4 v201, s[8:11], s40 offen lds
s_add_u32 m0, s48, 34816
s_nop 0
buffer_load_dwordx4 v200, s[8:11], s42 offen lds
s_add_u32 m0, s48, 35840
s_nop 0
buffer_load_dwordx4 v201, s[8:11], s42 offen lds
s_add_u32 s40, s40, 128
s_cmp_eq_u32 s40, 1152
s_cselect_b32 s40, 0, s40
s_add_u32 s42, s40, 4608
s_add_u32 m0, s47, 73728
s_nop 0
buffer_load_dwordx4 v202, s[12:15], s41 offen lds
s_add_u32 m0, s47, 74752
s_nop 0
buffer_load_dwordx4 v203, s[12:15], s41 offen lds
s_add_u32 m0, s47, 75776
s_nop 0
buffer_load_dwordx4 v204, s[12:15], s41 offen lds
s_add_u32 m0, s47, 76800
s_nop 0
buffer_load_dwordx4 v205, s[12:15], s41 offen lds
s_add_u32 m0, s47, 77824
s_nop 0
buffer_load_dwordx4 v206, s[12:15], s41 offen lds
s_add_u32 m0, s47, 78848
s_nop 0
buffer_load_dwordx4 v207, s[12:15], s41 offen lds
s_add_u32 s41, s41, 589824
s_cmp_eq_u32 s41, 5308416
s_cselect_b32 s41, 0, s41
s_add_u32 s43, s41, 4608
s_waitcnt vmcnt(17)
s_barrier
s_add_u32 m0, s48, 0
s_nop 0
buffer_load_dwordx4 v200, s[8:11], s40 offen lds
s_add_u32 m0, s48, 1024
s_nop 0
buffer_load_dwordx4 v201, s[8:11], s40 offen lds
s_add_u32 m0, s48, 2048
s_nop 0
buffer_load_dwordx4 v200, s[8:11], s42 offen lds
s_add_u32 m0, s48, 3072
s_nop 0
buffer_load_dwordx4 v201, s[8:11], s42 offen lds
s_add_u32 s40, s40, 128
s_cmp_eq_u32 s40, 1152
s_cselect_b32 s40, 0, s40
s_add_u32 s42, s40, 4608
s_add_u32 m0, s47, 0
s_nop 0
buffer_load_dwordx4 v202, s[12:15], s41 offen lds
s_add_u32 m0, s47, 1024
s_nop 0
buffer_load_dwordx4 v203, s[12:15], s41 offen lds
s_add_u32 m0, s47, 2048
s_nop 0
buffer_load_dwordx4 v204, s[12:15], s41 offen lds
s_add_u32 m0, s47, 3072
s_nop 0
buffer_load_dwordx4 v205, s[12:15], s41 offen lds
s_add_u32 m0, s47, 4096
s_nop 0
buffer_load_dwordx4 v206, s[12:15], s41 offen lds
s_add_u32 m0, s47, 5120
s_nop 0
buffer_load_dwordx4 v207, s[12:15], s41 offen lds
s_add_u32 s41, s41, 589824
s_cmp_eq_u32 s41, 5308416
s_cselect_b32 s41, 0, s41
s_add_u32 s43, s41, 4608
buffer_load_dwordx4 v[112:115], v238, s[20:23], s34 offen offset:0 sc0 sc1
buffer_load_dwordx4 v[116:119], v238, s[20:23], s34 offen offset:1024 sc0 sc1
buffer_load_dwordx4 v[120:123], v238, s[20:23], s34 offen offset:2048 sc0 sc1
buffer_load_dwordx4 v[124:127], v238, s[20:23], s34 offen offset:3072 sc0 sc1
buffer_load_dwordx4 v[128:131], v238, s[20:23], s35 offen offset:0 sc0 sc1
buffer_load_dwordx4 v[132:135], v238, s[20:23], s35 offen offset:1024 sc0 sc1
s_waitcnt vmcnt(22)
s_barrier
s_waitcnt vmcnt(0)
s_mov_b32 s78, 0x20000
L_pc2:
v_xor_b32 v144, v113, v193
v_xor_b32 v149, v115, v193
v_add_f32 v145, v112, v116
v_bitop3_b32 v144, v144, v117, v193 bitop3:0xf6
v_add_f32 v146, v114, v118
v_bitop3_b32 v149, v149, v119, v193 bitop3:0xf6
v_add_f32 v145, v145, v120
v_bitop3_b32 v144, v144, v121, v193 bitop3:0xf6
v_add_f32 v146, v146, v122
v_bitop3_b32 v149, v149, v123, v193 bitop3:0xf6
v_add_f32 v145, v145, v124
v_bitop3_b32 v144, v144, v125, v193 bitop3:0xf6
v_add_f32 v146, v146, v126
v_bitop3_b32 v149, v149, v127, v193 bitop3:0xf6
v_add_f32 v145, v145, v128
v_bitop3_b32 v144, v144, v129, v193 bitop3:0xf6
v_add_f32 v146, v146, v130
v_bitop3_b32 v149, v149, v131, v193 bitop3:0xf6
v_add_f32 v145, v145, v132
v_bitop3_b32 v144, v144, v133, v193 bitop3:0xf6
v_add_f32 v146, v146, v134
v_bitop3_b32 v149, v149, v135, v193 bitop3:0xf6
v_or_b32 v144, v144, v149
v_cmp_ne_u32 vcc, 0, v144
s_cbranch_vccnz L_poll
L_pdone:
v_mov_b32 v147, v145
v_mov_b32 v148, v146
s_nop 1
v_permlane32_swap_b32 v145, v147
v_permlane32_swap_b32 v146, v148
s_nop 1
v_add_f32 v145, v145, v147
v_add_f32 v146, v146, v148
v_mul_f32 v145, 0x3a72c49e, v145
v_mul_f32 v146, 0x3b017fae, v146
v_fma_f32 v146, -v145, v145, v146
v_max_f32 v146, 0, v146
v_cvt_pk_bf16_f32 v145, v145, v145
v_and_b32 v145, 0xffff0000, v145
v_cvt_pk_bf16_f32 v146, v146, v146
v_and_b32 v146, 0xffff0000, v146
v_add_f32 v146, 0x3727c5ac, v146
v_cvt_pk_bf16_f32 v146, v146, v146
v_and_b32 v146, 0xffff0000, v146
v_sqrt_f32 v146, v146
s_nop 0
v_cvt_pk_bf16_f32 v146, v146, v146
v_and_b32 v146, 0xffff0000, v146
v_rcp_f32 v146, v146
s_nop 0
v_mul_f32_e64 v145, -v145, v146
v_mul_f32 v146, 0x40088e99, v146
s_mov_b32 exec_hi, 0
ds_write_b32 v188, v146 offset:4608
ds_write_b32 v188, v145 offset:5120
s_mov_b64 exec, -1
s_add_u32 m0, s48, 16384
s_nop 0
buffer_load_dwordx4 v200, s[8:11], s40 offen lds
s_add_u32 m0, s48, 17408
s_nop 0
buffer_load_dwordx4 v201, s[8:11], s40 offen lds
s_add_u32 m0, s48, 18432
s_nop 0
buffer_load_dwordx4 v200, s[8:11], s42 offen lds
s_add_u32 m0, s48, 19456
s_nop 0
buffer_load_dwordx4 v201, s[8:11], s42 offen lds
s_add_u32 s40, s40, 128
s_cmp_eq_u32 s40, 1152
s_cselect_b32 s40, 0, s40
s_add_u32 s42, s40, 4608
s_waitcnt lgkmcnt(0)
s_barrier
ds_read_b128 v[96:99], v239 offset:4608
ds_read_b128 v[112:115], v239 offset:5120
ds_read_b128 v[100:103], v239 offset:4624
ds_read_b128 v[116:119], v239 offset:5136
ds_read_b128 v[104:107], v239 offset:4736
ds_read_b128 v[120:123], v239 offset:5248
ds_read_b128 v[108:111], v239 offset:4752
ds_read_b128 v[124:127], v239 offset:5264
s_add_u32 m0, s47, 24576
s_nop 0
buffer_load_dwordx4 v202, s[12:15], s41 offen lds
s_add_u32 m0, s47, 25600
s_nop 0
buffer_load_dwordx4 v203, s[12:15], s41 offen lds
s_add_u32 m0, s47, 26624
s_nop 0
buffer_load_dwordx4 v204, s[12:15], s41 offen lds
s_add_u32 m0, s47, 27648
s_nop 0
buffer_load_dwordx4 v205, s[12:15], s41 offen lds
s_add_u32 m0, s47, 28672
s_nop 0
buffer_load_dwordx4 v206, s[12:15], s41 offen lds
s_add_u32 m0, s47, 29696
s_nop 0
buffer_load_dwordx4 v207, s[12:15], s41 offen lds
s_add_u32 s41, s41, 589824
s_cmp_eq_u32 s41, 5308416
s_cselect_b32 s41, 0, s41
s_add_u32 s43, s41, 4608
s_add_u32 m0, s48, 32768
s_nop 0
buffer_load_dwordx4 v200, s[8:11], s40 offen lds
s_add_u32 m0, s48, 33792
s_nop 0
buffer_load_dwordx4 v201, s[8:11], s40 offen lds
s_add_u32 m0, s48, 34816
s_nop 0
buffer_load_dwordx4 v200, s[8:11], s42 offen lds
s_add_u32 m0, s48, 35840
s_nop 0
buffer_load_dwordx4 v201, s[8:11], s42 offen lds
s_add_u32 s40, s40, 128
s_cmp_eq_u32 s40, 1152
s_cselect_b32 s40, 0, s40
s_add_u32 s42, s40, 4608
s_mov_b64 exec, 0xff
global_load_dword v243, v245, s[4:5]
s_mov_b64 exec, -1
s_waitcnt lgkmcnt(0)
v_fma_f32 v0, v0, v96, v112
v_fma_f32 v1, v1, v97, v113
v_fma_f32 v2, v2, v98, v114
v_fma_f32 v3, v3, v99, v115
v_fma_f32 v24, v24, v100, v116
v_fma_f32 v25, v25, v101, v117
v_fma_f32 v26, v26, v102, v118
v_fma_f32 v27, v27, v103, v119
v_cvt_pk_bf16_f32 v128, v0, v1
v_cvt_pk_bf16_f32 v129, v2, v3
v_cvt_pk_bf16_f32 v130, v24, v25
v_cvt_pk_bf16_f32 v131, v26, v27
buffer_store_dwordx4 v[128:131], v238, s[72:75], s52 offen offset:0 sc1
v_fma_f32 v4, v4, v96, v112
v_fma_f32 v5, v5, v97, v113
v_fma_f32 v6, v6, v98, v114
v_fma_f32 v7, v7, v99, v115
v_fma_f32 v28, v28, v100, v116
v_fma_f32 v29, v29, v101, v117
v_fma_f32 v30, v30, v102, v118
v_fma_f32 v31, v31, v103, v119
v_cvt_pk_bf16_f32 v132, v4, v5
v_cvt_pk_bf16_f32 v133, v6, v7
v_cvt_pk_bf16_f32 v134, v28, v29
v_cvt_pk_bf16_f32 v135, v30, v31
buffer_store_dwordx4 v[132:135], v238, s[72:75], s52 offen offset:1024 sc1
s_waitcnt vmcnt(13)
s_barrier
s_mov_b32 s78, 0x20000
L_c1c:
v_cmp_ne_u32 vcc, v187, v193
s_sub_u32 s78, s78, 1
s_cbranch_scc1 L_c1o
s_cbranch_vccz L_c1o
buffer_load_dwordx2 v[186:187], v181, s[20:23], s36 offen sc0 sc1
s_waitcnt vmcnt(0)
s_branch L_c1c
L_c1o:
s_mov_b32 exec_hi, 0xffff
ds_write_b32 v189, v186 offset:768
s_mov_b64 exec, -1
s_waitcnt lgkmcnt(0)
v_fma_f32 v8, v8, v96, v112
v_fma_f32 v9, v9, v97, v113
v_fma_f32 v10, v10, v98, v114
v_fma_f32 v11, v11, v99, v115
v_fma_f32 v32, v32, v100, v116
v_fma_f32 v33, v33, v101, v117
v_fma_f32 v34, v34, v102, v118
v_fma_f32 v35, v35, v103, v119
v_cvt_pk_bf16_f32 v136, v8, v9
v_cvt_pk_bf16_f32 v137, v10, v11
v_cvt_pk_bf16_f32 v138, v32, v33
v_cvt_pk_bf16_f32 v139, v34, v35
buffer_store_dwordx4 v[136:139], v238, s[72:75], s52 offen offset:2048 sc1
v_fma_f32 v12, v12, v96, v112
v_fma_f32 v13, v13, v97, v113
v_fma_f32 v14, v14, v98, v114
v_fma_f32 v15, v15, v99, v115
v_fma_f32 v36, v36, v100, v116
v_fma_f32 v37, v37, v101, v117
v_fma_f32 v38, v38, v102, v118
v_fma_f32 v39, v39, v103, v119
v_cvt_pk_bf16_f32 v140, v12, v13
v_cvt_pk_bf16_f32 v141, v14, v15
v_cvt_pk_bf16_f32 v142, v36, v37
v_cvt_pk_bf16_f32 v143, v38, v39
buffer_store_dwordx4 v[140:143], v238, s[72:75], s52 offen offset:3072 sc1
v_fma_f32 v16, v16, v96, v112
v_fma_f32 v17, v17, v97, v113
v_fma_f32 v18, v18, v98, v114
v_fma_f32 v19, v19, v99, v115
v_fma_f32 v40, v40, v100, v116
v_fma_f32 v41, v41, v101, v117
v_fma_f32 v42, v42, v102, v118
v_fma_f32 v43, v43, v103, v119
v_cvt_pk_bf16_f32 v144, v16, v17
v_cvt_pk_bf16_f32 v145, v18, v19
v_cvt_pk_bf16_f32 v146, v40, v41
v_cvt_pk_bf16_f32 v147, v42, v43
buffer_store_dwordx4 v[144:147], v238, s[72:75], s53 offen offset:0 sc1
s_waitcnt vmcnt(6)
s_barrier
s_waitcnt lgkmcnt(0)
v_fma_f32 v20, v20, v96, v112
v_fma_f32 v21, v21, v97, v113
v_fma_f32 v22, v22, v98, v114
v_fma_f32 v23, v23, v99, v115
v_fma_f32 v44, v44, v100, v116
v_fma_f32 v45, v45, v101, v117
v_fma_f32 v46, v46, v102, v118
v_fma_f32 v47, v47, v103, v119
v_cvt_pk_bf16_f32 v148, v20, v21
v_cvt_pk_bf16_f32 v149, v22, v23
v_cvt_pk_bf16_f32 v150, v44, v45
v_cvt_pk_bf16_f32 v151, v46, v47
buffer_store_dwordx4 v[148:151], v238, s[72:75], s53 offen offset:1024 sc1
v_fma_f32 v48, v48, v104, v120
v_fma_f32 v49, v49, v105, v121
v_fma_f32 v50, v50, v106, v122
v_fma_f32 v51, v51, v107, v123
v_fma_f32 v72, v72, v108, v124
v_fma_f32 v73, v73, v109, v125
v_fma_f32 v74, v74, v110, v126
v_fma_f32 v75, v75, v111, v127
v_cvt_pk_bf16_f32 v152, v48, v49
v_cvt_pk_bf16_f32 v153, v50, v51
v_cvt_pk_bf16_f32 v154, v72, v73
v_cvt_pk_bf16_f32 v155, v74, v75
buffer_store_dwordx4 v[152:155], v238, s[72:75], s54 offen offset:0 sc1
v_fma_f32 v52, v52, v104, v120
v_fma_f32 v53, v53, v105, v121
v_fma_f32 v54, v54, v106, v122
v_fma_f32 v55, v55, v107, v123
v_fma_f32 v76, v76, v108, v124
v_fma_f32 v77, v77, v109, v125
v_fma_f32 v78, v78, v110, v126
v_fma_f32 v79, v79, v111, v127
v_cvt_pk_bf16_f32 v156, v52, v53
v_cvt_pk_bf16_f32 v157, v54, v55
v_cvt_pk_bf16_f32 v158, v76, v77
v_cvt_pk_bf16_f32 v159, v78, v79
buffer_store_dwordx4 v[156:159], v238, s[72:75], s54 offen offset:1024 sc1
s_lshr_b32 s46, s18, 2
s_lshl_b32 s46, s46, 3
s_mul_i32 s47, s27, 6144
s_add_u32 s47, s47, 65536
s_mul_i32 s41, s46, 24576
s_add_u32 s43, s41, 4096
s_mul_i32 s30, s19, 786432
s_mov_b32 s14, 786432
s_mov_b32 s15, 0x20000
s_lshl_b32 s40, s46, 7
s_add_u32 s42, s40, 16384
s_add_u32 s12, s6, s30
s_addc_u32 s13, s7, 0
s_and_b32 s13, s13, 0xffff
s_mov_b32 s36, s38
s_mov_b32 s8, s62
s_and_b32 s9, s63, 0xffff
s_mov_b32 s10, 8388608
s_mov_b32 s11, 0x20000
s_load_dwordx4 s[80:83], s[0:1], 80
s_load_dwordx2 s[84:85], s[0:1], 0
s_load_dwordx2 s[86:87], s[0:1], 96
s_barrier
v_fma_f32 v56, v56, v104, v120
v_fma_f32 v57, v57, v105, v121
v_fma_f32 v58, v58, v106, v122
v_fma_f32 v59, v59, v107, v123
v_fma_f32 v80, v80, v108, v124
v_fma_f32 v81, v81, v109, v125
v_fma_f32 v82, v82, v110, v126
v_fma_f32 v83, v83, v111, v127
v_cvt_pk_bf16_f32 v160, v56, v57
v_cvt_pk_bf16_f32 v161, v58, v59
v_cvt_pk_bf16_f32 v162, v80, v81
v_cvt_pk_bf16_f32 v163, v82, v83
buffer_store_dwordx4 v[160:163], v238, s[72:75], s54 offen offset:2048 sc1
v_fma_f32 v60, v60, v104, v120
v_fma_f32 v61, v61, v105, v121
v_fma_f32 v62, v62, v106, v122
v_fma_f32 v63, v63, v107, v123
v_fma_f32 v84, v84, v108, v124
v_fma_f32 v85, v85, v109, v125
v_fma_f32 v86, v86, v110, v126
v_fma_f32 v87, v87, v111, v127
v_cvt_pk_bf16_f32 v164, v60, v61
v_cvt_pk_bf16_f32 v165, v62, v63
v_cvt_pk_bf16_f32 v166, v84, v85
v_cvt_pk_bf16_f32 v167, v86, v87
buffer_store_dwordx4 v[164:167], v238, s[72:75], s54 offen offset:3072 sc1
v_fma_f32 v64, v64, v104, v120
v_fma_f32 v65, v65, v105, v121
v_fma_f32 v66, v66, v106, v122
v_fma_f32 v67, v67, v107, v123
v_fma_f32 v88, v88, v108, v124
v_fma_f32 v89, v89, v109, v125
v_fma_f32 v90, v90, v110, v126
v_fma_f32 v91, v91, v111, v127
v_cvt_pk_bf16_f32 v168, v64, v65
v_cvt_pk_bf16_f32 v169, v66, v67
v_cvt_pk_bf16_f32 v170, v88, v89
v_cvt_pk_bf16_f32 v171, v90, v91
buffer_store_dwordx4 v[168:171], v238, s[72:75], s55 offen offset:0 sc1
v_fma_f32 v68, v68, v104, v120
v_fma_f32 v69, v69, v105, v121
v_fma_f32 v70, v70, v106, v122
v_fma_f32 v71, v71, v107, v123
v_fma_f32 v92, v92, v108, v124
v_fma_f32 v93, v93, v109, v125
v_fma_f32 v94, v94, v110, v126
v_fma_f32 v95, v95, v111, v127
v_cvt_pk_bf16_f32 v172, v68, v69
v_cvt_pk_bf16_f32 v173, v70, v71
v_cvt_pk_bf16_f32 v174, v92, v93
v_cvt_pk_bf16_f32 v175, v94, v95
buffer_store_dwordx4 v[172:175], v238, s[72:75], s55 offen offset:1024 sc1
s_lshl_b32 s40, s98, 1
s_add_u32 s40, s40, 0
s_and_b32 s40, s40, 7
s_add_u32 s40, s40, s46
s_lshl_b32 s40, s40, 7
s_add_u32 s42, s40, 16384
s_add_u32 m0, s48, 0
s_nop 0
buffer_load_dwordx4 v214, s[8:11], s40 offen lds
s_add_u32 m0, s48, 1024
s_nop 0
buffer_load_dwordx4 v215, s[8:11], s40 offen lds
s_add_u32 m0, s48, 2048
s_nop 0
buffer_load_dwordx4 v214, s[8:11], s42 offen lds
s_add_u32 m0, s48, 3072
s_nop 0
buffer_load_dwordx4 v215, s[8:11], s42 offen lds
s_lshl_b32 s40, s98, 1
s_add_u32 s40, s40, 1
s_and_b32 s40, s40, 7
s_add_u32 s40, s40, s46
s_lshl_b32 s40, s40, 7
s_add_u32 s42, s40, 16384
s_add_u32 m0, s48, 16384
s_nop 0
buffer_load_dwordx4 v214, s[8:11], s40 offen lds
s_add_u32 m0, s48, 17408
s_nop 0
buffer_load_dwordx4 v215, s[8:11], s40 offen lds
s_add_u32 m0, s48, 18432
s_nop 0
buffer_load_dwordx4 v214, s[8:11], s42 offen lds
s_add_u32 m0, s48, 19456
s_nop 0
buffer_load_dwordx4 v215, s[8:11], s42 offen lds
ds_write_b128 v218, v[128:131] offset:0
ds_write_b128 v218, v[132:135] offset:1024
ds_write_b128 v218, v[136:139] offset:2048
ds_write_b128 v218, v[140:143] offset:3072
ds_write_b128 v218, v[144:147] offset:4096
ds_write_b128 v218, v[148:151] offset:5120
ds_write_b128 v218, v[152:155] offset:12288
ds_write_b128 v218, v[156:159] offset:13312
ds_write_b128 v218, v[160:163] offset:14336
ds_write_b128 v218, v[164:167] offset:15360
ds_write_b128 v218, v[168:171] offset:16384
ds_write_b128 v218, v[172:175] offset:17408
s_waitcnt vmcnt(8)
s_mov_b64 exec, 1
ds_add_rtn_u32 v217, v241, v217
s_waitcnt lgkmcnt(0)
v_readfirstlane_b32 s30, v217
s_nop 0
s_cmp_eq_u32 s30, 3
s_cselect_b32 s39, s39, 0x40000000
buffer_store_dword v193, off, s[20:23], s39 sc0 sc1
s_mov_b64 exec, -1
s_lshl_b32 s40, s98, 1
s_add_u32 s40, s40, 2
s_and_b32 s40, s40, 7
s_add_u32 s40, s40, s46
s_lshl_b32 s40, s40, 7
s_add_u32 s42, s40, 16384
s_add_u32 m0, s48, 32768
s_nop 0
buffer_load_dwordx4 v214, s[8:11], s40 offen lds
s_add_u32 m0, s48, 33792
s_nop 0
buffer_load_dwordx4 v215, s[8:11], s40 offen lds
s_add_u32 m0, s48, 34816
s_nop 0
buffer_load_dwordx4 v214, s[8:11], s42 offen lds
s_add_u32 m0, s48, 35840
s_nop 0
buffer_load_dwordx4 v215, s[8:11], s42 offen lds
s_lshl_b32 s40, s98, 1
s_add_u32 s40, s40, 3
s_and_b32 s40, s40, 7
s_add_u32 s40, s40, s46
s_lshl_b32 s40, s40, 7
s_add_u32 s42, s40, 16384
s_add_u32 m0, s48, 49152
s_nop 0
buffer_load_dwordx4 v214, s[8:11], s40 offen lds
s_add_u32 m0, s48, 50176
s_nop 0
buffer_load_dwordx4 v215, s[8:11], s40 offen lds
s_add_u32 m0, s48, 51200
s_nop 0
buffer_load_dwordx4 v214, s[8:11], s42 offen lds
s_add_u32 m0, s48, 52224
s_nop 0
buffer_load_dwordx4 v215, s[8:11], s42 offen lds
s_add_u32 s30, s17, 8
s_and_b32 s29, s16, 1
s_mul_i32 s25, s30, 43
s_lshr_b32 s25, s25, 7
s_mul_i32 s31, s25, 3
s_sub_u32 s31, s30, s31
s_mov_b32 s35, s31
s_cmp_lt_u32 s31, 2
s_cselect_b32 s28, 5, 4
s_mul_i32 s24, s29, 18
s_mul_i32 s31, s31, 5
s_add_u32 s24, s24, s31
s_sub_u32 s31, s30, 27
s_lshl_b32 s31, s31, 1
s_add_u32 s31, s31, s29
s_cmp_ge_u32 s30, 27
s_cselect_b32 s25, s31, s25
s_cselect_b32 s24, 14, s24
s_cselect_b32 s28, 4, s28
s_lshr_b32 s31, s16, 1
s_lshl_b32 s31, s31, 5
s_add_u32 s24, s24, s31
s_mul_i32 s35, s35, 0
s_mul_i32 s30, s25, 0
s_add_u32 s35, s35, s30
s_mul_i32 s30, s35, 57
s_lshr_b32 s30, s30, 9
s_mul_i32 s30, s30, 9
s_sub_u32 s35, s35, s30
s_lshl_b32 s65, s35, 10
s_add_u32 s66, s65, 1024
s_cmp_eq_u32 s66, 9216
s_cselect_b32 s66, 0, s66
s_add_u32 s67, s66, 1024
s_cmp_eq_u32 s67, 9216
s_cselect_b32 s67, 0, s67
s_add_u32 s68, s67, 1024
s_cmp_eq_u32 s68, 9216
s_cselect_b32 s68, 0, s68
s_add_u32 s69, s68, 1024
s_cmp_eq_u32 s69, 9216
s_cselect_b32 s69, 0, s69
s_add_u32 s70, s69, 1024
s_cmp_eq_u32 s70, 9216
s_cselect_b32 s70, 0, s70
s_add_u32 s71, s70, 1024
s_cmp_eq_u32 s71, 9216
s_cselect_b32 s71, 0, s71
s_add_u32 s72, s71, 1024
s_cmp_eq_u32 s72, 9216
s_cselect_b32 s72, 0, s72
s_add_u32 s73, s72, 1024
s_cmp_eq_u32 s73, 9216
s_cselect_b32 s73, 0, s73
v_lshrrev_b32 v234, 3, v255
v_and_b32 v235, 6, v234
v_and_b32 v236, 7, v255
v_xor_b32 v235, v235, v236
v_mul_u32_u24 v234, 1152, v234
v_lshl_add_u32 v234, v235, 4, v234
s_lshl_b32 s30, s25, 7
s_mul_i32 s31, s27, 331776
s_add_u32 s30, s30, s31
v_add_u32 v229, s30, v234
s_mul_i32 s50, s29, 1327104
s_xor_b32 s31, s29, 1
s_mul_i32 s51, s31, 1327104
s_mul_i32 s52, s29, 36864
s_mul_i32 s53, s31, 36864
s_mul_i32 s26, s27, 32768
s_waitcnt lgkmcnt(0)
s_mov_b32 s56, s80
s_and_b32 s57, s81, 0xffff
s_mov_b32 s58, 2654208
s_mov_b32 s59, 0x20000
s_mov_b32 s78, 0x20000
s_branch L_zf_1
L_zf_l:
s_sleep 3
L_zf_1:
buffer_load_dword v180, v178, s[20:23], s36 offen sc0 sc1
s_waitcnt vmcnt(0)
v_xor_b32 v180, v180, v193
v_cmp_ne_u32 vcc, 0, v180
s_sub_u32 s78, s78, 1
s_cbranch_scc1 L_zf_o
s_cbranch_vccnz L_zf_l
L_zf_o:
s_lshl_b32 s41, s98, 1
s_add_u32 s41, s41, 2
s_and_b32 s41, s41, 7
s_add_u32 s41, s41, s46
s_mul_i32 s41, s41, 24576
s_add_u32 m0, s47, 49152
s_add_u32 s43, s41, 4096
buffer_load_dwordx4 v216, s[12:15], s41 offen offset:0 sc1 lds
buffer_load_dwordx4 v216, s[12:15], s41 offen offset:1024 sc1 lds
buffer_load_dwordx4 v216, s[12:15], s41 offen offset:2048 sc1 lds
buffer_load_dwordx4 v216, s[12:15], s41 offen offset:3072 sc1 lds
s_add_u32 m0, s47, 53248
s_nop 0
buffer_load_dwordx4 v216, s[12:15], s43 offen offset:0 sc1 lds
buffer_load_dwordx4 v216, s[12:15], s43 offen offset:1024 sc1 lds
s_barrier
s_barrier
v_readfirstlane_b32 s64, v193
s_lshl_b32 s41, s98, 1
s_add_u32 s41, s41, 3
s_and_b32 s41, s41, 7
s_add_u32 s41, s41, s46
s_mul_i32 s41, s41, 24576
s_add_u32 m0, s47, 73728
s_add_u32 s43, s41, 4096
buffer_load_dwordx4 v216, s[12:15], s41 offen offset:0 sc1 lds
buffer_load_dwordx4 v216, s[12:15], s41 offen offset:1024 sc1 lds
buffer_load_dwordx4 v216, s[12:15], s41 offen offset:2048 sc1 lds
buffer_load_dwordx4 v216, s[12:15], s41 offen offset:3072 sc1 lds
s_add_u32 m0, s47, 77824
s_nop 0
buffer_load_dwordx4 v216, s[12:15], s43 offen offset:0 sc1 lds
buffer_load_dwordx4 v216, s[12:15], s43 offen offset:1024 sc1 lds
s_lshl_b32 s40, s98, 1
s_add_u32 s40, s40, 4
s_and_b32 s40, s40, 7
s_add_u32 s40, s40, s46
s_lshl_b32 s40, s40, 7
s_add_u32 s42, s40, 16384
s_add_u32 m0, s48, 0
s_nop 0
buffer_load_dwordx4 v214, s[8:11], s40 offen lds
s_add_u32 m0, s48, 1024
s_nop 0
buffer_load_dwordx4 v215, s[8:11], s40 offen lds
s_add_u32 m0, s48, 2048
s_nop 0
buffer_load_dwordx4 v214, s[8:11], s42 offen lds
s_add_u32 m0, s48, 3072
s_nop 0
buffer_load_dwordx4 v215, s[8:11], s42 offen lds
s_waitcnt vmcnt(10)
s_barrier
s_lshl_b32 s41, s98, 1
s_add_u32 s41, s41, 4
s_and_b32 s41, s41, 7
s_add_u32 s41, s41, s46
s_mul_i32 s41, s41, 24576
s_add_u32 m0, s47, 0
s_add_u32 s43, s41, 4096
buffer_load_dwordx4 v216, s[12:15], s41 offen offset:0 sc1 lds
buffer_load_dwordx4 v216, s[12:15], s41 offen offset:1024 sc1 lds
buffer_load_dwordx4 v216, s[12:15], s41 offen offset:2048 sc1 lds
buffer_load_dwordx4 v216, s[12:15], s41 offen offset:3072 sc1 lds
s_add_u32 m0, s47, 4096
s_nop 0
buffer_load_dwordx4 v216, s[12:15], s43 offen offset:0 sc1 lds
buffer_load_dwordx4 v216, s[12:15], s43 offen offset:1024 sc1 lds
s_lshl_b32 s40, s98, 1
s_add_u32 s40, s40, 5
s_and_b32 s40, s40, 7
s_add_u32 s40, s40, s46
s_lshl_b32 s40, s40, 7
s_add_u32 s42, s40, 16384
s_add_u32 m0, s48, 16384
s_nop 0
buffer_load_dwordx4 v214, s[8:11], s40 offen lds
s_add_u32 m0, s48, 17408
s_nop 0
buffer_load_dwordx4 v215, s[8:11], s40 offen lds
s_add_u32 m0, s48, 18432
s_nop 0
buffer_load_dwordx4 v214, s[8:11], s42 offen lds
s_add_u32 m0, s48, 19456
s_nop 0
buffer_load_dwordx4 v215, s[8:11], s42 offen lds
s_waitcnt vmcnt(14)
s_barrier
s_lshl_b32 s41, s98, 1
s_add_u32 s41, s41, 5
s_and_b32 s41, s41, 7
s_add_u32 s41, s41, s46
s_mul_i32 s41, s41, 24576
s_add_u32 m0, s47, 24576
s_add_u32 s43, s41, 4096
buffer_load_dwordx4 v216, s[12:15], s41 offen offset:0 sc1 lds
buffer_load_dwordx4 v216, s[12:15], s41 offen offset:1024 sc1 lds
buffer_load_dwordx4 v216, s[12:15], s41 offen offset:2048 sc1 lds
buffer_load_dwordx4 v216, s[12:15], s41 offen offset:3072 sc1 lds
s_add_u32 m0, s47, 28672
s_nop 0
buffer_load_dwordx4 v216, s[12:15], s43 offen offset:0 sc1 lds
buffer_load_dwordx4 v216, s[12:15], s43 offen offset:1024 sc1 lds
s_lshl_b32 s40, s98, 1
s_add_u32 s40, s40, 6
s_and_b32 s40, s40, 7
s_add_u32 s40, s40, s46
s_lshl_b32 s40, s40, 7
s_add_u32 s42, s40, 16384
s_add_u32 m0, s48, 32768
s_nop 0
buffer_load_dwordx4 v214, s[8:11], s40 offen lds
s_add_u32 m0, s48, 33792
s_nop 0
buffer_load_dwordx4 v215, s[8:11], s40 offen lds
s_add_u32 m0, s48, 34816
s_nop 0
buffer_load_dwordx4 v214, s[8:11], s42 offen lds
s_add_u32 m0, s48, 35840
s_nop 0
buffer_load_dwordx4 v215, s[8:11], s42 offen lds
s_waitcnt vmcnt(14)
s_barrier
s_lshl_b32 s41, s98, 1
s_add_u32 s41, s41, 6
s_and_b32 s41, s41, 7
s_add_u32 s41, s41, s46
s_mul_i32 s41, s41, 24576
s_add_u32 m0, s47, 49152
s_add_u32 s43, s41, 4096
buffer_load_dwordx4 v216, s[12:15], s41 offen offset:0 sc1 lds
buffer_load_dwordx4 v216, s[12:15], s41 offen offset:1024 sc1 lds
buffer_load_dwordx4 v216, s[12:15], s41 offen offset:2048 sc1 lds
buffer_load_dwordx4 v216, s[12:15], s41 offen offset:3072 sc1 lds
s_add_u32 m0, s47, 53248
s_nop 0
buffer_load_dwordx4 v216, s[12:15], s43 offen offset:0 sc1 lds
buffer_load_dwordx4 v216, s[12:15], s43 offen offset:1024 sc1 lds
s_lshl_b32 s40, s98, 1
s_add_u32 s40, s40, 7
s_and_b32 s40, s40, 7
s_add_u32 s40, s40, s46
s_lshl_b32 s40, s40, 7
s_add_u32 s42, s40, 16384
s_add_u32 m0, s48, 49152
s_nop 0
buffer_load_dwordx4 v214, s[8:11], s40 offen lds
s_add_u32 m0, s48, 50176
s_nop 0
buffer_load_dwordx4 v215, s[8:11], s40 offen lds
s_add_u32 m0, s48, 51200
s_nop 0
buffer_load_dwordx4 v214, s[8:11], s42 offen lds
s_add_u32 m0, s48, 52224
s_nop 0
buffer_load_dwordx4 v215, s[8:11], s42 offen lds
buffer_load_dword v180, v179, s[20:23], s36 offen sc0 sc1
s_waitcnt vmcnt(15)
s_barrier
s_lshl_b32 s41, s98, 1
s_add_u32 s41, s41, 7
s_and_b32 s41, s41, 7
s_add_u32 s41, s41, s46
s_mul_i32 s41, s41, 24576
s_add_u32 m0, s47, 73728
s_add_u32 s43, s41, 4096
buffer_load_dwordx4 v216, s[12:15], s41 offen offset:0 sc1 lds
buffer_load_dwordx4 v216, s[12:15], s41 offen offset:1024 sc1 lds
buffer_load_dwordx4 v216, s[12:15], s41 offen offset:2048 sc1 lds
buffer_load_dwordx4 v216, s[12:15], s41 offen offset:3072 sc1 lds
s_add_u32 m0, s47, 77824
s_nop 0
buffer_load_dwordx4 v216, s[12:15], s43 offen offset:0 sc1 lds
buffer_load_dwordx4 v216, s[12:15], s43 offen offset:1024 sc1 lds
s_cmp_eq_u32 s98, 0
s_cselect_b32 s40, 12, 8
s_add_u32 s40, s40, s46
s_and_b32 s40, s40, 31
s_lshl_b32 s40, s40, 7
s_add_u32 s42, s40, 16384
s_add_u32 m0, s48, 0
s_nop 0
buffer_load_dwordx4 v214, s[8:11], s40 offen lds
s_add_u32 m0, s48, 1024
s_nop 0
buffer_load_dwordx4 v215, s[8:11], s40 offen lds
s_add_u32 m0, s48, 2048
s_nop 0
buffer_load_dwordx4 v214, s[8:11], s42 offen lds
s_add_u32 m0, s48, 3072
s_nop 0
buffer_load_dwordx4 v215, s[8:11], s42 offen lds
s_waitcnt vmcnt(15)
s_barrier
s_waitcnt vmcnt(10)
s_mov_b32 s78, 0x20000
L_zg:
v_cmp_ne_u32 vcc, v180, v193
s_sub_u32 s78, s78, 1
s_cbranch_scc1 L_zgo
s_cbranch_vccz L_zgo
s_sleep 2
buffer_load_dword v180, v179, s[20:23], s36 offen sc0 sc1
s_waitcnt vmcnt(0)
s_branch L_zg
L_zgo:
s_cmp_eq_u32 s98, 0
s_cselect_b32 s41, 12, 8
s_add_u32 s41, s41, s46
s_and_b32 s41, s41, 31
s_mul_i32 s41, s41, 24576
s_add_u32 m0, s47, 0
s_add_u32 s43, s41, 4096
buffer_load_dwordx4 v216, s[12:15], s41 offen offset:0 sc1 lds
buffer_load_dwordx4 v216, s[12:15], s41 offen offset:1024 sc1 lds
buffer_load_dwordx4 v216, s[12:15], s41 offen offset:2048 sc1 lds
buffer_load_dwordx4 v216, s[12:15], s41 offen offset:3072 sc1 lds
s_add_u32 m0, s47, 4096
s_nop 0
buffer_load_dwordx4 v216, s[12:15], s43 offen offset:0 sc1 lds
buffer_load_dwordx4 v216, s[12:15], s43 offen offset:1024 sc1 lds
s_cmp_eq_u32 s98, 1
s_cselect_b32 s40, 13, 9
s_add_u32 s40, s40, s46
s_and_b32 s40, s40, 31
s_lshl_b32 s40, s40, 7
s_add_u32 s42, s40, 16384
s_add_u32 m0, s48, 16384
s_nop 0
buffer_load_dwordx4 v214, s[8:11], s40 offen lds
s_add_u32 m0, s48, 17408
s_nop 0
buffer_load_dwordx4 v215, s[8:11], s40 offen lds
s_add_u32 m0, s48, 18432
s_nop 0
buffer_load_dwordx4 v214, s[8:11], s42 offen lds
s_add_u32 m0, s48, 19456
s_nop 0
buffer_load_dwordx4 v215, s[8:11], s42 offen lds
s_waitcnt vmcnt(14)
s_barrier
s_cmp_eq_u32 s98, 1
s_cselect_b32 s41, 13, 9
s_add_u32 s41, s41, s46
s_and_b32 s41, s41, 31
s_mul_i32 s41, s41, 24576
s_add_u32 m0, s47, 24576
s_add_u32 s43, s41, 4096
buffer_load_dwordx4 v216, s[12:15], s41 offen offset:0 sc1 lds
buffer_load_dwordx4 v216, s[12:15], s41 offen offset:1024 sc1 lds
buffer_load_dwordx4 v216, s[12:15], s41 offen offset:2048 sc1 lds
buffer_load_dwordx4 v216, s[12:15], s41 offen offset:3072 sc1 lds
s_add_u32 m0, s47, 28672
s_nop 0
buffer_load_dwordx4 v216, s[12:15], s43 offen offset:0 sc1 lds
buffer_load_dwordx4 v216, s[12:15], s43 offen offset:1024 sc1 lds
s_cmp_eq_u32 s98, 2
s_cselect_b32 s40, 14, 10
s_add_u32 s40, s40, s46
s_and_b32 s40, s40, 31
s_lshl_b32 s40, s40, 7
s_add_u32 s42, s40, 16384
s_add_u32 m0, s48, 32768
s_nop 0
buffer_load_dwordx4 v214, s[8:11], s40 offen lds
s_add_u32 m0, s48, 33792
s_nop 0
buffer_load_dwordx4 v215, s[8:11], s40 offen lds
s_add_u32 m0, s48, 34816
s_nop 0
buffer_load_dwordx4 v214, s[8:11], s42 offen lds
s_add_u32 m0, s48, 35840
s_nop 0
buffer_load_dwordx4 v215, s[8:11], s42 offen lds
s_waitcnt vmcnt(14)
s_barrier
s_cmp_eq_u32 s98, 2
s_cselect_b32 s41, 14, 10
s_add_u32 s41, s41, s46
s_and_b32 s41, s41, 31
s_mul_i32 s41, s41, 24576
s_add_u32 m0, s47, 49152
s_add_u32 s43, s41, 4096
buffer_load_dwordx4 v216, s[12:15], s41 offen offset:0 sc1 lds
buffer_load_dwordx4 v216, s[12:15], s41 offen offset:1024 sc1 lds
buffer_load_dwordx4 v216, s[12:15], s41 offen offset:2048 sc1 lds
buffer_load_dwordx4 v216, s[12:15], s41 offen offset:3072 sc1 lds
s_add_u32 m0, s47, 53248
s_nop 0
buffer_load_dwordx4 v216, s[12:15], s43 offen offset:0 sc1 lds
buffer_load_dwordx4 v216, s[12:15], s43 offen offset:1024 sc1 lds
s_cmp_eq_u32 s98, 3
s_cselect_b32 s40, 15, 11
s_add_u32 s40, s40, s46
s_and_b32 s40, s40, 31
s_lshl_b32 s40, s40, 7
s_add_u32 s42, s40, 16384
s_add_u32 m0, s48, 49152
s_nop 0
buffer_load_dwordx4 v214, s[8:11], s40 offen lds
s_add_u32 m0, s48, 50176
s_nop 0
buffer_load_dwordx4 v215, s[8:11], s40 offen lds
s_add_u32 m0, s48, 51200
s_nop 0
buffer_load_dwordx4 v214, s[8:11], s42 offen lds
s_add_u32 m0, s48, 52224
s_nop 0
buffer_load_dwordx4 v215, s[8:11], s42 offen lds
s_waitcnt vmcnt(14)
s_barrier
s_cmp_eq_u32 s98, 3
s_cselect_b32 s41, 15, 11
s_add_u32 s41, s41, s46
s_and_b32 s41, s41, 31
s_mul_i32 s41, s41, 24576
s_add_u32 m0, s47, 73728
s_add_u32 s43, s41, 4096
buffer_load_dwordx4 v216, s[12:15], s41 offen offset:0 sc1 lds
buffer_load_dwordx4 v216, s[12:15], s41 offen offset:1024 sc1 lds
buffer_load_dwordx4 v216, s[12:15], s41 offen offset:2048 sc1 lds
buffer_load_dwordx4 v216, s[12:15], s41 offen offset:3072 sc1 lds
s_add_u32 m0, s47, 77824
s_nop 0
buffer_load_dwordx4 v216, s[12:15], s43 offen offset:0 sc1 lds
buffer_load_dwordx4 v216, s[12:15], s43 offen offset:1024 sc1 lds
s_cmp_eq_u32 s98, 0
s_cselect_b32 s40, 16, 12
s_add_u32 s40, s40, s46
s_and_b32 s40, s40, 31
s_lshl_b32 s40, s40, 7
s_add_u32 s42, s40, 16384
s_add_u32 m0, s48, 0
s_nop 0
buffer_load_dwordx4 v214, s[8:11], s40 offen lds
s_add_u32 m0, s48, 1024
s_nop 0
buffer_load_dwordx4 v215, s[8:11], s40 offen lds
s_add_u32 m0, s48, 2048
s_nop 0
buffer_load_dwordx4 v214, s[8:11], s42 offen lds
s_add_u32 m0, s48, 3072
s_nop 0
buffer_load_dwordx4 v215, s[8:11], s42 offen lds
s_waitcnt vmcnt(14)
s_barrier
s_cmp_eq_u32 s98, 0
s_cselect_b32 s41, 16, 12
s_add_u32 s41, s41, s46
s_and_b32 s41, s41, 31
s_mul_i32 s41, s41, 24576
s_add_u32 m0, s47, 0
s_add_u32 s43, s41, 4096
buffer_load_dwordx4 v216, s[12:15], s41 offen offset:0 sc1 lds
buffer_load_dwordx4 v216, s[12:15], s41 offen offset:1024 sc1 lds
buffer_load_dwordx4 v216, s[12:15], s41 offen offset:2048 sc1 lds
buffer_load_dwordx4 v216, s[12:15], s41 offen offset:3072 sc1 lds
s_add_u32 m0, s47, 4096
s_nop 0
buffer_load_dwordx4 v216, s[12:15], s43 offen offset:0 sc1 lds
buffer_load_dwordx4 v216, s[12:15], s43 offen offset:1024 sc1 lds
s_cmp_eq_u32 s98, 1
s_cselect_b32 s40, 17, 13
s_add_u32 s40, s40, s46
s_and_b32 s40, s40, 31
s_lshl_b32 s40, s40, 7
s_add_u32 s42, s40, 16384
s_add_u32 m0, s48, 16384
s_nop 0
buffer_load_dwordx4 v214, s[8:11], s40 offen lds
s_add_u32 m0, s48, 17408
s_nop 0
buffer_load_dwordx4 v215, s[8:11], s40 offen lds
s_add_u32 m0, s48, 18432
s_nop 0
buffer_load_dwordx4 v214, s[8:11], s42 offen lds
s_add_u32 m0, s48, 19456
s_nop 0
buffer_load_dwordx4 v215, s[8:11], s42 offen lds
s_waitcnt vmcnt(14)
s_barrier
s_cmp_eq_u32 s98, 1
s_cselect_b32 s41, 17, 13
s_add_u32 s41, s41, s46
s_and_b32 s41, s41, 31
s_mul_i32 s41, s41, 24576
s_add_u32 m0, s47, 24576
s_add_u32 s43, s41, 4096
buffer_load_dwordx4 v216, s[12:15], s41 offen offset:0 sc1 lds
buffer_load_dwordx4 v216, s[12:15], s41 offen offset:1024 sc1 lds
buffer_load_dwordx4 v216, s[12:15], s41 offen offset:2048 sc1 lds
buffer_load_dwordx4 v216, s[12:15], s41 offen offset:3072 sc1 lds
s_add_u32 m0, s47, 28672
s_nop 0
buffer_load_dwordx4 v216, s[12:15], s43 offen offset:0 sc1 lds
buffer_load_dwordx4 v216, s[12:15], s43 offen offset:1024 sc1 lds
s_cmp_eq_u32 s98, 2
s_cselect_b32 s40, 18, 14
s_add_u32 s40, s40, s46
s_and_b32 s40, s40, 31
s_lshl_b32 s40, s40, 7
s_add_u32 s42, s40, 16384
s_add_u32 m0, s48, 32768
s_nop 0
buffer_load_dwordx4 v214, s[8:11], s40 offen lds
s_add_u32 m0, s48, 33792
s_nop 0
buffer_load_dwordx4 v215, s[8:11], s40 offen lds
s_add_u32 m0, s48, 34816
s_nop 0
buffer_load_dwordx4 v214, s[8:11], s42 offen lds
s_add_u32 m0, s48, 35840
s_nop 0
buffer_load_dwordx4 v215, s[8:11], s42 offen lds
s_waitcnt vmcnt(14)
s_barrier
s_cmp_eq_u32 s98, 2
s_cselect_b32 s41, 18, 14
s_add_u32 s41, s41, s46
s_and_b32 s41, s41, 31
s_mul_i32 s41, s41, 24576
s_add_u32 m0, s47, 49152
s_add_u32 s43, s41, 4096
buffer_load_dwordx4 v216, s[12:15], s41 offen offset:0 sc1 lds
buffer_load_dwordx4 v216, s[12:15], s41 offen offset:1024 sc1 lds
buffer_load_dwordx4 v216, s[12:15], s41 offen offset:2048 sc1 lds
buffer_load_dwordx4 v216, s[12:15], s41 offen offset:3072 sc1 lds
s_add_u32 m0, s47, 53248
s_nop 0
buffer_load_dwordx4 v216, s[12:15], s43 offen offset:0 sc1 lds
buffer_load_dwordx4 v216, s[12:15], s43 offen offset:1024 sc1 lds
s_cmp_eq_u32 s98, 3
s_cselect_b32 s40, 19, 15
s_add_u32 s40, s40, s46
s_and_b32 s40, s40, 31
s_lshl_b32 s40, s40, 7
s_add_u32 s42, s40, 16384
s_add_u32 m0, s48, 49152
s_nop 0
buffer_load_dwordx4 v214, s[8:11], s40 offen lds
s_add_u32 m0, s48, 50176
s_nop 0
buffer_load_dwordx4 v215, s[8:11], s40 offen lds
s_add_u32 m0, s48, 51200
s_nop 0
buffer_load_dwordx4 v214, s[8:11], s42 offen lds
s_add_u32 m0, s48, 52224
s_nop 0
buffer_load_dwordx4 v215, s[8:11], s42 offen lds
s_waitcnt vmcnt(14)
s_barrier
s_cmp_eq_u32 s98, 3
s_cselect_b32 s41, 19, 15
s_add_u32 s41, s41, s46
s_and_b32 s41, s41, 31
s_mul_i32 s41, s41, 24576
s_add_u32 m0, s47, 73728
s_add_u32 s43, s41, 4096
buffer_load_dwordx4 v216, s[12:15], s41 offen offset:0 sc1 lds
buffer_load_dwordx4 v216, s[12:15], s41 offen offset:1024 sc1 lds
buffer_load_dwordx4 v216, s[12:15], s41 offen offset:2048 sc1 lds
buffer_load_dwordx4 v216, s[12:15], s41 offen offset:3072 sc1 lds
s_add_u32 m0, s47, 77824
s_nop 0
buffer_load_dwordx4 v216, s[12:15], s43 offen offset:0 sc1 lds
buffer_load_dwordx4 v216, s[12:15], s43 offen offset:1024 sc1 lds
s_cmp_eq_u32 s98, 0
s_cselect_b32 s40, 20, 16
s_add_u32 s40, s40, s46
s_and_b32 s40, s40, 31
s_lshl_b32 s40, s40, 7
s_add_u32 s42, s40, 16384
s_add_u32 m0, s48, 0
s_nop 0
buffer_load_dwordx4 v214, s[8:11], s40 offen lds
s_add_u32 m0, s48, 1024
s_nop 0
buffer_load_dwordx4 v215, s[8:11], s40 offen lds
s_add_u32 m0, s48, 2048
s_nop 0
buffer_load_dwordx4 v214, s[8:11], s42 offen lds
s_add_u32 m0, s48, 3072
s_nop 0
buffer_load_dwordx4 v215, s[8:11], s42 offen lds
s_waitcnt vmcnt(14)
s_barrier
s_cmp_eq_u32 s98, 0
s_cselect_b32 s41, 20, 16
s_add_u32 s41, s41, s46
s_and_b32 s41, s41, 31
s_mul_i32 s41, s41, 24576
s_add_u32 m0, s47, 0
s_add_u32 s43, s41, 4096
buffer_load_dwordx4 v216, s[12:15], s41 offen offset:0 sc1 lds
buffer_load_dwordx4 v216, s[12:15], s41 offen offset:1024 sc1 lds
buffer_load_dwordx4 v216, s[12:15], s41 offen offset:2048 sc1 lds
buffer_load_dwordx4 v216, s[12:15], s41 offen offset:3072 sc1 lds
s_add_u32 m0, s47, 4096
s_nop 0
buffer_load_dwordx4 v216, s[12:15], s43 offen offset:0 sc1 lds
buffer_load_dwordx4 v216, s[12:15], s43 offen offset:1024 sc1 lds
s_cmp_eq_u32 s98, 1
s_cselect_b32 s40, 21, 17
s_add_u32 s40, s40, s46
s_and_b32 s40, s40, 31
s_lshl_b32 s40, s40, 7
s_add_u32 s42, s40, 16384
s_add_u32 m0, s48, 16384
s_nop 0
buffer_load_dwordx4 v214, s[8:11], s40 offen lds
s_add_u32 m0, s48, 17408
s_nop 0
buffer_load_dwordx4 v215, s[8:11], s40 offen lds
s_add_u32 m0, s48, 18432
s_nop 0
buffer_load_dwordx4 v214, s[8:11], s42 offen lds
s_add_u32 m0, s48, 19456
s_nop 0
buffer_load_dwordx4 v215, s[8:11], s42 offen lds
s_waitcnt vmcnt(14)
s_barrier
s_cmp_eq_u32 s98, 1
s_cselect_b32 s41, 21, 17
s_add_u32 s41, s41, s46
s_and_b32 s41, s41, 31
s_mul_i32 s41, s41, 24576
s_add_u32 m0, s47, 24576
s_add_u32 s43, s41, 4096
buffer_load_dwordx4 v216, s[12:15], s41 offen offset:0 sc1 lds
buffer_load_dwordx4 v216, s[12:15], s41 offen offset:1024 sc1 lds
buffer_load_dwordx4 v216, s[12:15], s41 offen offset:2048 sc1 lds
buffer_load_dwordx4 v216, s[12:15], s41 offen offset:3072 sc1 lds
s_add_u32 m0, s47, 28672
s_nop 0
buffer_load_dwordx4 v216, s[12:15], s43 offen offset:0 sc1 lds
buffer_load_dwordx4 v216, s[12:15], s43 offen offset:1024 sc1 lds
s_cmp_eq_u32 s98, 2
s_cselect_b32 s40, 22, 18
s_add_u32 s40, s40, s46
s_and_b32 s40, s40, 31
s_lshl_b32 s40, s40, 7
s_add_u32 s42, s40, 16384
s_add_u32 m0, s48, 32768
s_nop 0
buffer_load_dwordx4 v214, s[8:11], s40 offen lds
s_add_u32 m0, s48, 33792
s_nop 0
buffer_load_dwordx4 v215, s[8:11], s40 offen lds
s_add_u32 m0, s48, 34816
s_nop 0
buffer_load_dwordx4 v214, s[8:11], s42 offen lds
s_add_u32 m0, s48, 35840
s_nop 0
buffer_load_dwordx4 v215, s[8:11], s42 offen lds
s_waitcnt vmcnt(14)
s_barrier
s_cmp_eq_u32 s98, 2
s_cselect_b32 s41, 22, 18
s_add_u32 s41, s41, s46
s_and_b32 s41, s41, 31
s_mul_i32 s41, s41, 24576
s_add_u32 m0, s47, 49152
s_add_u32 s43, s41, 4096
buffer_load_dwordx4 v216, s[12:15], s41 offen offset:0 sc1 lds
buffer_load_dwordx4 v216, s[12:15], s41 offen offset:1024 sc1 lds
buffer_load_dwordx4 v216, s[12:15], s41 offen offset:2048 sc1 lds
buffer_load_dwordx4 v216, s[12:15], s41 offen offset:3072 sc1 lds
s_add_u32 m0, s47, 53248
s_nop 0
buffer_load_dwordx4 v216, s[12:15], s43 offen offset:0 sc1 lds
buffer_load_dwordx4 v216, s[12:15], s43 offen offset:1024 sc1 lds
s_cmp_eq_u32 s98, 3
s_cselect_b32 s40, 23, 19
s_add_u32 s40, s40, s46
s_and_b32 s40, s40, 31
s_lshl_b32 s40, s40, 7
s_add_u32 s42, s40, 16384
s_add_u32 m0, s48, 49152
s_nop 0
buffer_load_dwordx4 v214, s[8:11], s40 offen lds
s_add_u32 m0, s48, 50176
s_nop 0
buffer_load_dwordx4 v215, s[8:11], s40 offen lds
s_add_u32 m0, s48, 51200
s_nop 0
buffer_load_dwordx4 v214, s[8:11], s42 offen lds
s_add_u32 m0, s48, 52224
s_nop 0
buffer_load_dwordx4 v215, s[8:11], s42 offen lds
s_waitcnt vmcnt(14)
s_barrier
s_cmp_eq_u32 s98, 3
s_cselect_b32 s41, 23, 19
s_add_u32 s41, s41, s46
s_and_b32 s41, s41, 31
s_mul_i32 s41, s41, 24576
s_add_u32 m0, s47, 73728
s_add_u32 s43, s41, 4096
buffer_load_dwordx4 v216, s[12:15], s41 offen offset:0 sc1 lds
buffer_load_dwordx4 v216, s[12:15], s41 offen offset:1024 sc1 lds
buffer_load_dwordx4 v216, s[12:15], s41 offen offset:2048 sc1 lds
buffer_load_dwordx4 v216, s[12:15], s41 offen offset:3072 sc1 lds
s_add_u32 m0, s47, 77824
s_nop 0
buffer_load_dwordx4 v216, s[12:15], s43 offen offset:0 sc1 lds
buffer_load_dwordx4 v216, s[12:15], s43 offen offset:1024 sc1 lds
s_cmp_eq_u32 s98, 0
s_cselect_b32 s40, 24, 20
s_add_u32 s40, s40, s46
s_and_b32 s40, s40, 31
s_lshl_b32 s40, s40, 7
s_add_u32 s42, s40, 16384
s_add_u32 m0, s48, 0
s_nop 0
buffer_load_dwordx4 v214, s[8:11], s40 offen lds
s_add_u32 m0, s48, 1024
s_nop 0
buffer_load_dwordx4 v215, s[8:11], s40 offen lds
s_add_u32 m0, s48, 2048
s_nop 0
buffer_load_dwordx4 v214, s[8:11], s42 offen lds
s_add_u32 m0, s48, 3072
s_nop 0
buffer_load_dwordx4 v215, s[8:11], s42 offen lds
s_waitcnt vmcnt(14)
s_barrier
s_cmp_eq_u32 s98, 0
s_cselect_b32 s41, 24, 20
s_add_u32 s41, s41, s46
s_and_b32 s41, s41, 31
s_mul_i32 s41, s41, 24576
s_add_u32 m0, s47, 0
s_add_u32 s43, s41, 4096
buffer_load_dwordx4 v216, s[12:15], s41 offen offset:0 sc1 lds
buffer_load_dwordx4 v216, s[12:15], s41 offen offset:1024 sc1 lds
buffer_load_dwordx4 v216, s[12:15], s41 offen offset:2048 sc1 lds
buffer_load_dwordx4 v216, s[12:15], s41 offen offset:3072 sc1 lds
s_add_u32 m0, s47, 4096
s_nop 0
buffer_load_dwordx4 v216, s[12:15], s43 offen offset:0 sc1 lds
buffer_load_dwordx4 v216, s[12:15], s43 offen offset:1024 sc1 lds
s_cmp_eq_u32 s98, 1
s_cselect_b32 s40, 25, 21
s_add_u32 s40, s40, s46
s_and_b32 s40, s40, 31
s_lshl_b32 s40, s40, 7
s_add_u32 s42, s40, 16384
s_add_u32 m0, s48, 16384
s_nop 0
buffer_load_dwordx4 v214, s[8:11], s40 offen lds
s_add_u32 m0, s48, 17408
s_nop 0
buffer_load_dwordx4 v215, s[8:11], s40 offen lds
s_add_u32 m0, s48, 18432
s_nop 0
buffer_load_dwordx4 v214, s[8:11], s42 offen lds
s_add_u32 m0, s48, 19456
s_nop 0
buffer_load_dwordx4 v215, s[8:11], s42 offen lds
s_waitcnt vmcnt(14)
s_barrier
s_cmp_eq_u32 s98, 1
s_cselect_b32 s41, 25, 21
s_add_u32 s41, s41, s46
s_and_b32 s41, s41, 31
s_mul_i32 s41, s41, 24576
s_add_u32 m0, s47, 24576
s_add_u32 s43, s41, 4096
buffer_load_dwordx4 v216, s[12:15], s41 offen offset:0 sc1 lds
buffer_load_dwordx4 v216, s[12:15], s41 offen offset:1024 sc1 lds
buffer_load_dwordx4 v216, s[12:15], s41 offen offset:2048 sc1 lds
buffer_load_dwordx4 v216, s[12:15], s41 offen offset:3072 sc1 lds
s_add_u32 m0, s47, 28672
s_nop 0
buffer_load_dwordx4 v216, s[12:15], s43 offen offset:0 sc1 lds
buffer_load_dwordx4 v216, s[12:15], s43 offen offset:1024 sc1 lds
s_cmp_eq_u32 s98, 2
s_cselect_b32 s40, 26, 22
s_add_u32 s40, s40, s46
s_and_b32 s40, s40, 31
s_lshl_b32 s40, s40, 7
s_add_u32 s42, s40, 16384
s_add_u32 m0, s48, 32768
s_nop 0
buffer_load_dwordx4 v214, s[8:11], s40 offen lds
s_add_u32 m0, s48, 33792
s_nop 0
buffer_load_dwordx4 v215, s[8:11], s40 offen lds
s_add_u32 m0, s48, 34816
s_nop 0
buffer_load_dwordx4 v214, s[8:11], s42 offen lds
s_add_u32 m0, s48, 35840
s_nop 0
buffer_load_dwordx4 v215, s[8:11], s42 offen lds
s_waitcnt vmcnt(14)
s_barrier
s_cmp_eq_u32 s98, 2
s_cselect_b32 s41, 26, 22
s_add_u32 s41, s41, s46
s_and_b32 s41, s41, 31
s_mul_i32 s41, s41, 24576
s_add_u32 m0, s47, 49152
s_add_u32 s43, s41, 4096
buffer_load_dwordx4 v216, s[12:15], s41 offen offset:0 sc1 lds
buffer_load_dwordx4 v216, s[12:15], s41 offen offset:1024 sc1 lds
buffer_load_dwordx4 v216, s[12:15], s41 offen offset:2048 sc1 lds
buffer_load_dwordx4 v216, s[12:15], s41 offen offset:3072 sc1 lds
s_add_u32 m0, s47, 53248
s_nop 0
buffer_load_dwordx4 v216, s[12:15], s43 offen offset:0 sc1 lds
buffer_load_dwordx4 v216, s[12:15], s43 offen offset:1024 sc1 lds
s_cmp_eq_u32 s98, 3
s_cselect_b32 s40, 27, 23
s_add_u32 s40, s40, s46
s_and_b32 s40, s40, 31
s_lshl_b32 s40, s40, 7
s_add_u32 s42, s40, 16384
s_add_u32 m0, s48, 49152
s_nop 0
buffer_load_dwordx4 v214, s[8:11], s40 offen lds
s_add_u32 m0, s48, 50176
s_nop 0
buffer_load_dwordx4 v215, s[8:11], s40 offen lds
s_add_u32 m0, s48, 51200
s_nop 0
buffer_load_dwordx4 v214, s[8:11], s42 offen lds
s_add_u32 m0, s48, 52224
s_nop 0
buffer_load_dwordx4 v215, s[8:11], s42 offen lds
s_waitcnt vmcnt(14)
s_barrier
s_cmp_eq_u32 s98, 3
s_cselect_b32 s41, 27, 23
s_add_u32 s41, s41, s46
s_and_b32 s41, s41, 31
s_mul_i32 s41, s41, 24576
s_add_u32 m0, s47, 73728
s_add_u32 s43, s41, 4096
buffer_load_dwordx4 v216, s[12:15], s41 offen offset:0 sc1 lds
buffer_load_dwordx4 v216, s[12:15], s41 offen offset:1024 sc1 lds
buffer_load_dwordx4 v216, s[12:15], s41 offen offset:2048 sc1 lds
buffer_load_dwordx4 v216, s[12:15], s41 offen offset:3072 sc1 lds
s_add_u32 m0, s47, 77824
s_nop 0
buffer_load_dwordx4 v216, s[12:15], s43 offen offset:0 sc1 lds
buffer_load_dwordx4 v216, s[12:15], s43 offen offset:1024 sc1 lds
s_cmp_eq_u32 s98, 0
s_cselect_b32 s40, 28, 24
s_add_u32 s40, s40, s46
s_and_b32 s40, s40, 31
s_lshl_b32 s40, s40, 7
s_add_u32 s42, s40, 16384
s_add_u32 m0, s48, 0
s_nop 0
buffer_load_dwordx4 v214, s[8:11], s40 offen lds
s_add_u32 m0, s48, 1024
s_nop 0
buffer_load_dwordx4 v215, s[8:11], s40 offen lds
s_add_u32 m0, s48, 2048
s_nop 0
buffer_load_dwordx4 v214, s[8:11], s42 offen lds
s_add_u32 m0, s48, 3072
s_nop 0
buffer_load_dwordx4 v215, s[8:11], s42 offen lds
s_waitcnt vmcnt(14)
s_barrier
s_cmp_eq_u32 s98, 0
s_cselect_b32 s41, 28, 24
s_add_u32 s41, s41, s46
s_and_b32 s41, s41, 31
s_mul_i32 s41, s41, 24576
s_add_u32 m0, s47, 0
s_add_u32 s43, s41, 4096
buffer_load_dwordx4 v216, s[12:15], s41 offen offset:0 sc1 lds
buffer_load_dwordx4 v216, s[12:15], s41 offen offset:1024 sc1 lds
buffer_load_dwordx4 v216, s[12:15], s41 offen offset:2048 sc1 lds
buffer_load_dwordx4 v216, s[12:15], s41 offen offset:3072 sc1 lds
s_add_u32 m0, s47, 4096
s_nop 0
buffer_load_dwordx4 v216, s[12:15], s43 offen offset:0 sc1 lds
buffer_load_dwordx4 v216, s[12:15], s43 offen offset:1024 sc1 lds
s_cmp_eq_u32 s98, 1
s_cselect_b32 s40, 29, 25
s_add_u32 s40, s40, s46
s_and_b32 s40, s40, 31
s_lshl_b32 s40, s40, 7
s_add_u32 s42, s40, 16384
s_add_u32 m0, s48, 16384
s_nop 0
buffer_load_dwordx4 v214, s[8:11], s40 offen lds
s_add_u32 m0, s48, 17408
s_nop 0
buffer_load_dwordx4 v215, s[8:11], s40 offen lds
s_add_u32 m0, s48, 18432
s_nop 0
buffer_load_dwordx4 v214, s[8:11], s42 offen lds
s_add_u32 m0, s48, 19456
s_nop 0
buffer_load_dwordx4 v215, s[8:11], s42 offen lds
s_waitcnt vmcnt(14)
s_barrier
s_cmp_eq_u32 s98, 1
s_cselect_b32 s41, 29, 25
s_add_u32 s41, s41, s46
s_and_b32 s41, s41, 31
s_mul_i32 s41, s41, 24576
s_add_u32 m0, s47, 24576
s_add_u32 s43, s41, 4096
buffer_load_dwordx4 v216, s[12:15], s41 offen offset:0 sc1 lds
buffer_load_dwordx4 v216, s[12:15], s41 offen offset:1024 sc1 lds
buffer_load_dwordx4 v216, s[12:15], s41 offen offset:2048 sc1 lds
buffer_load_dwordx4 v216, s[12:15], s41 offen offset:3072 sc1 lds
s_add_u32 m0, s47, 28672
s_nop 0
buffer_load_dwordx4 v216, s[12:15], s43 offen offset:0 sc1 lds
buffer_load_dwordx4 v216, s[12:15], s43 offen offset:1024 sc1 lds
s_cmp_eq_u32 s98, 2
s_cselect_b32 s40, 30, 26
s_add_u32 s40, s40, s46
s_and_b32 s40, s40, 31
s_lshl_b32 s40, s40, 7
s_add_u32 s42, s40, 16384
s_add_u32 m0, s48, 32768
s_nop 0
buffer_load_dwordx4 v214, s[8:11], s40 offen lds
s_add_u32 m0, s48, 33792
s_nop 0
buffer_load_dwordx4 v215, s[8:11], s40 offen lds
s_add_u32 m0, s48, 34816
s_nop 0
buffer_load_dwordx4 v214, s[8:11], s42 offen lds
s_add_u32 m0, s48, 35840
s_nop 0
buffer_load_dwordx4 v215, s[8:11], s42 offen lds
s_waitcnt vmcnt(14)
s_barrier
s_cmp_eq_u32 s98, 2
s_cselect_b32 s41, 30, 26
s_add_u32 s41, s41, s46
s_and_b32 s41, s41, 31
s_mul_i32 s41, s41, 24576
s_add_u32 m0, s47, 49152
s_add_u32 s43, s41, 4096
buffer_load_dwordx4 v216, s[12:15], s41 offen offset:0 sc1 lds
buffer_load_dwordx4 v216, s[12:15], s41 offen offset:1024 sc1 lds
buffer_load_dwordx4 v216, s[12:15], s41 offen offset:2048 sc1 lds
buffer_load_dwordx4 v216, s[12:15], s41 offen offset:3072 sc1 lds
s_add_u32 m0, s47, 53248
s_nop 0
buffer_load_dwordx4 v216, s[12:15], s43 offen offset:0 sc1 lds
buffer_load_dwordx4 v216, s[12:15], s43 offen offset:1024 sc1 lds
s_cmp_eq_u32 s98, 3
s_cselect_b32 s40, 31, 27
s_add_u32 s40, s40, s46
s_and_b32 s40, s40, 31
s_lshl_b32 s40, s40, 7
s_add_u32 s42, s40, 16384
s_add_u32 m0, s48, 49152
s_nop 0
buffer_load_dwordx4 v214, s[8:11], s40 offen lds
s_add_u32 m0, s48, 50176
s_nop 0
buffer_load_dwordx4 v215, s[8:11], s40 offen lds
s_add_u32 m0, s48, 51200
s_nop 0
buffer_load_dwordx4 v214, s[8:11], s42 offen lds
s_add_u32 m0, s48, 52224
s_nop 0
buffer_load_dwordx4 v215, s[8:11], s42 offen lds
s_waitcnt vmcnt(14)
s_barrier
s_mov_b64 exec, 0xff
global_load_dword v243, v245, s[4:5]
s_mov_b64 exec, -1
s_cmp_eq_u32 s98, 3
s_cselect_b32 s41, 31, 27
s_add_u32 s41, s41, s46
s_and_b32 s41, s41, 31
s_mul_i32 s41, s41, 24576
s_add_u32 m0, s47, 73728
s_add_u32 s43, s41, 4096
buffer_load_dwordx4 v216, s[12:15], s41 offen offset:0 sc1 lds
buffer_load_dwordx4 v216, s[12:15], s41 offen offset:1024 sc1 lds
buffer_load_dwordx4 v216, s[12:15], s41 offen offset:2048 sc1 lds
buffer_load_dwordx4 v216, s[12:15], s41 offen offset:3072 sc1 lds
s_add_u32 m0, s47, 77824
s_nop 0
buffer_load_dwordx4 v216, s[12:15], s43 offen offset:0 sc1 lds
buffer_load_dwordx4 v216, s[12:15], s43 offen offset:1024 sc1 lds
s_cmp_eq_u32 s98, 0
s_cselect_b32 s40, 8, 28
s_add_u32 s40, s40, s46
s_and_b32 s40, s40, 31
s_lshl_b32 s40, s40, 7
s_add_u32 s42, s40, 16384
s_add_u32 m0, s48, 0
s_nop 0
buffer_load_dwordx4 v214, s[8:11], s40 offen lds
s_add_u32 m0, s48, 1024
s_nop 0
buffer_load_dwordx4 v215, s[8:11], s40 offen lds
s_add_u32 m0, s48, 2048
s_nop 0
buffer_load_dwordx4 v214, s[8:11], s42 offen lds
s_add_u32 m0, s48, 3072
s_nop 0
buffer_load_dwordx4 v215, s[8:11], s42 offen lds
s_mul_i32 s33, s65, 36
s_add_u32 s33, s33, s50
s_add_u32 s34, s33, 0
buffer_load_dwordx4 v[0:3], v229, s[56:59], s34 offen
s_add_u32 s34, s33, 9216
buffer_load_dwordx4 v[4:7], v229, s[56:59], s34 offen
s_waitcnt vmcnt(17)
s_barrier
s_cmp_eq_u32 s98, 0
s_cselect_b32 s41, 8, 28
s_add_u32 s41, s41, s46
s_and_b32 s41, s41, 31
s_mul_i32 s41, s41, 24576
s_add_u32 m0, s47, 0
s_add_u32 s43, s41, 4096
buffer_load_dwordx4 v216, s[12:15], s41 offen offset:0 sc1 lds
buffer_load_dwordx4 v216, s[12:15], s41 offen offset:1024 sc1 lds
buffer_load_dwordx4 v216, s[12:15], s41 offen offset:2048 sc1 lds
buffer_load_dwordx4 v216, s[12:15], s41 offen offset:3072 sc1 lds
s_add_u32 m0, s47, 4096
s_nop 0
buffer_load_dwordx4 v216, s[12:15], s43 offen offset:0 sc1 lds
buffer_load_dwordx4 v216, s[12:15], s43 offen offset:1024 sc1 lds
s_cmp_eq_u32 s98, 1
s_cselect_b32 s40, 9, 29
s_add_u32 s40, s40, s46
s_and_b32 s40, s40, 31
s_lshl_b32 s40, s40, 7
s_add_u32 s42, s40, 16384
s_add_u32 m0, s48, 16384
s_nop 0
buffer_load_dwordx4 v214, s[8:11], s40 offen lds
s_add_u32 m0, s48, 17408
s_nop 0
buffer_load_dwordx4 v215, s[8:11], s40 offen lds
s_add_u32 m0, s48, 18432
s_nop 0
buffer_load_dwordx4 v214, s[8:11], s42 offen lds
s_add_u32 m0, s48, 19456
s_nop 0
buffer_load_dwordx4 v215, s[8:11], s42 offen lds
s_add_u32 s34, s33, 18432
buffer_load_dwordx4 v[8:11], v229, s[56:59], s34 offen
s_add_u32 s34, s33, 27648
buffer_load_dwordx4 v[12:15], v229, s[56:59], s34 offen
s_waitcnt vmcnt(18)
s_barrier
s_cmp_eq_u32 s98, 1
s_cselect_b32 s41, 9, 29
s_add_u32 s41, s41, s46
s_and_b32 s41, s41, 31
s_mul_i32 s41, s41, 24576
s_add_u32 m0, s47, 24576
s_add_u32 s43, s41, 4096
buffer_load_dwordx4 v216, s[12:15], s41 offen offset:0 sc1 lds
buffer_load_dwordx4 v216, s[12:15], s41 offen offset:1024 sc1 lds
buffer_load_dwordx4 v216, s[12:15], s41 offen offset:2048 sc1 lds
buffer_load_dwordx4 v216, s[12:15], s41 offen offset:3072 sc1 lds
s_add_u32 m0, s47, 28672
s_nop 0
buffer_load_dwordx4 v216, s[12:15], s43 offen offset:0 sc1 lds
buffer_load_dwordx4 v216, s[12:15], s43 offen offset:1024 sc1 lds
s_cmp_eq_u32 s98, 2
s_cselect_b32 s40, 10, 30
s_add_u32 s40, s40, s46
s_and_b32 s40, s40, 31
s_lshl_b32 s40, s40, 7
s_add_u32 s42, s40, 16384
s_add_u32 m0, s48, 32768
s_nop 0
buffer_load_dwordx4 v214, s[8:11], s40 offen lds
s_add_u32 m0, s48, 33792
s_nop 0
buffer_load_dwordx4 v215, s[8:11], s40 offen lds
s_add_u32 m0, s48, 34816
s_nop 0
buffer_load_dwordx4 v214, s[8:11], s42 offen lds
s_add_u32 m0, s48, 35840
s_nop 0
buffer_load_dwordx4 v215, s[8:11], s42 offen lds
s_mul_i32 s33, s66, 36
s_add_u32 s33, s33, s50
s_add_u32 s34, s33, 0
buffer_load_dwordx4 v[16:19], v229, s[56:59], s34 offen
s_add_u32 s34, s33, 9216
buffer_load_dwordx4 v[20:23], v229, s[56:59], s34 offen
s_waitcnt vmcnt(18)
s_barrier
s_cmp_eq_u32 s98, 2
s_cselect_b32 s41, 10, 30
s_add_u32 s41, s41, s46
s_and_b32 s41, s41, 31
s_mul_i32 s41, s41, 24576
s_add_u32 m0, s47, 49152
s_add_u32 s43, s41, 4096
buffer_load_dwordx4 v216, s[12:15], s41 offen offset:0 sc1 lds
buffer_load_dwordx4 v216, s[12:15], s41 offen offset:1024 sc1 lds
buffer_load_dwordx4 v216, s[12:15], s41 offen offset:2048 sc1 lds
buffer_load_dwordx4 v216, s[12:15], s41 offen offset:3072 sc1 lds
s_add_u32 m0, s47, 53248
s_nop 0
buffer_load_dwordx4 v216, s[12:15], s43 offen offset:0 sc1 lds
buffer_load_dwordx4 v216, s[12:15], s43 offen offset:1024 sc1 lds
s_cmp_eq_u32 s98, 3
s_cselect_b32 s40, 11, 31
s_add_u32 s40, s40, s46
s_and_b32 s40, s40, 31
s_lshl_b32 s40, s40, 7
s_add_u32 s42, s40, 16384
s_add_u32 m0, s48, 49152
s_nop 0
buffer_load_dwordx4 v214, s[8:11], s40 offen lds
s_add_u32 m0, s48, 50176
s_nop 0
buffer_load_dwordx4 v215, s[8:11], s40 offen lds
s_add_u32 m0, s48, 51200
s_nop 0
buffer_load_dwordx4 v214, s[8:11], s42 offen lds
s_add_u32 m0, s48, 52224
s_nop 0
buffer_load_dwordx4 v215, s[8:11], s42 offen lds
s_add_u32 s34, s33, 18432
buffer_load_dwordx4 v[24:27], v229, s[56:59], s34 offen
s_add_u32 s34, s33, 27648
buffer_load_dwordx4 v[28:31], v229, s[56:59], s34 offen
s_mul_i32 s33, s67, 36
s_add_u32 s33, s33, s50
s_add_u32 s34, s33, 0
buffer_load_dwordx4 v[32:35], v229, s[56:59], s34 offen
s_add_u32 s34, s33, 9216
buffer_load_dwordx4 v[36:39], v229, s[56:59], s34 offen
s_waitcnt vmcnt(20)
s_barrier
s_cmp_eq_u32 s98, 3
s_cselect_b32 s41, 11, 31
s_add_u32 s41, s41, s46
s_and_b32 s41, s41, 31
s_mul_i32 s41, s41, 24576
s_add_u32 m0, s47, 73728
s_add_u32 s43, s41, 4096
buffer_load_dwordx4 v216, s[12:15], s41 offen offset:0 sc1 lds
buffer_load_dwordx4 v216, s[12:15], s41 offen offset:1024 sc1 lds
buffer_load_dwordx4 v216, s[12:15], s41 offen offset:2048 sc1 lds
buffer_load_dwordx4 v216, s[12:15], s41 offen offset:3072 sc1 lds
s_add_u32 m0, s47, 77824
s_nop 0
buffer_load_dwordx4 v216, s[12:15], s43 offen offset:0 sc1 lds
buffer_load_dwordx4 v216, s[12:15], s43 offen offset:1024 sc1 lds
s_add_u32 s34, s33, 18432
buffer_load_dwordx4 v[40:43], v229, s[56:59], s34 offen
s_add_u32 s34, s33, 27648
buffer_load_dwordx4 v[44:47], v229, s[56:59], s34 offen
s_mul_i32 s33, s68, 36
s_add_u32 s33, s33, s50
s_add_u32 s34, s33, 0
buffer_load_dwordx4 v[48:51], v229, s[56:59], s34 offen
s_add_u32 s34, s33, 9216
buffer_load_dwordx4 v[52:55], v229, s[56:59], s34 offen
s_add_u32 s34, s33, 18432
buffer_load_dwordx4 v[56:59], v229, s[56:59], s34 offen
s_add_u32 s34, s33, 27648
buffer_load_dwordx4 v[60:63], v229, s[56:59], s34 offen
s_waitcnt vmcnt(20)
s_barrier
s_mul_i32 s33, s69, 36
s_add_u32 s33, s33, s50
s_add_u32 s34, s33, 0
buffer_load_dwordx4 v[64:67], v229, s[56:59], s34 offen
s_add_u32 s34, s33, 9216
buffer_load_dwordx4 v[68:71], v229, s[56:59], s34 offen
s_add_u32 s34, s33, 18432
buffer_load_dwordx4 v[72:75], v229, s[56:59], s34 offen
s_add_u32 s34, s33, 27648
buffer_load_dwordx4 v[76:79], v229, s[56:59], s34 offen
s_mul_i32 s33, s70, 36
s_add_u32 s33, s33, s50
s_add_u32 s34, s33, 0
buffer_load_dwordx4 v[80:83], v229, s[56:59], s34 offen
s_add_u32 s34, s33, 9216
buffer_load_dwordx4 v[84:87], v229, s[56:59], s34 offen
s_add_u32 s34, s33, 18432
buffer_load_dwordx4 v[88:91], v229, s[56:59], s34 offen
s_add_u32 s34, s33, 27648
buffer_load_dwordx4 v[92:95], v229, s[56:59], s34 offen
s_waitcnt vmcnt(14)
s_barrier
s_mul_i32 s33, s71, 36
s_add_u32 s33, s33, s50
s_add_u32 s34, s33, 0
buffer_load_dwordx4 v[96:99], v229, s[56:59], s34 offen
s_add_u32 s34, s33, 9216
buffer_load_dwordx4 v[100:103], v229, s[56:59], s34 offen
s_add_u32 s34, s33, 18432
buffer_load_dwordx4 v[104:107], v229, s[56:59], s34 offen
s_add_u32 s34, s33, 27648
buffer_load_dwordx4 v[108:111], v229, s[56:59], s34 offen
s_mul_i32 s33, s72, 36
s_add_u32 s33, s33, s50
s_add_u32 s34, s33, 0
buffer_load_dwordx4 v[112:115], v229, s[56:59], s34 offen
s_add_u32 s34, s33, 9216
buffer_load_dwordx4 v[116:119], v229, s[56:59], s34 offen
s_add_u32 s34, s33, 18432
buffer_load_dwordx4 v[120:123], v229, s[56:59], s34 offen
s_add_u32 s34, s33, 27648
buffer_load_dwordx4 v[124:127], v229, s[56:59], s34 offen
s_setprio 0
s_cmp_ge_u32 s25, 9
s_cbranch_scc1 L_fin
L_p3a:
s_mul_i32 s30, s24, 73728
s_mul_i32 s31, s27, 9216
s_add_u32 s30, s30, s31
v_lshl_add_u32 v224, v255, 4, s30
v_add_u32 v225, 73728, v224
v_add_u32 v226, 147456, v224
v_add_u32 v227, 221184, v224
s_cmp_eq_u32 s28, 5
s_mov_b32 s31, 294912
s_cselect_b32 s31, s31, 0x40000000
v_add_u32 v228, s31, v224
v_lshrrev_b32 v234, 2, v255
v_bfe_u32 v235, v255, 3, 2
v_lshlrev_b32 v235, 5, v235
v_lshl_add_u32 v234, v234, 7, v235
v_and_b32 v235, 3, v255
v_lshl_add_u32 v234, v235, 3, v234
v_add_u32 v230, s26, v234
v_xor_b32 v231, 32, v230
v_xor_b32 v232, 64, v230
v_xor_b32 v233, 96, v230
s_lshr_b32 s36, s24, 2
s_add_u32 s31, s24, s28
s_sub_u32 s31, s31, 1
s_lshr_b32 s31, s31, 2
s_sub_u32 s31, s31, s36
s_mul_i32 s31, s31, 24
v_and_b32 v237, 3, v255
v_min_u32 v237, 2, v237
v_bfe_u32 v238, v255, 2, 1
v_mul_u32_u24 v238, s31, v238
v_add_lshl_u32 v237, v237, v238, 7
v_mov_b32 v238, s64
s_mul_i32 s36, s36, 24
s_mul_i32 s31, s27, 3
s_add_u32 s36, s36, s31
s_lshl_b32 s36, s36, 7
s_add_u32 s36, s36, 1310720
s_mul_i32 s31, s29, 1536
s_add_u32 s37, s36, 1536
s_sub_u32 s37, s37, s31
s_add_u32 s36, s36, s31
v_lshl_add_u32 v234, v255, 4, s26
s_add_u32 s12, s6, 20971520
s_addc_u32 s13, s7, 0
s_and_b32 s13, s13, 0xffff
s_mov_b32 s14, 9437184
s_mov_b32 s15, 0x20000
s_barrier
s_waitcnt vmcnt(28)
ds_write_b128 v234, v[0:3] offset:0
ds_write_b128 v234, v[4:7] offset:1024
ds_write_b128 v234, v[8:11] offset:2048
ds_write_b128 v234, v[12:15] offset:3072
ds_read_b64_tr_b16 v[160:161], v230 offset:0
ds_read_b64_tr_b16 v[162:163], v230 offset:2048
ds_read_b64_tr_b16 v[164:165], v231 offset:0
ds_read_b64_tr_b16 v[166:167], v231 offset:2048
ds_read_b64_tr_b16 v[168:169], v232 offset:0
ds_read_b64_tr_b16 v[170:171], v232 offset:2048
ds_read_b64_tr_b16 v[172:173], v233 offset:0
ds_read_b64_tr_b16 v[174:175], v233 offset:2048
s_waitcnt vmcnt(24)
ds_write_b128 v234, v[16:19] offset:4096
ds_write_b128 v234, v[20:23] offset:5120
ds_write_b128 v234, v[24:27] offset:6144
ds_write_b128 v234, v[28:31] offset:7168
ds_read_b64_tr_b16 v[176:177], v230 offset:4096
ds_read_b64_tr_b16 v[178:179], v230 offset:6144
ds_read_b64_tr_b16 v[180:181], v231 offset:4096
ds_read_b64_tr_b16 v[182:183], v231 offset:6144
ds_read_b64_tr_b16 v[184:185], v232 offset:4096
ds_read_b64_tr_b16 v[186:187], v232 offset:6144
ds_read_b64_tr_b16 v[188:189], v233 offset:4096
ds_read_b64_tr_b16 v[190:191], v233 offset:6144
s_waitcnt vmcnt(20)
ds_write_b128 v234, v[32:35] offset:8192
ds_write_b128 v234, v[36:39] offset:9216
ds_write_b128 v234, v[40:43] offset:10240
ds_write_b128 v234, v[44:47] offset:11264
ds_read_b64_tr_b16 v[192:193], v230 offset:8192
ds_read_b64_tr_b16 v[194:195], v230 offset:10240
ds_read_b64_tr_b16 v[196:197], v231 offset:8192
ds_read_b64_tr_b16 v[198:199], v231 offset:10240
ds_read_b64_tr_b16 v[200:201], v232 offset:8192
ds_read_b64_tr_b16 v[202:203], v232 offset:10240
ds_read_b64_tr_b16 v[204:205], v233 offset:8192
ds_read_b64_tr_b16 v[206:207], v233 offset:10240
s_waitcnt vmcnt(16)
ds_write_b128 v234, v[48:51] offset:12288
ds_write_b128 v234, v[52:55] offset:13312
ds_write_b128 v234, v[56:59] offset:14336
ds_write_b128 v234, v[60:63] offset:15360
ds_read_b64_tr_b16 v[208:209], v230 offset:12288
ds_read_b64_tr_b16 v[210:211], v230 offset:14336
ds_read_b64_tr_b16 v[212:213], v231 offset:12288
ds_read_b64_tr_b16 v[214:215], v231 offset:14336
ds_read_b64_tr_b16 v[216:217], v232 offset:12288
ds_read_b64_tr_b16 v[218:219], v232 offset:14336
ds_read_b64_tr_b16 v[220:221], v233 offset:12288
ds_read_b64_tr_b16 v[222:223], v233 offset:14336
s_waitcnt vmcnt(12)
ds_write_b128 v234, v[64:67] offset:16384
ds_write_b128 v234, v[68:71] offset:17408
ds_write_b128 v234, v[72:75] offset:18432
ds_write_b128 v234, v[76:79] offset:19456
s_waitcnt vmcnt(8)
ds_write_b128 v234, v[80:83] offset:20480
ds_write_b128 v234, v[84:87] offset:21504
ds_write_b128 v234, v[88:91] offset:22528
ds_write_b128 v234, v[92:95] offset:23552
s_waitcnt vmcnt(4)
ds_write_b128 v234, v[96:99] offset:24576
ds_write_b128 v234, v[100:103] offset:25600
ds_write_b128 v234, v[104:107] offset:26624
ds_write_b128 v234, v[108:111] offset:27648
s_waitcnt vmcnt(0)
ds_write_b128 v234, v[112:115] offset:28672
ds_write_b128 v234, v[116:119] offset:29696
ds_write_b128 v234, v[120:123] offset:30720
ds_write_b128 v234, v[124:127] offset:31744
s_waitcnt lgkmcnt(0)
s_barrier
s_add_u32 m0, s26, 0
s_mul_i32 s33, s73, 36
s_add_u32 s33, s33, s50
s_add_u32 s34, s33, 0
buffer_load_dwordx4 v229, s[56:59], s34 offen lds
s_add_u32 m0, s26, 1024
s_add_u32 s34, s33, 9216
buffer_load_dwordx4 v229, s[56:59], s34 offen lds
s_add_u32 m0, s26, 2048
s_add_u32 s34, s33, 18432
buffer_load_dwordx4 v229, s[56:59], s34 offen lds
s_add_u32 m0, s26, 3072
s_add_u32 s34, s33, 27648
buffer_load_dwordx4 v229, s[56:59], s34 offen lds
s_add_u32 m0, s26, 4096
s_mul_i32 s33, s65, 36
s_add_u32 s33, s33, s51
s_add_u32 s34, s33, 0
buffer_load_dwordx4 v229, s[56:59], s34 offen lds
s_add_u32 m0, s26, 5120
s_add_u32 s34, s33, 9216
buffer_load_dwordx4 v229, s[56:59], s34 offen lds
s_waitcnt vmcnt(5)
s_add_u32 m0, s26, 6144
s_add_u32 s34, s33, 18432
buffer_load_dwordx4 v229, s[56:59], s34 offen lds
s_waitcnt vmcnt(5)
s_add_u32 m0, s26, 7168
s_add_u32 s34, s33, 27648
buffer_load_dwordx4 v229, s[56:59], s34 offen lds
s_waitcnt vmcnt(5)
s_add_u32 m0, s26, 8192
s_mul_i32 s33, s66, 36
s_add_u32 s33, s33, s51
s_add_u32 s34, s33, 0
buffer_load_dwordx4 v229, s[56:59], s34 offen lds
s_waitcnt vmcnt(5)
s_add_u32 m0, s26, 9216
s_add_u32 s34, s33, 9216
buffer_load_dwordx4 v229, s[56:59], s34 offen lds
s_waitcnt vmcnt(5)
s_add_u32 m0, s26, 10240
s_add_u32 s34, s33, 18432
buffer_load_dwordx4 v229, s[56:59], s34 offen lds
s_waitcnt vmcnt(5)
s_add_u32 m0, s26, 11264
s_add_u32 s34, s33, 27648
buffer_load_dwordx4 v229, s[56:59], s34 offen lds
s_waitcnt vmcnt(5)
s_add_u32 m0, s26, 12288
s_mul_i32 s33, s67, 36
s_add_u32 s33, s33, s51
s_add_u32 s34, s33, 0
buffer_load_dwordx4 v229, s[56:59], s34 offen lds
s_waitcnt vmcnt(5)
s_add_u32 m0, s26, 13312
s_add_u32 s34, s33, 9216
buffer_load_dwordx4 v229, s[56:59], s34 offen lds
s_waitcnt vmcnt(5)
s_add_u32 m0, s26, 14336
s_add_u32 s34, s33, 18432
buffer_load_dwordx4 v229, s[56:59], s34 offen lds
s_waitcnt vmcnt(5)
s_add_u32 m0, s26, 15360
s_add_u32 s34, s33, 27648
buffer_load_dwordx4 v229, s[56:59], s34 offen lds
s_waitcnt vmcnt(5)
s_mov_b32 s78, 0x20000
s_branch L_ga_hf_1
L_ga_hf_l:
s_sleep 4
L_ga_hf_1:
buffer_load_dword v234, v237, s[20:23], s36 offen sc0 sc1
s_waitcnt vmcnt(0)
v_xor_b32 v234, v234, v238
v_cmp_ne_u32 vcc, 0, v234
s_sub_u32 s78, s78, 1
s_cbranch_scc1 L_ga_hf_o
s_cbranch_vccnz L_ga_hf_l
L_ga_hf_o:
s_add_u32 s32, s52, s65
buffer_load_dwordx4 v[80:83], v224, s[12:15], s32 offen sc1
buffer_load_dwordx4 v[84:87], v225, s[12:15], s32 offen sc1
buffer_load_dwordx4 v[88:91], v226, s[12:15], s32 offen sc1
buffer_load_dwordx4 v[92:95], v227, s[12:15], s32 offen sc1
buffer_load_dwordx4 v[96:99], v228, s[12:15], s32 offen sc1
s_add_u32 s32, s52, s66
buffer_load_dwordx4 v[100:103], v224, s[12:15], s32 offen sc1
buffer_load_dwordx4 v[104:107], v225, s[12:15], s32 offen sc1
buffer_load_dwordx4 v[108:111], v226, s[12:15], s32 offen sc1
buffer_load_dwordx4 v[112:115], v227, s[12:15], s32 offen sc1
buffer_load_dwordx4 v[116:119], v228, s[12:15], s32 offen sc1
s_add_u32 s32, s52, s67
buffer_load_dwordx4 v[120:123], v224, s[12:15], s32 offen sc1
buffer_load_dwordx4 v[124:127], v225, s[12:15], s32 offen sc1
buffer_load_dwordx4 v[128:131], v226, s[12:15], s32 offen sc1
buffer_load_dwordx4 v[132:135], v227, s[12:15], s32 offen sc1
buffer_load_dwordx4 v[136:139], v228, s[12:15], s32 offen sc1
s_waitcnt vmcnt(10) lgkmcnt(0)
v_mfma_f32_16x16x32_bf16 v[0:3], v[160:163], v[80:83], 0
s_add_u32 s32, s52, s68
buffer_load_dwordx4 v[140:143], v224, s[12:15], s32 offen sc1
v_mfma_f32_16x16x32_bf16 v[16:19], v[160:163], v[84:87], 0
v_mfma_f32_16x16x32_bf16 v[32:35], v[160:163], v[88:91], 0
v_mfma_f32_16x16x32_bf16 v[48:51], v[160:163], v[92:95], 0
buffer_load_dwordx4 v[144:147], v225, s[12:15], s32 offen sc1
v_mfma_f32_16x16x32_bf16 v[64:67], v[160:163], v[96:99], 0
v_mfma_f32_16x16x32_bf16 v[4:7], v[164:167], v[80:83], 0
v_mfma_f32_16x16x32_bf16 v[20:23], v[164:167], v[84:87], 0
buffer_load_dwordx4 v[148:151], v226, s[12:15], s32 offen sc1
v_mfma_f32_16x16x32_bf16 v[36:39], v[164:167], v[88:91], 0
v_mfma_f32_16x16x32_bf16 v[52:55], v[164:167], v[92:95], 0
v_mfma_f32_16x16x32_bf16 v[68:71], v[164:167], v[96:99], 0
buffer_load_dwordx4 v[152:155], v227, s[12:15], s32 offen sc1
v_mfma_f32_16x16x32_bf16 v[8:11], v[168:171], v[80:83], 0
v_mfma_f32_16x16x32_bf16 v[24:27], v[168:171], v[84:87], 0
v_mfma_f32_16x16x32_bf16 v[40:43], v[168:171], v[88:91], 0
buffer_load_dwordx4 v[156:159], v228, s[12:15], s32 offen sc1
v_mfma_f32_16x16x32_bf16 v[56:59], v[168:171], v[92:95], 0
v_mfma_f32_16x16x32_bf16 v[72:75], v[168:171], v[96:99], 0
v_mfma_f32_16x16x32_bf16 v[12:15], v[172:175], v[80:83], 0
v_mfma_f32_16x16x32_bf16 v[28:31], v[172:175], v[84:87], 0
v_mfma_f32_16x16x32_bf16 v[44:47], v[172:175], v[88:91], 0
v_mfma_f32_16x16x32_bf16 v[60:63], v[172:175], v[92:95], 0
v_mfma_f32_16x16x32_bf16 v[76:79], v[172:175], v[96:99], 0
s_waitcnt vmcnt(10) lgkmcnt(0)
v_mfma_f32_16x16x32_bf16 v[0:3], v[176:179], v[100:103], v[0:3]
s_add_u32 s32, s52, s69
buffer_load_dwordx4 v[80:83], v224, s[12:15], s32 offen sc1
v_mfma_f32_16x16x32_bf16 v[16:19], v[176:179], v[104:107], v[16:19]
ds_read_b64_tr_b16 v[160:161], v230 offset:16384
v_mfma_f32_16x16x32_bf16 v[32:35], v[176:179], v[108:111], v[32:35]
ds_read_b64_tr_b16 v[162:163], v230 offset:18432
v_mfma_f32_16x16x32_bf16 v[48:51], v[176:179], v[112:115], v[48:51]
buffer_load_dwordx4 v[84:87], v225, s[12:15], s32 offen sc1
v_mfma_f32_16x16x32_bf16 v[64:67], v[176:179], v[116:119], v[64:67]
ds_read_b64_tr_b16 v[164:165], v231 offset:16384
v_mfma_f32_16x16x32_bf16 v[4:7], v[180:183], v[100:103], v[4:7]
ds_read_b64_tr_b16 v[166:167], v231 offset:18432
v_mfma_f32_16x16x32_bf16 v[20:23], v[180:183], v[104:107], v[20:23]
buffer_load_dwordx4 v[88:91], v226, s[12:15], s32 offen sc1
v_mfma_f32_16x16x32_bf16 v[36:39], v[180:183], v[108:111], v[36:39]
ds_read_b64_tr_b16 v[168:169], v232 offset:16384
v_mfma_f32_16x16x32_bf16 v[52:55], v[180:183], v[112:115], v[52:55]
ds_read_b64_tr_b16 v[170:171], v232 offset:18432
v_mfma_f32_16x16x32_bf16 v[68:71], v[180:183], v[116:119], v[68:71]
buffer_load_dwordx4 v[92:95], v227, s[12:15], s32 offen sc1
v_mfma_f32_16x16x32_bf16 v[8:11], v[184:187], v[100:103], v[8:11]
ds_read_b64_tr_b16 v[172:173], v233 offset:16384
v_mfma_f32_16x16x32_bf16 v[24:27], v[184:187], v[104:107], v[24:27]
ds_read_b64_tr_b16 v[174:175], v233 offset:18432
v_mfma_f32_16x16x32_bf16 v[40:43], v[184:187], v[108:111], v[40:43]
buffer_load_dwordx4 v[96:99], v228, s[12:15], s32 offen sc1
v_mfma_f32_16x16x32_bf16 v[56:59], v[184:187], v[112:115], v[56:59]
v_mfma_f32_16x16x32_bf16 v[72:75], v[184:187], v[116:119], v[72:75]
v_mfma_f32_16x16x32_bf16 v[12:15], v[188:191], v[100:103], v[12:15]
v_mfma_f32_16x16x32_bf16 v[28:31], v[188:191], v[104:107], v[28:31]
v_mfma_f32_16x16x32_bf16 v[44:47], v[188:191], v[108:111], v[44:47]
v_mfma_f32_16x16x32_bf16 v[60:63], v[188:191], v[112:115], v[60:63]
v_mfma_f32_16x16x32_bf16 v[76:79], v[188:191], v[116:119], v[76:79]
s_waitcnt vmcnt(10) lgkmcnt(0)
v_mfma_f32_16x16x32_bf16 v[0:3], v[192:195], v[120:123], v[0:3]
s_add_u32 s32, s52, s70
buffer_load_dwordx4 v[100:103], v224, s[12:15], s32 offen sc1
v_mfma_f32_16x16x32_bf16 v[16:19], v[192:195], v[124:127], v[16:19]
ds_read_b64_tr_b16 v[176:177], v230 offset:20480
v_mfma_f32_16x16x32_bf16 v[32:35], v[192:195], v[128:131], v[32:35]
ds_read_b64_tr_b16 v[178:179], v230 offset:22528
v_mfma_f32_16x16x32_bf16 v[48:51], v[192:195], v[132:135], v[48:51]
buffer_load_dwordx4 v[104:107], v225, s[12:15], s32 offen sc1
v_mfma_f32_16x16x32_bf16 v[64:67], v[192:195], v[136:139], v[64:67]
ds_read_b64_tr_b16 v[180:181], v231 offset:20480
v_mfma_f32_16x16x32_bf16 v[4:7], v[196:199], v[120:123], v[4:7]
ds_read_b64_tr_b16 v[182:183], v231 offset:22528
v_mfma_f32_16x16x32_bf16 v[20:23], v[196:199], v[124:127], v[20:23]
buffer_load_dwordx4 v[108:111], v226, s[12:15], s32 offen sc1
v_mfma_f32_16x16x32_bf16 v[36:39], v[196:199], v[128:131], v[36:39]
ds_read_b64_tr_b16 v[184:185], v232 offset:20480
v_mfma_f32_16x16x32_bf16 v[52:55], v[196:199], v[132:135], v[52:55]
ds_read_b64_tr_b16 v[186:187], v232 offset:22528
v_mfma_f32_16x16x32_bf16 v[68:71], v[196:199], v[136:139], v[68:71]
buffer_load_dwordx4 v[112:115], v227, s[12:15], s32 offen sc1
v_mfma_f32_16x16x32_bf16 v[8:11], v[200:203], v[120:123], v[8:11]
ds_read_b64_tr_b16 v[188:189], v233 offset:20480
v_mfma_f32_16x16x32_bf16 v[24:27], v[200:203], v[124:127], v[24:27]
ds_read_b64_tr_b16 v[190:191], v233 offset:22528
v_mfma_f32_16x16x32_bf16 v[40:43], v[200:203], v[128:131], v[40:43]
buffer_load_dwordx4 v[116:119], v228, s[12:15], s32 offen sc1
v_mfma_f32_16x16x32_bf16 v[56:59], v[200:203], v[132:135], v[56:59]
v_mfma_f32_16x16x32_bf16 v[72:75], v[200:203], v[136:139], v[72:75]
v_mfma_f32_16x16x32_bf16 v[12:15], v[204:207], v[120:123], v[12:15]
v_mfma_f32_16x16x32_bf16 v[28:31], v[204:207], v[124:127], v[28:31]
v_mfma_f32_16x16x32_bf16 v[44:47], v[204:207], v[128:131], v[44:47]
v_mfma_f32_16x16x32_bf16 v[60:63], v[204:207], v[132:135], v[60:63]
v_mfma_f32_16x16x32_bf16 v[76:79], v[204:207], v[136:139], v[76:79]
s_waitcnt vmcnt(10) lgkmcnt(0)
v_mfma_f32_16x16x32_bf16 v[0:3], v[208:211], v[140:143], v[0:3]
s_add_u32 s32, s52, s71
buffer_load_dwordx4 v[120:123], v224, s[12:15], s32 offen sc1
v_mfma_f32_16x16x32_bf16 v[16:19], v[208:211], v[144:147], v[16:19]
ds_read_b64_tr_b16 v[192:193], v230 offset:24576
v_mfma_f32_16x16x32_bf16 v[32:35], v[208:211], v[148:151], v[32:35]
ds_read_b64_tr_b16 v[194:195], v230 offset:26624
v_mfma_f32_16x16x32_bf16 v[48:51], v[208:211], v[152:155], v[48:51]
buffer_load_dwordx4 v[124:127], v225, s[12:15], s32 offen sc1
v_mfma_f32_16x16x32_bf16 v[64:67], v[208:211], v[156:159], v[64:67]
ds_read_b64_tr_b16 v[196:197], v231 offset:24576
v_mfma_f32_16x16x32_bf16 v[4:7], v[212:215], v[140:143], v[4:7]
ds_read_b64_tr_b16 v[198:199], v231 offset:26624
v_mfma_f32_16x16x32_bf16 v[20:23], v[212:215], v[144:147], v[20:23]
buffer_load_dwordx4 v[128:131], v226, s[12:15], s32 offen sc1
v_mfma_f32_16x16x32_bf16 v[36:39], v[212:215], v[148:151], v[36:39]
ds_read_b64_tr_b16 v[200:201], v232 offset:24576
v_mfma_f32_16x16x32_bf16 v[52:55], v[212:215], v[152:155], v[52:55]
ds_read_b64_tr_b16 v[202:203], v232 offset:26624
v_mfma_f32_16x16x32_bf16 v[68:71], v[212:215], v[156:159], v[68:71]
buffer_load_dwordx4 v[132:135], v227, s[12:15], s32 offen sc1
v_mfma_f32_16x16x32_bf16 v[8:11], v[216:219], v[140:143], v[8:11]
ds_read_b64_tr_b16 v[204:205], v233 offset:24576
v_mfma_f32_16x16x32_bf16 v[24:27], v[216:219], v[144:147], v[24:27]
ds_read_b64_tr_b16 v[206:207], v233 offset:26624
v_mfma_f32_16x16x32_bf16 v[40:43], v[216:219], v[148:151], v[40:43]
buffer_load_dwordx4 v[136:139], v228, s[12:15], s32 offen sc1
v_mfma_f32_16x16x32_bf16 v[56:59], v[216:219], v[152:155], v[56:59]
v_mfma_f32_16x16x32_bf16 v[72:75], v[216:219], v[156:159], v[72:75]
v_mfma_f32_16x16x32_bf16 v[12:15], v[220:223], v[140:143], v[12:15]
v_mfma_f32_16x16x32_bf16 v[28:31], v[220:223], v[144:147], v[28:31]
v_mfma_f32_16x16x32_bf16 v[44:47], v[220:223], v[148:151], v[44:47]
v_mfma_f32_16x16x32_bf16 v[60:63], v[220:223], v[152:155], v[60:63]
v_mfma_f32_16x16x32_bf16 v[76:79], v[220:223], v[156:159], v[76:79]
s_waitcnt vmcnt(10) lgkmcnt(0)
s_barrier
v_mfma_f32_16x16x32_bf16 v[0:3], v[160:163], v[80:83], v[0:3]
buffer_load_dword v234, v237, s[20:23], s37 offen sc0 sc1
v_mfma_f32_16x16x32_bf16 v[16:19], v[160:163], v[84:87], v[16:19]
ds_read_b64_tr_b16 v[208:209], v230 offset:28672
v_mfma_f32_16x16x32_bf16 v[32:35], v[160:163], v[88:91], v[32:35]
ds_read_b64_tr_b16 v[210:211], v230 offset:30720
v_mfma_f32_16x16x32_bf16 v[48:51], v[160:163], v[92:95], v[48:51]
s_add_u32 s32, s52, s72
buffer_load_dwordx4 v[140:143], v224, s[12:15], s32 offen sc1
v_mfma_f32_16x16x32_bf16 v[64:67], v[160:163], v[96:99], v[64:67]
ds_read_b64_tr_b16 v[212:213], v231 offset:28672
v_mfma_f32_16x16x32_bf16 v[4:7], v[164:167], v[80:83], v[4:7]
ds_read_b64_tr_b16 v[214:215], v231 offset:30720
v_mfma_f32_16x16x32_bf16 v[20:23], v[164:167], v[84:87], v[20:23]
buffer_load_dwordx4 v[144:147], v225, s[12:15], s32 offen sc1
v_mfma_f32_16x16x32_bf16 v[36:39], v[164:167], v[88:91], v[36:39]
ds_read_b64_tr_b16 v[216:217], v232 offset:28672
v_mfma_f32_16x16x32_bf16 v[52:55], v[164:167], v[92:95], v[52:55]
ds_read_b64_tr_b16 v[218:219], v232 offset:30720
v_mfma_f32_16x16x32_bf16 v[68:71], v[164:167], v[96:99], v[68:71]
buffer_load_dwordx4 v[148:151], v226, s[12:15], s32 offen sc1
v_mfma_f32_16x16x32_bf16 v[8:11], v[168:171], v[80:83], v[8:11]
ds_read_b64_tr_b16 v[220:221], v233 offset:28672
v_mfma_f32_16x16x32_bf16 v[24:27], v[168:171], v[84:87], v[24:27]
ds_read_b64_tr_b16 v[222:223], v233 offset:30720
v_mfma_f32_16x16x32_bf16 v[40:43], v[168:171], v[88:91], v[40:43]
buffer_load_dwordx4 v[152:155], v227, s[12:15], s32 offen sc1
v_mfma_f32_16x16x32_bf16 v[56:59], v[168:171], v[92:95], v[56:59]
v_mfma_f32_16x16x32_bf16 v[72:75], v[168:171], v[96:99], v[72:75]
v_mfma_f32_16x16x32_bf16 v[12:15], v[172:175], v[80:83], v[12:15]
buffer_load_dwordx4 v[156:159], v228, s[12:15], s32 offen sc1
v_mfma_f32_16x16x32_bf16 v[28:31], v[172:175], v[84:87], v[28:31]
v_mfma_f32_16x16x32_bf16 v[44:47], v[172:175], v[88:91], v[44:47]
v_mfma_f32_16x16x32_bf16 v[60:63], v[172:175], v[92:95], v[60:63]
v_mfma_f32_16x16x32_bf16 v[76:79], v[172:175], v[96:99], v[76:79]
s_waitcnt vmcnt(11) lgkmcnt(0)
v_mfma_f32_16x16x32_bf16 v[0:3], v[176:179], v[100:103], v[0:3]
s_add_u32 s32, s52, s73
buffer_load_dwordx4 v[80:83], v224, s[12:15], s32 offen sc1
v_mfma_f32_16x16x32_bf16 v[16:19], v[176:179], v[104:107], v[16:19]
ds_read_b64_tr_b16 v[160:161], v230 offset:0
v_mfma_f32_16x16x32_bf16 v[32:35], v[176:179], v[108:111], v[32:35]
ds_read_b64_tr_b16 v[162:163], v230 offset:2048
v_mfma_f32_16x16x32_bf16 v[48:51], v[176:179], v[112:115], v[48:51]
buffer_load_dwordx4 v[84:87], v225, s[12:15], s32 offen sc1
v_mfma_f32_16x16x32_bf16 v[64:67], v[176:179], v[116:119], v[64:67]
ds_read_b64_tr_b16 v[164:165], v231 offset:0
v_mfma_f32_16x16x32_bf16 v[4:7], v[180:183], v[100:103], v[4:7]
ds_read_b64_tr_b16 v[166:167], v231 offset:2048
v_mfma_f32_16x16x32_bf16 v[20:23], v[180:183], v[104:107], v[20:23]
buffer_load_dwordx4 v[88:91], v226, s[12:15], s32 offen sc1
v_mfma_f32_16x16x32_bf16 v[36:39], v[180:183], v[108:111], v[36:39]
ds_read_b64_tr_b16 v[168:169], v232 offset:0
v_mfma_f32_16x16x32_bf16 v[52:55], v[180:183], v[112:115], v[52:55]
ds_read_b64_tr_b16 v[170:171], v232 offset:2048
v_mfma_f32_16x16x32_bf16 v[68:71], v[180:183], v[116:119], v[68:71]
buffer_load_dwordx4 v[92:95], v227, s[12:15], s32 offen sc1
v_mfma_f32_16x16x32_bf16 v[8:11], v[184:187], v[100:103], v[8:11]
ds_read_b64_tr_b16 v[172:173], v233 offset:0
v_mfma_f32_16x16x32_bf16 v[24:27], v[184:187], v[104:107], v[24:27]
ds_read_b64_tr_b16 v[174:175], v233 offset:2048
v_mfma_f32_16x16x32_bf16 v[40:43], v[184:187], v[108:111], v[40:43]
buffer_load_dwordx4 v[96:99], v228, s[12:15], s32 offen sc1
v_mfma_f32_16x16x32_bf16 v[56:59], v[184:187], v[112:115], v[56:59]
v_mfma_f32_16x16x32_bf16 v[72:75], v[184:187], v[116:119], v[72:75]
v_mfma_f32_16x16x32_bf16 v[12:15], v[188:191], v[100:103], v[12:15]
v_mfma_f32_16x16x32_bf16 v[28:31], v[188:191], v[104:107], v[28:31]
v_mfma_f32_16x16x32_bf16 v[44:47], v[188:191], v[108:111], v[44:47]
v_mfma_f32_16x16x32_bf16 v[60:63], v[188:191], v[112:115], v[60:63]
v_mfma_f32_16x16x32_bf16 v[76:79], v[188:191], v[116:119], v[76:79]
s_waitcnt vmcnt(10) lgkmcnt(0)
s_mov_b32 s78, 0x20000
L_ga_f2:
v_cmp_ne_u32 vcc, v234, v238
s_sub_u32 s78, s78, 1
s_cbranch_scc1 L_ga_f2o
s_cbranch_vccz L_ga_f2o
s_sleep 2
buffer_load_dword v234, v237, s[20:23], s37 offen sc0 sc1
s_waitcnt vmcnt(0)
s_branch L_ga_f2
L_ga_f2o:
v_mfma_f32_16x16x32_bf16 v[0:3], v[192:195], v[120:123], v[0:3]
s_add_u32 s32, s53, s65
buffer_load_dwordx4 v[100:103], v224, s[12:15], s32 offen sc1
v_mfma_f32_16x16x32_bf16 v[16:19], v[192:195], v[124:127], v[16:19]
ds_read_b64_tr_b16 v[176:177], v230 offset:4096
v_mfma_f32_16x16x32_bf16 v[32:35], v[192:195], v[128:131], v[32:35]
ds_read_b64_tr_b16 v[178:179], v230 offset:6144
v_mfma_f32_16x16x32_bf16 v[48:51], v[192:195], v[132:135], v[48:51]
buffer_load_dwordx4 v[104:107], v225, s[12:15], s32 offen sc1
v_mfma_f32_16x16x32_bf16 v[64:67], v[192:195], v[136:139], v[64:67]
ds_read_b64_tr_b16 v[180:181], v231 offset:4096
v_mfma_f32_16x16x32_bf16 v[4:7], v[196:199], v[120:123], v[4:7]
ds_read_b64_tr_b16 v[182:183], v231 offset:6144
v_mfma_f32_16x16x32_bf16 v[20:23], v[196:199], v[124:127], v[20:23]
buffer_load_dwordx4 v[108:111], v226, s[12:15], s32 offen sc1
v_mfma_f32_16x16x32_bf16 v[36:39], v[196:199], v[128:131], v[36:39]
ds_read_b64_tr_b16 v[184:185], v232 offset:4096
v_mfma_f32_16x16x32_bf16 v[52:55], v[196:199], v[132:135], v[52:55]
ds_read_b64_tr_b16 v[186:187], v232 offset:6144
v_mfma_f32_16x16x32_bf16 v[68:71], v[196:199], v[136:139], v[68:71]
buffer_load_dwordx4 v[112:115], v227, s[12:15], s32 offen sc1
v_mfma_f32_16x16x32_bf16 v[8:11], v[200:203], v[120:123], v[8:11]
ds_read_b64_tr_b16 v[188:189], v233 offset:4096
v_mfma_f32_16x16x32_bf16 v[24:27], v[200:203], v[124:127], v[24:27]
ds_read_b64_tr_b16 v[190:191], v233 offset:6144
v_mfma_f32_16x16x32_bf16 v[40:43], v[200:203], v[128:131], v[40:43]
buffer_load_dwordx4 v[116:119], v228, s[12:15], s32 offen sc1
v_mfma_f32_16x16x32_bf16 v[56:59], v[200:203], v[132:135], v[56:59]
v_mfma_f32_16x16x32_bf16 v[72:75], v[200:203], v[136:139], v[72:75]
v_mfma_f32_16x16x32_bf16 v[12:15], v[204:207], v[120:123], v[12:15]
v_mfma_f32_16x16x32_bf16 v[28:31], v[204:207], v[124:127], v[28:31]
v_mfma_f32_16x16x32_bf16 v[44:47], v[204:207], v[128:131], v[44:47]
v_mfma_f32_16x16x32_bf16 v[60:63], v[204:207], v[132:135], v[60:63]
v_mfma_f32_16x16x32_bf16 v[76:79], v[204:207], v[136:139], v[76:79]
s_waitcnt vmcnt(10) lgkmcnt(0)
v_mfma_f32_16x16x32_bf16 v[0:3], v[208:211], v[140:143], v[0:3]
s_add_u32 s32, s53, s66
buffer_load_dwordx4 v[120:123], v224, s[12:15], s32 offen sc1
v_mfma_f32_16x16x32_bf16 v[16:19], v[208:211], v[144:147], v[16:19]
ds_read_b64_tr_b16 v[192:193], v230 offset:8192
v_mfma_f32_16x16x32_bf16 v[32:35], v[208:211], v[148:151], v[32:35]
ds_read_b64_tr_b16 v[194:195], v230 offset:10240
v_mfma_f32_16x16x32_bf16 v[48:51], v[208:211], v[152:155], v[48:51]
buffer_load_dwordx4 v[124:127], v225, s[12:15], s32 offen sc1
v_mfma_f32_16x16x32_bf16 v[64:67], v[208:211], v[156:159], v[64:67]
ds_read_b64_tr_b16 v[196:197], v231 offset:8192
v_mfma_f32_16x16x32_bf16 v[4:7], v[212:215], v[140:143], v[4:7]
ds_read_b64_tr_b16 v[198:199], v231 offset:10240
v_mfma_f32_16x16x32_bf16 v[20:23], v[212:215], v[144:147], v[20:23]
buffer_load_dwordx4 v[128:131], v226, s[12:15], s32 offen sc1
v_mfma_f32_16x16x32_bf16 v[36:39], v[212:215], v[148:151], v[36:39]
ds_read_b64_tr_b16 v[200:201], v232 offset:8192
v_mfma_f32_16x16x32_bf16 v[52:55], v[212:215], v[152:155], v[52:55]
ds_read_b64_tr_b16 v[202:203], v232 offset:10240
v_mfma_f32_16x16x32_bf16 v[68:71], v[212:215], v[156:159], v[68:71]
buffer_load_dwordx4 v[132:135], v227, s[12:15], s32 offen sc1
v_mfma_f32_16x16x32_bf16 v[8:11], v[216:219], v[140:143], v[8:11]
ds_read_b64_tr_b16 v[204:205], v233 offset:8192
v_mfma_f32_16x16x32_bf16 v[24:27], v[216:219], v[144:147], v[24:27]
ds_read_b64_tr_b16 v[206:207], v233 offset:10240
v_mfma_f32_16x16x32_bf16 v[40:43], v[216:219], v[148:151], v[40:43]
buffer_load_dwordx4 v[136:139], v228, s[12:15], s32 offen sc1
v_mfma_f32_16x16x32_bf16 v[56:59], v[216:219], v[152:155], v[56:59]
v_mfma_f32_16x16x32_bf16 v[72:75], v[216:219], v[156:159], v[72:75]
v_mfma_f32_16x16x32_bf16 v[12:15], v[220:223], v[140:143], v[12:15]
v_mfma_f32_16x16x32_bf16 v[28:31], v[220:223], v[144:147], v[28:31]
v_mfma_f32_16x16x32_bf16 v[44:47], v[220:223], v[148:151], v[44:47]
v_mfma_f32_16x16x32_bf16 v[60:63], v[220:223], v[152:155], v[60:63]
v_mfma_f32_16x16x32_bf16 v[76:79], v[220:223], v[156:159], v[76:79]
s_waitcnt vmcnt(10) lgkmcnt(0)
s_barrier
v_mfma_f32_16x16x32_bf16 v[0:3], v[160:163], v[80:83], v[0:3]
s_add_u32 s32, s53, s67
buffer_load_dwordx4 v[140:143], v224, s[12:15], s32 offen sc1
v_mfma_f32_16x16x32_bf16 v[16:19], v[160:163], v[84:87], v[16:19]
ds_read_b64_tr_b16 v[208:209], v230 offset:12288
v_mfma_f32_16x16x32_bf16 v[32:35], v[160:163], v[88:91], v[32:35]
ds_read_b64_tr_b16 v[210:211], v230 offset:14336
v_mfma_f32_16x16x32_bf16 v[48:51], v[160:163], v[92:95], v[48:51]
buffer_load_dwordx4 v[144:147], v225, s[12:15], s32 offen sc1
v_mfma_f32_16x16x32_bf16 v[64:67], v[160:163], v[96:99], v[64:67]
ds_read_b64_tr_b16 v[212:213], v231 offset:12288
v_mfma_f32_16x16x32_bf16 v[4:7], v[164:167], v[80:83], v[4:7]
ds_read_b64_tr_b16 v[214:215], v231 offset:14336
v_mfma_f32_16x16x32_bf16 v[20:23], v[164:167], v[84:87], v[20:23]
buffer_load_dwordx4 v[148:151], v226, s[12:15], s32 offen sc1
v_mfma_f32_16x16x32_bf16 v[36:39], v[164:167], v[88:91], v[36:39]
ds_read_b64_tr_b16 v[216:217], v232 offset:12288
v_mfma_f32_16x16x32_bf16 v[52:55], v[164:167], v[92:95], v[52:55]
ds_read_b64_tr_b16 v[218:219], v232 offset:14336
v_mfma_f32_16x16x32_bf16 v[68:71], v[164:167], v[96:99], v[68:71]
buffer_load_dwordx4 v[152:155], v227, s[12:15], s32 offen sc1
v_mfma_f32_16x16x32_bf16 v[8:11], v[168:171], v[80:83], v[8:11]
ds_read_b64_tr_b16 v[220:221], v233 offset:12288
v_mfma_f32_16x16x32_bf16 v[24:27], v[168:171], v[84:87], v[24:27]
ds_read_b64_tr_b16 v[222:223], v233 offset:14336
v_mfma_f32_16x16x32_bf16 v[40:43], v[168:171], v[88:91], v[40:43]
buffer_load_dwordx4 v[156:159], v228, s[12:15], s32 offen sc1
v_mfma_f32_16x16x32_bf16 v[56:59], v[168:171], v[92:95], v[56:59]
v_mfma_f32_16x16x32_bf16 v[72:75], v[168:171], v[96:99], v[72:75]
v_mfma_f32_16x16x32_bf16 v[12:15], v[172:175], v[80:83], v[12:15]
v_mfma_f32_16x16x32_bf16 v[28:31], v[172:175], v[84:87], v[28:31]
v_mfma_f32_16x16x32_bf16 v[44:47], v[172:175], v[88:91], v[44:47]
v_mfma_f32_16x16x32_bf16 v[60:63], v[172:175], v[92:95], v[60:63]
v_mfma_f32_16x16x32_bf16 v[76:79], v[172:175], v[96:99], v[76:79]
s_waitcnt vmcnt(10) lgkmcnt(0)
v_mfma_f32_16x16x32_bf16 v[0:3], v[176:179], v[100:103], v[0:3]
s_add_u32 s32, s53, s68
buffer_load_dwordx4 v[80:83], v224, s[12:15], s32 offen sc1
v_mfma_f32_16x16x32_bf16 v[16:19], v[176:179], v[104:107], v[16:19]
ds_read_b64_tr_b16 v[160:161], v230 offset:16384
v_mfma_f32_16x16x32_bf16 v[32:35], v[176:179], v[108:111], v[32:35]
ds_read_b64_tr_b16 v[162:163], v230 offset:18432
v_mfma_f32_16x16x32_bf16 v[48:51], v[176:179], v[112:115], v[48:51]
buffer_load_dwordx4 v[84:87], v225, s[12:15], s32 offen sc1
v_mfma_f32_16x16x32_bf16 v[64:67], v[176:179], v[116:119], v[64:67]
ds_read_b64_tr_b16 v[164:165], v231 offset:16384
v_mfma_f32_16x16x32_bf16 v[4:7], v[180:183], v[100:103], v[4:7]
ds_read_b64_tr_b16 v[166:167], v231 offset:18432
v_mfma_f32_16x16x32_bf16 v[20:23], v[180:183], v[104:107], v[20:23]
buffer_load_dwordx4 v[88:91], v226, s[12:15], s32 offen sc1
v_mfma_f32_16x16x32_bf16 v[36:39], v[180:183], v[108:111], v[36:39]
ds_read_b64_tr_b16 v[168:169], v232 offset:16384
v_mfma_f32_16x16x32_bf16 v[52:55], v[180:183], v[112:115], v[52:55]
ds_read_b64_tr_b16 v[170:171], v232 offset:18432
v_mfma_f32_16x16x32_bf16 v[68:71], v[180:183], v[116:119], v[68:71]
buffer_load_dwordx4 v[92:95], v227, s[12:15], s32 offen sc1
v_mfma_f32_16x16x32_bf16 v[8:11], v[184:187], v[100:103], v[8:11]
ds_read_b64_tr_b16 v[172:173], v233 offset:16384
v_mfma_f32_16x16x32_bf16 v[24:27], v[184:187], v[104:107], v[24:27]
ds_read_b64_tr_b16 v[174:175], v233 offset:18432
v_mfma_f32_16x16x32_bf16 v[40:43], v[184:187], v[108:111], v[40:43]
buffer_load_dwordx4 v[96:99], v228, s[12:15], s32 offen sc1
v_mfma_f32_16x16x32_bf16 v[56:59], v[184:187], v[112:115], v[56:59]
v_mfma_f32_16x16x32_bf16 v[72:75], v[184:187], v[116:119], v[72:75]
v_mfma_f32_16x16x32_bf16 v[12:15], v[188:191], v[100:103], v[12:15]
v_mfma_f32_16x16x32_bf16 v[28:31], v[188:191], v[104:107], v[28:31]
v_mfma_f32_16x16x32_bf16 v[44:47], v[188:191], v[108:111], v[44:47]
v_mfma_f32_16x16x32_bf16 v[60:63], v[188:191], v[112:115], v[60:63]
v_mfma_f32_16x16x32_bf16 v[76:79], v[188:191], v[116:119], v[76:79]
s_waitcnt vmcnt(10) lgkmcnt(0)
v_mfma_f32_16x16x32_bf16 v[0:3], v[192:195], v[120:123], v[0:3]
s_add_u32 s32, s53, s69
buffer_load_dwordx4 v[100:103], v224, s[12:15], s32 offen sc1
v_mfma_f32_16x16x32_bf16 v[16:19], v[192:195], v[124:127], v[16:19]
ds_read_b64_tr_b16 v[176:177], v230 offset:20480
v_mfma_f32_16x16x32_bf16 v[32:35], v[192:195], v[128:131], v[32:35]
ds_read_b64_tr_b16 v[178:179], v230 offset:22528
v_mfma_f32_16x16x32_bf16 v[48:51], v[192:195], v[132:135], v[48:51]
buffer_load_dwordx4 v[104:107], v225, s[12:15], s32 offen sc1
v_mfma_f32_16x16x32_bf16 v[64:67], v[192:195], v[136:139], v[64:67]
ds_read_b64_tr_b16 v[180:181], v231 offset:20480
v_mfma_f32_16x16x32_bf16 v[4:7], v[196:199], v[120:123], v[4:7]
ds_read_b64_tr_b16 v[182:183], v231 offset:22528
v_mfma_f32_16x16x32_bf16 v[20:23], v[196:199], v[124:127], v[20:23]
buffer_load_dwordx4 v[108:111], v226, s[12:15], s32 offen sc1
v_mfma_f32_16x16x32_bf16 v[36:39], v[196:199], v[128:131], v[36:39]
ds_read_b64_tr_b16 v[184:185], v232 offset:20480
v_mfma_f32_16x16x32_bf16 v[52:55], v[196:199], v[132:135], v[52:55]
ds_read_b64_tr_b16 v[186:187], v232 offset:22528
v_mfma_f32_16x16x32_bf16 v[68:71], v[196:199], v[136:139], v[68:71]
buffer_load_dwordx4 v[112:115], v227, s[12:15], s32 offen sc1
v_mfma_f32_16x16x32_bf16 v[8:11], v[200:203], v[120:123], v[8:11]
ds_read_b64_tr_b16 v[188:189], v233 offset:20480
v_mfma_f32_16x16x32_bf16 v[24:27], v[200:203], v[124:127], v[24:27]
ds_read_b64_tr_b16 v[190:191], v233 offset:22528
v_mfma_f32_16x16x32_bf16 v[40:43], v[200:203], v[128:131], v[40:43]
buffer_load_dwordx4 v[116:119], v228, s[12:15], s32 offen sc1
v_mfma_f32_16x16x32_bf16 v[56:59], v[200:203], v[132:135], v[56:59]
v_mfma_f32_16x16x32_bf16 v[72:75], v[200:203], v[136:139], v[72:75]
v_mfma_f32_16x16x32_bf16 v[12:15], v[204:207], v[120:123], v[12:15]
v_mfma_f32_16x16x32_bf16 v[28:31], v[204:207], v[124:127], v[28:31]
v_mfma_f32_16x16x32_bf16 v[44:47], v[204:207], v[128:131], v[44:47]
v_mfma_f32_16x16x32_bf16 v[60:63], v[204:207], v[132:135], v[60:63]
v_mfma_f32_16x16x32_bf16 v[76:79], v[204:207], v[136:139], v[76:79]
s_waitcnt vmcnt(10) lgkmcnt(0)
v_mfma_f32_16x16x32_bf16 v[0:3], v[208:211], v[140:143], v[0:3]
s_add_u32 s32, s53, s70
buffer_load_dwordx4 v[120:123], v224, s[12:15], s32 offen sc1
v_mfma_f32_16x16x32_bf16 v[16:19], v[208:211], v[144:147], v[16:19]
ds_read_b64_tr_b16 v[192:193], v230 offset:24576
v_mfma_f32_16x16x32_bf16 v[32:35], v[208:211], v[148:151], v[32:35]
ds_read_b64_tr_b16 v[194:195], v230 offset:26624
v_mfma_f32_16x16x32_bf16 v[48:51], v[208:211], v[152:155], v[48:51]
buffer_load_dwordx4 v[124:127], v225, s[12:15], s32 offen sc1
v_mfma_f32_16x16x32_bf16 v[64:67], v[208:211], v[156:159], v[64:67]
ds_read_b64_tr_b16 v[196:197], v231 offset:24576
v_mfma_f32_16x16x32_bf16 v[4:7], v[212:215], v[140:143], v[4:7]
ds_read_b64_tr_b16 v[198:199], v231 offset:26624
v_mfma_f32_16x16x32_bf16 v[20:23], v[212:215], v[144:147], v[20:23]
buffer_load_dwordx4 v[128:131], v226, s[12:15], s32 offen sc1
v_mfma_f32_16x16x32_bf16 v[36:39], v[212:215], v[148:151], v[36:39]
ds_read_b64_tr_b16 v[200:201], v232 offset:24576
v_mfma_f32_16x16x32_bf16 v[52:55], v[212:215], v[152:155], v[52:55]
ds_read_b64_tr_b16 v[202:203], v232 offset:26624
v_mfma_f32_16x16x32_bf16 v[68:71], v[212:215], v[156:159], v[68:71]
buffer_load_dwordx4 v[132:135], v227, s[12:15], s32 offen sc1
v_mfma_f32_16x16x32_bf16 v[8:11], v[216:219], v[140:143], v[8:11]
ds_read_b64_tr_b16 v[204:205], v233 offset:24576
v_mfma_f32_16x16x32_bf16 v[24:27], v[216:219], v[144:147], v[24:27]
ds_read_b64_tr_b16 v[206:207], v233 offset:26624
v_mfma_f32_16x16x32_bf16 v[40:43], v[216:219], v[148:151], v[40:43]
buffer_load_dwordx4 v[136:139], v228, s[12:15], s32 offen sc1
v_mfma_f32_16x16x32_bf16 v[56:59], v[216:219], v[152:155], v[56:59]
v_mfma_f32_16x16x32_bf16 v[72:75], v[216:219], v[156:159], v[72:75]
v_mfma_f32_16x16x32_bf16 v[12:15], v[220:223], v[140:143], v[12:15]
v_mfma_f32_16x16x32_bf16 v[28:31], v[220:223], v[144:147], v[28:31]
v_mfma_f32_16x16x32_bf16 v[44:47], v[220:223], v[148:151], v[44:47]
v_mfma_f32_16x16x32_bf16 v[60:63], v[220:223], v[152:155], v[60:63]
v_mfma_f32_16x16x32_bf16 v[76:79], v[220:223], v[156:159], v[76:79]
s_waitcnt vmcnt(10) lgkmcnt(0)
s_barrier
v_mfma_f32_16x16x32_bf16 v[0:3], v[160:163], v[80:83], v[0:3]
s_add_u32 s32, s53, s71
buffer_load_dwordx4 v[140:143], v224, s[12:15], s32 offen sc1
v_mfma_f32_16x16x32_bf16 v[16:19], v[160:163], v[84:87], v[16:19]
ds_read_b64_tr_b16 v[208:209], v230 offset:28672
v_mfma_f32_16x16x32_bf16 v[32:35], v[160:163], v[88:91], v[32:35]
ds_read_b64_tr_b16 v[210:211], v230 offset:30720
v_mfma_f32_16x16x32_bf16 v[48:51], v[160:163], v[92:95], v[48:51]
buffer_load_dwordx4 v[144:147], v225, s[12:15], s32 offen sc1
v_mfma_f32_16x16x32_bf16 v[64:67], v[160:163], v[96:99], v[64:67]
ds_read_b64_tr_b16 v[212:213], v231 offset:28672
v_mfma_f32_16x16x32_bf16 v[4:7], v[164:167], v[80:83], v[4:7]
ds_read_b64_tr_b16 v[214:215], v231 offset:30720
v_mfma_f32_16x16x32_bf16 v[20:23], v[164:167], v[84:87], v[20:23]
buffer_load_dwordx4 v[148:151], v226, s[12:15], s32 offen sc1
v_mfma_f32_16x16x32_bf16 v[36:39], v[164:167], v[88:91], v[36:39]
ds_read_b64_tr_b16 v[216:217], v232 offset:28672
v_mfma_f32_16x16x32_bf16 v[52:55], v[164:167], v[92:95], v[52:55]
ds_read_b64_tr_b16 v[218:219], v232 offset:30720
v_mfma_f32_16x16x32_bf16 v[68:71], v[164:167], v[96:99], v[68:71]
buffer_load_dwordx4 v[152:155], v227, s[12:15], s32 offen sc1
v_mfma_f32_16x16x32_bf16 v[8:11], v[168:171], v[80:83], v[8:11]
ds_read_b64_tr_b16 v[220:221], v233 offset:28672
v_mfma_f32_16x16x32_bf16 v[24:27], v[168:171], v[84:87], v[24:27]
ds_read_b64_tr_b16 v[222:223], v233 offset:30720
v_mfma_f32_16x16x32_bf16 v[40:43], v[168:171], v[88:91], v[40:43]
buffer_load_dwordx4 v[156:159], v228, s[12:15], s32 offen sc1
v_mfma_f32_16x16x32_bf16 v[56:59], v[168:171], v[92:95], v[56:59]
v_mfma_f32_16x16x32_bf16 v[72:75], v[168:171], v[96:99], v[72:75]
v_mfma_f32_16x16x32_bf16 v[12:15], v[172:175], v[80:83], v[12:15]
v_mfma_f32_16x16x32_bf16 v[28:31], v[172:175], v[84:87], v[28:31]
v_mfma_f32_16x16x32_bf16 v[44:47], v[172:175], v[88:91], v[44:47]
v_mfma_f32_16x16x32_bf16 v[60:63], v[172:175], v[92:95], v[60:63]
v_mfma_f32_16x16x32_bf16 v[76:79], v[172:175], v[96:99], v[76:79]
s_waitcnt vmcnt(10) lgkmcnt(0)
v_mfma_f32_16x16x32_bf16 v[0:3], v[176:179], v[100:103], v[0:3]
s_add_u32 s32, s53, s72
buffer_load_dwordx4 v[80:83], v224, s[12:15], s32 offen sc1
v_mfma_f32_16x16x32_bf16 v[16:19], v[176:179], v[104:107], v[16:19]
ds_read_b64_tr_b16 v[160:161], v230 offset:0
v_mfma_f32_16x16x32_bf16 v[32:35], v[176:179], v[108:111], v[32:35]
ds_read_b64_tr_b16 v[162:163], v230 offset:2048
v_mfma_f32_16x16x32_bf16 v[48:51], v[176:179], v[112:115], v[48:51]
buffer_load_dwordx4 v[84:87], v225, s[12:15], s32 offen sc1
v_mfma_f32_16x16x32_bf16 v[64:67], v[176:179], v[116:119], v[64:67]
ds_read_b64_tr_b16 v[164:165], v231 offset:0
v_mfma_f32_16x16x32_bf16 v[4:7], v[180:183], v[100:103], v[4:7]
ds_read_b64_tr_b16 v[166:167], v231 offset:2048
v_mfma_f32_16x16x32_bf16 v[20:23], v[180:183], v[104:107], v[20:23]
buffer_load_dwordx4 v[88:91], v226, s[12:15], s32 offen sc1
v_mfma_f32_16x16x32_bf16 v[36:39], v[180:183], v[108:111], v[36:39]
ds_read_b64_tr_b16 v[168:169], v232 offset:0
v_mfma_f32_16x16x32_bf16 v[52:55], v[180:183], v[112:115], v[52:55]
ds_read_b64_tr_b16 v[170:171], v232 offset:2048
v_mfma_f32_16x16x32_bf16 v[68:71], v[180:183], v[116:119], v[68:71]
buffer_load_dwordx4 v[92:95], v227, s[12:15], s32 offen sc1
v_mfma_f32_16x16x32_bf16 v[8:11], v[184:187], v[100:103], v[8:11]
ds_read_b64_tr_b16 v[172:173], v233 offset:0
v_mfma_f32_16x16x32_bf16 v[24:27], v[184:187], v[104:107], v[24:27]
ds_read_b64_tr_b16 v[174:175], v233 offset:2048
v_mfma_f32_16x16x32_bf16 v[40:43], v[184:187], v[108:111], v[40:43]
buffer_load_dwordx4 v[96:99], v228, s[12:15], s32 offen sc1
v_mfma_f32_16x16x32_bf16 v[56:59], v[184:187], v[112:115], v[56:59]
v_mfma_f32_16x16x32_bf16 v[72:75], v[184:187], v[116:119], v[72:75]
v_mfma_f32_16x16x32_bf16 v[12:15], v[188:191], v[100:103], v[12:15]
v_mfma_f32_16x16x32_bf16 v[28:31], v[188:191], v[104:107], v[28:31]
v_mfma_f32_16x16x32_bf16 v[44:47], v[188:191], v[108:111], v[44:47]
v_mfma_f32_16x16x32_bf16 v[60:63], v[188:191], v[112:115], v[60:63]
v_mfma_f32_16x16x32_bf16 v[76:79], v[188:191], v[116:119], v[76:79]
s_waitcnt vmcnt(10) lgkmcnt(0)
v_mfma_f32_16x16x32_bf16 v[0:3], v[192:195], v[120:123], v[0:3]
s_add_u32 s32, s53, s73
buffer_load_dwordx4 v[100:103], v224, s[12:15], s32 offen sc1
v_mfma_f32_16x16x32_bf16 v[16:19], v[192:195], v[124:127], v[16:19]
ds_read_b64_tr_b16 v[176:177], v230 offset:4096
v_mfma_f32_16x16x32_bf16 v[32:35], v[192:195], v[128:131], v[32:35]
ds_read_b64_tr_b16 v[178:179], v230 offset:6144
v_mfma_f32_16x16x32_bf16 v[48:51], v[192:195], v[132:135], v[48:51]
buffer_load_dwordx4 v[104:107], v225, s[12:15], s32 offen sc1
v_mfma_f32_16x16x32_bf16 v[64:67], v[192:195], v[136:139], v[64:67]
ds_read_b64_tr_b16 v[180:181], v231 offset:4096
v_mfma_f32_16x16x32_bf16 v[4:7], v[196:199], v[120:123], v[4:7]
ds_read_b64_tr_b16 v[182:183], v231 offset:6144
v_mfma_f32_16x16x32_bf16 v[20:23], v[196:199], v[124:127], v[20:23]
buffer_load_dwordx4 v[108:111], v226, s[12:15], s32 offen sc1
v_mfma_f32_16x16x32_bf16 v[36:39], v[196:199], v[128:131], v[36:39]
ds_read_b64_tr_b16 v[184:185], v232 offset:4096
v_mfma_f32_16x16x32_bf16 v[52:55], v[196:199], v[132:135], v[52:55]
ds_read_b64_tr_b16 v[186:187], v232 offset:6144
v_mfma_f32_16x16x32_bf16 v[68:71], v[196:199], v[136:139], v[68:71]
buffer_load_dwordx4 v[112:115], v227, s[12:15], s32 offen sc1
v_mfma_f32_16x16x32_bf16 v[8:11], v[200:203], v[120:123], v[8:11]
ds_read_b64_tr_b16 v[188:189], v233 offset:4096
v_mfma_f32_16x16x32_bf16 v[24:27], v[200:203], v[124:127], v[24:27]
ds_read_b64_tr_b16 v[190:191], v233 offset:6144
v_mfma_f32_16x16x32_bf16 v[40:43], v[200:203], v[128:131], v[40:43]
buffer_load_dwordx4 v[116:119], v228, s[12:15], s32 offen sc1
v_mfma_f32_16x16x32_bf16 v[56:59], v[200:203], v[132:135], v[56:59]
v_mfma_f32_16x16x32_bf16 v[72:75], v[200:203], v[136:139], v[72:75]
v_mfma_f32_16x16x32_bf16 v[12:15], v[204:207], v[120:123], v[12:15]
v_mfma_f32_16x16x32_bf16 v[28:31], v[204:207], v[124:127], v[28:31]
v_mfma_f32_16x16x32_bf16 v[44:47], v[204:207], v[128:131], v[44:47]
v_mfma_f32_16x16x32_bf16 v[60:63], v[204:207], v[132:135], v[60:63]
v_mfma_f32_16x16x32_bf16 v[76:79], v[204:207], v[136:139], v[76:79]
s_waitcnt vmcnt(10) lgkmcnt(0)
v_mfma_f32_16x16x32_bf16 v[0:3], v[208:211], v[140:143], v[0:3]
v_mfma_f32_16x16x32_bf16 v[16:19], v[208:211], v[144:147], v[16:19]
v_mfma_f32_16x16x32_bf16 v[32:35], v[208:211], v[148:151], v[32:35]
v_mfma_f32_16x16x32_bf16 v[48:51], v[208:211], v[152:155], v[48:51]
v_mfma_f32_16x16x32_bf16 v[64:67], v[208:211], v[156:159], v[64:67]
v_mfma_f32_16x16x32_bf16 v[4:7], v[212:215], v[140:143], v[4:7]
v_mfma_f32_16x16x32_bf16 v[20:23], v[212:215], v[144:147], v[20:23]
v_mfma_f32_16x16x32_bf16 v[36:39], v[212:215], v[148:151], v[36:39]
v_mfma_f32_16x16x32_bf16 v[52:55], v[212:215], v[152:155], v[52:55]
v_mfma_f32_16x16x32_bf16 v[68:71], v[212:215], v[156:159], v[68:71]
v_mfma_f32_16x16x32_bf16 v[8:11], v[216:219], v[140:143], v[8:11]
v_mfma_f32_16x16x32_bf16 v[24:27], v[216:219], v[144:147], v[24:27]
v_mfma_f32_16x16x32_bf16 v[40:43], v[216:219], v[148:151], v[40:43]
v_mfma_f32_16x16x32_bf16 v[56:59], v[216:219], v[152:155], v[56:59]
v_mfma_f32_16x16x32_bf16 v[72:75], v[216:219], v[156:159], v[72:75]
v_mfma_f32_16x16x32_bf16 v[12:15], v[220:223], v[140:143], v[12:15]
v_mfma_f32_16x16x32_bf16 v[28:31], v[220:223], v[144:147], v[28:31]
v_mfma_f32_16x16x32_bf16 v[44:47], v[220:223], v[148:151], v[44:47]
v_mfma_f32_16x16x32_bf16 v[60:63], v[220:223], v[152:155], v[60:63]
v_mfma_f32_16x16x32_bf16 v[76:79], v[220:223], v[156:159], v[76:79]
s_waitcnt vmcnt(5) lgkmcnt(0)
v_mfma_f32_16x16x32_bf16 v[0:3], v[160:163], v[80:83], v[0:3]
v_mfma_f32_16x16x32_bf16 v[16:19], v[160:163], v[84:87], v[16:19]
v_mfma_f32_16x16x32_bf16 v[32:35], v[160:163], v[88:91], v[32:35]
v_mfma_f32_16x16x32_bf16 v[48:51], v[160:163], v[92:95], v[48:51]
v_mfma_f32_16x16x32_bf16 v[64:67], v[160:163], v[96:99], v[64:67]
v_mfma_f32_16x16x32_bf16 v[4:7], v[164:167], v[80:83], v[4:7]
v_mfma_f32_16x16x32_bf16 v[20:23], v[164:167], v[84:87], v[20:23]
v_mfma_f32_16x16x32_bf16 v[36:39], v[164:167], v[88:91], v[36:39]
v_mfma_f32_16x16x32_bf16 v[52:55], v[164:167], v[92:95], v[52:55]
v_mfma_f32_16x16x32_bf16 v[68:71], v[164:167], v[96:99], v[68:71]
v_mfma_f32_16x16x32_bf16 v[8:11], v[168:171], v[80:83], v[8:11]
v_mfma_f32_16x16x32_bf16 v[24:27], v[168:171], v[84:87], v[24:27]
v_mfma_f32_16x16x32_bf16 v[40:43], v[168:171], v[88:91], v[40:43]
v_mfma_f32_16x16x32_bf16 v[56:59], v[168:171], v[92:95], v[56:59]
v_mfma_f32_16x16x32_bf16 v[72:75], v[168:171], v[96:99], v[72:75]
v_mfma_f32_16x16x32_bf16 v[12:15], v[172:175], v[80:83], v[12:15]
v_mfma_f32_16x16x32_bf16 v[28:31], v[172:175], v[84:87], v[28:31]
v_mfma_f32_16x16x32_bf16 v[44:47], v[172:175], v[88:91], v[44:47]
v_mfma_f32_16x16x32_bf16 v[60:63], v[172:175], v[92:95], v[60:63]
v_mfma_f32_16x16x32_bf16 v[76:79], v[172:175], v[96:99], v[76:79]
s_waitcnt vmcnt(0) lgkmcnt(0)
v_mfma_f32_16x16x32_bf16 v[0:3], v[176:179], v[100:103], v[0:3]
v_mfma_f32_16x16x32_bf16 v[16:19], v[176:179], v[104:107], v[16:19]
v_mfma_f32_16x16x32_bf16 v[32:35], v[176:179], v[108:111], v[32:35]
v_mfma_f32_16x16x32_bf16 v[48:51], v[176:179], v[112:115], v[48:51]
v_mfma_f32_16x16x32_bf16 v[64:67], v[176:179], v[116:119], v[64:67]
v_mfma_f32_16x16x32_bf16 v[4:7], v[180:183], v[100:103], v[4:7]
v_mfma_f32_16x16x32_bf16 v[20:23], v[180:183], v[104:107], v[20:23]
v_mfma_f32_16x16x32_bf16 v[36:39], v[180:183], v[108:111], v[36:39]
v_mfma_f32_16x16x32_bf16 v[52:55], v[180:183], v[112:115], v[52:55]
v_mfma_f32_16x16x32_bf16 v[68:71], v[180:183], v[116:119], v[68:71]
v_mfma_f32_16x16x32_bf16 v[8:11], v[184:187], v[100:103], v[8:11]
v_mfma_f32_16x16x32_bf16 v[24:27], v[184:187], v[104:107], v[24:27]
v_mfma_f32_16x16x32_bf16 v[40:43], v[184:187], v[108:111], v[40:43]
v_mfma_f32_16x16x32_bf16 v[56:59], v[184:187], v[112:115], v[56:59]
v_mfma_f32_16x16x32_bf16 v[72:75], v[184:187], v[116:119], v[72:75]
v_mfma_f32_16x16x32_bf16 v[12:15], v[188:191], v[100:103], v[12:15]
v_mfma_f32_16x16x32_bf16 v[28:31], v[188:191], v[104:107], v[28:31]
v_mfma_f32_16x16x32_bf16 v[44:47], v[188:191], v[108:111], v[44:47]
v_mfma_f32_16x16x32_bf16 v[60:63], v[188:191], v[112:115], v[60:63]
v_mfma_f32_16x16x32_bf16 v[76:79], v[188:191], v[116:119], v[76:79]
v_and_b32 v234, 15, v255
v_lshrrev_b32 v235, 4, v255
v_mul_u32_u24 v234, 272, v234
v_lshl_add_u32 v234, v235, 4, v234
v_add_u32 v234, s26, v234
s_nop 3
ds_write_b128 v234, v[0:3] offset:0
ds_write_b128 v234, v[16:19] offset:4352
ds_write_b128 v234, v[32:35] offset:8704
ds_write_b128 v234, v[48:51] offset:13056
ds_write_b128 v234, v[64:67] offset:17408
ds_write_b128 v234, v[4:7] offset:64
ds_write_b128 v234, v[20:23] offset:4416
ds_write_b128 v234, v[36:39] offset:8768
ds_write_b128 v234, v[52:55] offset:13120
ds_write_b128 v234, v[68:71] offset:17472
ds_write_b128 v234, v[8:11] offset:128
ds_write_b128 v234, v[24:27] offset:4480
ds_write_b128 v234, v[40:43] offset:8832
ds_write_b128 v234, v[56:59] offset:13184
ds_write_b128 v234, v[72:75] offset:17536
ds_write_b128 v234, v[12:15] offset:192
ds_write_b128 v234, v[28:31] offset:4544
ds_write_b128 v234, v[44:47] offset:8896
ds_write_b128 v234, v[60:63] offset:13248
ds_write_b128 v234, v[76:79] offset:17600
s_waitcnt lgkmcnt(0)
s_barrier
s_branch L_fin
L_help:
s_load_dwordx2 s[80:81], s[0:1], 32
s_load_dwordx2 s[84:85], s[0:1], 80
s_load_dwordx2 s[86:87], s[0:1], 40
s_lshl_b32 s29, s16, 3
s_add_u32 s29, s29, s17
s_and_b32 s26, s16, 1
s_lshl_b32 s25, s17, 2
s_lshr_b32 s30, s16, 1
s_add_u32 s25, s25, s30
v_lshrrev_b32 v1, 3, v255
v_and_b32 v2, 7, v255
s_memrealtime s[76:77]
s_waitcnt lgkmcnt(0)
s_mov_b32 s8, s52
s_and_b32 s9, s53, 0xffff
s_mov_b32 s10, 2359296
s_mov_b32 s11, 0x20000
s_mov_b32 s12, s60
s_and_b32 s13, s61, 0xffff
s_mov_b32 s14, 5308416
s_mov_b32 s15, 0x20000
s_mov_b32 s6, s66
s_mov_b32 s7, s67
s_mov_b32 s82, s62
s_mov_b32 s83, s63
s_mov_b32 s68, s64
s_and_b32 s69, s65, 0xffff
s_mov_b32 s70, 256
s_mov_b32 s71, 0x20000
s_or_b32 s30, s29, s49
s_cmp_lg_u32 s30, 0
s_cbranch_scc1 L_hn
s_or_b32 s76, s76, 1
v_mov_b32 v4, s76
v_mov_b32 v5, 0
s_mov_b64 exec, 1
buffer_atomic_cmpswap v[4:5], off, s[68:71], 0 sc1
s_mov_b64 exec, -1
L_hn:
s_cmp_ge_u32 s25, 18
s_cbranch_scc1 L_hst
s_mul_i32 s28, s26, 18
s_add_u32 s28, s28, s25
s_add_u32 s28, s28, 36
s_mul_i32 s30, s49, 73728
s_lshl_b32 s31, s28, 7
s_add_u32 s30, s30, s31
v_mul_u32_u24 v4, 9216, v1
v_lshl_add_u32 v4, v2, 4, v4
buffer_load_dwordx4 v[16:19], v4, s[12:15], s30 offen
s_add_u32 s30, s30, 589824
buffer_load_dwordx4 v[20:23], v4, s[12:15], s30 offen
s_add_u32 s30, s30, 589824
buffer_load_dwordx4 v[24:27], v4, s[12:15], s30 offen
s_add_u32 s30, s30, 589824
buffer_load_dwordx4 v[28:31], v4, s[12:15], s30 offen
s_add_u32 s30, s30, 589824
buffer_load_dwordx4 v[32:35], v4, s[12:15], s30 offen
s_add_u32 s30, s30, 589824
buffer_load_dwordx4 v[36:39], v4, s[12:15], s30 offen
s_add_u32 s30, s30, 589824
buffer_load_dwordx4 v[40:43], v4, s[12:15], s30 offen
s_add_u32 s30, s30, 589824
buffer_load_dwordx4 v[44:47], v4, s[12:15], s30 offen
s_add_u32 s30, s30, 589824
buffer_load_dwordx4 v[48:51], v4, s[12:15], s30 offen
s_add_u32 s30, s30, 589824
s_add_u32 s20, s6, 41943040
s_addc_u32 s21, s7, 0
s_and_b32 s21, s21, 0xffff
s_mov_b32 s22, 1409024
s_mov_b32 s23, 0x20000
buffer_load_dword v7, off, s[68:71], 0 sc1
s_mov_b32 s50, 0x3f80
s_mov_b32 s51, 0x3f800000
v_mov_b32 v8, 0
v_mov_b32 v9, 0
v_mov_b32 v10, 0
v_mov_b32 v11, 0
v_mov_b32 v12, 0
v_mov_b32 v13, 0
v_mov_b32 v14, 0
v_mov_b32 v15, 0
s_waitcnt vmcnt(7)
v_dot2_f32_bf16 v8, v16, s50, v8
v_dot2_f32_bf16 v9, v16, s51, v9
v_dot2_f32_bf16 v10, v17, s50, v10
v_dot2_f32_bf16 v11, v17, s51, v11
v_dot2_f32_bf16 v12, v18, s50, v12
v_dot2_f32_bf16 v13, v18, s51, v13
v_dot2_f32_bf16 v14, v19, s50, v14
v_dot2_f32_bf16 v15, v19, s51, v15
v_dot2_f32_bf16 v8, v20, s50, v8
v_dot2_f32_bf16 v9, v20, s51, v9
v_dot2_f32_bf16 v10, v21, s50, v10
v_dot2_f32_bf16 v11, v21, s51, v11
v_dot2_f32_bf16 v12, v22, s50, v12
v_dot2_f32_bf16 v13, v22, s51, v13
v_dot2_f32_bf16 v14, v23, s50, v14
v_dot2_f32_bf16 v15, v23, s51, v15
v_dot2_f32_bf16 v8, v24, s50, v8
v_dot2_f32_bf16 v9, v24, s51, v9
v_dot2_f32_bf16 v10, v25, s50, v10
v_dot2_f32_bf16 v11, v25, s51, v11
v_dot2_f32_bf16 v12, v26, s50, v12
v_dot2_f32_bf16 v13, v26, s51, v13
v_dot2_f32_bf16 v14, v27, s50, v14
v_dot2_f32_bf16 v15, v27, s51, v15
s_waitcnt vmcnt(4)
v_dot2_f32_bf16 v8, v28, s50, v8
v_dot2_f32_bf16 v9, v28, s51, v9
v_dot2_f32_bf16 v10, v29, s50, v10
v_dot2_f32_bf16 v11, v29, s51, v11
v_dot2_f32_bf16 v12, v30, s50, v12
v_dot2_f32_bf16 v13, v30, s51, v13
v_dot2_f32_bf16 v14, v31, s50, v14
v_dot2_f32_bf16 v15, v31, s51, v15
v_dot2_f32_bf16 v8, v32, s50, v8
v_dot2_f32_bf16 v9, v32, s51, v9
v_dot2_f32_bf16 v10, v33, s50, v10
v_dot2_f32_bf16 v11, v33, s51, v11
v_dot2_f32_bf16 v12, v34, s50, v12
v_dot2_f32_bf16 v13, v34, s51, v13
v_dot2_f32_bf16 v14, v35, s50, v14
v_dot2_f32_bf16 v15, v35, s51, v15
v_dot2_f32_bf16 v8, v36, s50, v8
v_dot2_f32_bf16 v9, v36, s51, v9
v_dot2_f32_bf16 v10, v37, s50, v10
v_dot2_f32_bf16 v11, v37, s51, v11
v_dot2_f32_bf16 v12, v38, s50, v12
v_dot2_f32_bf16 v13, v38, s51, v13
v_dot2_f32_bf16 v14, v39, s50, v14
v_dot2_f32_bf16 v15, v39, s51, v15
s_waitcnt vmcnt(1)
v_dot2_f32_bf16 v8, v40, s50, v8
v_dot2_f32_bf16 v9, v40, s51, v9
v_dot2_f32_bf16 v10, v41, s50, v10
v_dot2_f32_bf16 v11, v41, s51, v11
v_dot2_f32_bf16 v12, v42, s50, v12
v_dot2_f32_bf16 v13, v42, s51, v13
v_dot2_f32_bf16 v14, v43, s50, v14
v_dot2_f32_bf16 v15, v43, s51, v15
v_dot2_f32_bf16 v8, v44, s50, v8
v_dot2_f32_bf16 v9, v44, s51, v9
v_dot2_f32_bf16 v10, v45, s50, v10
v_dot2_f32_bf16 v11, v45, s51, v11
v_dot2_f32_bf16 v12, v46, s50, v12
v_dot2_f32_bf16 v13, v46, s51, v13
v_dot2_f32_bf16 v14, v47, s50, v14
v_dot2_f32_bf16 v15, v47, s51, v15
v_dot2_f32_bf16 v8, v48, s50, v8
v_dot2_f32_bf16 v9, v48, s51, v9
v_dot2_f32_bf16 v10, v49, s50, v10
v_dot2_f32_bf16 v11, v49, s51, v11
v_dot2_f32_bf16 v12, v50, s50, v12
v_dot2_f32_bf16 v13, v50, s51, v13
v_dot2_f32_bf16 v14, v51, s50, v14
v_dot2_f32_bf16 v15, v51, s51, v15
s_lshl_b32 s30, s49, 10
v_lshl_add_u32 v4, v255, 5, s30
s_nop 1
v_permlane32_swap_b32 v8, v9
v_permlane32_swap_b32 v10, v11
v_permlane32_swap_b32 v12, v13
v_permlane32_swap_b32 v14, v15
v_add_f32 v8, v8, v9
v_add_f32 v9, v10, v11
v_add_f32 v10, v12, v13
v_add_f32 v11, v14, v15
v_lshl_add_u32 v4, v255, 4, s30
ds_write_b128 v4, v[8:11]
s_waitcnt lgkmcnt(0)
s_barrier
s_cmp_lg_u32 s49, 0
s_cbranch_scc1 L_hc1
v_and_b32 v5, 1, v255
v_lshlrev_b32 v4, 9, v5
v_lshl_add_u32 v4, v1, 4, v4
v_bfe_u32 v5, v255, 1, 2
v_lshl_add_u32 v4, v5, 2, v4
ds_read_b32 v16, v4 offset:0
ds_read_b32 v17, v4 offset:128
ds_read_b32 v18, v4 offset:256
ds_read_b32 v19, v4 offset:384
ds_read_b32 v20, v4 offset:1024
ds_read_b32 v21, v4 offset:1152
ds_read_b32 v22, v4 offset:1280
ds_read_b32 v23, v4 offset:1408
ds_read_b32 v24, v4 offset:2048
ds_read_b32 v25, v4 offset:2176
ds_read_b32 v26, v4 offset:2304
ds_read_b32 v27, v4 offset:2432
ds_read_b32 v28, v4 offset:3072
ds_read_b32 v29, v4 offset:3200
ds_read_b32 v30, v4 offset:3328
ds_read_b32 v31, v4 offset:3456
ds_read_b32 v32, v4 offset:4096
ds_read_b32 v33, v4 offset:4224
ds_read_b32 v34, v4 offset:4352
ds_read_b32 v35, v4 offset:4480
ds_read_b32 v36, v4 offset:5120
ds_read_b32 v37, v4 offset:5248
ds_read_b32 v38, v4 offset:5376
ds_read_b32 v39, v4 offset:5504
ds_read_b32 v40, v4 offset:6144
ds_read_b32 v41, v4 offset:6272
ds_read_b32 v42, v4 offset:6400
ds_read_b32 v43, v4 offset:6528
ds_read_b32 v44, v4 offset:7168
ds_read_b32 v45, v4 offset:7296
ds_read_b32 v46, v4 offset:7424
ds_read_b32 v47, v4 offset:7552
s_waitcnt lgkmcnt(0)
v_add_f32 v16, v16, v32
v_add_f32 v17, v17, v33
v_add_f32 v18, v18, v34
v_add_f32 v19, v19, v35
v_add_f32 v20, v20, v36
v_add_f32 v21, v21, v37
v_add_f32 v22, v22, v38
v_add_f32 v23, v23, v39
v_add_f32 v24, v24, v40
v_add_f32 v25, v25, v41
v_add_f32 v26, v26, v42
v_add_f32 v27, v27, v43
v_add_f32 v28, v28, v44
v_add_f32 v29, v29, v45
v_add_f32 v30, v30, v46
v_add_f32 v31, v31, v47
v_add_f32 v16, v16, v24
v_add_f32 v17, v17, v25
v_add_f32 v18, v18, v26
v_add_f32 v19, v19, v27
v_add_f32 v20, v20, v28
v_add_f32 v21, v21, v29
v_add_f32 v22, v22, v30
v_add_f32 v23, v23, v31
v_add_f32 v16, v16, v20
v_add_f32 v17, v17, v21
v_add_f32 v18, v18, v22
v_add_f32 v19, v19, v23
v_add_f32 v16, v16, v18
v_add_f32 v17, v17, v19
v_add_f32 v16, v16, v17
s_waitcnt vmcnt(0)
s_mov_b32 s78, 0x20000
s_branch L_hcn_c
L_hcn_l:
buffer_load_dword v7, off, s[68:71], 0 sc1
s_waitcnt vmcnt(0)
L_hcn_c:
v_readfirstlane_b32 s64, v7
s_sub_u32 s78, s78, 1
s_cbranch_scc1 L_hcn_o
s_cmp_eq_u32 s64, 0
s_cbranch_scc1 L_hcn_l
L_hcn_o:
s_lshl_b32 s30, s28, 9
s_add_u32 s30, s30, 1081344
v_lshlrev_b32 v4, 3, v255
v_mov_b32 v17, s64
buffer_store_dwordx2 v[16:17], v4, s[20:23], s30 offen sc0 sc1
L_hc1:
s_branch L_h1
L_hst:
s_sub_u32 s30, s25, 18
s_lshl_b32 s30, s30, 1
s_add_u32 s30, s30, s26
s_mul_i32 s30, s30, 80
s_lshl_b32 s31, s49, 3
s_add_u32 s30, s30, s31
v_add_u32 v3, s30, v1
v_mul_u32_u24 v4, 1152, v3
v_lshl_add_u32 v4, v2, 4, v4
buffer_load_dwordx4 v[16:19], v4, s[8:11], 0 offen offset:0
buffer_load_dwordx4 v[20:23], v4, s[8:11], 0 offen offset:128
buffer_load_dwordx4 v[24:27], v4, s[8:11], 0 offen offset:256
buffer_load_dwordx4 v[28:31], v4, s[8:11], 0 offen offset:384
buffer_load_dwordx4 v[32:35], v4, s[8:11], 0 offen offset:512
buffer_load_dwordx4 v[36:39], v4, s[8:11], 0 offen offset:640
buffer_load_dwordx4 v[40:43], v4, s[8:11], 0 offen offset:768
buffer_load_dwordx4 v[44:47], v4, s[8:11], 0 offen offset:896
buffer_load_dwordx4 v[48:51], v4, s[8:11], 0 offen offset:1024
s_cmp_lt_u32 s49, 2
s_mov_b32 s30, 73728
s_cselect_b32 s30, s30, 0x40000000
buffer_load_dwordx4 v[52:55], v4, s[8:11], s30 offen offset:0
buffer_load_dwordx4 v[56:59], v4, s[8:11], s30 offen offset:128
buffer_load_dwordx4 v[60:63], v4, s[8:11], s30 offen offset:256
buffer_load_dwordx4 v[64:67], v4, s[8:11], s30 offen offset:384
buffer_load_dwordx4 v[68:71], v4, s[8:11], s30 offen offset:512
buffer_load_dwordx4 v[72:75], v4, s[8:11], s30 offen offset:640
buffer_load_dwordx4 v[76:79], v4, s[8:11], s30 offen offset:768
buffer_load_dwordx4 v[80:83], v4, s[8:11], s30 offen offset:896
buffer_load_dwordx4 v[84:87], v4, s[8:11], s30 offen offset:1024
s_add_u32 s20, s6, 41943040
s_addc_u32 s21, s7, 0
s_and_b32 s21, s21, 0xffff
s_mov_b32 s22, 1409024
s_mov_b32 s23, 0x20000
buffer_load_dword v7, off, s[68:71], 0 sc1
s_mov_b32 s51, 0x3f803f80
v_mov_b32 v8, 0
v_mov_b32 v9, 0
v_mov_b32 v10, 0
v_mov_b32 v11, 0
s_waitcnt vmcnt(10)
v_dot2_f32_bf16 v8, v16, s51, v8
v_dot2_f32_bf16 v9, v16, v16, v9
v_dot2_f32_bf16 v8, v17, s51, v8
v_dot2_f32_bf16 v9, v17, v17, v9
v_dot2_f32_bf16 v8, v18, s51, v8
v_dot2_f32_bf16 v9, v18, v18, v9
v_dot2_f32_bf16 v8, v19, s51, v8
v_dot2_f32_bf16 v9, v19, v19, v9
v_dot2_f32_bf16 v8, v20, s51, v8
v_dot2_f32_bf16 v9, v20, v20, v9
v_dot2_f32_bf16 v8, v21, s51, v8
v_dot2_f32_bf16 v9, v21, v21, v9
v_dot2_f32_bf16 v8, v22, s51, v8
v_dot2_f32_bf16 v9, v22, v22, v9
v_dot2_f32_bf16 v8, v23, s51, v8
v_dot2_f32_bf16 v9, v23, v23, v9
v_dot2_f32_bf16 v8, v24, s51, v8
v_dot2_f32_bf16 v9, v24, v24, v9
v_dot2_f32_bf16 v8, v25, s51, v8
v_dot2_f32_bf16 v9, v25, v25, v9
v_dot2_f32_bf16 v8, v26, s51, v8
v_dot2_f32_bf16 v9, v26, v26, v9
v_dot2_f32_bf16 v8, v27, s51, v8
v_dot2_f32_bf16 v9, v27, v27, v9
v_dot2_f32_bf16 v8, v28, s51, v8
v_dot2_f32_bf16 v9, v28, v28, v9
v_dot2_f32_bf16 v8, v29, s51, v8
v_dot2_f32_bf16 v9, v29, v29, v9
v_dot2_f32_bf16 v8, v30, s51, v8
v_dot2_f32_bf16 v9, v30, v30, v9
v_dot2_f32_bf16 v8, v31, s51, v8
v_dot2_f32_bf16 v9, v31, v31, v9
v_dot2_f32_bf16 v8, v32, s51, v8
v_dot2_f32_bf16 v9, v32, v32, v9
v_dot2_f32_bf16 v8, v33, s51, v8
v_dot2_f32_bf16 v9, v33, v33, v9
v_dot2_f32_bf16 v8, v34, s51, v8
v_dot2_f32_bf16 v9, v34, v34, v9
v_dot2_f32_bf16 v8, v35, s51, v8
v_dot2_f32_bf16 v9, v35, v35, v9
v_dot2_f32_bf16 v8, v36, s51, v8
v_dot2_f32_bf16 v9, v36, v36, v9
v_dot2_f32_bf16 v8, v37, s51, v8
v_dot2_f32_bf16 v9, v37, v37, v9
v_dot2_f32_bf16 v8, v38, s51, v8
v_dot2_f32_bf16 v9, v38, v38, v9
v_dot2_f32_bf16 v8, v39, s51, v8
v_dot2_f32_bf16 v9, v39, v39, v9
v_dot2_f32_bf16 v8, v40, s51, v8
v_dot2_f32_bf16 v9, v40, v40, v9
v_dot2_f32_bf16 v8, v41, s51, v8
v_dot2_f32_bf16 v9, v41, v41, v9
v_dot2_f32_bf16 v8, v42, s51, v8
v_dot2_f32_bf16 v9, v42, v42, v9
v_dot2_f32_bf16 v8, v43, s51, v8
v_dot2_f32_bf16 v9, v43, v43, v9
v_dot2_f32_bf16 v8, v44, s51, v8
v_dot2_f32_bf16 v9, v44, v44, v9
v_dot2_f32_bf16 v8, v45, s51, v8
v_dot2_f32_bf16 v9, v45, v45, v9
v_dot2_f32_bf16 v8, v46, s51, v8
v_dot2_f32_bf16 v9, v46, v46, v9
v_dot2_f32_bf16 v8, v47, s51, v8
v_dot2_f32_bf16 v9, v47, v47, v9
v_dot2_f32_bf16 v8, v48, s51, v8
v_dot2_f32_bf16 v9, v48, v48, v9
v_dot2_f32_bf16 v8, v49, s51, v8
v_dot2_f32_bf16 v9, v49, v49, v9
v_dot2_f32_bf16 v8, v50, s51, v8
v_dot2_f32_bf16 v9, v50, v50, v9
v_dot2_f32_bf16 v8, v51, s51, v8
v_dot2_f32_bf16 v9, v51, v51, v9
s_cmp_ge_u32 s49, 2
s_cbranch_scc1 L_hs2
s_waitcnt vmcnt(0)
v_dot2_f32_bf16 v10, v52, s51, v10
v_dot2_f32_bf16 v11, v52, v52, v11
v_dot2_f32_bf16 v10, v53, s51, v10
v_dot2_f32_bf16 v11, v53, v53, v11
v_dot2_f32_bf16 v10, v54, s51, v10
v_dot2_f32_bf16 v11, v54, v54, v11
v_dot2_f32_bf16 v10, v55, s51, v10
v_dot2_f32_bf16 v11, v55, v55, v11
v_dot2_f32_bf16 v10, v56, s51, v10
v_dot2_f32_bf16 v11, v56, v56, v11
v_dot2_f32_bf16 v10, v57, s51, v10
v_dot2_f32_bf16 v11, v57, v57, v11
v_dot2_f32_bf16 v10, v58, s51, v10
v_dot2_f32_bf16 v11, v58, v58, v11
v_dot2_f32_bf16 v10, v59, s51, v10
v_dot2_f32_bf16 v11, v59, v59, v11
v_dot2_f32_bf16 v10, v60, s51, v10
v_dot2_f32_bf16 v11, v60, v60, v11
v_dot2_f32_bf16 v10, v61, s51, v10
v_dot2_f32_bf16 v11, v61, v61, v11
v_dot2_f32_bf16 v10, v62, s51, v10
v_dot2_f32_bf16 v11, v62, v62, v11
v_dot2_f32_bf16 v10, v63, s51, v10
v_dot2_f32_bf16 v11, v63, v63, v11
v_dot2_f32_bf16 v10, v64, s51, v10
v_dot2_f32_bf16 v11, v64, v64, v11
v_dot2_f32_bf16 v10, v65, s51, v10
v_dot2_f32_bf16 v11, v65, v65, v11
v_dot2_f32_bf16 v10, v66, s51, v10
v_dot2_f32_bf16 v11, v66, v66, v11
v_dot2_f32_bf16 v10, v67, s51, v10
v_dot2_f32_bf16 v11, v67, v67, v11
v_dot2_f32_bf16 v10, v68, s51, v10
v_dot2_f32_bf16 v11, v68, v68, v11
v_dot2_f32_bf16 v10, v69, s51, v10
v_dot2_f32_bf16 v11, v69, v69, v11
v_dot2_f32_bf16 v10, v70, s51, v10
v_dot2_f32_bf16 v11, v70, v70, v11
v_dot2_f32_bf16 v10, v71, s51, v10
v_dot2_f32_bf16 v11, v71, v71, v11
v_dot2_f32_bf16 v10, v72, s51, v10
v_dot2_f32_bf16 v11, v72, v72, v11
v_dot2_f32_bf16 v10, v73, s51, v10
v_dot2_f32_bf16 v11, v73, v73, v11
v_dot2_f32_bf16 v10, v74, s51, v10
v_dot2_f32_bf16 v11, v74, v74, v11
v_dot2_f32_bf16 v10, v75, s51, v10
v_dot2_f32_bf16 v11, v75, v75, v11
v_dot2_f32_bf16 v10, v76, s51, v10
v_dot2_f32_bf16 v11, v76, v76, v11
v_dot2_f32_bf16 v10, v77, s51, v10
v_dot2_f32_bf16 v11, v77, v77, v11
v_dot2_f32_bf16 v10, v78, s51, v10
v_dot2_f32_bf16 v11, v78, v78, v11
v_dot2_f32_bf16 v10, v79, s51, v10
v_dot2_f32_bf16 v11, v79, v79, v11
v_dot2_f32_bf16 v10, v80, s51, v10
v_dot2_f32_bf16 v11, v80, v80, v11
v_dot2_f32_bf16 v10, v81, s51, v10
v_dot2_f32_bf16 v11, v81, v81, v11
v_dot2_f32_bf16 v10, v82, s51, v10
v_dot2_f32_bf16 v11, v82, v82, v11
v_dot2_f32_bf16 v10, v83, s51, v10
v_dot2_f32_bf16 v11, v83, v83, v11
v_dot2_f32_bf16 v10, v84, s51, v10
v_dot2_f32_bf16 v11, v84, v84, v11
v_dot2_f32_bf16 v10, v85, s51, v10
v_dot2_f32_bf16 v11, v85, v85, v11
v_dot2_f32_bf16 v10, v86, s51, v10
v_dot2_f32_bf16 v11, v86, v86, v11
v_dot2_f32_bf16 v10, v87, s51, v10
v_dot2_f32_bf16 v11, v87, v87, v11
L_hs2:
s_nop 2
v_add_f32_dpp v8, v8, v8 quad_perm:[1,0,3,2] row_mask:0xf bank_mask:0xf
v_add_f32_dpp v9, v9, v9 quad_perm:[1,0,3,2] row_mask:0xf bank_mask:0xf
v_add_f32_dpp v10, v10, v10 quad_perm:[1,0,3,2] row_mask:0xf bank_mask:0xf
v_add_f32_dpp v11, v11, v11 quad_perm:[1,0,3,2] row_mask:0xf bank_mask:0xf
v_add_f32_dpp v8, v8, v8 quad_perm:[2,3,0,1] row_mask:0xf bank_mask:0xf
v_add_f32_dpp v9, v9, v9 quad_perm:[2,3,0,1] row_mask:0xf bank_mask:0xf
v_add_f32_dpp v10, v10, v10 quad_perm:[2,3,0,1] row_mask:0xf bank_mask:0xf
v_add_f32_dpp v11, v11, v11 quad_perm:[2,3,0,1] row_mask:0xf bank_mask:0xf
v_add_f32_dpp v8, v8, v8 row_half_mirror row_mask:0xf bank_mask:0xf
v_add_f32_dpp v9, v9, v9 row_half_mirror row_mask:0xf bank_mask:0xf
v_add_f32_dpp v10, v10, v10 row_half_mirror row_mask:0xf bank_mask:0xf
v_add_f32_dpp v11, v11, v11 row_half_mirror row_mask:0xf bank_mask:0xf
v_cmp_eq_u32 vcc, 1, v2
s_cmp_lt_u32 s49, 2
s_cselect_b32 s30, 2, 1
v_add_u32 v6, 64, v3
v_cndmask_b32 v8, v8, v10, vcc
v_cndmask_b32 v9, v9, v11, vcc
v_cndmask_b32 v3, v3, v6, vcc
v_mul_f32 v8, 0x3ae38e39, v8
v_mul_f32 v9, 0x3ae38e39, v9
v_fma_f32 v9, -v8, v8, v9
v_max_f32 v9, 0, v9
v_cvt_pk_bf16_f32 v8, v8, v8
v_and_b32 v8, 0xffff0000, v8
v_cvt_pk_bf16_f32 v9, v9, v9
v_and_b32 v9, 0xffff0000, v9
v_add_f32 v9, 0x3727c5ac, v9
v_cvt_pk_bf16_f32 v9, v9, v9
v_and_b32 v9, 0xffff0000, v9
v_sqrt_f32 v9, v9
s_nop 0
v_cvt_pk_bf16_f32 v9, v9, v9
v_and_b32 v9, 0xffff0000, v9
v_rcp_f32 v9, v9
s_nop 0
v_cmp_gt_u32 vcc, s30, v2
v_mov_b32 v5, 0x10000
s_mov_b32 s30, 1048576
v_cndmask_b32 v3, v5, v3, vcc
v_cmp_gt_u32 vcc, 2048, v3
v_lshlrev_b32 v3, 4, v3
v_mov_b32 v5, 0x7f000000
v_cndmask_b32 v3, v5, v3, vcc
v_mov_b32 v10, v9
s_waitcnt vmcnt(0)
s_mov_b32 s78, 0x20000
s_branch L_hsn_c
L_hsn_l:
buffer_load_dword v7, off, s[68:71], 0 sc1
s_waitcnt vmcnt(0)
L_hsn_c:
v_readfirstlane_b32 s64, v7
s_sub_u32 s78, s78, 1
s_cbranch_scc1 L_hsn_o
s_cmp_eq_u32 s64, 0
s_cbranch_scc1 L_hsn_l
L_hsn_o:
v_mov_b32 v9, s64
v_mov_b32 v11, s64
buffer_store_dwordx4 v[8:11], v3, s[20:23], s30 offen sc0 sc1
L_h1:
s_mov_b32 s60, s58
s_and_b32 s61, s59, 0xffff
s_mov_b32 s62, 4608
s_mov_b32 s63, 0x20000
s_mov_b32 s52, s54
s_and_b32 s53, s55, 0xffff
s_mov_b32 s54, 2359296
s_mov_b32 s55, 0x20000
s_and_b32 s57, s57, 0xffff
s_mov_b32 s58, 2359296
s_mov_b32 s59, 0x20000
s_add_u32 s72, s6, 31457280
s_addc_u32 s73, s7, 0
s_and_b32 s73, s73, 0xffff
s_mov_b32 s74, 2359296
s_mov_b32 s75, 0x20000
s_mul_i32 s36, s29, 9
s_add_u32 s36, s36, s49
s_mul_i32 s35, s49, 8960
s_add_u32 s35, s35, 8192
s_mov_b32 s37, 0
L_kvl:
s_mov_b32 s30, s36
s_mul_i32 s31, s30, 7282
s_lshr_b32 s31, s31, 16
s_mul_i32 s32, s31, 9
s_sub_u32 s32, s30, s32
s_mul_i32 s33, s31, 36864
s_lshl_b32 s34, s32, 7
s_add_u32 s33, s33, s34
v_lshrrev_b32 v200, 4, v255
v_and_b32 v207, 15, v255
v_mul_u32_u24 v201, 9216, v200
v_lshl_add_u32 v201, v207, 3, v201
v_add_u32 v201, s33, v201
v_mov_b32 v204, 0x7f000000
v_subrev_u32 v202, 3456, v201
v_add_u32 v203, 4608, v201
s_lshl_b32 s33, s32, 9
v_lshl_add_u32 v205, v207, 5, s33
s_mul_i32 s34, s31, 36864
s_lshl_b32 s33, s32, 12
s_add_u32 s34, s34, s33
v_lshlrev_b32 v206, 8, v207
v_lshl_add_u32 v206, v200, 4, v206
v_add_u32 v206, s35, v206
v_lshlrev_b32 v208, 4, v255
v_add_u32 v209, s35, v208
buffer_load_dwordx4 v[188:191], v205, s[60:63], 0 offen
buffer_load_dwordx4 v[192:195], v205, s[60:63], 0 offen offset:16
buffer_load_dwordx2 v[150:151], v202, s[52:55], 0 offen offset:0
buffer_load_dwordx2 v[152:153], v202, s[52:55], 0 offen offset:1152
buffer_load_dwordx2 v[154:155], v202, s[52:55], 0 offen offset:2304
buffer_load_dwordx2 v[156:157], v201, s[52:55], 0 offen offset:0
buffer_load_dwordx2 v[158:159], v201, s[52:55], 0 offen offset:1152
buffer_load_dwordx2 v[160:161], v201, s[52:55], 0 offen offset:2304
buffer_load_dwordx2 v[162:163], v201, s[52:55], 0 offen offset:3456
buffer_load_dwordx2 v[164:165], v203, s[52:55], 0 offen offset:0
buffer_load_dwordx2 v[166:167], v203, s[52:55], 0 offen offset:1152
buffer_load_dwordx2 v[168:169], v203, s[52:55], 0 offen offset:2304
buffer_load_dwordx2 v[170:171], v203, s[52:55], 0 offen offset:3456
buffer_load_dwordx2 v[172:173], v201, s[56:59], 0 offen offset:0
buffer_load_dwordx2 v[174:175], v201, s[56:59], 0 offen offset:1152
buffer_load_dwordx2 v[176:177], v201, s[56:59], 0 offen offset:2304
buffer_load_dwordx2 v[178:179], v201, s[56:59], 0 offen offset:3456
buffer_load_dwordx2 v[180:181], v203, s[56:59], 0 offen offset:0
buffer_load_dwordx2 v[182:183], v203, s[56:59], 0 offen offset:1152
buffer_load_dwordx2 v[184:185], v203, s[56:59], 0 offen offset:2304
buffer_load_dwordx2 v[186:187], v203, s[56:59], 0 offen offset:3456
s_waitcnt vmcnt(0)
v_lshlrev_b32 v0, 16, v150
v_and_b32 v1, 0xffff0000, v150
v_lshlrev_b32 v2, 16, v151
v_and_b32 v3, 0xffff0000, v151
v_lshlrev_b32 v4, 16, v152
v_and_b32 v5, 0xffff0000, v152
v_lshlrev_b32 v6, 16, v153
v_and_b32 v7, 0xffff0000, v153
v_lshlrev_b32 v8, 16, v154
v_and_b32 v9, 0xffff0000, v154
v_lshlrev_b32 v10, 16, v155
v_and_b32 v11, 0xffff0000, v155
v_lshlrev_b32 v12, 16, v156
v_and_b32 v13, 0xffff0000, v156
v_lshlrev_b32 v14, 16, v157
v_and_b32 v15, 0xffff0000, v157
v_lshlrev_b32 v16, 16, v158
v_and_b32 v17, 0xffff0000, v158
v_lshlrev_b32 v18, 16, v159
v_and_b32 v19, 0xffff0000, v159
v_lshlrev_b32 v20, 16, v160
v_and_b32 v21, 0xffff0000, v160
v_lshlrev_b32 v22, 16, v161
v_and_b32 v23, 0xffff0000, v161
v_lshlrev_b32 v24, 16, v162
v_and_b32 v25, 0xffff0000, v162
v_lshlrev_b32 v26, 16, v163
v_and_b32 v27, 0xffff0000, v163
v_lshlrev_b32 v28, 16, v164
v_and_b32 v29, 0xffff0000, v164
v_lshlrev_b32 v30, 16, v165
v_and_b32 v31, 0xffff0000, v165
v_lshlrev_b32 v32, 16, v166
v_and_b32 v33, 0xffff0000, v166
v_lshlrev_b32 v34, 16, v167
v_and_b32 v35, 0xffff0000, v167
v_lshlrev_b32 v36, 16, v168
v_and_b32 v37, 0xffff0000, v168
v_lshlrev_b32 v38, 16, v169
v_and_b32 v39, 0xffff0000, v169
v_lshlrev_b32 v40, 16, v170
v_and_b32 v41, 0xffff0000, v170
v_lshlrev_b32 v42, 16, v171
v_and_b32 v43, 0xffff0000, v171
v_lshlrev_b32 v44, 16, v172
v_and_b32 v45, 0xffff0000, v172
v_lshlrev_b32 v46, 16, v173
v_and_b32 v47, 0xffff0000, v173
v_lshlrev_b32 v48, 16, v174
v_and_b32 v49, 0xffff0000, v174
v_lshlrev_b32 v50, 16, v175
v_and_b32 v51, 0xffff0000, v175
v_lshlrev_b32 v52, 16, v176
v_and_b32 v53, 0xffff0000, v176
v_lshlrev_b32 v54, 16, v177
v_and_b32 v55, 0xffff0000, v177
v_lshlrev_b32 v56, 16, v178
v_and_b32 v57, 0xffff0000, v178
v_lshlrev_b32 v58, 16, v179
v_and_b32 v59, 0xffff0000, v179
v_lshlrev_b32 v60, 16, v180
v_and_b32 v61, 0xffff0000, v180
v_lshlrev_b32 v62, 16, v181
v_and_b32 v63, 0xffff0000, v181
v_lshlrev_b32 v64, 16, v182
v_and_b32 v65, 0xffff0000, v182
v_lshlrev_b32 v66, 16, v183
v_and_b32 v67, 0xffff0000, v183
v_lshlrev_b32 v68, 16, v184
v_and_b32 v69, 0xffff0000, v184
v_lshlrev_b32 v70, 16, v185
v_and_b32 v71, 0xffff0000, v185
v_lshlrev_b32 v72, 16, v186
v_and_b32 v73, 0xffff0000, v186
v_lshlrev_b32 v74, 16, v187
v_and_b32 v75, 0xffff0000, v187
v_lshlrev_b32 v76, 16, v188
v_and_b32 v80, 0xffff0000, v188
v_lshlrev_b32 v84, 16, v189
v_and_b32 v88, 0xffff0000, v189
v_lshlrev_b32 v77, 16, v190
v_and_b32 v81, 0xffff0000, v190
v_lshlrev_b32 v85, 16, v191
v_and_b32 v89, 0xffff0000, v191
v_lshlrev_b32 v78, 16, v192
v_and_b32 v82, 0xffff0000, v192
v_lshlrev_b32 v86, 16, v193
v_and_b32 v90, 0xffff0000, v193
v_lshlrev_b32 v79, 16, v194
v_and_b32 v83, 0xffff0000, v194
v_lshlrev_b32 v87, 16, v195
v_and_b32 v91, 0xffff0000, v195
v_pk_mul_f32 v[92:93], v[12:13], v[76:77]
v_pk_mul_f32 v[94:95], v[14:15], v[78:79]
v_pk_mul_f32 v[96:97], v[16:17], v[76:77]
v_pk_mul_f32 v[98:99], v[18:19], v[78:79]
v_pk_mul_f32 v[100:101], v[20:21], v[76:77]
v_pk_mul_f32 v[102:103], v[22:23], v[78:79]
v_pk_mul_f32 v[104:105], v[24:25], v[76:77]
v_pk_mul_f32 v[106:107], v[26:27], v[78:79]
v_pk_mul_f32 v[108:109], v[28:29], v[76:77]
v_pk_mul_f32 v[110:111], v[30:31], v[78:79]
v_pk_mul_f32 v[112:113], v[32:33], v[76:77]
v_pk_mul_f32 v[114:115], v[34:35], v[78:79]
v_pk_mul_f32 v[116:117], v[36:37], v[76:77]
v_pk_mul_f32 v[118:119], v[38:39], v[78:79]
v_pk_mul_f32 v[120:121], v[40:41], v[76:77]
v_pk_mul_f32 v[122:123], v[42:43], v[78:79]
v_pk_fma_f32 v[92:93], v[8:9], v[80:81], v[92:93]
v_pk_fma_f32 v[94:95], v[10:11], v[82:83], v[94:95]
v_pk_fma_f32 v[96:97], v[12:13], v[80:81], v[96:97]
v_pk_fma_f32 v[98:99], v[14:15], v[82:83], v[98:99]
v_pk_fma_f32 v[100:101], v[16:17], v[80:81], v[100:101]
v_pk_fma_f32 v[102:103], v[18:19], v[82:83], v[102:103]
v_pk_fma_f32 v[104:105], v[20:21], v[80:81], v[104:105]
v_pk_fma_f32 v[106:107], v[22:23], v[82:83], v[106:107]
v_pk_fma_f32 v[108:109], v[24:25], v[80:81], v[108:109]
v_pk_fma_f32 v[110:111], v[26:27], v[82:83], v[110:111]
v_pk_fma_f32 v[112:113], v[28:29], v[80:81], v[112:113]
v_pk_fma_f32 v[114:115], v[30:31], v[82:83], v[114:115]
v_pk_fma_f32 v[116:117], v[32:33], v[80:81], v[116:117]
v_pk_fma_f32 v[118:119], v[34:35], v[82:83], v[118:119]
v_pk_fma_f32 v[120:121], v[36:37], v[80:81], v[120:121]
v_pk_fma_f32 v[122:123], v[38:39], v[82:83], v[122:123]
v_pk_fma_f32 v[92:93], v[4:5], v[84:85], v[92:93]
v_pk_fma_f32 v[94:95], v[6:7], v[86:87], v[94:95]
v_pk_fma_f32 v[96:97], v[8:9], v[84:85], v[96:97]
v_pk_fma_f32 v[98:99], v[10:11], v[86:87], v[98:99]
v_pk_fma_f32 v[100:101], v[12:13], v[84:85], v[100:101]
v_pk_fma_f32 v[102:103], v[14:15], v[86:87], v[102:103]
v_pk_fma_f32 v[104:105], v[16:17], v[84:85], v[104:105]
v_pk_fma_f32 v[106:107], v[18:19], v[86:87], v[106:107]
v_pk_fma_f32 v[108:109], v[20:21], v[84:85], v[108:109]
v_pk_fma_f32 v[110:111], v[22:23], v[86:87], v[110:111]
v_pk_fma_f32 v[112:113], v[24:25], v[84:85], v[112:113]
v_pk_fma_f32 v[114:115], v[26:27], v[86:87], v[114:115]
v_pk_fma_f32 v[116:117], v[28:29], v[84:85], v[116:117]
v_pk_fma_f32 v[118:119], v[30:31], v[86:87], v[118:119]
v_pk_fma_f32 v[120:121], v[32:33], v[84:85], v[120:121]
v_pk_fma_f32 v[122:123], v[34:35], v[86:87], v[122:123]
v_pk_fma_f32 v[92:93], v[0:1], v[88:89], v[92:93]
v_pk_fma_f32 v[94:95], v[2:3], v[90:91], v[94:95]
v_pk_fma_f32 v[96:97], v[4:5], v[88:89], v[96:97]
v_pk_fma_f32 v[98:99], v[6:7], v[90:91], v[98:99]
v_pk_fma_f32 v[100:101], v[8:9], v[88:89], v[100:101]
v_pk_fma_f32 v[102:103], v[10:11], v[90:91], v[102:103]
v_pk_fma_f32 v[104:105], v[12:13], v[88:89], v[104:105]
v_pk_fma_f32 v[106:107], v[14:15], v[90:91], v[106:107]
v_pk_fma_f32 v[108:109], v[16:17], v[88:89], v[108:109]
v_pk_fma_f32 v[110:111], v[18:19], v[90:91], v[110:111]
v_pk_fma_f32 v[112:113], v[20:21], v[88:89], v[112:113]
v_pk_fma_f32 v[114:115], v[22:23], v[90:91], v[114:115]
v_pk_fma_f32 v[116:117], v[24:25], v[88:89], v[116:117]
v_pk_fma_f32 v[118:119], v[26:27], v[90:91], v[118:119]
v_pk_fma_f32 v[120:121], v[28:29], v[88:89], v[120:121]
v_pk_fma_f32 v[122:123], v[30:31], v[90:91], v[122:123]
v_pk_mul_f32 v[92:93], v[92:93], v[44:45]
v_pk_mul_f32 v[94:95], v[94:95], v[46:47]
v_pk_mul_f32 v[96:97], v[96:97], v[48:49]
v_pk_mul_f32 v[98:99], v[98:99], v[50:51]
v_pk_mul_f32 v[100:101], v[100:101], v[52:53]
v_pk_mul_f32 v[102:103], v[102:103], v[54:55]
v_pk_mul_f32 v[104:105], v[104:105], v[56:57]
v_pk_mul_f32 v[106:107], v[106:107], v[58:59]
v_pk_mul_f32 v[108:109], v[108:109], v[60:61]
v_pk_mul_f32 v[110:111], v[110:111], v[62:63]
v_pk_mul_f32 v[112:113], v[112:113], v[64:65]
v_pk_mul_f32 v[114:115], v[114:115], v[66:67]
v_pk_mul_f32 v[116:117], v[116:117], v[68:69]
v_pk_mul_f32 v[118:119], v[118:119], v[70:71]
v_pk_mul_f32 v[120:121], v[120:121], v[72:73]
v_pk_mul_f32 v[122:123], v[122:123], v[74:75]
v_cvt_pk_bf16_f32 v152, v92, v108
v_cvt_pk_bf16_f32 v153, v96, v112
v_cvt_pk_bf16_f32 v154, v100, v116
v_cvt_pk_bf16_f32 v155, v104, v120
v_cvt_pk_bf16_f32 v156, v93, v109
v_cvt_pk_bf16_f32 v157, v97, v113
v_cvt_pk_bf16_f32 v158, v101, v117
v_cvt_pk_bf16_f32 v159, v105, v121
v_cvt_pk_bf16_f32 v160, v94, v110
v_cvt_pk_bf16_f32 v161, v98, v114
v_cvt_pk_bf16_f32 v162, v102, v118
v_cvt_pk_bf16_f32 v163, v106, v122
v_cvt_pk_bf16_f32 v164, v95, v111
v_cvt_pk_bf16_f32 v165, v99, v115
v_cvt_pk_bf16_f32 v166, v103, v119
v_cvt_pk_bf16_f32 v167, v107, v123
s_nop 1
v_permlane32_swap_b32 v152, v154
v_permlane32_swap_b32 v153, v155
v_permlane32_swap_b32 v156, v158
v_permlane32_swap_b32 v157, v159
v_permlane32_swap_b32 v160, v162
v_permlane32_swap_b32 v161, v163
v_permlane32_swap_b32 v164, v166
v_permlane32_swap_b32 v165, v167
v_permlane16_swap_b32 v152, v153
v_permlane16_swap_b32 v154, v155
v_permlane16_swap_b32 v156, v157
v_permlane16_swap_b32 v158, v159
v_permlane16_swap_b32 v160, v161
v_permlane16_swap_b32 v162, v163
v_permlane16_swap_b32 v164, v165
v_permlane16_swap_b32 v166, v167
ds_write_b128 v206, v[152:155] offset:0
ds_write_b128 v206, v[156:159] offset:64
ds_write_b128 v206, v[160:163] offset:128
ds_write_b128 v206, v[164:167] offset:192
ds_read_b128 v[168:171], v209 offset:0
ds_read_b128 v[172:175], v209 offset:1024
ds_read_b128 v[176:179], v209 offset:2048
ds_read_b128 v[180:183], v209 offset:3072
s_waitcnt lgkmcnt(3)
buffer_store_dwordx4 v[168:171], v208, s[72:75], s34 offen offset:0 sc1
s_waitcnt lgkmcnt(2)
buffer_store_dwordx4 v[172:175], v208, s[72:75], s34 offen offset:1024 sc1
s_waitcnt lgkmcnt(1)
buffer_store_dwordx4 v[176:179], v208, s[72:75], s34 offen offset:2048 sc1
s_waitcnt lgkmcnt(0)
buffer_store_dwordx4 v[180:183], v208, s[72:75], s34 offen offset:3072 sc1
s_cmp_ge_u32 s25, 14
s_cbranch_scc1 L_kve
s_cmp_lg_u32 s37, 0
s_cbranch_scc1 L_kve
s_mov_b32 s37, 1
s_lshl_b32 s36, s25, 1
s_add_u32 s36, s36, s26
s_mul_i32 s30, s49, 28
s_add_u32 s36, s36, s30
s_cmp_lt_u32 s36, 64
s_mul_i32 s36, s36, 9
s_cselect_b32 s37, 1, 2
s_add_u32 s36, s36, 8
s_cmp_eq_u32 s37, 1
s_cbranch_scc1 L_kvl
L_kve:
s_waitcnt vmcnt(0)
s_barrier
s_cmp_lg_u32 s49, 7
s_cbranch_scc1 L_kvf
v_mov_b32 v4, 1
s_mov_b64 exec, 1
buffer_atomic_add v4, off, s[68:71], 0 offset:128 sc1
s_mov_b64 exec, -1
L_kvf:
v_lshrrev_b32 v1, 3, v255
v_and_b32 v2, 7, v255
s_cmp_lt_u32 s25, 14
s_cbranch_scc1 L_h2
s_mul_i32 s28, s26, 18
s_add_u32 s28, s28, s25
s_sub_u32 s28, s28, 14
s_mul_i32 s30, s49, 73728
s_lshl_b32 s31, s28, 7
s_add_u32 s30, s30, s31
v_mul_u32_u24 v4, 9216, v1
v_lshl_add_u32 v4, v2, 4, v4
buffer_load_dwordx4 v[16:19], v4, s[12:15], s30 offen
s_add_u32 s30, s30, 589824
buffer_load_dwordx4 v[20:23], v4, s[12:15], s30 offen
s_add_u32 s30, s30, 589824
buffer_load_dwordx4 v[24:27], v4, s[12:15], s30 offen
s_add_u32 s30, s30, 589824
buffer_load_dwordx4 v[28:31], v4, s[12:15], s30 offen
s_add_u32 s30, s30, 589824
buffer_load_dwordx4 v[32:35], v4, s[12:15], s30 offen
s_add_u32 s30, s30, 589824
buffer_load_dwordx4 v[36:39], v4, s[12:15], s30 offen
s_add_u32 s30, s30, 589824
buffer_load_dwordx4 v[40:43], v4, s[12:15], s30 offen
s_add_u32 s30, s30, 589824
buffer_load_dwordx4 v[44:47], v4, s[12:15], s30 offen
s_add_u32 s30, s30, 589824
buffer_load_dwordx4 v[48:51], v4, s[12:15], s30 offen
s_add_u32 s30, s30, 589824
s_mov_b32 s50, 0x3f80
s_mov_b32 s51, 0x3f800000
v_mov_b32 v8, 0
v_mov_b32 v9, 0
v_mov_b32 v10, 0
v_mov_b32 v11, 0
v_mov_b32 v12, 0
v_mov_b32 v13, 0
v_mov_b32 v14, 0
v_mov_b32 v15, 0
s_waitcnt vmcnt(6)
v_dot2_f32_bf16 v8, v16, s50, v8
v_dot2_f32_bf16 v9, v16, s51, v9
v_dot2_f32_bf16 v10, v17, s50, v10
v_dot2_f32_bf16 v11, v17, s51, v11
v_dot2_f32_bf16 v12, v18, s50, v12
v_dot2_f32_bf16 v13, v18, s51, v13
v_dot2_f32_bf16 v14, v19, s50, v14
v_dot2_f32_bf16 v15, v19, s51, v15
v_dot2_f32_bf16 v8, v20, s50, v8
v_dot2_f32_bf16 v9, v20, s51, v9
v_dot2_f32_bf16 v10, v21, s50, v10
v_dot2_f32_bf16 v11, v21, s51, v11
v_dot2_f32_bf16 v12, v22, s50, v12
v_dot2_f32_bf16 v13, v22, s51, v13
v_dot2_f32_bf16 v14, v23, s50, v14
v_dot2_f32_bf16 v15, v23, s51, v15
v_dot2_f32_bf16 v8, v24, s50, v8
v_dot2_f32_bf16 v9, v24, s51, v9
v_dot2_f32_bf16 v10, v25, s50, v10
v_dot2_f32_bf16 v11, v25, s51, v11
v_dot2_f32_bf16 v12, v26, s50, v12
v_dot2_f32_bf16 v13, v26, s51, v13
v_dot2_f32_bf16 v14, v27, s50, v14
v_dot2_f32_bf16 v15, v27, s51, v15
s_waitcnt vmcnt(3)
v_dot2_f32_bf16 v8, v28, s50, v8
v_dot2_f32_bf16 v9, v28, s51, v9
v_dot2_f32_bf16 v10, v29, s50, v10
v_dot2_f32_bf16 v11, v29, s51, v11
v_dot2_f32_bf16 v12, v30, s50, v12
v_dot2_f32_bf16 v13, v30, s51, v13
v_dot2_f32_bf16 v14, v31, s50, v14
v_dot2_f32_bf16 v15, v31, s51, v15
v_dot2_f32_bf16 v8, v32, s50, v8
v_dot2_f32_bf16 v9, v32, s51, v9
v_dot2_f32_bf16 v10, v33, s50, v10
v_dot2_f32_bf16 v11, v33, s51, v11
v_dot2_f32_bf16 v12, v34, s50, v12
v_dot2_f32_bf16 v13, v34, s51, v13
v_dot2_f32_bf16 v14, v35, s50, v14
v_dot2_f32_bf16 v15, v35, s51, v15
v_dot2_f32_bf16 v8, v36, s50, v8
v_dot2_f32_bf16 v9, v36, s51, v9
v_dot2_f32_bf16 v10, v37, s50, v10
v_dot2_f32_bf16 v11, v37, s51, v11
v_dot2_f32_bf16 v12, v38, s50, v12
v_dot2_f32_bf16 v13, v38, s51, v13
v_dot2_f32_bf16 v14, v39, s50, v14
v_dot2_f32_bf16 v15, v39, s51, v15
s_waitcnt vmcnt(0)
v_dot2_f32_bf16 v8, v40, s50, v8
v_dot2_f32_bf16 v9, v40, s51, v9
v_dot2_f32_bf16 v10, v41, s50, v10
v_dot2_f32_bf16 v11, v41, s51, v11
v_dot2_f32_bf16 v12, v42, s50, v12
v_dot2_f32_bf16 v13, v42, s51, v13
v_dot2_f32_bf16 v14, v43, s50, v14
v_dot2_f32_bf16 v15, v43, s51, v15
v_dot2_f32_bf16 v8, v44, s50, v8
v_dot2_f32_bf16 v9, v44, s51, v9
v_dot2_f32_bf16 v10, v45, s50, v10
v_dot2_f32_bf16 v11, v45, s51, v11
v_dot2_f32_bf16 v12, v46, s50, v12
v_dot2_f32_bf16 v13, v46, s51, v13
v_dot2_f32_bf16 v14, v47, s50, v14
v_dot2_f32_bf16 v15, v47, s51, v15
v_dot2_f32_bf16 v8, v48, s50, v8
v_dot2_f32_bf16 v9, v48, s51, v9
v_dot2_f32_bf16 v10, v49, s50, v10
v_dot2_f32_bf16 v11, v49, s51, v11
v_dot2_f32_bf16 v12, v50, s50, v12
v_dot2_f32_bf16 v13, v50, s51, v13
v_dot2_f32_bf16 v14, v51, s50, v14
v_dot2_f32_bf16 v15, v51, s51, v15
s_lshl_b32 s30, s49, 10
v_lshl_add_u32 v4, v255, 5, s30
s_nop 1
v_permlane32_swap_b32 v8, v9
v_permlane32_swap_b32 v10, v11
v_permlane32_swap_b32 v12, v13
v_permlane32_swap_b32 v14, v15
v_add_f32 v8, v8, v9
v_add_f32 v9, v10, v11
v_add_f32 v10, v12, v13
v_add_f32 v11, v14, v15
v_lshl_add_u32 v4, v255, 4, s30
ds_write_b128 v4, v[8:11]
s_waitcnt lgkmcnt(0)
s_barrier
s_cmp_lg_u32 s49, 0
s_cbranch_scc1 L_hc2
v_and_b32 v5, 1, v255
v_lshlrev_b32 v4, 9, v5
v_lshl_add_u32 v4, v1, 4, v4
v_bfe_u32 v5, v255, 1, 2
v_lshl_add_u32 v4, v5, 2, v4
ds_read_b32 v16, v4 offset:0
ds_read_b32 v17, v4 offset:128
ds_read_b32 v18, v4 offset:256
ds_read_b32 v19, v4 offset:384
ds_read_b32 v20, v4 offset:1024
ds_read_b32 v21, v4 offset:1152
ds_read_b32 v22, v4 offset:1280
ds_read_b32 v23, v4 offset:1408
ds_read_b32 v24, v4 offset:2048
ds_read_b32 v25, v4 offset:2176
ds_read_b32 v26, v4 offset:2304
ds_read_b32 v27, v4 offset:2432
ds_read_b32 v28, v4 offset:3072
ds_read_b32 v29, v4 offset:3200
ds_read_b32 v30, v4 offset:3328
ds_read_b32 v31, v4 offset:3456
ds_read_b32 v32, v4 offset:4096
ds_read_b32 v33, v4 offset:4224
ds_read_b32 v34, v4 offset:4352
ds_read_b32 v35, v4 offset:4480
ds_read_b32 v36, v4 offset:5120
ds_read_b32 v37, v4 offset:5248
ds_read_b32 v38, v4 offset:5376
ds_read_b32 v39, v4 offset:5504
ds_read_b32 v40, v4 offset:6144
ds_read_b32 v41, v4 offset:6272
ds_read_b32 v42, v4 offset:6400
ds_read_b32 v43, v4 offset:6528
ds_read_b32 v44, v4 offset:7168
ds_read_b32 v45, v4 offset:7296
ds_read_b32 v46, v4 offset:7424
ds_read_b32 v47, v4 offset:7552
s_waitcnt lgkmcnt(0)
v_add_f32 v16, v16, v32
v_add_f32 v17, v17, v33
v_add_f32 v18, v18, v34
v_add_f32 v19, v19, v35
v_add_f32 v20, v20, v36
v_add_f32 v21, v21, v37
v_add_f32 v22, v22, v38
v_add_f32 v23, v23, v39
v_add_f32 v24, v24, v40
v_add_f32 v25, v25, v41
v_add_f32 v26, v26, v42
v_add_f32 v27, v27, v43
v_add_f32 v28, v28, v44
v_add_f32 v29, v29, v45
v_add_f32 v30, v30, v46
v_add_f32 v31, v31, v47
v_add_f32 v16, v16, v24
v_add_f32 v17, v17, v25
v_add_f32 v18, v18, v26
v_add_f32 v19, v19, v27
v_add_f32 v20, v20, v28
v_add_f32 v21, v21, v29
v_add_f32 v22, v22, v30
v_add_f32 v23, v23, v31
v_add_f32 v16, v16, v20
v_add_f32 v17, v17, v21
v_add_f32 v18, v18, v22
v_add_f32 v19, v19, v23
v_add_f32 v16, v16, v18
v_add_f32 v17, v17, v19
v_add_f32 v16, v16, v17
s_lshl_b32 s30, s28, 9
s_add_u32 s30, s30, 1081344
v_lshlrev_b32 v4, 3, v255
v_mov_b32 v17, s64
buffer_store_dwordx2 v[16:17], v4, s[20:23], s30 offen sc0 sc1
L_hc2:
L_h2:
s_cmp_eq_u32 s49, 7
s_cbranch_scc1 L_hpf
s_mul_i32 s28, s29, 9
s_add_u32 s33, s28, 9
s_add_u32 s28, s28, s49
s_mul_i32 s29, s49, 8960
v_bfe_u32 v232, v255, 2, 2
v_lshrrev_b32 v233, 4, v255
v_and_b32 v234, 3, v255
v_sub_u32 v235, v232, v233
v_lshlrev_b32 v235, 6, v235
v_lshl_add_u32 v235, v234, 4, v235
s_add_u32 s30, s29, 4416
v_add_u32 v216, s30, v235
v_sub_u32 v235, v234, v232
v_lshlrev_b32 v235, 3, v235
v_lshl_add_u32 v235, v233, 6, v235
s_add_u32 s30, s29, 32
v_add_u32 v217, s30, v235
v_mul_u32_u24 v235, 2064, v234
v_add_u32 v223, s29, v235
v_lshl_add_u32 v235, v232, 7, v223
v_lshl_add_u32 v235, v233, 4, v235
v_add_u32 v218, 16, v235
v_lshl_add_u32 v219, v255, 5, s29
v_lshlrev_b32 v220, 4, v255
v_add_u32 v222, s29, v220
v_lshrrev_b32 v235, 2, v255
v_mul_u32_u24 v235, 36864, v235
v_lshl_add_u32 v221, v234, 4, v235
v_mov_b32 v226, 0
v_mov_b32 v227, 0
v_mov_b32 v228, 0
v_mov_b32 v229, 0
s_mov_b32 s60, s80
s_and_b32 s61, s81, 0xffff
s_mov_b32 s62, 2359296
s_mov_b32 s63, 0x20000
s_mov_b32 s56, s86
s_and_b32 s57, s87, 0xffff
s_mov_b32 s58, 1152
s_mov_b32 s59, 0x20000
s_add_u32 s68, s6, 31457280
s_addc_u32 s69, s7, 0
s_and_b32 s69, s69, 0xffff
s_mov_b32 s70, 2359296
s_mov_b32 s71, 0x20000
s_add_u32 s72, s6, 37748736
s_addc_u32 s73, s7, 0
s_and_b32 s73, s73, 0xffff
s_mov_b32 s74, 2359296
s_mov_b32 s75, 0x20000
v_and_b32 v4, 31, v255
v_lshlrev_b32 v4, 7, v4
v_lshrrev_b32 v5, 5, v255
v_mul_u32_u24 v5, 28672, v5
v_add_u32 v4, v4, v5
s_lshl_b32 s30, s28, 12
s_cmp_lt_u32 s49, 2
s_cselect_b32 exec_hi, -1, 0
buffer_load_dword v5, v4, s[60:63], s30 offen
s_mov_b32 exec_hi, -1
s_barrier
L_cloop:
s_lshl_b32 s30, s28, 1
v_mov_b32 v224, s30
buffer_load_ushort v224, v224, s[56:59], 0 offen
s_lshl_b32 s31, s28, 12
s_add_u32 m0, s29, 64
s_lshl_b32 s32, s28, 6
buffer_load_dwordx4 v220, s[60:63], s31 offen offset:0 lds
buffer_load_dwordx4 v220, s[60:63], s31 offen offset:1024 lds
buffer_load_dwordx4 v220, s[60:63], s31 offen offset:2048 lds
buffer_load_dwordx4 v220, s[60:63], s31 offen offset:3072 lds
s_add_u32 m0, s29, 4416
s_nop 0
buffer_load_dwordx4 v221, s[68:71], s32 offen sc1 lds
s_add_u32 s32, s32, 589824
s_add_u32 m0, s29, 5440
s_nop 0
buffer_load_dwordx4 v221, s[68:71], s32 offen sc1 lds
s_add_u32 s32, s32, 589824
s_add_u32 m0, s29, 6464
s_nop 0
buffer_load_dwordx4 v221, s[68:71], s32 offen sc1 lds
s_add_u32 s32, s32, 589824
s_add_u32 m0, s29, 7488
s_nop 0
buffer_load_dwordx4 v221, s[68:71], s32 offen sc1 lds
s_add_u32 s32, s32, 589824
s_mov_b64 exec, 0xffffff
ds_write_b128 v222, v[226:229] offset:8512
s_mov_b64 exec, 0xffff
ds_write_b128 v222, v[226:229] offset:4160
s_mov_b64 exec, 0xf
ds_write_b128 v222, v[226:229] offset:0
s_mov_b64 exec, 1
s_waitcnt vmcnt(8)
ds_write_b16 v222, v224 offset:8576
s_mov_b64 exec, -1
s_waitcnt vmcnt(0)
ds_read_b64_tr_b16 v[192:193], v217 offset:8576
ds_read_b64_tr_b16 v[194:195], v217 offset:8544
ds_read_b64_tr_b16 v[196:197], v217 offset:8512
ds_read_b128 v[128:131], v216 offset:0
ds_read_b128 v[132:135], v216 offset:256
ds_read_b128 v[136:139], v216 offset:512
ds_read_b128 v[140:143], v216 offset:768
ds_read_b128 v[144:147], v216 offset:1024
ds_read_b128 v[148:151], v216 offset:1280
ds_read_b128 v[152:155], v216 offset:1536
ds_read_b128 v[156:159], v216 offset:1792
ds_read_b128 v[160:163], v216 offset:2048
ds_read_b128 v[164:167], v216 offset:2304
ds_read_b128 v[168:171], v216 offset:2560
ds_read_b128 v[172:175], v216 offset:2816
ds_read_b128 v[176:179], v216 offset:3072
ds_read_b128 v[180:183], v216 offset:3328
ds_read_b128 v[184:187], v216 offset:3584
ds_read_b128 v[188:191], v216 offset:3840
ds_read_b64_tr_b16 v[198:199], v217 offset:64
ds_read_b64_tr_b16 v[200:201], v217 offset:32
ds_read_b64_tr_b16 v[202:203], v217 offset:0
s_waitcnt lgkmcnt(15)
v_mfma_f32_16x16x32_bf16 v[0:3], v[194:197], v[128:131], 0
v_mfma_f32_16x16x32_bf16 v[4:7], v[192:195], v[128:131], 0
ds_read_b64_tr_b16 v[204:205], v217 offset:320
ds_read_b64_tr_b16 v[206:207], v217 offset:288
ds_read_b64_tr_b16 v[208:209], v217 offset:256
v_mfma_f32_16x16x32_bf16 v[8:11], v[194:197], v[132:135], 0
v_mfma_f32_16x16x32_bf16 v[12:15], v[192:195], v[132:135], 0
v_mfma_f32_16x16x32_bf16 v[16:19], v[194:197], v[136:139], 0
v_mfma_f32_16x16x32_bf16 v[20:23], v[192:195], v[136:139], 0
v_mfma_f32_16x16x32_bf16 v[24:27], v[194:197], v[140:143], 0
v_mfma_f32_16x16x32_bf16 v[28:31], v[192:195], v[140:143], 0
s_waitcnt lgkmcnt(14)
v_mfma_f32_16x16x32_bf16 v[32:35], v[194:197], v[144:147], 0
v_mfma_f32_16x16x32_bf16 v[36:39], v[192:195], v[144:147], 0
v_mfma_f32_16x16x32_bf16 v[40:43], v[194:197], v[148:151], 0
v_mfma_f32_16x16x32_bf16 v[44:47], v[192:195], v[148:151], 0
v_mfma_f32_16x16x32_bf16 v[48:51], v[194:197], v[152:155], 0
v_mfma_f32_16x16x32_bf16 v[52:55], v[192:195], v[152:155], 0
v_mfma_f32_16x16x32_bf16 v[56:59], v[194:197], v[156:159], 0
v_mfma_f32_16x16x32_bf16 v[60:63], v[192:195], v[156:159], 0
s_waitcnt lgkmcnt(10)
v_mfma_f32_16x16x32_bf16 v[64:67], v[194:197], v[160:163], 0
v_mfma_f32_16x16x32_bf16 v[68:71], v[192:195], v[160:163], 0
v_mfma_f32_16x16x32_bf16 v[72:75], v[194:197], v[164:167], 0
v_mfma_f32_16x16x32_bf16 v[76:79], v[192:195], v[164:167], 0
v_mfma_f32_16x16x32_bf16 v[80:83], v[194:197], v[168:171], 0
v_mfma_f32_16x16x32_bf16 v[84:87], v[192:195], v[168:171], 0
v_mfma_f32_16x16x32_bf16 v[88:91], v[194:197], v[172:175], 0
v_mfma_f32_16x16x32_bf16 v[92:95], v[192:195], v[172:175], 0
s_waitcnt lgkmcnt(6)
v_mfma_f32_16x16x32_bf16 v[96:99], v[194:197], v[176:179], 0
v_mfma_f32_16x16x32_bf16 v[100:103], v[192:195], v[176:179], 0
v_mfma_f32_16x16x32_bf16 v[104:107], v[194:197], v[180:183], 0
v_mfma_f32_16x16x32_bf16 v[108:111], v[192:195], v[180:183], 0
v_mfma_f32_16x16x32_bf16 v[112:115], v[194:197], v[184:187], 0
v_mfma_f32_16x16x32_bf16 v[116:119], v[192:195], v[184:187], 0
v_mfma_f32_16x16x32_bf16 v[120:123], v[194:197], v[188:191], 0
v_mfma_f32_16x16x32_bf16 v[124:127], v[192:195], v[188:191], 0
s_waitcnt lgkmcnt(3)
v_mfma_f32_16x16x32_bf16 v[0:3], v[200:203], v[128:131], v[0:3]
v_mfma_f32_16x16x32_bf16 v[4:7], v[198:201], v[128:131], v[4:7]
ds_read_b64_tr_b16 v[192:193], v217 offset:576
ds_read_b64_tr_b16 v[194:195], v217 offset:544
ds_read_b64_tr_b16 v[196:197], v217 offset:512
v_mfma_f32_16x16x32_bf16 v[8:11], v[200:203], v[132:135], v[8:11]
v_mfma_f32_16x16x32_bf16 v[12:15], v[198:201], v[132:135], v[12:15]
v_mfma_f32_16x16x32_bf16 v[16:19], v[200:203], v[136:139], v[16:19]
v_mfma_f32_16x16x32_bf16 v[20:23], v[198:201], v[136:139], v[20:23]
v_mfma_f32_16x16x32_bf16 v[24:27], v[200:203], v[140:143], v[24:27]
v_mfma_f32_16x16x32_bf16 v[28:31], v[198:201], v[140:143], v[28:31]
v_mfma_f32_16x16x32_bf16 v[32:35], v[200:203], v[144:147], v[32:35]
v_mfma_f32_16x16x32_bf16 v[36:39], v[198:201], v[144:147], v[36:39]
v_mfma_f32_16x16x32_bf16 v[40:43], v[200:203], v[148:151], v[40:43]
v_mfma_f32_16x16x32_bf16 v[44:47], v[198:201], v[148:151], v[44:47]
v_mfma_f32_16x16x32_bf16 v[48:51], v[200:203], v[152:155], v[48:51]
v_mfma_f32_16x16x32_bf16 v[52:55], v[198:201], v[152:155], v[52:55]
v_mfma_f32_16x16x32_bf16 v[56:59], v[200:203], v[156:159], v[56:59]
v_mfma_f32_16x16x32_bf16 v[60:63], v[198:201], v[156:159], v[60:63]
v_mfma_f32_16x16x32_bf16 v[64:67], v[200:203], v[160:163], v[64:67]
v_mfma_f32_16x16x32_bf16 v[68:71], v[198:201], v[160:163], v[68:71]
v_mfma_f32_16x16x32_bf16 v[72:75], v[200:203], v[164:167], v[72:75]
v_mfma_f32_16x16x32_bf16 v[76:79], v[198:201], v[164:167], v[76:79]
v_mfma_f32_16x16x32_bf16 v[80:83], v[200:203], v[168:171], v[80:83]
v_mfma_f32_16x16x32_bf16 v[84:87], v[198:201], v[168:171], v[84:87]
v_mfma_f32_16x16x32_bf16 v[88:91], v[200:203], v[172:175], v[88:91]
v_mfma_f32_16x16x32_bf16 v[92:95], v[198:201], v[172:175], v[92:95]
v_mfma_f32_16x16x32_bf16 v[96:99], v[200:203], v[176:179], v[96:99]
v_mfma_f32_16x16x32_bf16 v[100:103], v[198:201], v[176:179], v[100:103]
v_mfma_f32_16x16x32_bf16 v[104:107], v[200:203], v[180:183], v[104:107]
v_mfma_f32_16x16x32_bf16 v[108:111], v[198:201], v[180:183], v[108:111]
v_mfma_f32_16x16x32_bf16 v[112:115], v[200:203], v[184:187], v[112:115]
v_mfma_f32_16x16x32_bf16 v[116:119], v[198:201], v[184:187], v[116:119]
v_mfma_f32_16x16x32_bf16 v[120:123], v[200:203], v[188:191], v[120:123]
v_mfma_f32_16x16x32_bf16 v[124:127], v[198:201], v[188:191], v[124:127]
s_waitcnt lgkmcnt(3)
v_mfma_f32_16x16x32_bf16 v[8:11], v[206:209], v[128:131], v[8:11]
v_mfma_f32_16x16x32_bf16 v[12:15], v[204:207], v[128:131], v[12:15]
ds_read_b64_tr_b16 v[198:199], v217 offset:832
ds_read_b64_tr_b16 v[200:201], v217 offset:800
ds_read_b64_tr_b16 v[202:203], v217 offset:768
v_mfma_f32_16x16x32_bf16 v[16:19], v[206:209], v[132:135], v[16:19]
v_mfma_f32_16x16x32_bf16 v[20:23], v[204:207], v[132:135], v[20:23]
v_mfma_f32_16x16x32_bf16 v[24:27], v[206:209], v[136:139], v[24:27]
v_mfma_f32_16x16x32_bf16 v[28:31], v[204:207], v[136:139], v[28:31]
v_mfma_f32_16x16x32_bf16 v[32:35], v[206:209], v[140:143], v[32:35]
v_mfma_f32_16x16x32_bf16 v[36:39], v[204:207], v[140:143], v[36:39]
v_mfma_f32_16x16x32_bf16 v[40:43], v[206:209], v[144:147], v[40:43]
v_mfma_f32_16x16x32_bf16 v[44:47], v[204:207], v[144:147], v[44:47]
v_mfma_f32_16x16x32_bf16 v[48:51], v[206:209], v[148:151], v[48:51]
v_mfma_f32_16x16x32_bf16 v[52:55], v[204:207], v[148:151], v[52:55]
v_mfma_f32_16x16x32_bf16 v[56:59], v[206:209], v[152:155], v[56:59]
v_mfma_f32_16x16x32_bf16 v[60:63], v[204:207], v[152:155], v[60:63]
v_mfma_f32_16x16x32_bf16 v[64:67], v[206:209], v[156:159], v[64:67]
v_mfma_f32_16x16x32_bf16 v[68:71], v[204:207], v[156:159], v[68:71]
v_mfma_f32_16x16x32_bf16 v[72:75], v[206:209], v[160:163], v[72:75]
v_mfma_f32_16x16x32_bf16 v[76:79], v[204:207], v[160:163], v[76:79]
v_mfma_f32_16x16x32_bf16 v[80:83], v[206:209], v[164:167], v[80:83]
v_mfma_f32_16x16x32_bf16 v[84:87], v[204:207], v[164:167], v[84:87]
v_mfma_f32_16x16x32_bf16 v[88:91], v[206:209], v[168:171], v[88:91]
v_mfma_f32_16x16x32_bf16 v[92:95], v[204:207], v[168:171], v[92:95]
v_mfma_f32_16x16x32_bf16 v[96:99], v[206:209], v[172:175], v[96:99]
v_mfma_f32_16x16x32_bf16 v[100:103], v[204:207], v[172:175], v[100:103]
v_mfma_f32_16x16x32_bf16 v[104:107], v[206:209], v[176:179], v[104:107]
v_mfma_f32_16x16x32_bf16 v[108:111], v[204:207], v[176:179], v[108:111]
v_mfma_f32_16x16x32_bf16 v[112:115], v[206:209], v[180:183], v[112:115]
v_mfma_f32_16x16x32_bf16 v[116:119], v[204:207], v[180:183], v[116:119]
v_mfma_f32_16x16x32_bf16 v[120:123], v[206:209], v[184:187], v[120:123]
v_mfma_f32_16x16x32_bf16 v[124:127], v[204:207], v[184:187], v[124:127]
s_waitcnt lgkmcnt(3)
v_mfma_f32_16x16x32_bf16 v[16:19], v[194:197], v[128:131], v[16:19]
v_mfma_f32_16x16x32_bf16 v[20:23], v[192:195], v[128:131], v[20:23]
ds_read_b64_tr_b16 v[204:205], v217 offset:1088
ds_read_b64_tr_b16 v[206:207], v217 offset:1056
ds_read_b64_tr_b16 v[208:209], v217 offset:1024
v_mfma_f32_16x16x32_bf16 v[24:27], v[194:197], v[132:135], v[24:27]
v_mfma_f32_16x16x32_bf16 v[28:31], v[192:195], v[132:135], v[28:31]
v_mfma_f32_16x16x32_bf16 v[32:35], v[194:197], v[136:139], v[32:35]
v_mfma_f32_16x16x32_bf16 v[36:39], v[192:195], v[136:139], v[36:39]
v_mfma_f32_16x16x32_bf16 v[40:43], v[194:197], v[140:143], v[40:43]
v_mfma_f32_16x16x32_bf16 v[44:47], v[192:195], v[140:143], v[44:47]
v_mfma_f32_16x16x32_bf16 v[48:51], v[194:197], v[144:147], v[48:51]
v_mfma_f32_16x16x32_bf16 v[52:55], v[192:195], v[144:147], v[52:55]
v_mfma_f32_16x16x32_bf16 v[56:59], v[194:197], v[148:151], v[56:59]
v_mfma_f32_16x16x32_bf16 v[60:63], v[192:195], v[148:151], v[60:63]
v_mfma_f32_16x16x32_bf16 v[64:67], v[194:197], v[152:155], v[64:67]
v_mfma_f32_16x16x32_bf16 v[68:71], v[192:195], v[152:155], v[68:71]
v_mfma_f32_16x16x32_bf16 v[72:75], v[194:197], v[156:159], v[72:75]
v_mfma_f32_16x16x32_bf16 v[76:79], v[192:195], v[156:159], v[76:79]
v_mfma_f32_16x16x32_bf16 v[80:83], v[194:197], v[160:163], v[80:83]
v_mfma_f32_16x16x32_bf16 v[84:87], v[192:195], v[160:163], v[84:87]
v_mfma_f32_16x16x32_bf16 v[88:91], v[194:197], v[164:167], v[88:91]
v_mfma_f32_16x16x32_bf16 v[92:95], v[192:195], v[164:167], v[92:95]
v_mfma_f32_16x16x32_bf16 v[96:99], v[194:197], v[168:171], v[96:99]
v_mfma_f32_16x16x32_bf16 v[100:103], v[192:195], v[168:171], v[100:103]
v_mfma_f32_16x16x32_bf16 v[104:107], v[194:197], v[172:175], v[104:107]
v_mfma_f32_16x16x32_bf16 v[108:111], v[192:195], v[172:175], v[108:111]
v_mfma_f32_16x16x32_bf16 v[112:115], v[194:197], v[176:179], v[112:115]
v_mfma_f32_16x16x32_bf16 v[116:119], v[192:195], v[176:179], v[116:119]
v_mfma_f32_16x16x32_bf16 v[120:123], v[194:197], v[180:183], v[120:123]
v_mfma_f32_16x16x32_bf16 v[124:127], v[192:195], v[180:183], v[124:127]
s_waitcnt lgkmcnt(3)
v_mfma_f32_16x16x32_bf16 v[24:27], v[200:203], v[128:131], v[24:27]
v_mfma_f32_16x16x32_bf16 v[28:31], v[198:201], v[128:131], v[28:31]
ds_read_b64_tr_b16 v[192:193], v217 offset:1344
ds_read_b64_tr_b16 v[194:195], v217 offset:1312
ds_read_b64_tr_b16 v[196:197], v217 offset:1280
v_mfma_f32_16x16x32_bf16 v[32:35], v[200:203], v[132:135], v[32:35]
v_mfma_f32_16x16x32_bf16 v[36:39], v[198:201], v[132:135], v[36:39]
v_mfma_f32_16x16x32_bf16 v[40:43], v[200:203], v[136:139], v[40:43]
v_mfma_f32_16x16x32_bf16 v[44:47], v[198:201], v[136:139], v[44:47]
v_mfma_f32_16x16x32_bf16 v[48:51], v[200:203], v[140:143], v[48:51]
v_mfma_f32_16x16x32_bf16 v[52:55], v[198:201], v[140:143], v[52:55]
v_mfma_f32_16x16x32_bf16 v[56:59], v[200:203], v[144:147], v[56:59]
v_mfma_f32_16x16x32_bf16 v[60:63], v[198:201], v[144:147], v[60:63]
v_mfma_f32_16x16x32_bf16 v[64:67], v[200:203], v[148:151], v[64:67]
v_mfma_f32_16x16x32_bf16 v[68:71], v[198:201], v[148:151], v[68:71]
v_mfma_f32_16x16x32_bf16 v[72:75], v[200:203], v[152:155], v[72:75]
v_mfma_f32_16x16x32_bf16 v[76:79], v[198:201], v[152:155], v[76:79]
v_mfma_f32_16x16x32_bf16 v[80:83], v[200:203], v[156:159], v[80:83]
v_mfma_f32_16x16x32_bf16 v[84:87], v[198:201], v[156:159], v[84:87]
v_mfma_f32_16x16x32_bf16 v[88:91], v[200:203], v[160:163], v[88:91]
v_mfma_f32_16x16x32_bf16 v[92:95], v[198:201], v[160:163], v[92:95]
v_mfma_f32_16x16x32_bf16 v[96:99], v[200:203], v[164:167], v[96:99]
v_mfma_f32_16x16x32_bf16 v[100:103], v[198:201], v[164:167], v[100:103]
v_mfma_f32_16x16x32_bf16 v[104:107], v[200:203], v[168:171], v[104:107]
v_mfma_f32_16x16x32_bf16 v[108:111], v[198:201], v[168:171], v[108:111]
v_mfma_f32_16x16x32_bf16 v[112:115], v[200:203], v[172:175], v[112:115]
v_mfma_f32_16x16x32_bf16 v[116:119], v[198:201], v[172:175], v[116:119]
v_mfma_f32_16x16x32_bf16 v[120:123], v[200:203], v[176:179], v[120:123]
v_mfma_f32_16x16x32_bf16 v[124:127], v[198:201], v[176:179], v[124:127]
s_waitcnt lgkmcnt(3)
v_mfma_f32_16x16x32_bf16 v[32:35], v[206:209], v[128:131], v[32:35]
v_mfma_f32_16x16x32_bf16 v[36:39], v[204:207], v[128:131], v[36:39]
ds_read_b64_tr_b16 v[198:199], v217 offset:1600
ds_read_b64_tr_b16 v[200:201], v217 offset:1568
ds_read_b64_tr_b16 v[202:203], v217 offset:1536
v_mfma_f32_16x16x32_bf16 v[40:43], v[206:209], v[132:135], v[40:43]
v_mfma_f32_16x16x32_bf16 v[44:47], v[204:207], v[132:135], v[44:47]
v_mfma_f32_16x16x32_bf16 v[48:51], v[206:209], v[136:139], v[48:51]
v_mfma_f32_16x16x32_bf16 v[52:55], v[204:207], v[136:139], v[52:55]
v_mfma_f32_16x16x32_bf16 v[56:59], v[206:209], v[140:143], v[56:59]
v_mfma_f32_16x16x32_bf16 v[60:63], v[204:207], v[140:143], v[60:63]
v_mfma_f32_16x16x32_bf16 v[64:67], v[206:209], v[144:147], v[64:67]
v_mfma_f32_16x16x32_bf16 v[68:71], v[204:207], v[144:147], v[68:71]
v_mfma_f32_16x16x32_bf16 v[72:75], v[206:209], v[148:151], v[72:75]
v_mfma_f32_16x16x32_bf16 v[76:79], v[204:207], v[148:151], v[76:79]
v_mfma_f32_16x16x32_bf16 v[80:83], v[206:209], v[152:155], v[80:83]
v_mfma_f32_16x16x32_bf16 v[84:87], v[204:207], v[152:155], v[84:87]
v_mfma_f32_16x16x32_bf16 v[88:91], v[206:209], v[156:159], v[88:91]
v_mfma_f32_16x16x32_bf16 v[92:95], v[204:207], v[156:159], v[92:95]
v_mfma_f32_16x16x32_bf16 v[96:99], v[206:209], v[160:163], v[96:99]
v_mfma_f32_16x16x32_bf16 v[100:103], v[204:207], v[160:163], v[100:103]
v_mfma_f32_16x16x32_bf16 v[104:107], v[206:209], v[164:167], v[104:107]
v_mfma_f32_16x16x32_bf16 v[108:111], v[204:207], v[164:167], v[108:111]
v_mfma_f32_16x16x32_bf16 v[112:115], v[206:209], v[168:171], v[112:115]
v_mfma_f32_16x16x32_bf16 v[116:119], v[204:207], v[168:171], v[116:119]
v_mfma_f32_16x16x32_bf16 v[120:123], v[206:209], v[172:175], v[120:123]
v_mfma_f32_16x16x32_bf16 v[124:127], v[204:207], v[172:175], v[124:127]
s_waitcnt lgkmcnt(3)
v_mfma_f32_16x16x32_bf16 v[40:43], v[194:197], v[128:131], v[40:43]
v_mfma_f32_16x16x32_bf16 v[44:47], v[192:195], v[128:131], v[44:47]
ds_read_b64_tr_b16 v[204:205], v217 offset:1856
ds_read_b64_tr_b16 v[206:207], v217 offset:1824
ds_read_b64_tr_b16 v[208:209], v217 offset:1792
v_mfma_f32_16x16x32_bf16 v[48:51], v[194:197], v[132:135], v[48:51]
v_mfma_f32_16x16x32_bf16 v[52:55], v[192:195], v[132:135], v[52:55]
v_mfma_f32_16x16x32_bf16 v[56:59], v[194:197], v[136:139], v[56:59]
v_mfma_f32_16x16x32_bf16 v[60:63], v[192:195], v[136:139], v[60:63]
v_mfma_f32_16x16x32_bf16 v[64:67], v[194:197], v[140:143], v[64:67]
v_mfma_f32_16x16x32_bf16 v[68:71], v[192:195], v[140:143], v[68:71]
v_mfma_f32_16x16x32_bf16 v[72:75], v[194:197], v[144:147], v[72:75]
v_mfma_f32_16x16x32_bf16 v[76:79], v[192:195], v[144:147], v[76:79]
v_mfma_f32_16x16x32_bf16 v[80:83], v[194:197], v[148:151], v[80:83]
v_mfma_f32_16x16x32_bf16 v[84:87], v[192:195], v[148:151], v[84:87]
v_mfma_f32_16x16x32_bf16 v[88:91], v[194:197], v[152:155], v[88:91]
v_mfma_f32_16x16x32_bf16 v[92:95], v[192:195], v[152:155], v[92:95]
v_mfma_f32_16x16x32_bf16 v[96:99], v[194:197], v[156:159], v[96:99]
v_mfma_f32_16x16x32_bf16 v[100:103], v[192:195], v[156:159], v[100:103]
v_mfma_f32_16x16x32_bf16 v[104:107], v[194:197], v[160:163], v[104:107]
v_mfma_f32_16x16x32_bf16 v[108:111], v[192:195], v[160:163], v[108:111]
v_mfma_f32_16x16x32_bf16 v[112:115], v[194:197], v[164:167], v[112:115]
v_mfma_f32_16x16x32_bf16 v[116:119], v[192:195], v[164:167], v[116:119]
v_mfma_f32_16x16x32_bf16 v[120:123], v[194:197], v[168:171], v[120:123]
v_mfma_f32_16x16x32_bf16 v[124:127], v[192:195], v[168:171], v[124:127]
s_waitcnt lgkmcnt(3)
v_mfma_f32_16x16x32_bf16 v[48:51], v[200:203], v[128:131], v[48:51]
v_mfma_f32_16x16x32_bf16 v[52:55], v[198:201], v[128:131], v[52:55]
ds_read_b64_tr_b16 v[192:193], v217 offset:2112
ds_read_b64_tr_b16 v[194:195], v217 offset:2080
ds_read_b64_tr_b16 v[196:197], v217 offset:2048
v_mfma_f32_16x16x32_bf16 v[56:59], v[200:203], v[132:135], v[56:59]
v_mfma_f32_16x16x32_bf16 v[60:63], v[198:201], v[132:135], v[60:63]
v_mfma_f32_16x16x32_bf16 v[64:67], v[200:203], v[136:139], v[64:67]
v_mfma_f32_16x16x32_bf16 v[68:71], v[198:201], v[136:139], v[68:71]
v_mfma_f32_16x16x32_bf16 v[72:75], v[200:203], v[140:143], v[72:75]
v_mfma_f32_16x16x32_bf16 v[76:79], v[198:201], v[140:143], v[76:79]
v_mfma_f32_16x16x32_bf16 v[80:83], v[200:203], v[144:147], v[80:83]
v_mfma_f32_16x16x32_bf16 v[84:87], v[198:201], v[144:147], v[84:87]
v_mfma_f32_16x16x32_bf16 v[88:91], v[200:203], v[148:151], v[88:91]
v_mfma_f32_16x16x32_bf16 v[92:95], v[198:201], v[148:151], v[92:95]
v_mfma_f32_16x16x32_bf16 v[96:99], v[200:203], v[152:155], v[96:99]
v_mfma_f32_16x16x32_bf16 v[100:103], v[198:201], v[152:155], v[100:103]
v_mfma_f32_16x16x32_bf16 v[104:107], v[200:203], v[156:159], v[104:107]
v_mfma_f32_16x16x32_bf16 v[108:111], v[198:201], v[156:159], v[108:111]
v_mfma_f32_16x16x32_bf16 v[112:115], v[200:203], v[160:163], v[112:115]
v_mfma_f32_16x16x32_bf16 v[116:119], v[198:201], v[160:163], v[116:119]
v_mfma_f32_16x16x32_bf16 v[120:123], v[200:203], v[164:167], v[120:123]
v_mfma_f32_16x16x32_bf16 v[124:127], v[198:201], v[164:167], v[124:127]
s_waitcnt lgkmcnt(3)
v_mfma_f32_16x16x32_bf16 v[56:59], v[206:209], v[128:131], v[56:59]
v_mfma_f32_16x16x32_bf16 v[60:63], v[204:207], v[128:131], v[60:63]
ds_read_b64_tr_b16 v[198:199], v217 offset:2368
ds_read_b64_tr_b16 v[200:201], v217 offset:2336
ds_read_b64_tr_b16 v[202:203], v217 offset:2304
v_mfma_f32_16x16x32_bf16 v[64:67], v[206:209], v[132:135], v[64:67]
v_mfma_f32_16x16x32_bf16 v[68:71], v[204:207], v[132:135], v[68:71]
v_mfma_f32_16x16x32_bf16 v[72:75], v[206:209], v[136:139], v[72:75]
v_mfma_f32_16x16x32_bf16 v[76:79], v[204:207], v[136:139], v[76:79]
v_mfma_f32_16x16x32_bf16 v[80:83], v[206:209], v[140:143], v[80:83]
v_mfma_f32_16x16x32_bf16 v[84:87], v[204:207], v[140:143], v[84:87]
v_mfma_f32_16x16x32_bf16 v[88:91], v[206:209], v[144:147], v[88:91]
v_mfma_f32_16x16x32_bf16 v[92:95], v[204:207], v[144:147], v[92:95]
v_mfma_f32_16x16x32_bf16 v[96:99], v[206:209], v[148:151], v[96:99]
v_mfma_f32_16x16x32_bf16 v[100:103], v[204:207], v[148:151], v[100:103]
v_mfma_f32_16x16x32_bf16 v[104:107], v[206:209], v[152:155], v[104:107]
v_mfma_f32_16x16x32_bf16 v[108:111], v[204:207], v[152:155], v[108:111]
v_mfma_f32_16x16x32_bf16 v[112:115], v[206:209], v[156:159], v[112:115]
v_mfma_f32_16x16x32_bf16 v[116:119], v[204:207], v[156:159], v[116:119]
v_mfma_f32_16x16x32_bf16 v[120:123], v[206:209], v[160:163], v[120:123]
v_mfma_f32_16x16x32_bf16 v[124:127], v[204:207], v[160:163], v[124:127]
s_waitcnt lgkmcnt(3)
v_mfma_f32_16x16x32_bf16 v[64:67], v[194:197], v[128:131], v[64:67]
v_mfma_f32_16x16x32_bf16 v[68:71], v[192:195], v[128:131], v[68:71]
ds_read_b64_tr_b16 v[204:205], v217 offset:2624
ds_read_b64_tr_b16 v[206:207], v217 offset:2592
ds_read_b64_tr_b16 v[208:209], v217 offset:2560
v_mfma_f32_16x16x32_bf16 v[72:75], v[194:197], v[132:135], v[72:75]
v_mfma_f32_16x16x32_bf16 v[76:79], v[192:195], v[132:135], v[76:79]
v_mfma_f32_16x16x32_bf16 v[80:83], v[194:197], v[136:139], v[80:83]
v_mfma_f32_16x16x32_bf16 v[84:87], v[192:195], v[136:139], v[84:87]
v_mfma_f32_16x16x32_bf16 v[88:91], v[194:197], v[140:143], v[88:91]
v_mfma_f32_16x16x32_bf16 v[92:95], v[192:195], v[140:143], v[92:95]
v_mfma_f32_16x16x32_bf16 v[96:99], v[194:197], v[144:147], v[96:99]
v_mfma_f32_16x16x32_bf16 v[100:103], v[192:195], v[144:147], v[100:103]
v_mfma_f32_16x16x32_bf16 v[104:107], v[194:197], v[148:151], v[104:107]
v_mfma_f32_16x16x32_bf16 v[108:111], v[192:195], v[148:151], v[108:111]
v_mfma_f32_16x16x32_bf16 v[112:115], v[194:197], v[152:155], v[112:115]
v_mfma_f32_16x16x32_bf16 v[116:119], v[192:195], v[152:155], v[116:119]
v_mfma_f32_16x16x32_bf16 v[120:123], v[194:197], v[156:159], v[120:123]
v_mfma_f32_16x16x32_bf16 v[124:127], v[192:195], v[156:159], v[124:127]
s_waitcnt lgkmcnt(3)
v_mfma_f32_16x16x32_bf16 v[72:75], v[200:203], v[128:131], v[72:75]
v_mfma_f32_16x16x32_bf16 v[76:79], v[198:201], v[128:131], v[76:79]
ds_read_b64_tr_b16 v[192:193], v217 offset:2880
ds_read_b64_tr_b16 v[194:195], v217 offset:2848
ds_read_b64_tr_b16 v[196:197], v217 offset:2816
v_mfma_f32_16x16x32_bf16 v[80:83], v[200:203], v[132:135], v[80:83]
v_mfma_f32_16x16x32_bf16 v[84:87], v[198:201], v[132:135], v[84:87]
v_mfma_f32_16x16x32_bf16 v[88:91], v[200:203], v[136:139], v[88:91]
v_mfma_f32_16x16x32_bf16 v[92:95], v[198:201], v[136:139], v[92:95]
v_mfma_f32_16x16x32_bf16 v[96:99], v[200:203], v[140:143], v[96:99]
v_mfma_f32_16x16x32_bf16 v[100:103], v[198:201], v[140:143], v[100:103]
v_mfma_f32_16x16x32_bf16 v[104:107], v[200:203], v[144:147], v[104:107]
v_mfma_f32_16x16x32_bf16 v[108:111], v[198:201], v[144:147], v[108:111]
v_mfma_f32_16x16x32_bf16 v[112:115], v[200:203], v[148:151], v[112:115]
v_mfma_f32_16x16x32_bf16 v[116:119], v[198:201], v[148:151], v[116:119]
v_mfma_f32_16x16x32_bf16 v[120:123], v[200:203], v[152:155], v[120:123]
v_mfma_f32_16x16x32_bf16 v[124:127], v[198:201], v[152:155], v[124:127]
s_waitcnt lgkmcnt(3)
v_mfma_f32_16x16x32_bf16 v[80:83], v[206:209], v[128:131], v[80:83]
v_mfma_f32_16x16x32_bf16 v[84:87], v[204:207], v[128:131], v[84:87]
ds_read_b64_tr_b16 v[198:199], v217 offset:3136
ds_read_b64_tr_b16 v[200:201], v217 offset:3104
ds_read_b64_tr_b16 v[202:203], v217 offset:3072
v_mfma_f32_16x16x32_bf16 v[88:91], v[206:209], v[132:135], v[88:91]
v_mfma_f32_16x16x32_bf16 v[92:95], v[204:207], v[132:135], v[92:95]
v_mfma_f32_16x16x32_bf16 v[96:99], v[206:209], v[136:139], v[96:99]
v_mfma_f32_16x16x32_bf16 v[100:103], v[204:207], v[136:139], v[100:103]
v_mfma_f32_16x16x32_bf16 v[104:107], v[206:209], v[140:143], v[104:107]
v_mfma_f32_16x16x32_bf16 v[108:111], v[204:207], v[140:143], v[108:111]
v_mfma_f32_16x16x32_bf16 v[112:115], v[206:209], v[144:147], v[112:115]
v_mfma_f32_16x16x32_bf16 v[116:119], v[204:207], v[144:147], v[116:119]
v_mfma_f32_16x16x32_bf16 v[120:123], v[206:209], v[148:151], v[120:123]
v_mfma_f32_16x16x32_bf16 v[124:127], v[204:207], v[148:151], v[124:127]
s_waitcnt lgkmcnt(3)
v_mfma_f32_16x16x32_bf16 v[88:91], v[194:197], v[128:131], v[88:91]
v_mfma_f32_16x16x32_bf16 v[92:95], v[192:195], v[128:131], v[92:95]
ds_read_b64_tr_b16 v[204:205], v217 offset:3392
ds_read_b64_tr_b16 v[206:207], v217 offset:3360
ds_read_b64_tr_b16 v[208:209], v217 offset:3328
v_mfma_f32_16x16x32_bf16 v[96:99], v[194:197], v[132:135], v[96:99]
v_mfma_f32_16x16x32_bf16 v[100:103], v[192:195], v[132:135], v[100:103]
v_mfma_f32_16x16x32_bf16 v[104:107], v[194:197], v[136:139], v[104:107]
v_mfma_f32_16x16x32_bf16 v[108:111], v[192:195], v[136:139], v[108:111]
v_mfma_f32_16x16x32_bf16 v[112:115], v[194:197], v[140:143], v[112:115]
v_mfma_f32_16x16x32_bf16 v[116:119], v[192:195], v[140:143], v[116:119]
v_mfma_f32_16x16x32_bf16 v[120:123], v[194:197], v[144:147], v[120:123]
v_mfma_f32_16x16x32_bf16 v[124:127], v[192:195], v[144:147], v[124:127]
s_waitcnt lgkmcnt(3)
v_mfma_f32_16x16x32_bf16 v[96:99], v[200:203], v[128:131], v[96:99]
v_mfma_f32_16x16x32_bf16 v[100:103], v[198:201], v[128:131], v[100:103]
ds_read_b64_tr_b16 v[192:193], v217 offset:3648
ds_read_b64_tr_b16 v[194:195], v217 offset:3616
ds_read_b64_tr_b16 v[196:197], v217 offset:3584
v_mfma_f32_16x16x32_bf16 v[104:107], v[200:203], v[132:135], v[104:107]
v_mfma_f32_16x16x32_bf16 v[108:111], v[198:201], v[132:135], v[108:111]
v_mfma_f32_16x16x32_bf16 v[112:115], v[200:203], v[136:139], v[112:115]
v_mfma_f32_16x16x32_bf16 v[116:119], v[198:201], v[136:139], v[116:119]
v_mfma_f32_16x16x32_bf16 v[120:123], v[200:203], v[140:143], v[120:123]
v_mfma_f32_16x16x32_bf16 v[124:127], v[198:201], v[140:143], v[124:127]
s_waitcnt lgkmcnt(3)
v_mfma_f32_16x16x32_bf16 v[104:107], v[206:209], v[128:131], v[104:107]
v_mfma_f32_16x16x32_bf16 v[108:111], v[204:207], v[128:131], v[108:111]
ds_read_b64_tr_b16 v[198:199], v217 offset:3904
ds_read_b64_tr_b16 v[200:201], v217 offset:3872
ds_read_b64_tr_b16 v[202:203], v217 offset:3840
v_mfma_f32_16x16x32_bf16 v[112:115], v[206:209], v[132:135], v[112:115]
v_mfma_f32_16x16x32_bf16 v[116:119], v[204:207], v[132:135], v[116:119]
v_mfma_f32_16x16x32_bf16 v[120:123], v[206:209], v[136:139], v[120:123]
v_mfma_f32_16x16x32_bf16 v[124:127], v[204:207], v[136:139], v[124:127]
s_waitcnt lgkmcnt(3)
v_mfma_f32_16x16x32_bf16 v[112:115], v[194:197], v[128:131], v[112:115]
v_mfma_f32_16x16x32_bf16 v[116:119], v[192:195], v[128:131], v[116:119]
v_mfma_f32_16x16x32_bf16 v[120:123], v[194:197], v[132:135], v[120:123]
v_mfma_f32_16x16x32_bf16 v[124:127], v[192:195], v[132:135], v[124:127]
s_waitcnt lgkmcnt(0)
v_mfma_f32_16x16x32_bf16 v[120:123], v[200:203], v[128:131], v[120:123]
v_mfma_f32_16x16x32_bf16 v[124:127], v[198:201], v[128:131], v[124:127]
s_lshl_b32 s31, s28, 12
s_mov_b32 exec_lo, 0
s_mov_b32 exec_hi, 0xf0000000
ds_write_b128 v223, v[226:229]
s_mov_b64 exec, -1
ds_write_b128 v218, v[0:3] offset:0
ds_write_b128 v218, v[4:7] offset:64
ds_write_b128 v218, v[8:11] offset:512
ds_write_b128 v218, v[12:15] offset:576
ds_write_b128 v218, v[16:19] offset:1024
ds_write_b128 v218, v[20:23] offset:1088
ds_write_b128 v218, v[24:27] offset:1536
ds_write_b128 v218, v[28:31] offset:1600
ds_read_b128 v[132:135], v219 offset:16
ds_read_b128 v[136:139], v219 offset:32
ds_read_b128 v[140:143], v219 offset:2064
ds_read_b128 v[144:147], v219 offset:2080
ds_read_b128 v[148:151], v219 offset:2096
ds_read_b128 v[152:155], v219 offset:4128
ds_read_b128 v[156:159], v219 offset:4144
ds_read_b128 v[160:163], v219 offset:4160
ds_read_b128 v[164:167], v219 offset:6192
ds_read_b128 v[168:171], v219 offset:6208
ds_read_b128 v[172:175], v219 offset:6224
s_waitcnt lgkmcnt(6)
v_add_f32 v132, v132, v143
v_add_f32 v133, v133, v144
v_add_f32 v134, v134, v145
v_add_f32 v135, v135, v146
v_add_f32 v136, v136, v147
v_add_f32 v137, v137, v148
v_add_f32 v138, v138, v149
v_add_f32 v139, v139, v150
s_waitcnt lgkmcnt(3)
v_add_f32 v132, v132, v154
v_add_f32 v133, v133, v155
v_add_f32 v134, v134, v156
v_add_f32 v135, v135, v157
v_add_f32 v136, v136, v158
v_add_f32 v137, v137, v159
v_add_f32 v138, v138, v160
v_add_f32 v139, v139, v161
s_waitcnt lgkmcnt(0)
v_add_f32 v132, v132, v165
v_add_f32 v133, v133, v166
v_add_f32 v134, v134, v167
v_add_f32 v135, v135, v168
v_add_f32 v136, v136, v169
v_add_f32 v137, v137, v170
v_add_f32 v138, v138, v171
v_add_f32 v139, v139, v172
v_cvt_pk_bf16_f32 v176, v132, v133
v_cvt_pk_bf16_f32 v177, v134, v135
v_cvt_pk_bf16_f32 v178, v136, v137
v_cvt_pk_bf16_f32 v179, v138, v139
buffer_store_dwordx4 v[176:179], v220, s[72:75], s31 offen offset:0 sc1
s_mov_b32 exec_lo, 0
s_mov_b32 exec_hi, 0xf0000000
ds_write_b128 v223, v[28:31]
s_mov_b64 exec, -1
ds_write_b128 v218, v[32:35] offset:0
ds_write_b128 v218, v[36:39] offset:64
ds_write_b128 v218, v[40:43] offset:512
ds_write_b128 v218, v[44:47] offset:576
ds_write_b128 v218, v[48:51] offset:1024
ds_write_b128 v218, v[52:55] offset:1088
ds_write_b128 v218, v[56:59] offset:1536
ds_write_b128 v218, v[60:63] offset:1600
ds_read_b128 v[132:135], v219 offset:16
ds_read_b128 v[136:139], v219 offset:32
ds_read_b128 v[140:143], v219 offset:2064
ds_read_b128 v[144:147], v219 offset:2080
ds_read_b128 v[148:151], v219 offset:2096
ds_read_b128 v[152:155], v219 offset:4128
ds_read_b128 v[156:159], v219 offset:4144
ds_read_b128 v[160:163], v219 offset:4160
ds_read_b128 v[164:167], v219 offset:6192
ds_read_b128 v[168:171], v219 offset:6208
ds_read_b128 v[172:175], v219 offset:6224
s_waitcnt lgkmcnt(6)
v_add_f32 v132, v132, v143
v_add_f32 v133, v133, v144
v_add_f32 v134, v134, v145
v_add_f32 v135, v135, v146
v_add_f32 v136, v136, v147
v_add_f32 v137, v137, v148
v_add_f32 v138, v138, v149
v_add_f32 v139, v139, v150
s_waitcnt lgkmcnt(3)
v_add_f32 v132, v132, v154
v_add_f32 v133, v133, v155
v_add_f32 v134, v134, v156
v_add_f32 v135, v135, v157
v_add_f32 v136, v136, v158
v_add_f32 v137, v137, v159
v_add_f32 v138, v138, v160
v_add_f32 v139, v139, v161
s_waitcnt lgkmcnt(0)
v_add_f32 v132, v132, v165
v_add_f32 v133, v133, v166
v_add_f32 v134, v134, v167
v_add_f32 v135, v135, v168
v_add_f32 v136, v136, v169
v_add_f32 v137, v137, v170
v_add_f32 v138, v138, v171
v_add_f32 v139, v139, v172
v_cvt_pk_bf16_f32 v180, v132, v133
v_cvt_pk_bf16_f32 v181, v134, v135
v_cvt_pk_bf16_f32 v182, v136, v137
v_cvt_pk_bf16_f32 v183, v138, v139
buffer_store_dwordx4 v[180:183], v220, s[72:75], s31 offen offset:1024 sc1
s_mov_b32 exec_lo, 0
s_mov_b32 exec_hi, 0xf0000000
ds_write_b128 v223, v[60:63]
s_mov_b64 exec, -1
ds_write_b128 v218, v[64:67] offset:0
ds_write_b128 v218, v[68:71] offset:64
ds_write_b128 v218, v[72:75] offset:512
ds_write_b128 v218, v[76:79] offset:576
ds_write_b128 v218, v[80:83] offset:1024
ds_write_b128 v218, v[84:87] offset:1088
ds_write_b128 v218, v[88:91] offset:1536
ds_write_b128 v218, v[92:95] offset:1600
ds_read_b128 v[132:135], v219 offset:16
ds_read_b128 v[136:139], v219 offset:32
ds_read_b128 v[140:143], v219 offset:2064
ds_read_b128 v[144:147], v219 offset:2080
ds_read_b128 v[148:151], v219 offset:2096
ds_read_b128 v[152:155], v219 offset:4128
ds_read_b128 v[156:159], v219 offset:4144
ds_read_b128 v[160:163], v219 offset:4160
ds_read_b128 v[164:167], v219 offset:6192
ds_read_b128 v[168:171], v219 offset:6208
ds_read_b128 v[172:175], v219 offset:6224
s_waitcnt lgkmcnt(6)
v_add_f32 v132, v132, v143
v_add_f32 v133, v133, v144
v_add_f32 v134, v134, v145
v_add_f32 v135, v135, v146
v_add_f32 v136, v136, v147
v_add_f32 v137, v137, v148
v_add_f32 v138, v138, v149
v_add_f32 v139, v139, v150
s_waitcnt lgkmcnt(3)
v_add_f32 v132, v132, v154
v_add_f32 v133, v133, v155
v_add_f32 v134, v134, v156
v_add_f32 v135, v135, v157
v_add_f32 v136, v136, v158
v_add_f32 v137, v137, v159
v_add_f32 v138, v138, v160
v_add_f32 v139, v139, v161
s_waitcnt lgkmcnt(0)
v_add_f32 v132, v132, v165
v_add_f32 v133, v133, v166
v_add_f32 v134, v134, v167
v_add_f32 v135, v135, v168
v_add_f32 v136, v136, v169
v_add_f32 v137, v137, v170
v_add_f32 v138, v138, v171
v_add_f32 v139, v139, v172
v_cvt_pk_bf16_f32 v184, v132, v133
v_cvt_pk_bf16_f32 v185, v134, v135
v_cvt_pk_bf16_f32 v186, v136, v137
v_cvt_pk_bf16_f32 v187, v138, v139
buffer_store_dwordx4 v[184:187], v220, s[72:75], s31 offen offset:2048 sc1
s_mov_b32 exec_lo, 0
s_mov_b32 exec_hi, 0xf0000000
ds_write_b128 v223, v[92:95]
s_mov_b64 exec, -1
ds_write_b128 v218, v[96:99] offset:0
ds_write_b128 v218, v[100:103] offset:64
ds_write_b128 v218, v[104:107] offset:512
ds_write_b128 v218, v[108:111] offset:576
ds_write_b128 v218, v[112:115] offset:1024
ds_write_b128 v218, v[116:119] offset:1088
ds_write_b128 v218, v[120:123] offset:1536
ds_write_b128 v218, v[124:127] offset:1600
ds_read_b128 v[132:135], v219 offset:16
ds_read_b128 v[136:139], v219 offset:32
ds_read_b128 v[140:143], v219 offset:2064
ds_read_b128 v[144:147], v219 offset:2080
ds_read_b128 v[148:151], v219 offset:2096
ds_read_b128 v[152:155], v219 offset:4128
ds_read_b128 v[156:159], v219 offset:4144
ds_read_b128 v[160:163], v219 offset:4160
ds_read_b128 v[164:167], v219 offset:6192
ds_read_b128 v[168:171], v219 offset:6208
ds_read_b128 v[172:175], v219 offset:6224
s_waitcnt lgkmcnt(6)
v_add_f32 v132, v132, v143
v_add_f32 v133, v133, v144
v_add_f32 v134, v134, v145
v_add_f32 v135, v135, v146
v_add_f32 v136, v136, v147
v_add_f32 v137, v137, v148
v_add_f32 v138, v138, v149
v_add_f32 v139, v139, v150
s_waitcnt lgkmcnt(3)
v_add_f32 v132, v132, v154
v_add_f32 v133, v133, v155
v_add_f32 v134, v134, v156
v_add_f32 v135, v135, v157
v_add_f32 v136, v136, v158
v_add_f32 v137, v137, v159
v_add_f32 v138, v138, v160
v_add_f32 v139, v139, v161
s_waitcnt lgkmcnt(0)
v_add_f32 v132, v132, v165
v_add_f32 v133, v133, v166
v_add_f32 v134, v134, v167
v_add_f32 v135, v135, v168
v_add_f32 v136, v136, v169
v_add_f32 v137, v137, v170
v_add_f32 v138, v138, v171
v_add_f32 v139, v139, v172
v_cvt_pk_bf16_f32 v188, v132, v133
v_cvt_pk_bf16_f32 v189, v134, v135
v_cvt_pk_bf16_f32 v190, v136, v137
v_cvt_pk_bf16_f32 v191, v138, v139
buffer_store_dwordx4 v[188:191], v220, s[72:75], s31 offen offset:3072 sc1
s_add_u32 s28, s28, 7
s_cmp_lt_u32 s28, s33
s_cbranch_scc1 L_cloop
s_branch L_h3
L_hpf:
s_mov_b32 s8, s82
s_and_b32 s9, s83, 0xffff
s_mov_b32 s10, 8388608
s_mov_b32 s11, 0x20000
s_lshr_b32 s30, s16, 1
s_lshl_b32 s31, s30, 3
s_and_b32 s32, s17, 0
s_add_u32 s31, s31, s32
s_add_u32 s31, s31, s26
s_lshl_b32 s31, s31, 7
s_lshl_b32 s30, s30, 9
s_lshl_b32 s32, s17, 6
s_add_u32 s30, s30, s32
v_add_u32 v4, s30, v255
v_lshlrev_b32 v4, 12, v4
s_mov_b32 s33, 16
s_mov_b32 s78, 0x20000
L_pfa:
buffer_load_dword v6, off, s[68:71], 0 offset:128 sc1
s_cmp_eq_u32 s33, 0
s_cbranch_scc1 L_pfz
buffer_load_dword v5, v4, s[8:11], s31 offen
s_add_u32 s31, s31, 256
s_and_b32 s31, s31, 4095
s_sub_u32 s33, s33, 1
buffer_load_dword v5, v4, s[8:11], s31 offen
s_add_u32 s31, s31, 256
s_and_b32 s31, s31, 4095
s_sub_u32 s33, s33, 1
s_waitcnt vmcnt(2)
s_branch L_pfc
L_pfz:
s_sleep 8
s_waitcnt vmcnt(0)
L_pfc:
v_readfirstlane_b32 s30, v6
s_sub_u32 s78, s78, 1
s_cbranch_scc1 L_pfr
s_cmp_lt_u32 s30, 64
s_cbranch_scc1 L_pfa
L_pfr:
s_barrier
L_pfb:
s_cmp_eq_u32 s33, 0
s_cbranch_scc1 L_pfw
buffer_load_dword v5, v4, s[8:11], s31 offen
s_add_u32 s31, s31, 256
s_and_b32 s31, s31, 4095
s_sub_u32 s33, s33, 1
s_waitcnt vmcnt(2)
s_branch L_pfb
L_pfw:
v_lshlrev_b32 v4, 7, v255
s_mov_b32 s8, s84
s_and_b32 s9, s85, 0xffff
s_mov_b32 s10, 2654208
s_mov_b32 s11, 0x20000
s_lshl_b32 s30, s29, 13
L_pfl:
buffer_load_dword v5, v4, s[8:11], s30 offen
s_waitcnt vmcnt(2)
s_add_u32 s30, s30, 524288
s_cmp_lt_u32 s30, 2654208
s_cbranch_scc1 L_pfl
L_h3:
s_load_dwordx4 s[80:83], s[0:1], 80
s_load_dwordx2 s[84:85], s[0:1], 0
s_load_dwordx2 s[86:87], s[0:1], 96
s_waitcnt vmcnt(0) lgkmcnt(0)
s_barrier
s_mov_b32 s68, s86
s_and_b32 s69, s87, 0xffff
s_mov_b32 s70, 256
s_mov_b32 s71, 0x20000
s_cmp_lg_u32 s49, 7
s_cbranch_scc1 L_h4
v_mov_b32 v4, 1
s_mov_b64 exec, 1
buffer_atomic_add v4, off, s[68:71], 0 offset:132 sc1
s_mov_b64 exec, -1
L_h4:
buffer_load_dword v7, off, s[68:71], 0 sc1
s_waitcnt vmcnt(0)
s_mov_b32 s78, 0x20000
s_branch L_hn3_c
L_hn3_l:
buffer_load_dword v7, off, s[68:71], 0 sc1
s_waitcnt vmcnt(0)
L_hn3_c:
v_readfirstlane_b32 s64, v7
s_sub_u32 s78, s78, 1
s_cbranch_scc1 L_hn3_o
s_cmp_eq_u32 s64, 0
s_cbranch_scc1 L_hn3_l
L_hn3_o:
s_and_b32 s27, s49, 3
s_add_u32 s30, s17, 0
s_and_b32 s29, s16, 1
s_mul_i32 s25, s30, 43
s_lshr_b32 s25, s25, 7
s_mul_i32 s31, s25, 3
s_sub_u32 s31, s30, s31
s_mov_b32 s35, s31
s_cmp_lt_u32 s31, 2
s_cselect_b32 s28, 5, 4
s_mul_i32 s24, s29, 18
s_mul_i32 s31, s31, 5
s_add_u32 s24, s24, s31
s_sub_u32 s31, s30, 27
s_lshl_b32 s31, s31, 1
s_add_u32 s31, s31, s29
s_cmp_ge_u32 s30, 27
s_cselect_b32 s25, s31, s25
s_cselect_b32 s24, 14, s24
s_cselect_b32 s28, 4, s28
s_lshr_b32 s31, s16, 1
s_lshl_b32 s31, s31, 5
s_add_u32 s24, s24, s31
s_mul_i32 s35, s35, 0
s_mul_i32 s30, s25, 0
s_add_u32 s35, s35, s30
s_mul_i32 s30, s35, 57
s_lshr_b32 s30, s30, 9
s_mul_i32 s30, s30, 9
s_sub_u32 s35, s35, s30
s_lshl_b32 s65, s35, 10
s_add_u32 s66, s65, 1024
s_cmp_eq_u32 s66, 9216
s_cselect_b32 s66, 0, s66
s_add_u32 s67, s66, 1024
s_cmp_eq_u32 s67, 9216
s_cselect_b32 s67, 0, s67
s_add_u32 s68, s67, 1024
s_cmp_eq_u32 s68, 9216
s_cselect_b32 s68, 0, s68
s_add_u32 s69, s68, 1024
s_cmp_eq_u32 s69, 9216
s_cselect_b32 s69, 0, s69
s_add_u32 s70, s69, 1024
s_cmp_eq_u32 s70, 9216
s_cselect_b32 s70, 0, s70
s_add_u32 s71, s70, 1024
s_cmp_eq_u32 s71, 9216
s_cselect_b32 s71, 0, s71
s_add_u32 s72, s71, 1024
s_cmp_eq_u32 s72, 9216
s_cselect_b32 s72, 0, s72
s_add_u32 s73, s72, 1024
s_cmp_eq_u32 s73, 9216
s_cselect_b32 s73, 0, s73
v_lshrrev_b32 v234, 3, v255
v_and_b32 v235, 6, v234
v_and_b32 v236, 7, v255
v_xor_b32 v235, v235, v236
v_mul_u32_u24 v234, 1152, v234
v_lshl_add_u32 v234, v235, 4, v234
s_lshl_b32 s30, s25, 7
s_mul_i32 s31, s27, 331776
s_add_u32 s30, s30, s31
v_add_u32 v229, s30, v234
s_mul_i32 s50, s29, 1327104
s_xor_b32 s31, s29, 1
s_mul_i32 s51, s31, 1327104
s_mul_i32 s52, s29, 36864
s_mul_i32 s53, s31, 36864
s_mul_i32 s26, s27, 32768
s_waitcnt lgkmcnt(0)
s_mov_b32 s56, s80
s_and_b32 s57, s81, 0xffff
s_mov_b32 s58, 2654208
s_mov_b32 s59, 0x20000
s_cmp_lt_u32 s49, 4
s_cbranch_scc1 L_h6
s_barrier
s_barrier
s_lshl_b32 s30, s17, 2
s_add_u32 s30, s30, s27
s_mul_i32 s30, s30, 6912
v_min_u32 v1, 53, v255
v_lshl_add_u32 v1, v1, 7, s30
s_add_u32 s34, s51, 0
buffer_load_dword v2, v1, s[56:59], s34 offen
s_waitcnt vmcnt(1)
s_add_u32 s34, s51, 221184
buffer_load_dword v2, v1, s[56:59], s34 offen
s_waitcnt vmcnt(1)
s_add_u32 s34, s51, 442368
buffer_load_dword v2, v1, s[56:59], s34 offen
s_waitcnt vmcnt(1)
s_add_u32 s34, s51, 663552
buffer_load_dword v2, v1, s[56:59], s34 offen
s_waitcnt vmcnt(1)
s_add_u32 s34, s51, 884736
buffer_load_dword v2, v1, s[56:59], s34 offen
s_waitcnt vmcnt(1)
s_add_u32 s34, s51, 1105920
buffer_load_dword v2, v1, s[56:59], s34 offen
s_waitcnt vmcnt(1)
s_waitcnt vmcnt(0)
s_branch L_p3b
L_h6:
s_mul_i32 s33, s65, 36
s_add_u32 s33, s33, s50
s_add_u32 s34, s33, 0
buffer_load_dwordx4 v[0:3], v229, s[56:59], s34 offen
s_add_u32 s34, s33, 9216
buffer_load_dwordx4 v[4:7], v229, s[56:59], s34 offen
s_add_u32 s34, s33, 18432
buffer_load_dwordx4 v[8:11], v229, s[56:59], s34 offen
s_add_u32 s34, s33, 27648
buffer_load_dwordx4 v[12:15], v229, s[56:59], s34 offen
s_mul_i32 s33, s66, 36
s_add_u32 s33, s33, s50
s_add_u32 s34, s33, 0
buffer_load_dwordx4 v[16:19], v229, s[56:59], s34 offen
s_add_u32 s34, s33, 9216
buffer_load_dwordx4 v[20:23], v229, s[56:59], s34 offen
s_add_u32 s34, s33, 18432
buffer_load_dwordx4 v[24:27], v229, s[56:59], s34 offen
s_add_u32 s34, s33, 27648
buffer_load_dwordx4 v[28:31], v229, s[56:59], s34 offen
s_mul_i32 s33, s67, 36
s_add_u32 s33, s33, s50
s_add_u32 s34, s33, 0
buffer_load_dwordx4 v[32:35], v229, s[56:59], s34 offen
s_add_u32 s34, s33, 9216
buffer_load_dwordx4 v[36:39], v229, s[56:59], s34 offen
s_add_u32 s34, s33, 18432
buffer_load_dwordx4 v[40:43], v229, s[56:59], s34 offen
s_add_u32 s34, s33, 27648
buffer_load_dwordx4 v[44:47], v229, s[56:59], s34 offen
s_mul_i32 s33, s68, 36
s_add_u32 s33, s33, s50
s_add_u32 s34, s33, 0
buffer_load_dwordx4 v[48:51], v229, s[56:59], s34 offen
s_add_u32 s34, s33, 9216
buffer_load_dwordx4 v[52:55], v229, s[56:59], s34 offen
s_add_u32 s34, s33, 18432
buffer_load_dwordx4 v[56:59], v229, s[56:59], s34 offen
s_add_u32 s34, s33, 27648
buffer_load_dwordx4 v[60:63], v229, s[56:59], s34 offen
s_mul_i32 s33, s69, 36
s_add_u32 s33, s33, s50
s_add_u32 s34, s33, 0
buffer_load_dwordx4 v[64:67], v229, s[56:59], s34 offen
s_add_u32 s34, s33, 9216
buffer_load_dwordx4 v[68:71], v229, s[56:59], s34 offen
s_add_u32 s34, s33, 18432
buffer_load_dwordx4 v[72:75], v229, s[56:59], s34 offen
s_add_u32 s34, s33, 27648
buffer_load_dwordx4 v[76:79], v229, s[56:59], s34 offen
s_mul_i32 s33, s70, 36
s_add_u32 s33, s33, s50
s_add_u32 s34, s33, 0
buffer_load_dwordx4 v[80:83], v229, s[56:59], s34 offen
s_add_u32 s34, s33, 9216
buffer_load_dwordx4 v[84:87], v229, s[56:59], s34 offen
s_add_u32 s34, s33, 18432
buffer_load_dwordx4 v[88:91], v229, s[56:59], s34 offen
s_add_u32 s34, s33, 27648
buffer_load_dwordx4 v[92:95], v229, s[56:59], s34 offen
s_mul_i32 s33, s71, 36
s_add_u32 s33, s33, s50
s_add_u32 s34, s33, 0
buffer_load_dwordx4 v[96:99], v229, s[56:59], s34 offen
s_add_u32 s34, s33, 9216
buffer_load_dwordx4 v[100:103], v229, s[56:59], s34 offen
s_add_u32 s34, s33, 18432
buffer_load_dwordx4 v[104:107], v229, s[56:59], s34 offen
s_add_u32 s34, s33, 27648
buffer_load_dwordx4 v[108:111], v229, s[56:59], s34 offen
s_mul_i32 s33, s72, 36
s_add_u32 s33, s33, s50
s_add_u32 s34, s33, 0
buffer_load_dwordx4 v[112:115], v229, s[56:59], s34 offen
s_add_u32 s34, s33, 9216
buffer_load_dwordx4 v[116:119], v229, s[56:59], s34 offen
s_add_u32 s34, s33, 18432
buffer_load_dwordx4 v[120:123], v229, s[56:59], s34 offen
s_add_u32 s34, s33, 27648
buffer_load_dwordx4 v[124:127], v229, s[56:59], s34 offen
s_branch L_p3a
L_fin:
L_end:
s_endpgm
L_cl:
s_sub_u32 s78, s78, 1
s_cbranch_scc1 L_co
buffer_load_dwordx4 v[182:185], v179, s[20:23], s37 offen sc0 sc1
buffer_load_dwordx2 v[186:187], v181, s[20:23], s38 offen sc0 sc1
s_waitcnt vmcnt(0)
s_branch L_cc
L_gb_yl:
s_sub_u32 s78, s78, 1
s_cbranch_scc1 L_gb_yo
s_sleep 8
buffer_load_dword v221, off, s[8:11], 0 offset:132 sc1
s_waitcnt vmcnt(0)
s_branch L_gb_yc
L_poll:
s_sub_u32 s78, s78, 1
s_cbranch_scc1 L_pdone
s_sleep 2
buffer_load_dwordx4 v[112:115], v238, s[20:23], s34 offen offset:0 sc0 sc1
buffer_load_dwordx4 v[116:119], v238, s[20:23], s34 offen offset:1024 sc0 sc1
buffer_load_dwordx4 v[120:123], v238, s[20:23], s34 offen offset:2048 sc0 sc1
buffer_load_dwordx4 v[124:127], v238, s[20:23], s34 offen offset:3072 sc0 sc1
buffer_load_dwordx4 v[128:131], v238, s[20:23], s35 offen offset:0 sc0 sc1
buffer_load_dwordx4 v[132:135], v238, s[20:23], s35 offen offset:1024 sc0 sc1
s_waitcnt vmcnt(0)
s_branch L_pc2
code_end:
.section .rodata,"a"
.p2align 6
.amdhsa_kernel parallel_sum__ssm_conv_h3__mixer_gmlp__prompt_kernel
  .amdhsa_next_free_vgpr 256
  .amdhsa_next_free_sgpr 102
  .amdhsa_accum_offset 256
  .amdhsa_group_segment_fixed_size 0
  .amdhsa_kernarg_size 112
  .amdhsa_user_sgpr_count 2
  .amdhsa_user_sgpr_kernarg_segment_ptr 1
  .amdhsa_system_sgpr_workgroup_id_x 1
  .amdhsa_float_denorm_mode_32 3
  .amdhsa_float_denorm_mode_16_64 3
.end_amdhsa_kernel
```
